```python
import torch

def _softmax(x, axis=-1):
    return torch.softmax(x, dim=axis)
def _gelu(x):
    return torch.nn.functional.gelu(x, approximate="tanh")
def _silu(x):
    return torch.nn.functional.silu(x)
def _sigmoid(x):
    return torch.sigmoid(x)
def _layernorm(x, axis=-1, eps=1e-5):
    m = x.mean(dim=axis, keepdim=True)
    v = x.var(dim=axis, keepdim=True, unbiased=False)
    return (x - m) / torch.sqrt(v + eps)
def _scatter_add(tgt, idx, src, axis=0):
    return tgt.clone().index_add_(axis, idx, src)
def _segment_sum(src, seg, n):
    out = torch.zeros((n,) + src.shape[1:], dtype=src.dtype)
    return out.index_add_(0, seg, src)
def _pad(x, pw):
    flat = tuple(v for pair in reversed(pw) for v in pair)
    return torch.nn.functional.pad(x, flat)

kernel_name = 'recurrent_scan__compressed_kv_cla__glu_gated_bilinear__prompt'

def setup_inputs():

    _w = (lambda a: (lambda t: t.to(torch.bfloat16) if t.is_floating_point() else t)(torch.as_tensor(a)))
    def _A_setup():
        B, H, Sq, Sk, D, M = 1, 32, 2048, 2048, 128, 640
        Dc = 4 * D
        return {
            "x": _w((lambda *s: torch.randn(*s, dtype=torch.bfloat16) * 0.05)(B, Sq, M)),
            "c_kv": _w((lambda *s: torch.randn(*s, dtype=torch.bfloat16) * 1.6)(B, Sk, Dc)),
            "w_q": _w((lambda *s: torch.randn(*s, dtype=torch.bfloat16) * 1.6)(M, H, D) * (M ** -0.5)),
            "w_uk": _w((lambda *s: torch.randn(*s, dtype=torch.bfloat16) * 1.6)(Dc, H, D) * (Dc ** -0.5)),
            "w_uv": _w((lambda *s: torch.randn(*s, dtype=torch.bfloat16) * 1.6)(Dc, H, D) * (Dc ** -0.5)),
            "w_o": _w((lambda *s: torch.randn(*s, dtype=torch.bfloat16) * 1.6)(H, D, M) * ((H * D) ** -0.5)),
        }
    _A_in = _A_setup()

    def _B_setup():
        B, S, D, F = 1, 2048, 640, 1728
        return {
            "x": _w((lambda *s: torch.randn(*s, dtype=torch.bfloat16) * 0.05)(B, S, D)),
            "w_gate": _w((lambda *s: torch.randn(*s, dtype=torch.bfloat16) * 0.2)(D, F) * (D ** -0.5)),
            "w_up": _w((lambda *s: torch.randn(*s, dtype=torch.bfloat16) * 0.2)(D, F) * (D ** -0.5)),
            "w_down": _w((lambda *s: torch.randn(*s, dtype=torch.bfloat16) * 0.2)(F, D) * (F ** -0.5)),
        }
    _B_in = _B_setup()

    return {
        "A_x": _A_in["x"],
        "A_c_kv": _A_in["c_kv"],
        "A_w_q": _A_in["w_q"],
        "A_w_uk": _A_in["w_uk"],
        "A_w_uv": _A_in["w_uv"],
        "A_w_o": _A_in["w_o"],
        "B_x": _B_in["x"],
        "B_w_gate": _B_in["w_gate"],
        "B_w_up": _B_in["w_up"],
        "B_w_down": _B_in["w_down"],
    }

def reference(A_x, A_c_kv, A_w_q, A_w_uk, A_w_uv, A_w_o, B_x, B_w_gate, B_w_up, B_w_down):
    def _A_ref(x, c_kv, w_q, w_uk, w_uv, w_o):
        B, Sq, M = x.shape[0], x.shape[1], x.shape[2]
        Sk = c_kv.shape[1]
        H, D = w_q.shape[1], w_q.shape[2]
        q = torch.einsum("bqm,mhd->bhqd", x, w_q)
        k = torch.einsum("bkc,chd->bhkd", c_kv, w_uk)
        v = torch.einsum("bkc,chd->bhkd", c_kv, w_uv)
        scores = torch.einsum("bhqd,bhkd->bhqk", q, k) * (D ** -0.5)
        off = Sk - Sq
        qi = torch.arange(Sq)[:, None]
        kj = torch.arange(Sk)[None, :]
        cmask = kj <= (qi + off)
        scores = torch.where(cmask[None, None], scores, -1e9)
        p = _softmax(scores, axis=-1)
        ctx = torch.einsum("bhqk,bhkd->bhqd", p, v)
        return torch.einsum("bhqd,hdm->bqm", ctx, w_o)

    def _B_ref(x, w_gate, w_up, w_down):
        g = torch.einsum("bsd,df->bsf", x, w_gate)
        u = torch.einsum("bsd,df->bsf", x, w_up)
        h = g * u
        return torch.einsum("bsf,fd->bsd", h, w_down)

    x = A_x
    xn = _layernorm(x, axis=-1)
    s = _A_ref(xn, A_c_kv, A_w_q, A_w_uk, A_w_uv, A_w_o)
    g = _silu(_B_ref(xn, B_w_gate, B_w_up, B_w_down))
    return x + s * g
```

```asm
; @launch grid=(256,1,1) block=(256,1,1) lds=163840
.amdgcn_target "amdgcn-amd-amdhsa--gfx950"
.macro MM d, a, b, c
  v_mfma_f32_16x16x32_bf16 \d, \a, \b, \c
.endm
.text
.globl recurrent_scan__compressed_kv_cla__glu_gated_bilinear__prompt_kernel
.p2align 8
.type recurrent_scan__compressed_kv_cla__glu_gated_bilinear__prompt_kernel,@function
recurrent_scan__compressed_kv_cla__glu_gated_bilinear__prompt_kernel:
 s_cmp_ge_u32 s2, 256
 s_cbranch_scc1 kend
 s_load_dwordx4 s[80:83], s[0:1], 0
 s_load_dwordx2 s[8:9], s[0:1], 24
 s_load_dwordx2 s[12:13], s[0:1], 32
 s_load_dwordx2 s[16:17], s[0:1], 96
 s_load_dwordx2 s[48:49], s[0:1], 16
 s_load_dwordx2 s[56:57], s[0:1], 40
 s_load_dwordx2 s[92:93], s[0:1], 56
 s_load_dwordx2 s[52:53], s[0:1], 64
 s_load_dwordx2 s[96:97], s[0:1], 88
 s_getpc_b64 s[94:95]
 s_memrealtime s[60:61]
 v_lshrrev_b32 v176, 6, v0
 v_and_b32 v182, 63, v0
 s_bfe_u32 s25, s2, 0x20001
 s_lshl_b32 s25, s25, 3
 s_bfe_u32 s40, s2, 0x30003
 v_readfirstlane_b32 s24, v176
 s_add_u32 s25, s25, s40
 s_and_b32 s26, s2, 1
 s_lshl_b32 s26, s26, 2
 s_lshr_b32 s42, s2, 6
 s_add_u32 s26, s26, s42
 s_lshl_b32 s42, s42, 1
 s_add_u32 s3, s40, s42
 v_lshlrev_b32 v1, 4, v182
 s_lshr_b32 s41, s2, 3
 s_min_u32 s41, s41, 27
 s_lshl_b32 s41, s41, 12
 v_lshlrev_b32 v181, 4, v0
 v_add_u32 v181, s41, v181
 v_lshrrev_b32 v176, 3, v182
 v_and_b32 v177, 7, v182
 v_lshrrev_b32 v178, 1, v176
 v_xor_b32 v179, v177, v178
 v_lshlrev_b32 v179, 4, v179
 v_lshl_add_u32 v2, v176, 10, v179
 v_xor_b32 v3, 64, v2
 v_and_b32 v178, 1, v178
 v_lshlrev_b32 v178, 1, v178
 v_xor_b32 v179, v177, v178
 v_lshlrev_b32 v179, 4, v179
 v_lshl_add_u32 v7, v176, 13, v179
 v_xor_b32 v8, 64, v7
 s_lshl_b32 s27, s26, 18
 s_lshl_b32 s40, s24, 16
 s_add_u32 s27, s27, s40
 s_lshl_b32 s28, s25, 8
 s_lshl_b32 s40, s24, 17
 s_add_u32 s28, s28, s40
 s_lshl_b32 s29, s24, 13
 s_lshl_b32 s30, s24, 11
 s_mov_b32 s6, 2097152
 s_mov_b32 s7, 0x20000
 s_mov_b32 s10, 4194304
 s_mov_b32 s11, 0x20000
 s_add_u32 s40, s3, 0
 s_and_b32 s40, s40, 7
 s_lshl_b32 s64, s40, 7
 s_add_u32 s64, s64, s27
 s_lshl_b32 s72, s40, 19
 s_add_u32 s72, s72, s28
 s_add_u32 s40, s3, 1
 s_and_b32 s40, s40, 7
 s_lshl_b32 s65, s40, 7
 s_add_u32 s65, s65, s27
 s_lshl_b32 s73, s40, 19
 s_add_u32 s73, s73, s28
 s_waitcnt lgkmcnt(0)
 s_mov_b32 s4, s82
 s_mov_b32 s5, s83
 s_add_u32 m0, s30, 98304
 s_add_u32 s41, s72, 0
 buffer_load_dwordx4 v7, s[8:11], s41 offen offset:0 lds
 s_add_u32 s42, s72, 64512
 buffer_load_dwordx4 v8, s[8:11], s42 offen offset:1024 lds
 s_add_u32 m0, s29, 32768
 s_add_u32 s43, s64, 0
 buffer_load_dwordx4 v2, s[4:7], s43 offen offset:0 lds
 s_add_u32 s40, s64, 7168
 buffer_load_dwordx4 v3, s[4:7], s40 offen offset:1024 lds
 s_add_u32 s41, s64, 14336
 buffer_load_dwordx4 v2, s[4:7], s41 offen offset:2048 lds
 s_add_u32 s42, s64, 21504
 buffer_load_dwordx4 v3, s[4:7], s42 offen offset:3072 lds
 s_add_u32 m0, s29, 36864
 s_add_u32 s43, s64, 32768
 buffer_load_dwordx4 v2, s[4:7], s43 offen offset:0 lds
 s_add_u32 s40, s64, 39936
 buffer_load_dwordx4 v3, s[4:7], s40 offen offset:1024 lds
 s_add_u32 s41, s64, 47104
 buffer_load_dwordx4 v2, s[4:7], s41 offen offset:2048 lds
 s_add_u32 s42, s64, 54272
 buffer_load_dwordx4 v3, s[4:7], s42 offen offset:3072 lds
 s_add_u32 m0, s30, 106496
 s_add_u32 s43, s72, 128
 buffer_load_dwordx4 v7, s[8:11], s43 offen offset:0 lds
 s_add_u32 s40, s72, 64640
 buffer_load_dwordx4 v8, s[8:11], s40 offen offset:1024 lds
 global_load_dwordx4 v[28:31], v181, s[94:95]
 s_mov_b32 s14, 4194304
 s_mov_b32 s15, 0x20000
 s_add_u32 s16, s16, 0
 s_addc_u32 s17, s17, 0
 s_mov_b32 s18, 81788928
 s_mov_b32 s19, 0x20000
 s_mov_b32 s50, 5242880
 s_mov_b32 s51, 0x20000
 s_mov_b32 s58, 5242880
 s_mov_b32 s59, 0x20000
 s_mov_b32 s54, 2211840
 s_mov_b32 s55, 0x20000
 s_mov_b32 s98, 256
 s_mov_b32 s99, 0x20000
 s_mov_b32 s20, s80
 s_mov_b32 s21, s81
 s_mov_b32 s22, 2621440
 s_mov_b32 s23, 0x20000
 s_cmp_eq_u32 s24, 0
 s_cselect_b32 s100, 0, 2130706432
 s_or_b32 s40, s60, 1
 v_mov_b32 v180, s40
 s_lshl_b32 s40, s2, 8
 s_add_u32 s62, s40, s100
 s_mov_b64 exec, 1
 buffer_store_dword v180, off, s[96:99], s62 sc1
 s_mov_b64 exec, -1
 s_lshl_b32 s60, s25, 8
 s_lshl_b32 s40, s26, 2
 s_add_u32 s60, s60, s40
 s_add_u32 s60, s60, 70717440
 s_lshl_b32 s40, s2, 3
 s_lshl_b32 s41, s24, 1
 s_add_u32 s40, s40, s41
 v_lshrrev_b32 v176, 5, v182
 v_add_u32 v176, s40, v176
 v_and_b32 v177, 31, v182
 v_mul_u32_u24 v178, 1280, v176
 v_lshl_add_u32 v178, v177, 3, v178
 v_lshrrev_b32 v23, 1, v177
 v_mul_u32_u24 v23, 144, v23
 v_and_b32 v179, 7, v176
 v_lshl_add_u32 v23, v179, 4, v23
 v_and_b32 v179, 1, v177
 v_lshl_add_u32 v23, v179, 3, v23
 v_add_u32 v23, 0x18000, v23
 s_add_u32 s40, s3, 2
 s_and_b32 s40, s40, 7
 s_lshl_b32 s66, s40, 7
 s_add_u32 s66, s66, s27
 s_lshl_b32 s74, s40, 19
 s_add_u32 s74, s74, s28
 s_add_u32 s40, s3, 3
 s_and_b32 s40, s40, 7
 s_lshl_b32 s67, s40, 7
 s_add_u32 s67, s67, s27
 s_lshl_b32 s75, s40, 19
 s_add_u32 s75, s75, s28
 s_add_u32 s40, s3, 4
 s_and_b32 s40, s40, 7
 s_lshl_b32 s68, s40, 7
 s_add_u32 s68, s68, s27
 s_lshl_b32 s76, s40, 19
 s_add_u32 s76, s76, s28
 s_add_u32 s40, s3, 5
 s_and_b32 s40, s40, 7
 s_lshl_b32 s69, s40, 7
 s_add_u32 s69, s69, s27
 s_lshl_b32 s77, s40, 19
 s_add_u32 s77, s77, s28
 s_add_u32 s40, s3, 6
 s_and_b32 s40, s40, 7
 s_lshl_b32 s70, s40, 7
 s_add_u32 s70, s70, s27
 s_lshl_b32 s78, s40, 19
 s_add_u32 s78, s78, s28
 s_add_u32 s40, s3, 7
 s_and_b32 s40, s40, 7
 s_lshl_b32 s71, s40, 7
 s_add_u32 s71, s71, s27
 s_lshl_b32 s79, s40, 19
 s_add_u32 s79, s79, s28
 v_and_b32 v176, 15, v182
 v_lshrrev_b32 v177, 4, v182
 v_lshrrev_b32 v179, 1, v176
 v_xor_b32 v179, v179, v177
 v_lshlrev_b32 v179, 4, v179
 v_lshl_add_u32 v179, v176, 7, v179
 v_add_u32 v4, s29, v179
 v_xor_b32 v5, 64, v4
 v_add_u32 v6, 0x10000, v4
 v_add_u32 v0, 0x10000, v5
 v_lshrrev_b32 v179, 2, v176
 v_and_b32 v180, 3, v176
 v_lshl_add_u32 v181, v177, 3, v179
 v_lshlrev_b32 v181, 7, v181
 v_lshl_add_u32 v181, v180, 3, v181
 v_lshrrev_b32 v179, 1, v179
 v_and_b32 v177, 1, v177
 v_lshl_or_b32 v179, v177, 1, v179
 v_xor_b32 v180, 0, v179
 v_lshl_add_u32 v11, v180, 5, v181
 v_add_u32 v15, 0x10000, v11
 v_add_u32 v19, 0x20000, v11
 v_xor_b32 v180, 1, v179
 v_lshl_add_u32 v12, v180, 5, v181
 v_add_u32 v16, 0x10000, v12
 v_add_u32 v20, 0x20000, v12
 v_xor_b32 v180, 2, v179
 v_lshl_add_u32 v13, v180, 5, v181
 v_add_u32 v17, 0x10000, v13
 v_add_u32 v21, 0x20000, v13
 v_xor_b32 v180, 3, v179
 v_lshl_add_u32 v14, v180, 5, v181
 v_add_u32 v18, 0x10000, v14
 v_add_u32 v22, 0x20000, v14
 s_lshl_b32 s40, s25, 19
 s_lshl_b32 s41, s26, 16
 s_add_u32 s40, s40, s41
 s_lshl_b32 s41, s24, 14
 s_add_u32 s40, s40, s41
 s_mov_b32 s44, 0x3e0293ee
 s_add_u32 s84, s40, 4194304
 s_add_u32 s88, s40, 20971520
 s_add_u32 s85, s40, 4198400
 s_add_u32 s89, s40, 20975616
 s_add_u32 s86, s40, 4202496
 s_add_u32 s90, s40, 20979712
 s_add_u32 s87, s40, 4206592
 s_add_u32 s91, s40, 20983808
 s_add_u32 s40, s3, s24
 s_add_u32 s40, s40, 0
 s_and_b32 s40, s40, 7
 s_lshl_b32 s38, s40, 19
 s_lshl_b32 s40, s25, 8
 s_add_u32 s38, s38, s40
 s_add_u32 s40, s3, s24
 s_add_u32 s40, s40, 4
 s_and_b32 s40, s40, 7
 s_lshl_b32 s39, s40, 19
 s_lshl_b32 s40, s25, 8
 s_add_u32 s39, s39, s40
 v_mov_b32 v27, v178
 s_waitcnt vmcnt(2)
 s_barrier
 ds_read_b64_tr_b16 v[192:193], v15 offset:32768
 ds_read_b64_tr_b16 v[194:195], v15 offset:33280
 ds_read_b64_tr_b16 v[196:197], v15 offset:36864
 ds_read_b64_tr_b16 v[198:199], v15 offset:37376
 ds_read_b128 a[128:131], v4 offset:32768
 ds_read_b128 a[132:135], v5 offset:32768
 ds_read_b128 a[160:163], v4 offset:34816
 ds_read_b128 a[164:167], v5 offset:34816
 ds_read_b128 a[192:195], v4 offset:36864
 ds_read_b128 a[196:199], v5 offset:36864
 ds_read_b128 a[224:227], v4 offset:38912
 ds_read_b128 a[228:231], v5 offset:38912
 ds_read_b64_tr_b16 v[200:201], v16 offset:32768
 ds_read_b64_tr_b16 v[202:203], v16 offset:33280
 ds_read_b64_tr_b16 v[204:205], v16 offset:36864
 ds_read_b64_tr_b16 v[206:207], v16 offset:37376
 s_add_u32 m0, s29, 65536
 s_add_u32 s41, s65, 0
 buffer_load_dwordx4 v2, s[4:7], s41 offen offset:0 lds
 s_add_u32 s42, s65, 7168
 buffer_load_dwordx4 v3, s[4:7], s42 offen offset:1024 lds
 s_add_u32 s43, s65, 14336
 buffer_load_dwordx4 v2, s[4:7], s43 offen offset:2048 lds
 s_add_u32 s40, s65, 21504
 buffer_load_dwordx4 v3, s[4:7], s40 offen offset:3072 lds
 s_waitcnt lgkmcnt(11)
 MM v[32:35], v[192:195], a[128:131], 0
 s_add_u32 m0, s29, 69632
 ds_read_b64_tr_b16 v[208:209], v17 offset:32768
 ds_read_b64_tr_b16 v[210:211], v17 offset:33280
 s_waitcnt lgkmcnt(12)
 MM v[32:35], v[196:199], a[132:135], v[32:35]
 s_add_u32 s41, s65, 32768
 ds_read_b64_tr_b16 v[212:213], v17 offset:36864
 ds_read_b64_tr_b16 v[214:215], v17 offset:37376
 s_waitcnt lgkmcnt(12)
 MM v[36:39], v[196:199], a[164:167], 0
 buffer_load_dwordx4 v2, s[4:7], s41 offen offset:0 lds
 MM v[36:39], v[192:195], a[160:163], v[36:39]
 s_add_u32 s42, s65, 39936
 ds_read_b64_tr_b16 v[216:217], v18 offset:32768
 ds_read_b64_tr_b16 v[218:219], v18 offset:33280
 s_waitcnt lgkmcnt(13)
 MM v[40:43], v[192:195], a[192:195], 0
 buffer_load_dwordx4 v3, s[4:7], s42 offen offset:1024 lds
 s_waitcnt lgkmcnt(12)
 MM v[40:43], v[196:199], a[196:199], v[40:43]
 s_add_u32 s43, s65, 47104
 ds_read_b64_tr_b16 v[220:221], v18 offset:36864
 ds_read_b64_tr_b16 v[222:223], v18 offset:37376
 s_waitcnt lgkmcnt(12)
 MM v[44:47], v[196:199], a[228:231], 0
 buffer_load_dwordx4 v2, s[4:7], s43 offen offset:2048 lds
 MM v[44:47], v[192:195], a[224:227], v[44:47]
 s_add_u32 s40, s65, 54272
 ds_read_b64_tr_b16 v[224:225], v15 offset:40960
 ds_read_b64_tr_b16 v[226:227], v15 offset:41472
 s_waitcnt lgkmcnt(8)
 MM v[60:63], v[200:203], a[224:227], 0
 buffer_load_dwordx4 v3, s[4:7], s40 offen offset:3072 lds
 MM v[60:63], v[204:207], a[228:231], v[60:63]
 s_add_u32 m0, s30, 114688
 s_add_u32 s41, s73, 0
 ds_read_b64_tr_b16 v[228:229], v15 offset:45056
 MM v[56:59], v[204:207], a[196:199], 0
 buffer_load_dwordx4 v7, s[8:11], s41 offen offset:0 lds
 MM v[56:59], v[200:203], a[192:195], v[56:59]
 s_add_u32 s42, s73, 64512
 ds_read_b64_tr_b16 v[230:231], v15 offset:45568
 ds_read_b64_tr_b16 v[232:233], v16 offset:40960
 MM v[52:55], v[200:203], a[160:163], 0
 buffer_load_dwordx4 v8, s[8:11], s42 offen offset:1024 lds
 MM v[52:55], v[204:207], a[164:167], v[52:55]
 s_add_u32 m0, s30, 122880
 s_add_u32 s43, s73, 128
 ds_read_b64_tr_b16 v[234:235], v16 offset:41472
 MM v[48:51], v[204:207], a[132:135], 0
 buffer_load_dwordx4 v7, s[8:11], s43 offen offset:0 lds
 MM v[48:51], v[200:203], a[128:131], v[48:51]
 s_add_u32 s40, s73, 64640
 ds_read_b64_tr_b16 v[236:237], v16 offset:45056
 ds_read_b64_tr_b16 v[238:239], v16 offset:45568
 MM v[64:67], v[208:211], a[128:131], 0
 buffer_load_dwordx4 v8, s[8:11], s40 offen offset:1024 lds
 s_waitcnt lgkmcnt(5)
 MM v[64:67], v[212:215], a[132:135], v[64:67]
 s_add_u32 m0, s29, 0
 s_add_u32 s41, s66, 0
 ds_read_b64_tr_b16 v[240:241], v17 offset:40960
 MM v[68:71], v[212:215], a[164:167], 0
 buffer_load_dwordx4 v2, s[4:7], s41 offen offset:0 lds
 MM v[68:71], v[208:211], a[160:163], v[68:71]
 s_add_u32 s42, s66, 7168
 ds_read_b64_tr_b16 v[242:243], v17 offset:41472
 ds_read_b64_tr_b16 v[244:245], v17 offset:45056
 MM v[72:75], v[208:211], a[192:195], 0
 buffer_load_dwordx4 v3, s[4:7], s42 offen offset:1024 lds
 MM v[72:75], v[212:215], a[196:199], v[72:75]
 s_add_u32 s43, s66, 14336
 ds_read_b64_tr_b16 v[246:247], v17 offset:45568
 ds_read_b64_tr_b16 v[248:249], v18 offset:40960
 MM v[76:79], v[212:215], a[228:231], 0
 ds_read_b64_tr_b16 v[250:251], v18 offset:41472
 ds_read_b64_tr_b16 v[252:253], v18 offset:45056
 MM v[76:79], v[208:211], a[224:227], v[76:79]
 buffer_load_dwordx4 v2, s[4:7], s43 offen offset:2048 lds
 MM v[92:95], v[216:219], a[224:227], 0
 s_add_u32 s40, s66, 21504
 ds_read_b64_tr_b16 v[254:255], v18 offset:45568
 MM v[92:95], v[220:223], a[228:231], v[92:95]
 MM v[88:91], v[220:223], a[196:199], 0
 buffer_load_dwordx4 v3, s[4:7], s40 offen offset:3072 lds
 MM v[88:91], v[216:219], a[192:195], v[88:91]
 s_add_u32 m0, s29, 4096
 s_add_u32 s41, s66, 32768
 MM v[84:87], v[216:219], a[160:163], 0
 MM v[84:87], v[220:223], a[164:167], v[84:87]
 buffer_load_dwordx4 v2, s[4:7], s41 offen offset:0 lds
 MM v[80:83], v[220:223], a[132:135], 0
 s_add_u32 s42, s66, 39936
 MM v[80:83], v[216:219], a[128:131], v[80:83]
 s_waitcnt lgkmcnt(0)
 MM v[96:99], v[224:227], a[128:131], 0
 buffer_load_dwordx4 v3, s[4:7], s42 offen offset:1024 lds
 MM v[96:99], v[228:231], a[132:135], v[96:99]
 s_add_u32 s43, s66, 47104
 MM v[100:103], v[228:231], a[164:167], 0
 MM v[100:103], v[224:227], a[160:163], v[100:103]
 buffer_load_dwordx4 v2, s[4:7], s43 offen offset:2048 lds
 MM v[104:107], v[224:227], a[192:195], 0
 s_add_u32 s40, s66, 54272
 MM v[104:107], v[228:231], a[196:199], v[104:107]
 MM v[108:111], v[228:231], a[228:231], 0
 buffer_load_dwordx4 v3, s[4:7], s40 offen offset:3072 lds
 MM v[108:111], v[224:227], a[224:227], v[108:111]
 s_add_u32 m0, s30, 131072
 s_add_u32 s41, s74, 0
 MM v[124:127], v[232:235], a[224:227], 0
 MM v[124:127], v[236:239], a[228:231], v[124:127]
 buffer_load_dwordx4 v7, s[8:11], s41 offen offset:0 lds
 MM v[120:123], v[236:239], a[196:199], 0
 s_add_u32 s42, s74, 64512
 MM v[120:123], v[232:235], a[192:195], v[120:123]
 MM v[116:119], v[232:235], a[160:163], 0
 buffer_load_dwordx4 v8, s[8:11], s42 offen offset:1024 lds
 MM v[116:119], v[236:239], a[164:167], v[116:119]
 s_add_u32 m0, s30, 139264
 s_add_u32 s43, s74, 128
 MM v[112:115], v[236:239], a[132:135], 0
 s_waitcnt vmcnt(10)
 s_barrier
 ds_read_b128 a[136:139], v6 offset:0
 MM v[112:115], v[232:235], a[128:131], v[112:115]
 ds_read_b128 a[140:143], v0 offset:0
 ds_read_b128 a[168:171], v6 offset:2048
 MM v[128:131], v[240:243], a[128:131], 0
 ds_read_b128 a[172:175], v0 offset:2048
 ds_read_b64_tr_b16 v[192:193], v15 offset:49152
 MM v[128:131], v[244:247], a[132:135], v[128:131]
 ds_read_b64_tr_b16 v[194:195], v15 offset:49664
 ds_read_b128 a[200:203], v6 offset:4096
 MM v[132:135], v[244:247], a[164:167], 0
 buffer_load_dwordx4 v7, s[8:11], s43 offen offset:0 lds
 MM v[132:135], v[240:243], a[160:163], v[132:135]
 s_add_u32 s40, s74, 64640
 ds_read_b128 a[204:207], v0 offset:4096
 ds_read_b64_tr_b16 v[196:197], v15 offset:53248
 MM v[136:139], v[240:243], a[192:195], 0
 ds_read_b64_tr_b16 v[198:199], v15 offset:53760
 ds_read_b128 a[232:235], v6 offset:6144
 MM v[136:139], v[244:247], a[196:199], v[136:139]
 ds_read_b128 a[236:239], v0 offset:6144
 ds_read_b64_tr_b16 v[200:201], v16 offset:49152
 MM v[140:143], v[244:247], a[228:231], 0
 buffer_load_dwordx4 v8, s[8:11], s40 offen offset:1024 lds
 MM v[140:143], v[240:243], a[224:227], v[140:143]
 buffer_load_dwordx2 v[160:161], v27, s[20:23], 0 offen offset:0
 MM v[156:159], v[248:251], a[224:227], 0
 ds_read_b64_tr_b16 v[202:203], v16 offset:49664
 ds_read_b64_tr_b16 v[204:205], v16 offset:53248
 MM v[156:159], v[252:255], a[228:231], v[156:159]
 buffer_load_dwordx2 v[162:163], v27, s[20:23], 0 offen offset:256
 MM v[152:155], v[252:255], a[196:199], 0
 ds_read_b64_tr_b16 v[206:207], v16 offset:53760
 ds_read_b64_tr_b16 v[208:209], v17 offset:49152
 MM v[152:155], v[248:251], a[192:195], v[152:155]
 buffer_load_dwordx2 v[164:165], v27, s[20:23], 0 offen offset:512
 MM v[148:151], v[248:251], a[160:163], 0
 buffer_load_dwordx2 v[166:167], v27, s[20:23], 0 offen offset:768
 MM v[148:151], v[252:255], a[164:167], v[148:151]
 buffer_load_dwordx2 v[168:169], v27, s[20:23], 0 offen offset:1024
 MM v[144:147], v[252:255], a[132:135], 0
 s_add_u32 m0, s29, 32768
 s_add_u32 s41, s67, 0
 ds_read_b64_tr_b16 v[210:211], v17 offset:49664
 MM v[144:147], v[248:251], a[128:131], v[144:147]
 buffer_load_dwordx4 v2, s[4:7], s41 offen offset:0 lds
 s_waitcnt lgkmcnt(3)
 MM v[32:35], v[192:195], a[136:139], v[32:35]
 s_add_u32 s42, s67, 7168
 ds_read_b64_tr_b16 v[212:213], v17 offset:53248
 ds_read_b64_tr_b16 v[214:215], v17 offset:53760
 MM v[32:35], v[196:199], a[140:143], v[32:35]
 ds_read_b64_tr_b16 v[216:217], v18 offset:49152
 ds_read_b64_tr_b16 v[218:219], v18 offset:49664
 MM v[36:39], v[196:199], a[172:175], v[36:39]
 ds_read_b64_tr_b16 v[220:221], v18 offset:53248
 ds_read_b64_tr_b16 v[222:223], v18 offset:53760
 MM v[36:39], v[192:195], a[168:171], v[36:39]
 ds_read_b64_tr_b16 v[224:225], v15 offset:57344
 ds_read_b64_tr_b16 v[226:227], v15 offset:57856
 MM v[40:43], v[192:195], a[200:203], v[40:43]
 buffer_load_dwordx4 v3, s[4:7], s42 offen offset:1024 lds
 MM v[40:43], v[196:199], a[204:207], v[40:43]
 s_add_u32 s43, s67, 14336
 ds_read_b64_tr_b16 v[228:229], v15 offset:61440
 ds_read_b64_tr_b16 v[230:231], v15 offset:61952
 MM v[44:47], v[196:199], a[236:239], v[44:47]
 ds_read_b64_tr_b16 v[232:233], v16 offset:57344
 ds_read_b64_tr_b16 v[234:235], v16 offset:57856
 MM v[44:47], v[192:195], a[232:235], v[44:47]
 ds_read_b64_tr_b16 v[236:237], v16 offset:61440
 ds_read_b64_tr_b16 v[238:239], v16 offset:61952
 MM v[60:63], v[200:203], a[232:235], v[60:63]
 s_waitcnt lgkmcnt(10)
 ds_read_b64_tr_b16 v[240:241], v17 offset:57344
 ds_read_b64_tr_b16 v[242:243], v17 offset:57856
 MM v[60:63], v[204:207], a[236:239], v[60:63]
 buffer_load_dwordx4 v2, s[4:7], s43 offen offset:2048 lds
 MM v[56:59], v[204:207], a[204:207], v[56:59]
 s_add_u32 s40, s67, 21504
 ds_read_b64_tr_b16 v[244:245], v17 offset:61440
 ds_read_b64_tr_b16 v[246:247], v17 offset:61952
 MM v[56:59], v[200:203], a[200:203], v[56:59]
 MM v[52:55], v[200:203], a[168:171], v[52:55]
 MM v[52:55], v[204:207], a[172:175], v[52:55]
 MM v[48:51], v[204:207], a[140:143], v[48:51]
 buffer_load_dwordx4 v3, s[4:7], s40 offen offset:3072 lds
 MM v[48:51], v[200:203], a[136:139], v[48:51]
 s_add_u32 m0, s29, 36864
 s_add_u32 s41, s67, 32768
 s_mov_b32 s20, s92
 MM v[64:67], v[208:211], a[136:139], v[64:67]
 s_mov_b32 s21, s93
 s_mov_b32 s22, 2211840
 ds_read_b64_tr_b16 v[248:249], v18 offset:57344
 MM v[64:67], v[212:215], a[140:143], v[64:67]
 ds_read_b64_tr_b16 v[250:251], v18 offset:57856
 ds_read_b64_tr_b16 v[252:253], v18 offset:61440
 MM v[68:71], v[212:215], a[172:175], v[68:71]
 ds_read_b64_tr_b16 v[254:255], v18 offset:61952
 MM v[68:71], v[208:211], a[168:171], v[68:71]
 buffer_load_dwordx4 v2, s[4:7], s41 offen offset:0 lds
 MM v[72:75], v[208:211], a[200:203], v[72:75]
 s_add_u32 s42, s67, 39936
 MM v[72:75], v[212:215], a[204:207], v[72:75]
 MM v[76:79], v[212:215], a[236:239], v[76:79]
 MM v[76:79], v[208:211], a[232:235], v[76:79]
 s_waitcnt lgkmcnt(3)
 MM v[92:95], v[216:219], a[232:235], v[92:95]
 buffer_load_dwordx4 v3, s[4:7], s42 offen offset:1024 lds
 MM v[92:95], v[220:223], a[236:239], v[92:95]
 s_add_u32 s43, s67, 47104
 MM v[88:91], v[220:223], a[204:207], v[88:91]
 MM v[88:91], v[216:219], a[200:203], v[88:91]
 MM v[84:87], v[216:219], a[168:171], v[84:87]
 MM v[84:87], v[220:223], a[172:175], v[84:87]
 buffer_load_dwordx4 v2, s[4:7], s43 offen offset:2048 lds
 MM v[80:83], v[220:223], a[140:143], v[80:83]
 s_add_u32 s40, s67, 54272
 MM v[80:83], v[216:219], a[136:139], v[80:83]
 MM v[96:99], v[224:227], a[136:139], v[96:99]
 MM v[96:99], v[228:231], a[140:143], v[96:99]
 MM v[100:103], v[228:231], a[172:175], v[100:103]
 buffer_load_dwordx4 v3, s[4:7], s40 offen offset:3072 lds
 MM v[100:103], v[224:227], a[168:171], v[100:103]
 s_add_u32 m0, s30, 147456
 s_add_u32 s41, s75, 0
 MM v[104:107], v[224:227], a[200:203], v[104:107]
 MM v[104:107], v[228:231], a[204:207], v[104:107]
 MM v[108:111], v[228:231], a[236:239], v[108:111]
 MM v[108:111], v[224:227], a[232:235], v[108:111]
 buffer_load_dwordx4 v7, s[8:11], s41 offen offset:0 lds
 MM v[124:127], v[232:235], a[232:235], v[124:127]
 s_add_u32 s42, s75, 64512
 MM v[124:127], v[236:239], a[236:239], v[124:127]
 MM v[120:123], v[236:239], a[204:207], v[120:123]
 MM v[120:123], v[232:235], a[200:203], v[120:123]
 MM v[116:119], v[232:235], a[168:171], v[116:119]
 buffer_load_dwordx4 v8, s[8:11], s42 offen offset:1024 lds
 MM v[116:119], v[236:239], a[172:175], v[116:119]
 s_add_u32 m0, s30, 155648
 s_add_u32 s43, s75, 128
 MM v[112:115], v[236:239], a[140:143], v[112:115]
 s_waitcnt vmcnt(15)
 s_barrier
 ds_read_b128 a[144:147], v4 offset:0
 MM v[112:115], v[232:235], a[136:139], v[112:115]
 ds_read_b128 a[148:151], v5 offset:0
 ds_read_b128 a[176:179], v4 offset:2048
 MM v[128:131], v[240:243], a[136:139], v[128:131]
 ds_read_b128 a[180:183], v5 offset:2048
 ds_read_b64_tr_b16 v[192:193], v19 offset:0
 MM v[128:131], v[244:247], a[140:143], v[128:131]
 ds_read_b64_tr_b16 v[194:195], v19 offset:512
 ds_read_b128 a[208:211], v4 offset:4096
 MM v[132:135], v[244:247], a[172:175], v[132:135]
 ds_read_b128 a[212:215], v5 offset:4096
 ds_read_b64_tr_b16 v[196:197], v19 offset:4096
 MM v[132:135], v[240:243], a[168:171], v[132:135]
 ds_read_b64_tr_b16 v[198:199], v19 offset:4608
 ds_read_b128 a[240:243], v4 offset:6144
 MM v[136:139], v[240:243], a[200:203], v[136:139]
 ds_read_b128 a[244:247], v5 offset:6144
 ds_read_b64_tr_b16 v[200:201], v20 offset:0
 MM v[136:139], v[244:247], a[204:207], v[136:139]
 buffer_load_dwordx4 v7, s[8:11], s43 offen offset:0 lds
 MM v[140:143], v[244:247], a[236:239], v[140:143]
 s_add_u32 s40, s75, 64640
 ds_read_b64_tr_b16 v[202:203], v20 offset:512
 ds_read_b64_tr_b16 v[204:205], v20 offset:4096
 MM v[140:143], v[240:243], a[232:235], v[140:143]
 buffer_load_dwordx4 v8, s[8:11], s40 offen offset:1024 lds
 s_waitcnt lgkmcnt(10)
 MM v[156:159], v[248:251], a[232:235], v[156:159]
 s_add_u32 m0, s29, 65536
 s_add_u32 s41, s68, 0
 ds_read_b64_tr_b16 v[206:207], v20 offset:4608
 MM v[156:159], v[252:255], a[236:239], v[156:159]
 ds_read_b64_tr_b16 v[208:209], v21 offset:0
 ds_read_b64_tr_b16 v[210:211], v21 offset:512
 MM v[152:155], v[252:255], a[204:207], v[152:155]
 ds_read_b64_tr_b16 v[212:213], v21 offset:4096
 ds_read_b64_tr_b16 v[214:215], v21 offset:4608
 MM v[152:155], v[248:251], a[200:203], v[152:155]
 buffer_load_dwordx4 v2, s[4:7], s41 offen offset:0 lds
 MM v[148:151], v[248:251], a[168:171], v[148:151]
 s_add_u32 s42, s68, 7168
 ds_read_b64_tr_b16 v[216:217], v22 offset:0
 ds_read_b64_tr_b16 v[218:219], v22 offset:512
 MM v[148:151], v[252:255], a[172:175], v[148:151]
 ds_read_b64_tr_b16 v[220:221], v22 offset:4096
 ds_read_b64_tr_b16 v[222:223], v22 offset:4608
 MM v[144:147], v[252:255], a[140:143], v[144:147]
 ds_read_b64_tr_b16 v[224:225], v19 offset:8192
 ds_read_b64_tr_b16 v[226:227], v19 offset:8704
 MM v[144:147], v[248:251], a[136:139], v[144:147]
 s_waitcnt lgkmcnt(10)
 ds_read_b64_tr_b16 v[228:229], v19 offset:12288
 ds_read_b64_tr_b16 v[230:231], v19 offset:12800
 MM v[32:35], v[192:195], a[144:147], v[32:35]
 buffer_load_dwordx4 v3, s[4:7], s42 offen offset:1024 lds
 MM v[32:35], v[196:199], a[148:151], v[32:35]
 s_add_u32 s43, s68, 14336
 ds_read_b64_tr_b16 v[232:233], v20 offset:8192
 ds_read_b64_tr_b16 v[234:235], v20 offset:8704
 MM v[36:39], v[196:199], a[180:183], v[36:39]
 ds_read_b64_tr_b16 v[236:237], v20 offset:12288
 s_waitcnt vmcnt(18)
 v_lshlrev_b32 v170, 16, v160
 MM v[36:39], v[192:195], a[176:179], v[36:39]
 ds_read_b64_tr_b16 v[238:239], v20 offset:12800
 v_and_b32 v171, 0xffff0000, v160
 MM v[40:43], v[192:195], a[208:211], v[40:43]
 v_lshlrev_b32 v172, 16, v161
 MM v[40:43], v[196:199], a[212:215], v[40:43]
 buffer_load_dwordx4 v2, s[4:7], s43 offen offset:2048 lds
 MM v[44:47], v[196:199], a[244:247], v[44:47]
 s_add_u32 s40, s68, 21504
 v_and_b32 v173, 0xffff0000, v161
 s_waitcnt vmcnt(18)
 v_lshlrev_b32 v174, 16, v162
 MM v[44:47], v[192:195], a[240:243], v[44:47]
 v_and_b32 v175, 0xffff0000, v162
 MM v[60:63], v[200:203], a[240:243], v[60:63]
 ds_read_b64_tr_b16 v[240:241], v21 offset:8192
 v_lshlrev_b32 v176, 16, v163
 MM v[60:63], v[204:207], a[244:247], v[60:63]
 ds_read_b64_tr_b16 v[242:243], v21 offset:8704
 v_and_b32 v177, 0xffff0000, v163
 MM v[56:59], v[204:207], a[212:215], v[56:59]
 buffer_load_dwordx4 v3, s[4:7], s40 offen offset:3072 lds
 MM v[56:59], v[200:203], a[208:211], v[56:59]
 s_add_u32 m0, s29, 69632
 s_add_u32 s41, s68, 32768
 ds_read_b64_tr_b16 v[244:245], v21 offset:12288
 MM v[52:55], v[200:203], a[176:179], v[52:55]
 ds_read_b64_tr_b16 v[246:247], v21 offset:12800
 s_waitcnt vmcnt(18)
 v_lshlrev_b32 v178, 16, v164
 MM v[52:55], v[204:207], a[180:183], v[52:55]
 v_and_b32 v179, 0xffff0000, v164
 v_lshlrev_b32 v180, 16, v165
 MM v[48:51], v[204:207], a[148:151], v[48:51]
 s_waitcnt lgkmcnt(4)
 v_and_b32 v181, 0xffff0000, v165
 s_waitcnt vmcnt(17)
 v_lshlrev_b32 v182, 16, v166
 MM v[48:51], v[200:203], a[144:147], v[48:51]
 buffer_load_dwordx4 v2, s[4:7], s41 offen offset:0 lds
 MM v[64:67], v[208:211], a[144:147], v[64:67]
 s_add_u32 s42, s68, 39936
 ds_read_b64_tr_b16 v[248:249], v22 offset:8192
 v_and_b32 v183, 0xffff0000, v166
 MM v[64:67], v[212:215], a[148:151], v[64:67]
 ds_read_b64_tr_b16 v[250:251], v22 offset:8704
 v_lshlrev_b32 v184, 16, v167
 MM v[68:71], v[212:215], a[180:183], v[68:71]
 ds_read_b64_tr_b16 v[252:253], v22 offset:12288
 v_and_b32 v185, 0xffff0000, v167
 MM v[68:71], v[208:211], a[176:179], v[68:71]
 ds_read_b64_tr_b16 v[254:255], v22 offset:12800
 s_waitcnt vmcnt(17)
 v_lshlrev_b32 v186, 16, v168
 MM v[72:75], v[208:211], a[208:211], v[72:75]
 buffer_load_dwordx4 v3, s[4:7], s42 offen offset:1024 lds
 MM v[72:75], v[212:215], a[212:215], v[72:75]
 s_add_u32 s43, s68, 47104
 v_and_b32 v187, 0xffff0000, v168
 v_lshlrev_b32 v188, 16, v169
 MM v[76:79], v[212:215], a[244:247], v[76:79]
 v_and_b32 v189, 0xffff0000, v169
 v_add_f32 v24, v170, v171
 MM v[76:79], v[208:211], a[240:243], v[76:79]
 v_add_f32 v25, v172, v173
 MM v[92:95], v[216:219], a[240:243], v[92:95]
 v_add_f32 v24, v24, v174
 MM v[92:95], v[220:223], a[244:247], v[92:95]
 buffer_load_dwordx4 v2, s[4:7], s43 offen offset:2048 lds
 MM v[88:91], v[220:223], a[212:215], v[88:91]
 s_add_u32 s40, s68, 54272
 v_add_f32 v25, v25, v175
 v_add_f32 v24, v24, v176
 MM v[88:91], v[216:219], a[208:211], v[88:91]
 v_add_f32 v25, v25, v177
 MM v[84:87], v[216:219], a[176:179], v[84:87]
 v_add_f32 v24, v24, v178
 MM v[84:87], v[220:223], a[180:183], v[84:87]
 v_add_f32 v25, v25, v179
 MM v[80:83], v[220:223], a[148:151], v[80:83]
 buffer_load_dwordx4 v3, s[4:7], s40 offen offset:3072 lds
 MM v[80:83], v[216:219], a[144:147], v[80:83]
 s_add_u32 m0, s30, 98304
 s_add_u32 s41, s76, 0
 v_add_f32 v24, v24, v180
 MM v[96:99], v[224:227], a[144:147], v[96:99]
 v_add_f32 v25, v25, v181
 v_add_f32 v24, v24, v182
 MM v[96:99], v[228:231], a[148:151], v[96:99]
 v_add_f32 v25, v25, v183
 MM v[100:103], v[228:231], a[180:183], v[100:103]
 v_add_f32 v24, v24, v184
 MM v[100:103], v[224:227], a[176:179], v[100:103]
 buffer_load_dwordx4 v7, s[8:11], s41 offen offset:0 lds
 MM v[104:107], v[224:227], a[208:211], v[104:107]
 s_add_u32 s42, s76, 64512
 v_add_f32 v25, v25, v185
 v_add_f32 v24, v24, v186
 MM v[104:107], v[228:231], a[212:215], v[104:107]
 v_add_f32 v25, v25, v187
 MM v[108:111], v[228:231], a[244:247], v[108:111]
 v_add_f32 v24, v24, v188
 MM v[108:111], v[224:227], a[240:243], v[108:111]
 v_add_f32 v25, v25, v189
 MM v[124:127], v[232:235], a[240:243], v[124:127]
 buffer_load_dwordx4 v8, s[8:11], s42 offen offset:1024 lds
 MM v[124:127], v[236:239], a[244:247], v[124:127]
 s_add_u32 m0, s30, 106496
 s_add_u32 s43, s76, 128
 v_add_f32 v24, v24, v25
 MM v[120:123], v[236:239], a[212:215], v[120:123]
 s_nop 0
 v_add_f32_dpp v24, v24, v24 row_ror:8 row_mask:0xf bank_mask:0xf
 s_nop 1
 v_add_f32_dpp v24, v24, v24 row_ror:4 row_mask:0xf bank_mask:0xf
 MM v[120:123], v[232:235], a[208:211], v[120:123]
 s_nop 0
 v_add_f32_dpp v24, v24, v24 row_ror:2 row_mask:0xf bank_mask:0xf
 MM v[116:119], v[232:235], a[176:179], v[116:119]
 s_nop 0
 v_add_f32_dpp v24, v24, v24 row_ror:1 row_mask:0xf bank_mask:0xf
 MM v[116:119], v[236:239], a[180:183], v[116:119]
 buffer_load_dwordx4 v7, s[8:11], s43 offen offset:0 lds
 MM v[112:115], v[236:239], a[148:151], v[112:115]
 s_waitcnt vmcnt(11)
 s_barrier
 ds_read_b128 a[152:155], v4 offset:32768
 MM v[112:115], v[232:235], a[144:147], v[112:115]
 s_add_u32 s40, s76, 64640
 ds_read_b128 a[156:159], v5 offset:32768
 v_mov_b32 v26, v24
 s_waitcnt lgkmcnt(2)
 MM v[128:131], v[240:243], a[144:147], v[128:131]
 ds_read_b128 a[184:187], v4 offset:34816
 v_permlane16_swap_b32 v24, v26
 MM v[128:131], v[244:247], a[148:151], v[128:131]
 ds_read_b128 a[188:191], v5 offset:34816
 v_add_f32 v24, v24, v26
 MM v[132:135], v[244:247], a[180:183], v[132:135]
 ds_read_b64_tr_b16 v[192:193], v19 offset:16384
 v_mul_f32 v27, 0x3acccccd, v24
 MM v[132:135], v[240:243], a[176:179], v[132:135]
 ds_read_b64_tr_b16 v[194:195], v19 offset:16896
 v_sub_f32 v170, v170, v27
 MM v[136:139], v[240:243], a[208:211], v[136:139]
 ds_read_b128 a[216:219], v4 offset:36864
 v_sub_f32 v171, v171, v27
 MM v[136:139], v[244:247], a[212:215], v[136:139]
 ds_read_b128 a[220:223], v5 offset:36864
 v_sub_f32 v172, v172, v27
 MM v[140:143], v[244:247], a[244:247], v[140:143]
 ds_read_b64_tr_b16 v[196:197], v19 offset:20480
 ds_read_b64_tr_b16 v[198:199], v19 offset:20992
 MM v[140:143], v[240:243], a[240:243], v[140:143]
 ds_read_b128 a[248:251], v4 offset:38912
 ds_read_b128 a[252:255], v5 offset:38912
 MM v[156:159], v[248:251], a[240:243], v[156:159]
 buffer_load_dwordx4 v8, s[8:11], s40 offen offset:1024 lds
 MM v[156:159], v[252:255], a[244:247], v[156:159]
 s_add_u32 m0, s29, 0
 s_add_u32 s41, s69, 0
 ds_read_b64_tr_b16 v[200:201], v20 offset:16384
 MM v[152:155], v[252:255], a[212:215], v[152:155]
 ds_read_b64_tr_b16 v[202:203], v20 offset:16896
 v_sub_f32 v173, v173, v27
 MM v[152:155], v[248:251], a[208:211], v[152:155]
 buffer_load_dwordx4 v2, s[4:7], s41 offen offset:0 lds
 MM v[148:151], v[248:251], a[176:179], v[148:151]
 s_add_u32 s42, s69, 7168
 ds_read_b64_tr_b16 v[204:205], v20 offset:20480
 v_sub_f32 v174, v174, v27
 MM v[148:151], v[252:255], a[180:183], v[148:151]
 s_waitcnt lgkmcnt(5)
 ds_read_b64_tr_b16 v[206:207], v20 offset:20992
 v_sub_f32 v175, v175, v27
 MM v[144:147], v[252:255], a[148:151], v[144:147]
 buffer_load_dwordx4 v3, s[4:7], s42 offen offset:1024 lds
 MM v[144:147], v[248:251], a[144:147], v[144:147]
 s_add_u32 s43, s69, 14336
 ds_read_b64_tr_b16 v[208:209], v21 offset:16384
 v_sub_f32 v176, v176, v27
 MM v[32:35], v[192:195], a[152:155], v[32:35]
 ds_read_b64_tr_b16 v[210:211], v21 offset:16896
 v_sub_f32 v177, v177, v27
 MM v[32:35], v[196:199], a[156:159], v[32:35]
 ds_read_b64_tr_b16 v[212:213], v21 offset:20480
 v_sub_f32 v178, v178, v27
 MM v[36:39], v[196:199], a[188:191], v[36:39]
 ds_read_b64_tr_b16 v[214:215], v21 offset:20992
 v_sub_f32 v179, v179, v27
 MM v[36:39], v[192:195], a[184:187], v[36:39]
 buffer_load_dwordx4 v2, s[4:7], s43 offen offset:2048 lds
 MM v[40:43], v[192:195], a[216:219], v[40:43]
 s_add_u32 s40, s69, 21504
 ds_read_b64_tr_b16 v[216:217], v22 offset:16384
 v_sub_f32 v180, v180, v27
 MM v[40:43], v[196:199], a[220:223], v[40:43]
 s_waitcnt lgkmcnt(5)
 ds_read_b64_tr_b16 v[218:219], v22 offset:16896
 v_sub_f32 v181, v181, v27
 MM v[44:47], v[196:199], a[252:255], v[44:47]
 buffer_load_dwordx4 v3, s[4:7], s40 offen offset:3072 lds
 MM v[44:47], v[192:195], a[248:251], v[44:47]
 s_add_u32 m0, s29, 4096
 s_add_u32 s41, s69, 32768
 ds_read_b64_tr_b16 v[220:221], v22 offset:20480
 MM v[60:63], v[200:203], a[248:251], v[60:63]
 buffer_load_dword v31, off, s[96:99], 0 sc1
 MM v[60:63], v[204:207], a[252:255], v[60:63]
 ds_read_b64_tr_b16 v[222:223], v22 offset:20992
 v_sub_f32 v182, v182, v27
 MM v[56:59], v[204:207], a[220:223], v[56:59]
 ds_read_b64_tr_b16 v[224:225], v19 offset:24576
 v_sub_f32 v183, v183, v27
 MM v[56:59], v[200:203], a[216:219], v[56:59]
 buffer_load_dwordx4 v2, s[4:7], s41 offen offset:0 lds
 MM v[52:55], v[200:203], a[184:187], v[52:55]
 s_add_u32 s42, s69, 39936
 ds_read_b64_tr_b16 v[226:227], v19 offset:25088
 v_sub_f32 v184, v184, v27
 MM v[52:55], v[204:207], a[188:191], v[52:55]
 ds_read_b64_tr_b16 v[228:229], v19 offset:28672
 v_sub_f32 v185, v185, v27
 MM v[48:51], v[204:207], a[156:159], v[48:51]
 ds_read_b64_tr_b16 v[230:231], v19 offset:29184
 v_sub_f32 v186, v186, v27
 MM v[48:51], v[200:203], a[152:155], v[48:51]
 s_waitcnt lgkmcnt(5)
 ds_read_b64_tr_b16 v[232:233], v20 offset:24576
 v_sub_f32 v187, v187, v27
 MM v[64:67], v[208:211], a[152:155], v[64:67]
 buffer_load_dwordx4 v3, s[4:7], s42 offen offset:1024 lds
 MM v[64:67], v[212:215], a[156:159], v[64:67]
 s_add_u32 s43, s69, 47104
 ds_read_b64_tr_b16 v[234:235], v20 offset:25088
 v_sub_f32 v188, v188, v27
 MM v[68:71], v[212:215], a[188:191], v[68:71]
 ds_read_b64_tr_b16 v[236:237], v20 offset:28672
 v_sub_f32 v189, v189, v27
 MM v[68:71], v[208:211], a[184:187], v[68:71]
 ds_read_b64_tr_b16 v[238:239], v20 offset:29184
 v_mul_f32 v24, v170, v170
 MM v[72:75], v[208:211], a[216:219], v[72:75]
 ds_read_b64_tr_b16 v[240:241], v21 offset:24576
 v_mul_f32 v25, v171, v171
 MM v[72:75], v[212:215], a[220:223], v[72:75]
 buffer_load_dwordx4 v2, s[4:7], s43 offen offset:2048 lds
 MM v[76:79], v[212:215], a[252:255], v[76:79]
 s_add_u32 s40, s69, 54272
 ds_read_b64_tr_b16 v[242:243], v21 offset:25088
 v_fmac_f32 v24, v172, v172
 MM v[76:79], v[208:211], a[248:251], v[76:79]
 ds_read_b64_tr_b16 v[244:245], v21 offset:28672
 v_fmac_f32 v25, v173, v173
 MM v[92:95], v[216:219], a[248:251], v[92:95]
 s_waitcnt lgkmcnt(5)
 ds_read_b64_tr_b16 v[246:247], v21 offset:29184
 v_fmac_f32 v24, v174, v174
 MM v[92:95], v[220:223], a[252:255], v[92:95]
 ds_read_b64_tr_b16 v[248:249], v22 offset:24576
 v_fmac_f32 v25, v175, v175
 MM v[88:91], v[220:223], a[220:223], v[88:91]
 buffer_load_dwordx4 v3, s[4:7], s40 offen offset:3072 lds
 MM v[88:91], v[216:219], a[216:219], v[88:91]
 s_add_u32 m0, s30, 114688
 s_add_u32 s41, s77, 0
 ds_read_b64_tr_b16 v[250:251], v22 offset:25088
 MM v[84:87], v[216:219], a[184:187], v[84:87]
 ds_read_b64_tr_b16 v[252:253], v22 offset:28672
 v_fmac_f32 v24, v176, v176
 MM v[84:87], v[220:223], a[188:191], v[84:87]
 ds_read_b64_tr_b16 v[254:255], v22 offset:29184
 v_fmac_f32 v25, v177, v177
 MM v[80:83], v[220:223], a[156:159], v[80:83]
 v_fmac_f32 v24, v178, v178
 v_fmac_f32 v25, v179, v179
 MM v[80:83], v[216:219], a[152:155], v[80:83]
 buffer_load_dwordx4 v7, s[8:11], s41 offen offset:0 lds
 MM v[96:99], v[224:227], a[152:155], v[96:99]
 s_add_u32 s42, s77, 64512
 v_fmac_f32 v24, v180, v180
 v_fmac_f32 v25, v181, v181
 MM v[96:99], v[228:231], a[156:159], v[96:99]
 v_fmac_f32 v24, v182, v182
 v_fmac_f32 v25, v183, v183
 MM v[100:103], v[228:231], a[188:191], v[100:103]
 v_fmac_f32 v24, v184, v184
 v_fmac_f32 v25, v185, v185
 MM v[100:103], v[224:227], a[184:187], v[100:103]
 v_fmac_f32 v24, v186, v186
 v_fmac_f32 v25, v187, v187
 MM v[104:107], v[224:227], a[216:219], v[104:107]
 buffer_load_dwordx4 v8, s[8:11], s42 offen offset:1024 lds
 MM v[104:107], v[228:231], a[220:223], v[104:107]
 s_add_u32 m0, s30, 122880
 s_add_u32 s43, s77, 128
 v_fmac_f32 v24, v188, v188
 MM v[108:111], v[228:231], a[252:255], v[108:111]
 v_fmac_f32 v25, v189, v189
 v_add_f32 v24, v24, v25
 MM v[108:111], v[224:227], a[248:251], v[108:111]
 s_nop 0
 v_add_f32_dpp v24, v24, v24 row_ror:8 row_mask:0xf bank_mask:0xf
 s_nop 1
 v_add_f32_dpp v24, v24, v24 row_ror:4 row_mask:0xf bank_mask:0xf
 MM v[124:127], v[232:235], a[248:251], v[124:127]
 s_waitcnt lgkmcnt(0)
 v_add_f32_dpp v24, v24, v24 row_ror:2 row_mask:0xf bank_mask:0xf
 s_nop 1
 v_add_f32_dpp v24, v24, v24 row_ror:1 row_mask:0xf bank_mask:0xf
 MM v[124:127], v[236:239], a[252:255], v[124:127]
 buffer_load_dwordx4 v7, s[8:11], s43 offen offset:0 lds
 MM v[120:123], v[236:239], a[220:223], v[120:123]
 s_add_u32 s40, s77, 64640
 v_mov_b32 v26, v24
 s_nop 1
 v_permlane16_swap_b32 v24, v26
 MM v[120:123], v[232:235], a[216:219], v[120:123]
 v_add_f32 v24, v24, v26
 v_mul_f32 v24, 0x3acccccd, v24
 MM v[116:119], v[232:235], a[184:187], v[116:119]
 v_cvt_pk_bf16_f32 v24, v24, v27
 v_and_b32 v27, 0xffff0000, v24
 MM v[116:119], v[236:239], a[188:191], v[116:119]
 v_lshlrev_b32 v24, 16, v24
 v_add_f32 v24, 0x3727c5ac, v24
 MM v[112:115], v[236:239], a[156:159], v[112:115]
 s_waitcnt vmcnt(12)
 s_barrier
 ds_read_b128 a[0:3], v6 offset:0
 MM v[112:115], v[232:235], a[152:155], v[112:115]
 ds_read_b128 a[4:7], v0 offset:0
 v_cvt_pk_bf16_f32 v24, v24, v24
 MM v[128:131], v[240:243], a[152:155], v[128:131]
 buffer_load_dwordx4 v8, s[8:11], s40 offen offset:1024 lds
 MM v[128:131], v[244:247], a[156:159], v[128:131]
 s_add_u32 m0, s29, 32768
 s_add_u32 s41, s70, 0
 ds_read_b128 a[32:35], v6 offset:2048
 MM v[132:135], v[244:247], a[188:191], v[132:135]
 ds_read_b128 a[36:39], v0 offset:2048
 v_lshlrev_b32 v24, 16, v24
 MM v[132:135], v[240:243], a[184:187], v[132:135]
 ds_read_b64_tr_b16 v[192:193], v15 offset:32768
 ds_read_b64_tr_b16 v[194:195], v15 offset:33280
 MM v[136:139], v[240:243], a[216:219], v[136:139]
 ds_read_b128 a[64:67], v6 offset:4096
 ds_read_b128 a[68:71], v0 offset:4096
 MM v[136:139], v[244:247], a[220:223], v[136:139]
 ds_read_b64_tr_b16 v[196:197], v15 offset:36864
 ds_read_b64_tr_b16 v[198:199], v15 offset:37376
 MM v[140:143], v[244:247], a[252:255], v[140:143]
 ds_read_b128 a[96:99], v6 offset:6144
 ds_read_b128 a[100:103], v0 offset:6144
 MM v[140:143], v[240:243], a[248:251], v[140:143]
 buffer_load_dwordx4 v2, s[4:7], s41 offen offset:0 lds
 MM v[156:159], v[248:251], a[248:251], v[156:159]
 s_add_u32 s42, s70, 7168
 ds_read_b64_tr_b16 v[200:201], v16 offset:32768
 ds_read_b64_tr_b16 v[202:203], v16 offset:33280
 MM v[156:159], v[252:255], a[252:255], v[156:159]
 ds_read_b64_tr_b16 v[204:205], v16 offset:36864
 ds_read_b64_tr_b16 v[206:207], v16 offset:37376
 MM v[152:155], v[252:255], a[220:223], v[152:155]
 buffer_load_dwordx4 v3, s[4:7], s42 offen offset:1024 lds
 MM v[152:155], v[248:251], a[216:219], v[152:155]
 s_add_u32 s43, s70, 14336
 ds_read_b64_tr_b16 v[208:209], v17 offset:32768
 ds_read_b64_tr_b16 v[210:211], v17 offset:33280
 MM v[148:151], v[248:251], a[184:187], v[148:151]
 ds_read_b64_tr_b16 v[212:213], v17 offset:36864
 ds_read_b64_tr_b16 v[214:215], v17 offset:37376
 MM v[148:151], v[252:255], a[188:191], v[148:151]
 buffer_load_dwordx4 v2, s[4:7], s43 offen offset:2048 lds
 MM v[144:147], v[252:255], a[156:159], v[144:147]
 s_add_u32 s40, s70, 21504
 ds_read_b64_tr_b16 v[216:217], v18 offset:32768
 ds_read_b64_tr_b16 v[218:219], v18 offset:33280
 MM v[144:147], v[248:251], a[152:155], v[144:147]
 s_waitcnt lgkmcnt(8)
 ds_read_b64_tr_b16 v[220:221], v18 offset:36864
 ds_read_b64_tr_b16 v[222:223], v18 offset:37376
 MM v[32:35], v[192:195], a[0:3], v[32:35]
 ds_read_b64_tr_b16 v[224:225], v15 offset:40960
 ds_read_b64_tr_b16 v[226:227], v15 offset:41472
 MM v[32:35], v[196:199], a[4:7], v[32:35]
 ds_read_b64_tr_b16 v[228:229], v15 offset:45056
 ds_read_b64_tr_b16 v[230:231], v15 offset:45568
 MM v[36:39], v[196:199], a[36:39], v[36:39]
 buffer_load_dwordx4 v3, s[4:7], s40 offen offset:3072 lds
 MM v[36:39], v[192:195], a[32:35], v[36:39]
 s_add_u32 m0, s29, 36864
 s_add_u32 s41, s70, 32768
 ds_read_b64_tr_b16 v[232:233], v16 offset:40960
 MM v[40:43], v[192:195], a[64:67], v[40:43]
 ds_read_b64_tr_b16 v[234:235], v16 offset:41472
 ds_read_b64_tr_b16 v[236:237], v16 offset:45056
 MM v[40:43], v[196:199], a[68:71], v[40:43]
 v_sqrt_f32 v24, v24
 MM v[44:47], v[196:199], a[100:103], v[44:47]
 s_waitcnt lgkmcnt(7)
 ds_read_b64_tr_b16 v[238:239], v16 offset:45568
 v_cvt_pk_bf16_f32 v24, v24, v24
 MM v[44:47], v[192:195], a[96:99], v[44:47]
 buffer_load_dwordx4 v2, s[4:7], s41 offen offset:0 lds
 MM v[60:63], v[200:203], a[96:99], v[60:63]
 s_add_u32 s42, s70, 39936
 ds_read_b64_tr_b16 v[240:241], v17 offset:40960
 v_lshlrev_b32 v24, 16, v24
 MM v[60:63], v[204:207], a[100:103], v[60:63]
 ds_read_b64_tr_b16 v[242:243], v17 offset:41472
 ds_read_b64_tr_b16 v[244:245], v17 offset:45056
 MM v[56:59], v[204:207], a[68:71], v[56:59]
 v_rcp_f32 v25, v24
 MM v[56:59], v[200:203], a[64:67], v[56:59]
 ds_read_b64_tr_b16 v[246:247], v17 offset:45568
 v_lshlrev_b32 v170, 16, v160
 MM v[52:55], v[200:203], a[32:35], v[52:55]
 buffer_load_dwordx4 v3, s[4:7], s42 offen offset:1024 lds
 MM v[52:55], v[204:207], a[36:39], v[52:55]
 s_add_u32 s43, s70, 47104
 v_and_b32 v171, 0xffff0000, v160
 v_lshlrev_b32 v172, 16, v161
 MM v[48:51], v[204:207], a[4:7], v[48:51]
 v_and_b32 v173, 0xffff0000, v161
 v_lshlrev_b32 v174, 16, v162
 MM v[48:51], v[200:203], a[0:3], v[48:51]
 v_and_b32 v175, 0xffff0000, v162
 v_lshlrev_b32 v176, 16, v163
 MM v[64:67], v[208:211], a[0:3], v[64:67]
 ds_read_b64_tr_b16 v[248:249], v18 offset:40960
 v_and_b32 v177, 0xffff0000, v163
 MM v[64:67], v[212:215], a[4:7], v[64:67]
 buffer_load_dwordx4 v2, s[4:7], s43 offen offset:2048 lds
 MM v[68:71], v[212:215], a[36:39], v[68:71]
 s_add_u32 s40, s70, 54272
 ds_read_b64_tr_b16 v[250:251], v18 offset:41472
 v_lshlrev_b32 v178, 16, v164
 MM v[68:71], v[208:211], a[32:35], v[68:71]
 ds_read_b64_tr_b16 v[252:253], v18 offset:45056
 v_and_b32 v179, 0xffff0000, v164
 MM v[72:75], v[208:211], a[64:67], v[72:75]
 ds_read_b64_tr_b16 v[254:255], v18 offset:45568
 v_lshlrev_b32 v180, 16, v165
 MM v[72:75], v[212:215], a[68:71], v[72:75]
 v_and_b32 v181, 0xffff0000, v165
 v_lshlrev_b32 v182, 16, v166
 MM v[76:79], v[212:215], a[100:103], v[76:79]
 buffer_load_dwordx4 v3, s[4:7], s40 offen offset:3072 lds
 MM v[76:79], v[208:211], a[96:99], v[76:79]
 s_add_u32 m0, s30, 131072
 s_add_u32 s41, s78, 0
 v_and_b32 v183, 0xffff0000, v166
 MM v[92:95], v[216:219], a[96:99], v[92:95]
 v_lshlrev_b32 v184, 16, v167
 v_and_b32 v185, 0xffff0000, v167
 MM v[92:95], v[220:223], a[100:103], v[92:95]
 v_lshlrev_b32 v186, 16, v168
 v_and_b32 v187, 0xffff0000, v168
 MM v[88:91], v[220:223], a[68:71], v[88:91]
 v_lshlrev_b32 v188, 16, v169
 v_and_b32 v189, 0xffff0000, v169
 MM v[88:91], v[216:219], a[64:67], v[88:91]
 buffer_load_dwordx4 v7, s[8:11], s41 offen offset:0 lds
 MM v[84:87], v[216:219], a[32:35], v[84:87]
 s_add_u32 s42, s78, 64512
 v_sub_f32 v170, v170, v27
 v_sub_f32 v171, v171, v27
 MM v[84:87], v[220:223], a[36:39], v[84:87]
 v_sub_f32 v172, v172, v27
 v_sub_f32 v173, v173, v27
 MM v[80:83], v[220:223], a[4:7], v[80:83]
 v_sub_f32 v174, v174, v27
 v_sub_f32 v175, v175, v27
 MM v[80:83], v[216:219], a[0:3], v[80:83]
 s_waitcnt lgkmcnt(0)
 v_sub_f32 v176, v176, v27
 v_sub_f32 v177, v177, v27
 MM v[96:99], v[224:227], a[0:3], v[96:99]
 buffer_load_dwordx4 v8, s[8:11], s42 offen offset:1024 lds
 MM v[96:99], v[228:231], a[4:7], v[96:99]
 s_add_u32 m0, s30, 139264
 s_add_u32 s43, s78, 128
 v_sub_f32 v178, v178, v27
 MM v[100:103], v[228:231], a[36:39], v[100:103]
 v_sub_f32 v179, v179, v27
 v_sub_f32 v180, v180, v27
 MM v[100:103], v[224:227], a[32:35], v[100:103]
 v_sub_f32 v181, v181, v27
 v_sub_f32 v182, v182, v27
 MM v[104:107], v[224:227], a[64:67], v[104:107]
 v_sub_f32 v183, v183, v27
 v_sub_f32 v184, v184, v27
 MM v[104:107], v[228:231], a[68:71], v[104:107]
 buffer_load_dwordx4 v7, s[8:11], s43 offen offset:0 lds
 MM v[108:111], v[228:231], a[100:103], v[108:111]
 s_add_u32 s40, s78, 64640
 v_sub_f32 v185, v185, v27
 v_sub_f32 v186, v186, v27
 MM v[108:111], v[224:227], a[96:99], v[108:111]
 v_sub_f32 v187, v187, v27
 v_sub_f32 v188, v188, v27
 MM v[124:127], v[232:235], a[96:99], v[124:127]
 v_sub_f32 v189, v189, v27
 v_cvt_pk_bf16_f32 v160, v170, v171
 MM v[124:127], v[236:239], a[100:103], v[124:127]
 v_cvt_pk_bf16_f32 v161, v172, v173
 v_cvt_pk_bf16_f32 v162, v174, v175
 MM v[120:123], v[236:239], a[68:71], v[120:123]
 buffer_load_dwordx4 v8, s[8:11], s40 offen offset:1024 lds
 MM v[120:123], v[232:235], a[64:67], v[120:123]
 s_add_u32 m0, s29, 65536
 s_add_u32 s41, s71, 0
 v_cvt_pk_bf16_f32 v163, v176, v177
 MM v[116:119], v[232:235], a[32:35], v[116:119]
 v_cvt_pk_bf16_f32 v164, v178, v179
 v_cvt_pk_bf16_f32 v165, v180, v181
 MM v[116:119], v[236:239], a[36:39], v[116:119]
 v_cvt_pk_bf16_f32 v166, v182, v183
 v_cvt_pk_bf16_f32 v167, v184, v185
 MM v[112:115], v[236:239], a[4:7], v[112:115]
 s_waitcnt vmcnt(12)
 s_barrier
 ds_read_b128 a[8:11], v4 offset:0
 MM v[112:115], v[232:235], a[0:3], v[112:115]
 ds_read_b128 a[12:15], v5 offset:0
 v_cvt_pk_bf16_f32 v168, v186, v187
 MM v[128:131], v[240:243], a[0:3], v[128:131]
 ds_read_b128 a[40:43], v4 offset:2048
 v_cvt_pk_bf16_f32 v169, v188, v189
 MM v[128:131], v[244:247], a[4:7], v[128:131]
 ds_read_b128 a[44:47], v5 offset:2048
 v_lshlrev_b32 v170, 16, v160
 MM v[132:135], v[244:247], a[36:39], v[132:135]
 ds_read_b64_tr_b16 v[192:193], v15 offset:49152
 v_and_b32 v171, 0xffff0000, v160
 MM v[132:135], v[240:243], a[32:35], v[132:135]
 ds_read_b64_tr_b16 v[194:195], v15 offset:49664
 v_lshlrev_b32 v172, 16, v161
 MM v[136:139], v[240:243], a[64:67], v[136:139]
 buffer_load_dwordx4 v2, s[4:7], s41 offen offset:0 lds
 MM v[136:139], v[244:247], a[68:71], v[136:139]
 s_add_u32 s42, s71, 7168
 ds_read_b128 a[72:75], v4 offset:4096
 v_and_b32 v173, 0xffff0000, v161
 MM v[140:143], v[244:247], a[100:103], v[140:143]
 ds_read_b128 a[76:79], v5 offset:4096
 ds_read_b64_tr_b16 v[196:197], v15 offset:53248
 MM v[140:143], v[240:243], a[96:99], v[140:143]
 ds_read_b64_tr_b16 v[198:199], v15 offset:53760
 ds_read_b128 a[104:107], v4 offset:6144
 MM v[156:159], v[248:251], a[96:99], v[156:159]
 ds_read_b128 a[108:111], v5 offset:6144
 v_lshlrev_b32 v174, 16, v162
 MM v[156:159], v[252:255], a[100:103], v[156:159]
 buffer_load_dwordx4 v3, s[4:7], s42 offen offset:1024 lds
 MM v[152:155], v[252:255], a[68:71], v[152:155]
 s_add_u32 s43, s71, 14336
 ds_read_b64_tr_b16 v[200:201], v16 offset:49152
 v_and_b32 v175, 0xffff0000, v162
 MM v[152:155], v[248:251], a[64:67], v[152:155]
 ds_read_b64_tr_b16 v[202:203], v16 offset:49664
 v_lshlrev_b32 v176, 16, v163
 MM v[148:151], v[248:251], a[32:35], v[148:151]
 ds_read_b64_tr_b16 v[204:205], v16 offset:53248
 v_and_b32 v177, 0xffff0000, v163
 MM v[148:151], v[252:255], a[36:39], v[148:151]
 s_waitcnt lgkmcnt(6)
 ds_read_b64_tr_b16 v[206:207], v16 offset:53760
 v_lshlrev_b32 v178, 16, v164
 MM v[144:147], v[252:255], a[4:7], v[144:147]
 buffer_load_dwordx4 v2, s[4:7], s43 offen offset:2048 lds
 MM v[144:147], v[248:251], a[0:3], v[144:147]
 s_add_u32 s40, s71, 21504
 ds_read_b64_tr_b16 v[208:209], v17 offset:49152
 v_and_b32 v179, 0xffff0000, v164
 MM v[32:35], v[192:195], a[8:11], v[32:35]
 buffer_load_dwordx4 v3, s[4:7], s40 offen offset:3072 lds
 s_waitcnt lgkmcnt(5)
 MM v[32:35], v[196:199], a[12:15], v[32:35]
 s_add_u32 m0, s29, 69632
 s_add_u32 s41, s71, 32768
 ds_read_b64_tr_b16 v[210:211], v17 offset:49664
 MM v[36:39], v[196:199], a[44:47], v[36:39]
 ds_read_b64_tr_b16 v[212:213], v17 offset:53248
 v_lshlrev_b32 v180, 16, v165
 MM v[36:39], v[192:195], a[40:43], v[36:39]
 ds_read_b64_tr_b16 v[214:215], v17 offset:53760
 v_and_b32 v181, 0xffff0000, v165
 MM v[40:43], v[192:195], a[72:75], v[40:43]
 buffer_load_dwordx4 v2, s[4:7], s41 offen offset:0 lds
 MM v[40:43], v[196:199], a[76:79], v[40:43]
 s_add_u32 s42, s71, 39936
 ds_read_b64_tr_b16 v[216:217], v18 offset:49152
 v_lshlrev_b32 v182, 16, v166
 MM v[44:47], v[196:199], a[108:111], v[44:47]
 ds_read_b64_tr_b16 v[218:219], v18 offset:49664
 v_and_b32 v183, 0xffff0000, v166
 MM v[44:47], v[192:195], a[104:107], v[44:47]
 s_waitcnt lgkmcnt(5)
 ds_read_b64_tr_b16 v[220:221], v18 offset:53248
 v_lshlrev_b32 v184, 16, v167
 MM v[60:63], v[200:203], a[104:107], v[60:63]
 ds_read_b64_tr_b16 v[222:223], v18 offset:53760
 v_and_b32 v185, 0xffff0000, v167
 MM v[60:63], v[204:207], a[108:111], v[60:63]
 buffer_load_dwordx4 v3, s[4:7], s42 offen offset:1024 lds
 MM v[56:59], v[204:207], a[76:79], v[56:59]
 v_cmp_eq_u32 vcc, 0, v31
 s_cbranch_vccnz spin0
spun0:
 v_readfirstlane_b32 s61, v31
 MM v[56:59], v[200:203], a[72:75], v[56:59]
 s_add_u32 s43, s71, 47104
 ds_read_b64_tr_b16 v[224:225], v15 offset:57344
 v_lshlrev_b32 v186, 16, v168
 MM v[52:55], v[200:203], a[40:43], v[52:55]
 ds_read_b64_tr_b16 v[226:227], v15 offset:57856
 v_and_b32 v187, 0xffff0000, v168
 MM v[52:55], v[204:207], a[44:47], v[52:55]
 buffer_load_dwordx4 v2, s[4:7], s43 offen offset:2048 lds
 MM v[48:51], v[204:207], a[12:15], v[48:51]
 s_add_u32 s40, s71, 54272
 ds_read_b64_tr_b16 v[228:229], v15 offset:61440
 v_lshlrev_b32 v188, 16, v169
 MM v[48:51], v[200:203], a[8:11], v[48:51]
 s_waitcnt lgkmcnt(3)
 ds_read_b64_tr_b16 v[230:231], v15 offset:61952
 v_and_b32 v189, 0xffff0000, v169
 MM v[64:67], v[208:211], a[8:11], v[64:67]
 ds_read_b64_tr_b16 v[232:233], v16 offset:57344
 v_mul_f32 v28, v170, v25
 MM v[64:67], v[212:215], a[12:15], v[64:67]
 ds_read_b64_tr_b16 v[234:235], v16 offset:57856
 v_fma_f32 v170, -v28, v24, v170
 MM v[68:71], v[212:215], a[44:47], v[68:71]
 buffer_load_dwordx4 v3, s[4:7], s40 offen offset:3072 lds
 MM v[68:71], v[208:211], a[40:43], v[68:71]
 s_add_u32 m0, s30, 147456
 s_add_u32 s41, s79, 0
 ds_read_b64_tr_b16 v[236:237], v16 offset:61440
 MM v[72:75], v[208:211], a[72:75], v[72:75]
 ds_read_b64_tr_b16 v[238:239], v16 offset:61952
 v_fmac_f32 v28, v170, v25
 MM v[72:75], v[212:215], a[76:79], v[72:75]
 ds_read_b64_tr_b16 v[240:241], v17 offset:57344
 v_mul_f32 v29, v171, v25
 MM v[76:79], v[212:215], a[108:111], v[76:79]
 ds_read_b64_tr_b16 v[242:243], v17 offset:57856
 v_fma_f32 v171, -v29, v24, v171
 MM v[76:79], v[208:211], a[104:107], v[76:79]
 buffer_load_dwordx4 v7, s[8:11], s41 offen offset:0 lds
 MM v[92:95], v[216:219], a[104:107], v[92:95]
 s_add_u32 s42, s79, 64512
 ds_read_b64_tr_b16 v[244:245], v17 offset:61440
 v_fmac_f32 v29, v171, v25
 MM v[92:95], v[220:223], a[108:111], v[92:95]
 ds_read_b64_tr_b16 v[246:247], v17 offset:61952
 v_cvt_pk_bf16_f32 v160, v28, v29
 MM v[88:91], v[220:223], a[76:79], v[88:91]
 ds_read_b64_tr_b16 v[248:249], v18 offset:57344
 v_mul_f32 v28, v172, v25
 MM v[88:91], v[216:219], a[72:75], v[88:91]
 ds_read_b64_tr_b16 v[250:251], v18 offset:57856
 v_fma_f32 v172, -v28, v24, v172
 MM v[84:87], v[216:219], a[40:43], v[84:87]
 buffer_load_dwordx4 v8, s[8:11], s42 offen offset:1024 lds
 MM v[84:87], v[220:223], a[44:47], v[84:87]
 s_add_u32 m0, s30, 155648
 s_add_u32 s43, s79, 128
 ds_read_b64_tr_b16 v[252:253], v18 offset:61440
 MM v[80:83], v[220:223], a[12:15], v[80:83]
 ds_read_b64_tr_b16 v[254:255], v18 offset:61952
 v_fmac_f32 v28, v172, v25
 MM v[80:83], v[216:219], a[8:11], v[80:83]
 s_waitcnt lgkmcnt(5)
 v_mul_f32 v29, v173, v25
 v_fma_f32 v173, -v29, v24, v173
 MM v[96:99], v[224:227], a[8:11], v[96:99]
 v_fmac_f32 v29, v173, v25
 v_cvt_pk_bf16_f32 v161, v28, v29
 MM v[96:99], v[228:231], a[12:15], v[96:99]
 buffer_load_dwordx4 v7, s[8:11], s43 offen offset:0 lds
 MM v[100:103], v[228:231], a[44:47], v[100:103]
 s_add_u32 s40, s79, 64640
 v_mul_f32 v28, v174, v25
 v_fma_f32 v174, -v28, v24, v174
 MM v[100:103], v[224:227], a[40:43], v[100:103]
 v_fmac_f32 v28, v174, v25
 v_mul_f32 v29, v175, v25
 MM v[104:107], v[224:227], a[72:75], v[104:107]
 v_fma_f32 v175, -v29, v24, v175
 v_fmac_f32 v29, v175, v25
 MM v[104:107], v[228:231], a[76:79], v[104:107]
 v_cvt_pk_bf16_f32 v162, v28, v29
 v_mul_f32 v28, v176, v25
 MM v[108:111], v[228:231], a[108:111], v[108:111]
 buffer_load_dwordx4 v8, s[8:11], s40 offen offset:1024 lds
 MM v[108:111], v[224:227], a[104:107], v[108:111]
 s_add_u32 m0, s29, 0
 s_add_u32 s41, s38, 0
 v_fma_f32 v176, -v28, v24, v176
 MM v[124:127], v[232:235], a[104:107], v[124:127]
 v_fmac_f32 v28, v176, v25
 v_mul_f32 v29, v177, v25
 MM v[124:127], v[236:239], a[108:111], v[124:127]
 v_fma_f32 v177, -v29, v24, v177
 v_fmac_f32 v29, v177, v25
 MM v[120:123], v[236:239], a[76:79], v[120:123]
 v_cvt_pk_bf16_f32 v163, v28, v29
 v_mul_f32 v28, v178, v25
 MM v[120:123], v[232:235], a[72:75], v[120:123]
 buffer_load_dwordx4 v7, s[12:15], s41 offen offset:0 lds
 MM v[116:119], v[232:235], a[40:43], v[116:119]
 s_add_u32 s42, s38, 64512
 v_fma_f32 v178, -v28, v24, v178
 v_fmac_f32 v28, v178, v25
 MM v[116:119], v[236:239], a[44:47], v[116:119]
 v_mul_f32 v29, v179, v25
 v_fma_f32 v179, -v29, v24, v179
 MM v[112:115], v[236:239], a[12:15], v[112:115]
 s_waitcnt vmcnt(13)
 s_barrier
 ds_read_b128 a[16:19], v4 offset:32768
 MM v[112:115], v[232:235], a[8:11], v[112:115]
 ds_read_b128 a[20:23], v5 offset:32768
 v_fmac_f32 v29, v179, v25
 MM v[128:131], v[240:243], a[8:11], v[128:131]
 s_waitcnt lgkmcnt(2)
 ds_read_b128 a[48:51], v4 offset:34816
 v_cvt_pk_bf16_f32 v164, v28, v29
 MM v[128:131], v[244:247], a[12:15], v[128:131]
 ds_read_b128 a[52:55], v5 offset:34816
 v_mul_f32 v28, v180, v25
 MM v[132:135], v[244:247], a[44:47], v[132:135]
 ds_read_b64_tr_b16 v[192:193], v19 offset:0
 v_fma_f32 v180, -v28, v24, v180
 MM v[132:135], v[240:243], a[40:43], v[132:135]
 ds_read_b64_tr_b16 v[194:195], v19 offset:512
 v_fmac_f32 v28, v180, v25
 MM v[136:139], v[240:243], a[72:75], v[136:139]
 buffer_load_dwordx4 v8, s[12:15], s42 offen offset:1024 lds
 MM v[136:139], v[244:247], a[76:79], v[136:139]
 s_add_u32 s43, s38, 129024
 ds_read_b128 a[80:83], v4 offset:36864
 v_mul_f32 v29, v181, v25
 MM v[140:143], v[244:247], a[108:111], v[140:143]
 ds_read_b128 a[84:87], v5 offset:36864
 ds_read_b64_tr_b16 v[196:197], v19 offset:4096
 MM v[140:143], v[240:243], a[104:107], v[140:143]
 ds_read_b64_tr_b16 v[198:199], v19 offset:4608
 ds_read_b128 a[112:115], v4 offset:38912
 MM v[156:159], v[248:251], a[104:107], v[156:159]
 ds_read_b128 a[116:119], v5 offset:38912
 v_fma_f32 v181, -v29, v24, v181
 MM v[156:159], v[252:255], a[108:111], v[156:159]
 buffer_load_dwordx4 v7, s[12:15], s43 offen offset:2048 lds
 MM v[152:155], v[252:255], a[76:79], v[152:155]
 s_add_u32 s40, s38, 193536
 ds_read_b64_tr_b16 v[200:201], v20 offset:0
 v_fmac_f32 v29, v181, v25
 MM v[152:155], v[248:251], a[72:75], v[152:155]
 ds_read_b64_tr_b16 v[202:203], v20 offset:512
 v_cvt_pk_bf16_f32 v165, v28, v29
 MM v[148:151], v[248:251], a[40:43], v[148:151]
 buffer_load_dwordx4 v8, s[12:15], s40 offen offset:3072 lds
 MM v[148:151], v[252:255], a[44:47], v[148:151]
 s_add_u32 m0, s29, 4096
 s_add_u32 s41, s38, 262144
 ds_read_b64_tr_b16 v[204:205], v20 offset:4096
 MM v[144:147], v[252:255], a[12:15], v[144:147]
 s_waitcnt lgkmcnt(4)
 ds_read_b64_tr_b16 v[206:207], v20 offset:4608
 v_mul_f32 v28, v182, v25
 MM v[144:147], v[248:251], a[8:11], v[144:147]
 buffer_load_dwordx4 v7, s[12:15], s41 offen offset:0 lds
 MM v[32:35], v[192:195], a[16:19], v[32:35]
 s_add_u32 s42, s38, 326656
 ds_read_b64_tr_b16 v[208:209], v21 offset:0
 v_fma_f32 v182, -v28, v24, v182
 MM v[32:35], v[196:199], a[20:23], v[32:35]
 ds_read_b64_tr_b16 v[210:211], v21 offset:512
 v_fmac_f32 v28, v182, v25
 MM v[36:39], v[196:199], a[52:55], v[36:39]
 buffer_load_dwordx4 v8, s[12:15], s42 offen offset:1024 lds
 MM v[36:39], v[192:195], a[48:51], v[36:39]
 s_add_u32 s43, s38, 391168
 ds_read_b64_tr_b16 v[212:213], v21 offset:4096
 v_mul_f32 v29, v183, v25
 MM v[40:43], v[192:195], a[80:83], v[40:43]
 s_waitcnt lgkmcnt(4)
 ds_read_b64_tr_b16 v[214:215], v21 offset:4608
 v_fma_f32 v183, -v29, v24, v183
 MM v[40:43], v[196:199], a[84:87], v[40:43]
 buffer_load_dwordx4 v7, s[12:15], s43 offen offset:2048 lds
 MM v[44:47], v[196:199], a[116:119], v[44:47]
 s_add_u32 s40, s38, 455680
 v_fmac_f32 v29, v183, v25
 v_cvt_pk_bf16_f32 v166, v28, v29
 MM v[44:47], v[192:195], a[112:115], v[44:47]
 v_mul_f32 v28, v184, v25
 v_fma_f32 v184, -v28, v24, v184
 MM v[60:63], v[200:203], a[112:115], v[60:63]
 s_waitcnt lgkmcnt(2)
 v_fmac_f32 v28, v184, v25
 v_mul_f32 v29, v185, v25
 MM v[60:63], v[204:207], a[116:119], v[60:63]
 v_fma_f32 v185, -v29, v24, v185
 v_fmac_f32 v29, v185, v25
 MM v[56:59], v[204:207], a[84:87], v[56:59]
 v_cvt_pk_bf16_f32 v167, v28, v29
 v_mul_f32 v28, v186, v25
 MM v[56:59], v[200:203], a[80:83], v[56:59]
 v_fma_f32 v186, -v28, v24, v186
 v_fmac_f32 v28, v186, v25
 MM v[52:55], v[200:203], a[48:51], v[52:55]
 v_mul_f32 v29, v187, v25
 v_fma_f32 v187, -v29, v24, v187
 MM v[52:55], v[204:207], a[52:55], v[52:55]
 v_fmac_f32 v29, v187, v25
 v_cvt_pk_bf16_f32 v168, v28, v29
 MM v[48:51], v[204:207], a[20:23], v[48:51]
 v_mul_f32 v28, v188, v25
 v_fma_f32 v188, -v28, v24, v188
 MM v[48:51], v[200:203], a[16:19], v[48:51]
 v_fmac_f32 v28, v188, v25
 v_mul_f32 v29, v189, v25
 MM v[64:67], v[208:211], a[16:19], v[64:67]
 s_waitcnt lgkmcnt(0)
 v_fma_f32 v189, -v29, v24, v189
 v_fmac_f32 v29, v189, v25
 v_cvt_pk_bf16_f32 v169, v28, v29
 MM v[64:67], v[212:215], a[20:23], v[64:67]
 buffer_load_dwordx4 v8, s[12:15], s40 offen offset:3072 lds
 ds_read_b64_tr_b16 v[216:217], v22 offset:0
 ds_read_b64_tr_b16 v[218:219], v22 offset:512
 MM v[68:71], v[212:215], a[52:55], v[68:71]
 s_add_u32 m0, s29, 32768
 ds_read_b64_tr_b16 v[220:221], v22 offset:4096
 ds_read_b64_tr_b16 v[222:223], v22 offset:4608
 MM v[68:71], v[208:211], a[48:51], v[68:71]
 s_add_u32 s41, s39, 0
 ds_read_b64_tr_b16 v[224:225], v19 offset:8192
 ds_read_b64_tr_b16 v[226:227], v19 offset:8704
 MM v[72:75], v[208:211], a[80:83], v[72:75]
 ds_write_b64 v23, v[160:161] offset:0
 MM v[72:75], v[212:215], a[84:87], v[72:75]
 buffer_load_dwordx4 v7, s[12:15], s41 offen offset:0 lds
 MM v[76:79], v[212:215], a[116:119], v[76:79]
 ds_write_b64 v23, v[162:163] offset:2304
 MM v[76:79], v[208:211], a[112:115], v[76:79]
 s_add_u32 s42, s39, 64512
 ds_read_b64_tr_b16 v[228:229], v19 offset:12288
 ds_read_b64_tr_b16 v[230:231], v19 offset:12800
 s_waitcnt lgkmcnt(8)
 MM v[92:95], v[216:219], a[112:115], v[92:95]
 buffer_load_dwordx4 v8, s[12:15], s42 offen offset:1024 lds
 s_waitcnt lgkmcnt(6)
 MM v[92:95], v[220:223], a[116:119], v[92:95]
 ds_write_b64 v23, v[164:165] offset:4608
 MM v[88:91], v[220:223], a[84:87], v[88:91]
 s_add_u32 s43, s39, 129024
 ds_read_b64_tr_b16 v[232:233], v20 offset:8192
 ds_read_b64_tr_b16 v[234:235], v20 offset:8704
 MM v[88:91], v[216:219], a[80:83], v[88:91]
 buffer_load_dwordx4 v7, s[12:15], s43 offen offset:2048 lds
 MM v[84:87], v[216:219], a[48:51], v[84:87]
 ds_write_b64 v23, v[166:167] offset:6912
 MM v[84:87], v[220:223], a[52:55], v[84:87]
 s_add_u32 s40, s39, 193536
 ds_read_b64_tr_b16 v[236:237], v20 offset:12288
 ds_read_b64_tr_b16 v[238:239], v20 offset:12800
 MM v[80:83], v[220:223], a[20:23], v[80:83]
 ds_write_b64 v23, v[168:169] offset:9216
 MM v[80:83], v[216:219], a[16:19], v[80:83]
 buffer_load_dwordx4 v8, s[12:15], s40 offen offset:3072 lds
 s_waitcnt lgkmcnt(7)
 MM v[96:99], v[224:227], a[16:19], v[96:99]
 s_add_u32 m0, s29, 36864
 s_add_u32 s41, s39, 262144
 ds_read_b64_tr_b16 v[240:241], v21 offset:8192
 MM v[96:99], v[228:231], a[20:23], v[96:99]
 buffer_load_dwordx4 v7, s[12:15], s41 offen offset:0 lds
 MM v[100:103], v[228:231], a[52:55], v[100:103]
 s_add_u32 s42, s39, 326656
 ds_read_b64_tr_b16 v[242:243], v21 offset:8704
 ds_read_b64_tr_b16 v[244:245], v21 offset:12288
 MM v[100:103], v[224:227], a[48:51], v[100:103]
 ds_read_b64_tr_b16 v[246:247], v21 offset:12800
 ds_read_b64_tr_b16 v[248:249], v22 offset:8192
 MM v[104:107], v[224:227], a[80:83], v[104:107]
 buffer_load_dwordx4 v8, s[12:15], s42 offen offset:1024 lds
 MM v[104:107], v[228:231], a[84:87], v[104:107]
 s_add_u32 s43, s39, 391168
 ds_read_b64_tr_b16 v[250:251], v22 offset:8704
 ds_read_b64_tr_b16 v[252:253], v22 offset:12288
 MM v[108:111], v[228:231], a[116:119], v[108:111]
 buffer_load_dwordx4 v7, s[12:15], s43 offen offset:2048 lds
 MM v[108:111], v[224:227], a[112:115], v[108:111]
 s_waitcnt lgkmcnt(6)
 s_add_u32 s40, s39, 455680
 ds_read_b64_tr_b16 v[254:255], v22 offset:12800
 MM v[124:127], v[232:235], a[112:115], v[124:127]
 s_waitcnt lgkmcnt(0)
 MM v[124:127], v[236:239], a[116:119], v[124:127]
 buffer_load_dwordx4 v8, s[12:15], s40 offen offset:3072 lds
 MM v[120:123], v[236:239], a[84:87], v[120:123]
 s_mul_i32 s92, s24, 2880
 s_add_u32 s92, s92, 0x18000
 v_lshrrev_b32 v28, 7, v1
 MM v[120:123], v[232:235], a[80:83], v[120:123]
 v_lshl_add_u32 v23, v28, 4, v1
 v_add_u32 v23, s92, v23
 MM v[116:119], v[232:235], a[48:51], v[116:119]
 v_lshl_add_u32 v28, v28, 7, v1
 v_lshrrev_b32 v29, 9, v1
 MM v[116:119], v[236:239], a[52:55], v[116:119]
 v_mul_u32_u24 v29, 0x700000, v29
 v_lshl_add_u32 v29, v29, 8, v28
 MM v[112:115], v[236:239], a[20:23], v[112:115]
 s_waitcnt vmcnt(16)
 s_barrier
 ds_read_b128 a[24:27], v6 offset:0
 MM v[112:115], v[232:235], a[16:19], v[112:115]
 s_lshr_b32 s92, s2, 1
 s_mul_i32 s92, s92, 20480
 ds_read_b128 a[28:31], v0 offset:0
 MM v[128:131], v[240:243], a[16:19], v[128:131]
 s_and_b32 s93, s2, 1
 s_lshl_b32 s93, s93, 7
 ds_read_b128 a[56:59], v6 offset:2048
 MM v[128:131], v[244:247], a[20:23], v[128:131]
 s_add_u32 s92, s92, s93
 s_mul_i32 s93, s24, 5120
 ds_read_b128 a[60:63], v0 offset:2048
 MM v[132:135], v[244:247], a[52:55], v[132:135]
 s_add_u32 s92, s92, s93
 s_add_u32 s93, s92, 0x1000
 ds_read_b64_tr_b16 v[192:193], v19 offset:16384
 MM v[132:135], v[240:243], a[48:51], v[132:135]
 ds_read_b64_tr_b16 v[194:195], v19 offset:16896
 v_lshrrev_b32 v24, 4, v1
 MM v[136:139], v[240:243], a[80:83], v[136:139]
 s_lshr_b32 s80, s2, 5
 ds_read_b128 a[88:91], v6 offset:4096
 ds_read_b128 a[92:95], v0 offset:4096
 MM v[136:139], v[244:247], a[84:87], v[136:139]
 s_lshl_b32 s81, s80, 4
 ds_read_b64_tr_b16 v[196:197], v19 offset:20480
 ds_read_b64_tr_b16 v[198:199], v19 offset:20992
 MM v[140:143], v[244:247], a[116:119], v[140:143]
 s_lshl_b32 s82, s24, 2
 ds_read_b128 a[120:123], v6 offset:6144
 ds_read_b128 a[124:127], v0 offset:6144
 MM v[140:143], v[240:243], a[112:115], v[140:143]
 s_add_u32 s81, s81, s82
 ds_read_b64_tr_b16 v[200:201], v20 offset:16384
 ds_read_b64_tr_b16 v[202:203], v20 offset:16896
 MM v[156:159], v[248:251], a[112:115], v[156:159]
 ds_read_b64_tr_b16 v[204:205], v20 offset:20480
 v_lshrrev_b32 v25, 3, v24
 MM v[156:159], v[252:255], a[116:119], v[156:159]
 ds_read_b64_tr_b16 v[206:207], v20 offset:20992
 ds_read_b64_tr_b16 v[208:209], v21 offset:16384
 MM v[152:155], v[252:255], a[84:87], v[152:155]
 ds_read_b64_tr_b16 v[210:211], v21 offset:16896
 v_lshlrev_b32 v25, 7, v25
 MM v[152:155], v[248:251], a[80:83], v[152:155]
 ds_read_b64_tr_b16 v[212:213], v21 offset:20480
 ds_read_b64_tr_b16 v[214:215], v21 offset:20992
 MM v[148:151], v[248:251], a[48:51], v[148:151]
 ds_read_b128 v[176:179], v23 offset:0
 v_bfe_u32 v26, v24, 1, 2
 MM v[148:151], v[252:255], a[52:55], v[148:151]
 ds_read_b128 v[180:183], v23 offset:1152
 ds_read_b128 v[184:187], v23 offset:2304
 MM v[144:147], v[252:255], a[20:23], v[144:147]
 ds_read_b64_tr_b16 v[216:217], v22 offset:16384
 v_add3_u32 v26, v26, v25, s81
 MM v[144:147], v[248:251], a[16:19], v[144:147]
 s_waitcnt lgkmcnt(9)
 ds_read_b64_tr_b16 v[218:219], v22 offset:16896
 ds_read_b64_tr_b16 v[220:221], v22 offset:20480
 MM v[32:35], v[192:195], a[24:27], v[32:35]
 ds_read_b64_tr_b16 v[222:223], v22 offset:20992
 v_lshlrev_b32 v25, 13, v26
 MM v[32:35], v[196:199], a[28:31], v[32:35]
 ds_read_b64_tr_b16 v[224:225], v19 offset:24576
 ds_read_b64_tr_b16 v[226:227], v19 offset:25088
 MM v[36:39], v[196:199], a[60:63], v[36:39]
 ds_read_b64_tr_b16 v[228:229], v19 offset:28672
 v_and_b32 v24, 1, v24
 MM v[36:39], v[192:195], a[56:59], v[36:39]
 ds_read_b64_tr_b16 v[230:231], v19 offset:29184
 ds_read_b64_tr_b16 v[232:233], v20 offset:24576
 MM v[40:43], v[192:195], a[88:91], v[40:43]
 ds_read_b64_tr_b16 v[234:235], v20 offset:25088
 v_lshl_add_u32 v25, v24, 7, v25
 MM v[40:43], v[196:199], a[92:95], v[40:43]
 ds_read_b64_tr_b16 v[236:237], v20 offset:28672
 ds_read_b64_tr_b16 v[238:239], v20 offset:29184
 MM v[44:47], v[196:199], a[124:127], v[44:47]
 v_mul_u32_u24 v26, 3456, v26
 MM v[44:47], v[192:195], a[120:123], v[44:47]
 s_waitcnt lgkmcnt(8)
 MM v[60:63], v[200:203], a[120:123], v[60:63]
 s_and_b32 s81, s2, 7
 ds_read_b64_tr_b16 v[240:241], v21 offset:24576
 ds_read_b64_tr_b16 v[242:243], v21 offset:25088
 MM v[60:63], v[204:207], a[124:127], v[60:63]
 ds_read_b64_tr_b16 v[244:245], v21 offset:28672
 ds_read_b64_tr_b16 v[246:247], v21 offset:29184
 MM v[56:59], v[204:207], a[92:95], v[56:59]
 s_bfe_u32 s82, s2, 0x20003
 MM v[56:59], v[200:203], a[88:91], v[56:59]
 MM v[52:55], v[200:203], a[56:59], v[52:55]
 s_add_u32 s80, s80, s81
 MM v[52:55], v[204:207], a[60:63], v[52:55]
 MM v[48:51], v[204:207], a[28:31], v[48:51]
 buffer_store_dwordx4 v[176:179], v28, s[16:19], s92 offen offset:0 sc1
 MM v[48:51], v[200:203], a[24:27], v[48:51]
 s_and_b32 s80, s80, 7
 MM v[64:67], v[208:211], a[24:27], v[64:67]
 s_add_u32 s80, s80, 19
 ds_read_b64_tr_b16 v[248:249], v22 offset:24576
 ds_read_b64_tr_b16 v[250:251], v22 offset:25088
 MM v[64:67], v[212:215], a[28:31], v[64:67]
 ds_read_b64_tr_b16 v[252:253], v22 offset:28672
 ds_read_b64_tr_b16 v[254:255], v22 offset:29184
 MM v[68:71], v[212:215], a[60:63], v[68:71]
 s_mul_i32 s83, s81, 3
 MM v[68:71], v[208:211], a[56:59], v[68:71]
 buffer_store_dwordx4 v[180:183], v28, s[16:19], s92 offen offset:2048 sc1
 MM v[72:75], v[208:211], a[88:91], v[72:75]
 s_add_u32 s83, s83, s82
 MM v[72:75], v[212:215], a[92:95], v[72:75]
 MM v[76:79], v[212:215], a[124:127], v[76:79]
 s_cmp_eq_u32 s82, 3
 s_cselect_b32 s83, s80, s83
 MM v[76:79], v[208:211], a[120:123], v[76:79]
 MM v[92:95], v[216:219], a[120:123], v[92:95]
 buffer_store_dwordx4 v[184:187], v29, s[16:19], s93 offen offset:0 sc1
 MM v[92:95], v[220:223], a[124:127], v[92:95]
 s_lshl_b32 s83, s83, 7
 MM v[88:91], v[220:223], a[92:95], v[88:91]
 s_lshl_b32 s81, s81, 2
 MM v[88:91], v[216:219], a[88:91], v[88:91]
 MM v[84:87], v[216:219], a[56:59], v[84:87]
 s_add_u32 s81, s81, s82
 MM v[84:87], v[220:223], a[60:63], v[84:87]
 MM v[80:83], v[220:223], a[28:31], v[80:83]
 s_lshl_b32 s81, s81, 8
 MM v[80:83], v[216:219], a[24:27], v[80:83]
 s_waitcnt lgkmcnt(0)
 MM v[96:99], v[224:227], a[24:27], v[96:99]
 MM v[96:99], v[228:231], a[28:31], v[96:99]
 MM v[100:103], v[228:231], a[60:63], v[100:103]
 s_waitcnt vmcnt(3)
 s_barrier
 s_add_u32 m0, s29, 65536
 MM v[100:103], v[224:227], a[56:59], v[100:103]
 s_add_u32 s41, s38, 128
 ds_read_b64_tr_b16 v[192:193], v11 offset:0
 ds_read_b64_tr_b16 v[194:195], v11 offset:512
 MM v[104:107], v[224:227], a[88:91], v[104:107]
 ds_read_b64_tr_b16 v[196:197], v11 offset:4096
 ds_read_b64_tr_b16 v[198:199], v11 offset:4608
 MM v[104:107], v[228:231], a[92:95], v[104:107]
 ds_read_b64_tr_b16 v[200:201], v11 offset:8192
 ds_read_b64_tr_b16 v[202:203], v11 offset:8704
 MM v[108:111], v[228:231], a[124:127], v[108:111]
 buffer_load_dwordx4 v7, s[12:15], s41 offen offset:0 lds
 MM v[108:111], v[224:227], a[120:123], v[108:111]
 s_add_u32 s42, s38, 64640
 ds_read_b64_tr_b16 v[204:205], v11 offset:12288
 ds_read_b64_tr_b16 v[206:207], v11 offset:12800
 MM v[124:127], v[232:235], a[120:123], v[124:127]
 ds_read_b64_tr_b16 v[208:209], v11 offset:16384
 ds_read_b64_tr_b16 v[210:211], v11 offset:16896
 MM v[124:127], v[236:239], a[124:127], v[124:127]
 ds_read_b64_tr_b16 v[212:213], v11 offset:20480
 ds_read_b64_tr_b16 v[214:215], v11 offset:20992
 MM v[120:123], v[236:239], a[92:95], v[120:123]
 buffer_load_dwordx4 v8, s[12:15], s42 offen offset:1024 lds
 MM v[120:123], v[232:235], a[88:91], v[120:123]
 s_add_u32 s43, s38, 129152
 ds_read_b64_tr_b16 v[216:217], v11 offset:24576
 ds_read_b64_tr_b16 v[218:219], v11 offset:25088
 MM v[116:119], v[232:235], a[56:59], v[116:119]
 ds_read_b64_tr_b16 v[220:221], v11 offset:28672
 ds_read_b64_tr_b16 v[222:223], v11 offset:29184
 MM v[116:119], v[236:239], a[60:63], v[116:119]
 MM v[112:115], v[236:239], a[28:31], v[112:115]
 buffer_load_dwordx4 v7, s[12:15], s43 offen offset:2048 lds
 MM v[112:115], v[232:235], a[24:27], v[112:115]
 s_add_u32 s40, s38, 193664
 MM v[128:131], v[240:243], a[24:27], v[128:131]
 MM v[128:131], v[244:247], a[28:31], v[128:131]
 MM v[132:135], v[244:247], a[60:63], v[132:135]
 buffer_load_dwordx4 v8, s[12:15], s40 offen offset:3072 lds
 MM v[132:135], v[240:243], a[56:59], v[132:135]
 s_add_u32 m0, s29, 69632
 s_add_u32 s41, s38, 262272
 MM v[136:139], v[240:243], a[88:91], v[136:139]
 MM v[136:139], v[244:247], a[92:95], v[136:139]
 MM v[140:143], v[244:247], a[124:127], v[140:143]
 buffer_load_dwordx4 v7, s[12:15], s41 offen offset:0 lds
 MM v[140:143], v[240:243], a[120:123], v[140:143]
 s_add_u32 s42, s38, 326784
 MM v[156:159], v[248:251], a[120:123], v[156:159]
 ds_read_b64_tr_b16 v[224:225], v11 offset:32768
 ds_read_b64_tr_b16 v[226:227], v11 offset:33280
 MM v[156:159], v[252:255], a[124:127], v[156:159]
 ds_read_b64_tr_b16 v[228:229], v11 offset:36864
 ds_read_b64_tr_b16 v[230:231], v11 offset:37376
 MM v[152:155], v[252:255], a[92:95], v[152:155]
 buffer_load_dwordx4 v8, s[12:15], s42 offen offset:1024 lds
 MM v[152:155], v[248:251], a[88:91], v[152:155]
 s_add_u32 s43, s38, 391296
 ds_read_b64_tr_b16 v[232:233], v11 offset:40960
 ds_read_b64_tr_b16 v[234:235], v11 offset:41472
 MM v[148:151], v[248:251], a[56:59], v[148:151]
 ds_read_b64_tr_b16 v[236:237], v11 offset:45056
 ds_read_b64_tr_b16 v[238:239], v11 offset:45568
 MM v[148:151], v[252:255], a[60:63], v[148:151]
 s_waitcnt lgkmcnt(8)
 ds_read_b64_tr_b16 v[240:241], v11 offset:49152
 ds_read_b64_tr_b16 v[242:243], v11 offset:49664
 MM v[144:147], v[252:255], a[28:31], v[144:147]
 buffer_load_dwordx4 v7, s[12:15], s43 offen offset:2048 lds
 MM v[144:147], v[248:251], a[24:27], v[144:147]
 s_add_u32 s40, s38, 455808
 ds_read_b64_tr_b16 v[244:245], v11 offset:53248
 ds_read_b64_tr_b16 v[246:247], v11 offset:53760
 MM v[160:163], a[128:131], v[192:195], 0
 ds_read_b64_tr_b16 v[248:249], v11 offset:57344
 ds_read_b64_tr_b16 v[250:251], v11 offset:57856
 MM v[160:163], a[132:135], v[196:199], v[160:163]
 ds_read_b64_tr_b16 v[252:253], v11 offset:61440
 ds_read_b64_tr_b16 v[254:255], v11 offset:61952
 MM v[160:163], a[136:139], v[200:203], v[160:163]
 buffer_load_dwordx4 v8, s[12:15], s40 offen offset:3072 lds
 MM v[160:163], a[140:143], v[204:207], v[160:163]
 s_add_u32 m0, s29, 98304
 s_add_u32 s41, s39, 128
 MM v[160:163], a[144:147], v[208:211], v[160:163]
 MM v[160:163], a[148:151], v[212:215], v[160:163]
 MM v[160:163], a[152:155], v[216:219], v[160:163]
 buffer_load_dwordx4 v7, s[12:15], s41 offen offset:0 lds
 MM v[160:163], a[156:159], v[220:223], v[160:163]
 s_add_u32 s42, s39, 64640
 MM v[164:167], a[188:191], v[220:223], 0
 MM v[164:167], a[184:187], v[216:219], v[164:167]
 MM v[164:167], a[180:183], v[212:215], v[164:167]
 buffer_load_dwordx4 v8, s[12:15], s42 offen offset:1024 lds
 MM v[164:167], a[176:179], v[208:211], v[164:167]
 s_add_u32 s43, s39, 129152
 MM v[164:167], a[172:175], v[204:207], v[164:167]
 MM v[164:167], a[168:171], v[200:203], v[164:167]
 MM v[164:167], a[164:167], v[196:199], v[164:167]
 buffer_load_dwordx4 v7, s[12:15], s43 offen offset:2048 lds
 MM v[164:167], a[160:163], v[192:195], v[164:167]
 s_add_u32 s40, s39, 193664
 v_mul_f32 v32, s44, v32
 v_mul_f32 v33, s44, v33
 MM v[168:171], a[192:195], v[192:195], 0
 v_mul_f32 v34, s44, v34
 v_mul_f32 v35, s44, v35
 MM v[168:171], a[196:199], v[196:199], v[168:171]
 v_mul_f32 v48, s44, v48
 v_mul_f32 v49, s44, v49
 MM v[168:171], a[200:203], v[200:203], v[168:171]
 buffer_load_dwordx4 v8, s[12:15], s40 offen offset:3072 lds
 MM v[168:171], a[204:207], v[204:207], v[168:171]
 s_add_u32 m0, s29, 102400
 s_add_u32 s41, s39, 262272
 v_mul_f32 v50, s44, v50
 MM v[168:171], a[208:211], v[208:211], v[168:171]
 s_lshr_b32 s3, s2, 4
 v_mul_f32 v51, s44, v51
 v_cvt_pk_bf16_f32 v32, v32, v33
 MM v[168:171], a[212:215], v[212:215], v[168:171]
 s_lshl_b32 s3, s3, 8
 v_cvt_pk_bf16_f32 v33, v34, v35
 v_cvt_pk_bf16_f32 v34, v48, v49
 MM v[168:171], a[216:219], v[216:219], v[168:171]
 buffer_load_dwordx4 v7, s[12:15], s41 offen offset:0 lds
 MM v[168:171], a[220:223], v[220:223], v[168:171]
 s_add_u32 s42, s39, 326784
 s_and_b32 s31, s2, 15
 v_cvt_pk_bf16_f32 v35, v50, v51
 MM v[172:175], a[252:255], v[220:223], 0
 s_lshl_b32 s31, s31, 2
 s_add_u32 s3, s3, s31
 s_add_u32 s3, s3, 70713344
 MM v[172:175], a[248:251], v[216:219], v[172:175]
 s_add_u32 s3, s3, s100
 s_lshl_b32 s64, s24, 13
 v_mov_b32 v31, s61
 MM v[172:175], a[244:247], v[212:215], v[172:175]
 buffer_load_dwordx4 v8, s[12:15], s42 offen offset:1024 lds
 MM v[172:175], a[240:243], v[208:211], v[172:175]
 s_add_u32 s43, s39, 391296
 s_add_u32 s64, s64, 0x20000
 v_add_u32 v22, s64, v1
 MM v[172:175], a[236:239], v[204:207], v[172:175]
 ds_read_b64_tr_b16 v[204:205], v12 offset:12288
 v_mul_f32 v36, s44, v36
 MM v[172:175], a[232:235], v[200:203], v[172:175]
 s_waitcnt lgkmcnt(1)
 ds_read_b64_tr_b16 v[200:201], v12 offset:8192
 v_mul_f32 v37, s44, v37
 MM v[172:175], a[228:231], v[196:199], v[172:175]
 buffer_load_dwordx4 v7, s[12:15], s43 offen offset:2048 lds
 MM v[172:175], a[224:227], v[192:195], v[172:175]
 s_add_u32 s40, s39, 455808
 ds_read_b64_tr_b16 v[192:193], v12 offset:0
 v_mul_f32 v38, s44, v38
 MM v[172:175], a[96:99], v[224:227], v[172:175]
 ds_read_b64_tr_b16 v[194:195], v12 offset:512
 v_mul_f32 v39, s44, v39
 MM v[172:175], a[100:103], v[228:231], v[172:175]
 ds_read_b64_tr_b16 v[196:197], v12 offset:4096
 v_mul_f32 v52, s44, v52
 MM v[172:175], a[104:107], v[232:235], v[172:175]
 buffer_load_dwordx4 v8, s[12:15], s40 offen offset:3072 lds
 MM v[172:175], a[108:111], v[236:239], v[172:175]
 ds_read_b64_tr_b16 v[198:199], v12 offset:4608
 v_mul_f32 v53, s44, v53
 MM v[172:175], a[112:115], v[240:243], v[172:175]
 ds_read_b64_tr_b16 v[202:203], v12 offset:8704
 v_mul_f32 v54, s44, v54
 MM v[172:175], a[116:119], v[244:247], v[172:175]
 ds_read_b64_tr_b16 v[206:207], v12 offset:12800
 v_mul_f32 v55, s44, v55
 MM v[172:175], a[120:123], v[248:251], v[172:175]
 v_cvt_pk_bf16_f32 v36, v36, v37
 v_cvt_pk_bf16_f32 v37, v38, v39
 MM v[172:175], a[124:127], v[252:255], v[172:175]
 v_cvt_pk_bf16_f32 v38, v52, v53
 v_cvt_pk_bf16_f32 v39, v54, v55
 MM v[168:171], a[92:95], v[252:255], v[168:171]
 ds_read_b64_tr_b16 v[208:209], v12 offset:16384
 v_mul_f32 v40, s44, v40
 MM v[168:171], a[88:91], v[248:251], v[168:171]
 ds_read_b64_tr_b16 v[210:211], v12 offset:16896
 v_mul_f32 v41, s44, v41
 MM v[168:171], a[84:87], v[244:247], v[168:171]
 ds_read_b64_tr_b16 v[212:213], v12 offset:20480
 v_mul_f32 v42, s44, v42
 MM v[168:171], a[80:83], v[240:243], v[168:171]
 ds_read_b64_tr_b16 v[214:215], v12 offset:20992
 v_mul_f32 v43, s44, v43
 MM v[168:171], a[76:79], v[236:239], v[168:171]
 ds_read_b64_tr_b16 v[216:217], v12 offset:24576
 v_mul_f32 v56, s44, v56
 MM v[168:171], a[72:75], v[232:235], v[168:171]
 ds_read_b64_tr_b16 v[218:219], v12 offset:25088
 v_mul_f32 v57, s44, v57
 MM v[168:171], a[68:71], v[228:231], v[168:171]
 ds_read_b64_tr_b16 v[220:221], v12 offset:28672
 v_mul_f32 v58, s44, v58
 MM v[168:171], a[64:67], v[224:227], v[168:171]
 ds_read_b64_tr_b16 v[222:223], v12 offset:29184
 v_mul_f32 v59, s44, v59
 MM v[164:167], a[32:35], v[224:227], v[164:167]
 v_cvt_pk_bf16_f32 v40, v40, v41
 v_cvt_pk_bf16_f32 v41, v42, v43
 MM v[164:167], a[36:39], v[228:231], v[164:167]
 v_cvt_pk_bf16_f32 v42, v56, v57
 v_cvt_pk_bf16_f32 v43, v58, v59
 MM v[164:167], a[40:43], v[232:235], v[164:167]
 v_mul_f32 v44, s44, v44
 v_mul_f32 v45, s44, v45
 MM v[164:167], a[44:47], v[236:239], v[164:167]
 v_mul_f32 v46, s44, v46
 v_mul_f32 v47, s44, v47
 MM v[164:167], a[48:51], v[240:243], v[164:167]
 v_mul_f32 v60, s44, v60
 v_mul_f32 v61, s44, v61
 MM v[164:167], a[52:55], v[244:247], v[164:167]
 v_mul_f32 v62, s44, v62
 v_mul_f32 v63, s44, v63
 MM v[164:167], a[56:59], v[248:251], v[164:167]
 s_waitcnt vmcnt(16)
 s_barrier
 v_cvt_pk_bf16_f32 v44, v44, v45
 MM v[164:167], a[60:63], v[252:255], v[164:167]
 v_cvt_pk_bf16_f32 v45, v46, v47
 v_cvt_pk_bf16_f32 v46, v60, v61
 MM v[160:163], a[28:31], v[252:255], v[160:163]
 s_mov_b64 exec, 1
 buffer_store_dword v31, off, s[16:19], s3 sc1
 s_mov_b64 exec, -1
 MM v[160:163], a[24:27], v[248:251], v[160:163]
 v_cvt_pk_bf16_f32 v47, v62, v63
 v_mul_f32 v64, s44, v64
 MM v[160:163], a[20:23], v[244:247], v[160:163]
 v_mul_f32 v65, s44, v65
 v_mul_f32 v66, s44, v66
 MM v[160:163], a[16:19], v[240:243], v[160:163]
 v_mul_f32 v67, s44, v67
 v_mul_f32 v80, s44, v80
 MM v[160:163], a[12:15], v[236:239], v[160:163]
 ds_read_b64_tr_b16 v[236:237], v12 offset:45056
 v_mul_f32 v81, s44, v81
 MM v[160:163], a[8:11], v[232:235], v[160:163]
 ds_read_b64_tr_b16 v[232:233], v12 offset:40960
 v_mul_f32 v82, s44, v82
 MM v[160:163], a[4:7], v[228:231], v[160:163]
 s_mov_b32 exec_lo, 0xffffffff
 s_mov_b32 exec_hi, 0xff
 buffer_load_dword v19, v25, s[48:51], s81 offen
 buffer_load_dword v19, v26, s[20:23], s83 offen
 buffer_load_dword v19, v26, s[52:55], s83 offen
 s_mov_b64 exec, -1
 MM v[160:163], a[0:3], v[224:227], v[160:163]
 s_waitcnt lgkmcnt(2)
 ds_read_b64_tr_b16 v[224:225], v12 offset:32768
 v_mul_f32 v83, s44, v83
 MM v[176:179], a[128:131], v[192:195], 0
 ds_read_b64_tr_b16 v[226:227], v12 offset:33280
 v_cvt_pk_bf16_f32 v64, v64, v65
 MM v[176:179], a[132:135], v[196:199], v[176:179]
 ds_read_b64_tr_b16 v[228:229], v12 offset:36864
 v_cvt_pk_bf16_f32 v65, v66, v67
 MM v[176:179], a[136:139], v[200:203], v[176:179]
 ds_read_b64_tr_b16 v[230:231], v12 offset:37376
 v_cvt_pk_bf16_f32 v66, v80, v81
 MM v[176:179], a[140:143], v[204:207], v[176:179]
 ds_read_b64_tr_b16 v[234:235], v12 offset:41472
 v_cvt_pk_bf16_f32 v67, v82, v83
 MM v[176:179], a[144:147], v[208:211], v[176:179]
 ds_read_b64_tr_b16 v[238:239], v12 offset:45568
 v_mul_f32 v68, s44, v68
 MM v[176:179], a[148:151], v[212:215], v[176:179]
 ds_read_b64_tr_b16 v[240:241], v12 offset:49152
 v_mul_f32 v69, s44, v69
 MM v[176:179], a[152:155], v[216:219], v[176:179]
 ds_read_b64_tr_b16 v[242:243], v12 offset:49664
 v_mul_f32 v70, s44, v70
 MM v[176:179], a[156:159], v[220:223], v[176:179]
 ds_read_b64_tr_b16 v[244:245], v12 offset:53248
 v_mul_f32 v71, s44, v71
 MM v[180:183], a[188:191], v[220:223], 0
 ds_read_b64_tr_b16 v[246:247], v12 offset:53760
 v_mul_f32 v84, s44, v84
 MM v[180:183], a[184:187], v[216:219], v[180:183]
 ds_read_b64_tr_b16 v[248:249], v12 offset:57344
 v_mul_f32 v85, s44, v85
 MM v[180:183], a[180:183], v[212:215], v[180:183]
 ds_read_b64_tr_b16 v[250:251], v12 offset:57856
 v_mul_f32 v86, s44, v86
 MM v[180:183], a[176:179], v[208:211], v[180:183]
 ds_read_b64_tr_b16 v[252:253], v12 offset:61440
 v_mul_f32 v87, s44, v87
 MM v[180:183], a[172:175], v[204:207], v[180:183]
 ds_read_b64_tr_b16 v[254:255], v12 offset:61952
 v_cvt_pk_bf16_f32 v68, v68, v69
 MM v[180:183], a[168:171], v[200:203], v[180:183]
 v_cvt_pk_bf16_f32 v69, v70, v71
 v_cvt_pk_bf16_f32 v70, v84, v85
 MM v[180:183], a[164:167], v[196:199], v[180:183]
 v_cvt_pk_bf16_f32 v71, v86, v87
 v_cvt_pk_bf16_f32 v160, v160, v161
 MM v[180:183], a[160:163], v[192:195], v[180:183]
 v_cvt_pk_bf16_f32 v161, v162, v163
 v_cvt_pk_bf16_f32 v162, v164, v165
 MM v[184:187], a[192:195], v[192:195], 0
 v_cvt_pk_bf16_f32 v163, v166, v167
 v_mul_f32 v72, s44, v72
 MM v[184:187], a[196:199], v[196:199], v[184:187]
 ds_write_b128 v22, v[160:163] offset:0
 MM v[184:187], a[200:203], v[200:203], v[184:187]
 v_mul_f32 v73, s44, v73
 v_mul_f32 v74, s44, v74
 MM v[184:187], a[204:207], v[204:207], v[184:187]
 v_mul_f32 v75, s44, v75
 v_mul_f32 v88, s44, v88
 MM v[184:187], a[208:211], v[208:211], v[184:187]
 v_mul_f32 v89, s44, v89
 v_mul_f32 v90, s44, v90
 MM v[184:187], a[212:215], v[212:215], v[184:187]
 v_mul_f32 v91, s44, v91
 v_cvt_pk_bf16_f32 v72, v72, v73
 MM v[184:187], a[216:219], v[216:219], v[184:187]
 v_cvt_pk_bf16_f32 v73, v74, v75
 v_cvt_pk_bf16_f32 v74, v88, v89
 MM v[184:187], a[220:223], v[220:223], v[184:187]
 v_cvt_pk_bf16_f32 v75, v90, v91
 v_mul_f32 v76, s44, v76
 MM v[188:191], a[252:255], v[220:223], 0
 v_mul_f32 v77, s44, v77
 v_mul_f32 v78, s44, v78
 MM v[188:191], a[248:251], v[216:219], v[188:191]
 v_mul_f32 v79, s44, v79
 v_mul_f32 v92, s44, v92
 MM v[188:191], a[244:247], v[212:215], v[188:191]
 v_mul_f32 v93, s44, v93
 v_mul_f32 v94, s44, v94
 MM v[188:191], a[240:243], v[208:211], v[188:191]
 v_mul_f32 v95, s44, v95
 v_cvt_pk_bf16_f32 v76, v76, v77
 MM v[188:191], a[236:239], v[204:207], v[188:191]
 ds_read_b64_tr_b16 v[204:205], v13 offset:12288
 v_cvt_pk_bf16_f32 v77, v78, v79
 MM v[188:191], a[232:235], v[200:203], v[188:191]
 ds_read_b64_tr_b16 v[200:201], v13 offset:8192
 v_cvt_pk_bf16_f32 v78, v92, v93
 MM v[188:191], a[228:231], v[196:199], v[188:191]
 ds_read_b64_tr_b16 v[196:197], v13 offset:4096
 v_cvt_pk_bf16_f32 v79, v94, v95
 MM v[188:191], a[224:227], v[192:195], v[188:191]
 s_waitcnt lgkmcnt(3)
 ds_read_b64_tr_b16 v[192:193], v13 offset:0
 v_cvt_pk_bf16_f32 v168, v168, v169
 MM v[188:191], a[96:99], v[224:227], v[188:191]
 ds_read_b64_tr_b16 v[194:195], v13 offset:512
 v_cvt_pk_bf16_f32 v169, v170, v171
 MM v[188:191], a[100:103], v[228:231], v[188:191]
 ds_read_b64_tr_b16 v[198:199], v13 offset:4608
 v_cvt_pk_bf16_f32 v170, v172, v173
 MM v[188:191], a[104:107], v[232:235], v[188:191]
 ds_read_b64_tr_b16 v[202:203], v13 offset:8704
 v_cvt_pk_bf16_f32 v171, v174, v175
 MM v[188:191], a[108:111], v[236:239], v[188:191]
 ds_read_b64_tr_b16 v[206:207], v13 offset:12800
 v_mul_f32 v96, s44, v96
 MM v[188:191], a[112:115], v[240:243], v[188:191]
 ds_read_b64_tr_b16 v[208:209], v13 offset:16384
 v_mul_f32 v97, s44, v97
 MM v[188:191], a[116:119], v[244:247], v[188:191]
 ds_read_b64_tr_b16 v[210:211], v13 offset:16896
 v_mul_f32 v98, s44, v98
 MM v[188:191], a[120:123], v[248:251], v[188:191]
 ds_read_b64_tr_b16 v[212:213], v13 offset:20480
 v_mul_f32 v99, s44, v99
 MM v[188:191], a[124:127], v[252:255], v[188:191]
 ds_read_b64_tr_b16 v[214:215], v13 offset:20992
 v_mul_f32 v112, s44, v112
 MM v[184:187], a[92:95], v[252:255], v[184:187]
 ds_read_b64_tr_b16 v[216:217], v13 offset:24576
 v_mul_f32 v113, s44, v113
 MM v[184:187], a[88:91], v[248:251], v[184:187]
 ds_read_b64_tr_b16 v[218:219], v13 offset:25088
 v_mul_f32 v114, s44, v114
 MM v[184:187], a[84:87], v[244:247], v[184:187]
 ds_read_b64_tr_b16 v[220:221], v13 offset:28672
 v_mul_f32 v115, s44, v115
 MM v[184:187], a[80:83], v[240:243], v[184:187]
 ds_read_b64_tr_b16 v[222:223], v13 offset:29184
 v_cvt_pk_bf16_f32 v96, v96, v97
 MM v[184:187], a[76:79], v[236:239], v[184:187]
 ds_write_b128 v22, v[168:171] offset:1024
 MM v[184:187], a[72:75], v[232:235], v[184:187]
 v_cvt_pk_bf16_f32 v97, v98, v99
 v_cvt_pk_bf16_f32 v98, v112, v113
 MM v[184:187], a[68:71], v[228:231], v[184:187]
 v_cvt_pk_bf16_f32 v99, v114, v115
 v_mul_f32 v100, s44, v100
 MM v[184:187], a[64:67], v[224:227], v[184:187]
 v_mul_f32 v101, s44, v101
 v_mul_f32 v102, s44, v102
 MM v[180:183], a[32:35], v[224:227], v[180:183]
 v_mul_f32 v103, s44, v103
 v_mul_f32 v116, s44, v116
 MM v[180:183], a[36:39], v[228:231], v[180:183]
 v_mul_f32 v117, s44, v117
 v_mul_f32 v118, s44, v118
 MM v[180:183], a[40:43], v[232:235], v[180:183]
 v_mul_f32 v119, s44, v119
 v_cvt_pk_bf16_f32 v100, v100, v101
 MM v[180:183], a[44:47], v[236:239], v[180:183]
 v_cvt_pk_bf16_f32 v101, v102, v103
 v_cvt_pk_bf16_f32 v102, v116, v117
 MM v[180:183], a[48:51], v[240:243], v[180:183]
 v_cvt_pk_bf16_f32 v103, v118, v119
 v_mul_f32 v104, s44, v104
 MM v[180:183], a[52:55], v[244:247], v[180:183]
 v_mul_f32 v105, s44, v105
 v_mul_f32 v106, s44, v106
 MM v[180:183], a[56:59], v[248:251], v[180:183]
 v_mul_f32 v107, s44, v107
 v_mul_f32 v120, s44, v120
 MM v[180:183], a[60:63], v[252:255], v[180:183]
 v_mul_f32 v121, s44, v121
 v_mul_f32 v122, s44, v122
 MM v[176:179], a[28:31], v[252:255], v[176:179]
 v_mul_f32 v123, s44, v123
 v_cvt_pk_bf16_f32 v104, v104, v105
 MM v[176:179], a[24:27], v[248:251], v[176:179]
 v_cvt_pk_bf16_f32 v105, v106, v107
 v_cvt_pk_bf16_f32 v106, v120, v121
 MM v[176:179], a[20:23], v[244:247], v[176:179]
 v_cvt_pk_bf16_f32 v107, v122, v123
 v_cvt_pk_bf16_f32 v184, v184, v185
 MM v[176:179], a[16:19], v[240:243], v[176:179]
 v_cvt_pk_bf16_f32 v185, v186, v187
 v_cvt_pk_bf16_f32 v186, v188, v189
 MM v[176:179], a[12:15], v[236:239], v[176:179]
 ds_read_b64_tr_b16 v[236:237], v13 offset:45056
 v_mul_f32 v108, s44, v108
 MM v[176:179], a[8:11], v[232:235], v[176:179]
 ds_read_b64_tr_b16 v[232:233], v13 offset:40960
 v_mul_f32 v109, s44, v109
 MM v[176:179], a[4:7], v[228:231], v[176:179]
 ds_read_b64_tr_b16 v[228:229], v13 offset:36864
 v_mul_f32 v110, s44, v110
 MM v[176:179], a[0:3], v[224:227], v[176:179]
 s_waitcnt lgkmcnt(3)
 ds_read_b64_tr_b16 v[224:225], v13 offset:32768
 v_mul_f32 v111, s44, v111
 MM v[160:163], a[128:131], v[192:195], 0
 ds_read_b64_tr_b16 v[226:227], v13 offset:33280
 v_mul_f32 v124, s44, v124
 MM v[160:163], a[132:135], v[196:199], v[160:163]
 ds_read_b64_tr_b16 v[230:231], v13 offset:37376
 v_mul_f32 v125, s44, v125
 MM v[160:163], a[136:139], v[200:203], v[160:163]
 ds_read_b64_tr_b16 v[234:235], v13 offset:41472
 v_mul_f32 v126, s44, v126
 MM v[160:163], a[140:143], v[204:207], v[160:163]
 ds_read_b64_tr_b16 v[238:239], v13 offset:45568
 v_mul_f32 v127, s44, v127
 MM v[160:163], a[144:147], v[208:211], v[160:163]
 ds_read_b64_tr_b16 v[240:241], v13 offset:49152
 v_cvt_pk_bf16_f32 v108, v108, v109
 MM v[160:163], a[148:151], v[212:215], v[160:163]
 ds_read_b64_tr_b16 v[242:243], v13 offset:49664
 v_cvt_pk_bf16_f32 v109, v110, v111
 MM v[160:163], a[152:155], v[216:219], v[160:163]
 ds_read_b64_tr_b16 v[244:245], v13 offset:53248
 v_cvt_pk_bf16_f32 v110, v124, v125
 MM v[160:163], a[156:159], v[220:223], v[160:163]
 ds_read_b64_tr_b16 v[246:247], v13 offset:53760
 v_cvt_pk_bf16_f32 v111, v126, v127
 MM v[164:167], a[188:191], v[220:223], 0
 ds_read_b64_tr_b16 v[248:249], v13 offset:57344
 v_cvt_pk_bf16_f32 v176, v176, v177
 MM v[164:167], a[184:187], v[216:219], v[164:167]
 ds_read_b64_tr_b16 v[250:251], v13 offset:57856
 v_cvt_pk_bf16_f32 v177, v178, v179
 MM v[164:167], a[180:183], v[212:215], v[164:167]
 ds_read_b64_tr_b16 v[252:253], v13 offset:61440
 v_cvt_pk_bf16_f32 v178, v180, v181
 MM v[164:167], a[176:179], v[208:211], v[164:167]
 ds_read_b64_tr_b16 v[254:255], v13 offset:61952
 v_cvt_pk_bf16_f32 v179, v182, v183
 MM v[164:167], a[172:175], v[204:207], v[164:167]
 ds_write_b128 v22, v[176:179] offset:2048
 MM v[164:167], a[168:171], v[200:203], v[164:167]
 v_mul_f32 v128, s44, v128
 v_mul_f32 v129, s44, v129
 MM v[164:167], a[164:167], v[196:199], v[164:167]
 v_mul_f32 v130, s44, v130
 v_mul_f32 v131, s44, v131
 MM v[164:167], a[160:163], v[192:195], v[164:167]
 v_mul_f32 v144, s44, v144
 v_mul_f32 v145, s44, v145
 MM v[168:171], a[192:195], v[192:195], 0
 v_mul_f32 v146, s44, v146
 v_mul_f32 v147, s44, v147
 MM v[168:171], a[196:199], v[196:199], v[168:171]
 v_cvt_pk_bf16_f32 v128, v128, v129
 v_cvt_pk_bf16_f32 v129, v130, v131
 MM v[168:171], a[200:203], v[200:203], v[168:171]
 v_cvt_pk_bf16_f32 v130, v144, v145
 v_cvt_pk_bf16_f32 v131, v146, v147
 MM v[168:171], a[204:207], v[204:207], v[168:171]
 v_cvt_pk_bf16_f32 v187, v190, v191
 v_mul_f32 v132, s44, v132
 MM v[168:171], a[208:211], v[208:211], v[168:171]
 ds_write_b128 v22, v[184:187] offset:3072
 MM v[168:171], a[212:215], v[212:215], v[168:171]
 v_mul_f32 v133, s44, v133
 v_mul_f32 v134, s44, v134
 MM v[168:171], a[216:219], v[216:219], v[168:171]
 v_mul_f32 v135, s44, v135
 v_mul_f32 v148, s44, v148
 MM v[168:171], a[220:223], v[220:223], v[168:171]
 v_mul_f32 v149, s44, v149
 v_mul_f32 v150, s44, v150
 MM v[172:175], a[252:255], v[220:223], 0
 v_mul_f32 v151, s44, v151
 v_cvt_pk_bf16_f32 v132, v132, v133
 MM v[172:175], a[248:251], v[216:219], v[172:175]
 v_cvt_pk_bf16_f32 v133, v134, v135
 v_cvt_pk_bf16_f32 v134, v148, v149
 MM v[172:175], a[244:247], v[212:215], v[172:175]
 v_cvt_pk_bf16_f32 v135, v150, v151
 v_mul_f32 v136, s44, v136
 MM v[172:175], a[240:243], v[208:211], v[172:175]
 v_mul_f32 v137, s44, v137
 v_mul_f32 v138, s44, v138
 MM v[172:175], a[236:239], v[204:207], v[172:175]
 ds_read_b64_tr_b16 v[204:205], v14 offset:12288
 v_mul_f32 v139, s44, v139
 MM v[172:175], a[232:235], v[200:203], v[172:175]
 ds_read_b64_tr_b16 v[200:201], v14 offset:8192
 v_mul_f32 v152, s44, v152
 MM v[172:175], a[228:231], v[196:199], v[172:175]
 ds_read_b64_tr_b16 v[196:197], v14 offset:4096
 v_mul_f32 v153, s44, v153
 MM v[172:175], a[224:227], v[192:195], v[172:175]
 s_waitcnt lgkmcnt(3)
 ds_read_b64_tr_b16 v[192:193], v14 offset:0
 v_mul_f32 v154, s44, v154
 MM v[172:175], a[96:99], v[224:227], v[172:175]
 ds_read_b64_tr_b16 v[194:195], v14 offset:512
 v_mul_f32 v155, s44, v155
 MM v[172:175], a[100:103], v[228:231], v[172:175]
 ds_read_b64_tr_b16 v[198:199], v14 offset:4608
 v_cvt_pk_bf16_f32 v136, v136, v137
 MM v[172:175], a[104:107], v[232:235], v[172:175]
 ds_read_b64_tr_b16 v[202:203], v14 offset:8704
 v_cvt_pk_bf16_f32 v137, v138, v139
 MM v[172:175], a[108:111], v[236:239], v[172:175]
 ds_read_b64_tr_b16 v[206:207], v14 offset:12800
 v_cvt_pk_bf16_f32 v138, v152, v153
 MM v[172:175], a[112:115], v[240:243], v[172:175]
 ds_read_b64_tr_b16 v[208:209], v14 offset:16384
 v_cvt_pk_bf16_f32 v139, v154, v155
 MM v[172:175], a[116:119], v[244:247], v[172:175]
 ds_read_b64_tr_b16 v[210:211], v14 offset:16896
 v_mul_f32 v140, s44, v140
 MM v[172:175], a[120:123], v[248:251], v[172:175]
 ds_read_b64_tr_b16 v[212:213], v14 offset:20480
 v_mul_f32 v141, s44, v141
 MM v[172:175], a[124:127], v[252:255], v[172:175]
 ds_read_b64_tr_b16 v[214:215], v14 offset:20992
 v_mul_f32 v142, s44, v142
 MM v[168:171], a[92:95], v[252:255], v[168:171]
 ds_read_b64_tr_b16 v[216:217], v14 offset:24576
 v_mul_f32 v143, s44, v143
 MM v[168:171], a[88:91], v[248:251], v[168:171]
 ds_read_b64_tr_b16 v[218:219], v14 offset:25088
 v_mul_f32 v156, s44, v156
 MM v[168:171], a[84:87], v[244:247], v[168:171]
 ds_read_b64_tr_b16 v[220:221], v14 offset:28672
 v_mul_f32 v157, s44, v157
 MM v[168:171], a[80:83], v[240:243], v[168:171]
 ds_read_b64_tr_b16 v[222:223], v14 offset:29184
 v_mul_f32 v158, s44, v158
 MM v[168:171], a[76:79], v[236:239], v[168:171]
 v_mul_f32 v159, s44, v159
 v_cvt_pk_bf16_f32 v140, v140, v141
 MM v[168:171], a[72:75], v[232:235], v[168:171]
 v_cvt_pk_bf16_f32 v141, v142, v143
 v_cvt_pk_bf16_f32 v142, v156, v157
 MM v[168:171], a[68:71], v[228:231], v[168:171]
 v_cvt_pk_bf16_f32 v143, v158, v159
 v_lshrrev_b32 v25, 4, v1
 MM v[168:171], a[64:67], v[224:227], v[168:171]
 s_and_b32 s94, s2, 7
 s_lshl_b32 s25, s94, 2
 s_bfe_u32 s93, s2, 0x20003
 MM v[164:167], a[32:35], v[224:227], v[164:167]
 s_add_u32 s25, s25, s93
 s_lshr_b32 s26, s2, 5
 s_mul_i32 s27, s94, 3
 MM v[164:167], a[36:39], v[228:231], v[164:167]
 s_add_u32 s27, s27, s93
 s_add_u32 s95, s94, s26
 s_and_b32 s95, s95, 7
 MM v[164:167], a[40:43], v[232:235], v[164:167]
 s_add_u32 s92, s95, 19
 s_mul_i32 s63, s26, 5
 s_add_u32 s63, s63, s95
 MM v[164:167], a[44:47], v[236:239], v[164:167]
 s_cmp_eq_u32 s93, 3
 s_cselect_b32 s27, s92, s27
 s_cselect_b32 s62, s95, 7
 MM v[164:167], a[48:51], v[240:243], v[164:167]
 s_lshl_b32 s47, s24, 12
 s_lshl_b32 s45, s25, 8
 s_lshl_b32 s92, s24, 18
 MM v[164:167], a[52:55], v[244:247], v[164:167]
 s_add_u32 s45, s45, s92
 s_lshl_b32 s46, s27, 7
 s_mul_i32 s92, s24, 110592
 MM v[164:167], a[56:59], v[248:251], v[164:167]
 s_add_u32 s46, s46, s92
 s_sub_u32 s93, 15, s26
 s_lshl_b32 s94, s24, 10
 MM v[164:167], a[60:63], v[252:255], v[164:167]
 s_lshl_b32 s95, s25, 14
 s_add_u32 s94, s94, s95
 s_add_u32 s94, s94, 37748736
 MM v[160:163], a[28:31], v[252:255], v[160:163]
 s_lshl_b32 s92, s26, 1
 s_add_u32 s92, s92, 0
 s_mul_i32 s32, s92, 745472
 MM v[160:163], a[24:27], v[248:251], v[160:163]
 s_add_u32 s32, s32, s94
 s_lshl_b32 s92, s92, 2
 s_add_u32 s92, s92, s24
 MM v[160:163], a[20:23], v[244:247], v[160:163]
 s_mul_i32 s36, s92, 20480
 s_lshl_b32 s92, s26, 1
 s_add_u32 s92, s92, 1
 MM v[160:163], a[16:19], v[240:243], v[160:163]
 s_mul_i32 s33, s92, 745472
 s_add_u32 s33, s33, s94
 s_lshl_b32 s92, s92, 2
 MM v[160:163], a[12:15], v[236:239], v[160:163]
 s_add_u32 s92, s92, s24
 s_mul_i32 s37, s92, 20480
 ds_read_b64_tr_b16 v[236:237], v14 offset:45056
 MM v[160:163], a[8:11], v[232:235], v[160:163]
 s_lshl_b32 s92, s93, 1
 s_add_u32 s92, s92, 0
 ds_read_b64_tr_b16 v[232:233], v14 offset:40960
 MM v[160:163], a[4:7], v[228:231], v[160:163]
 s_mul_i32 s34, s92, 745472
 s_add_u32 s34, s34, s94
 ds_read_b64_tr_b16 v[228:229], v14 offset:36864
 MM v[160:163], a[0:3], v[224:227], v[160:163]
 s_lshl_b32 s92, s92, 2
 s_add_u32 s92, s92, s24
 ds_read_b64_tr_b16 v[224:225], v14 offset:32768
 s_waitcnt lgkmcnt(4)
 MM v[176:179], a[128:131], v[192:195], 0
 s_mul_i32 s38, s92, 20480
 s_lshl_b32 s92, s93, 1
 ds_read_b64_tr_b16 v[226:227], v14 offset:33280
 MM v[176:179], a[132:135], v[196:199], v[176:179]
 s_add_u32 s92, s92, 1
 s_mul_i32 s35, s92, 745472
 ds_read_b64_tr_b16 v[230:231], v14 offset:37376
 MM v[176:179], a[136:139], v[200:203], v[176:179]
 s_add_u32 s35, s35, s94
 s_lshl_b32 s92, s92, 2
 ds_read_b64_tr_b16 v[234:235], v14 offset:41472
 MM v[176:179], a[140:143], v[204:207], v[176:179]
 s_add_u32 s92, s92, s24
 s_mul_i32 s39, s92, 20480
 ds_read_b64_tr_b16 v[238:239], v14 offset:45568
 MM v[176:179], a[144:147], v[208:211], v[176:179]
 s_lshl_b32 s27, s27, 13
 s_add_u32 s27, s27, 524288
 ds_read_b64_tr_b16 v[240:241], v14 offset:49152
 MM v[176:179], a[148:151], v[212:215], v[176:179]
 s_sub_u32 s27, s27, s95
 s_lshl_b32 s92, s25, 19
 ds_read_b64_tr_b16 v[242:243], v14 offset:49664
 MM v[176:179], a[152:155], v[216:219], v[176:179]
 s_add_u32 s94, s92, 4194304
 ds_read_b64_tr_b16 v[244:245], v14 offset:53248
 v_cvt_pk_bf16_f32 v168, v168, v169
 MM v[176:179], a[156:159], v[220:223], v[176:179]
 ds_read_b64_tr_b16 v[246:247], v14 offset:53760
 v_cvt_pk_bf16_f32 v160, v160, v161
 MM v[180:183], a[188:191], v[220:223], 0
 ds_read_b64_tr_b16 v[248:249], v14 offset:57344
 v_cvt_pk_bf16_f32 v161, v162, v163
 MM v[180:183], a[184:187], v[216:219], v[180:183]
 ds_read_b64_tr_b16 v[250:251], v14 offset:57856
 v_cvt_pk_bf16_f32 v162, v164, v165
 MM v[180:183], a[180:183], v[212:215], v[180:183]
 ds_read_b64_tr_b16 v[252:253], v14 offset:61440
 v_cvt_pk_bf16_f32 v163, v166, v167
 MM v[180:183], a[176:179], v[208:211], v[180:183]
 ds_read_b64_tr_b16 v[254:255], v14 offset:61952
 v_cvt_pk_bf16_f32 v169, v170, v171
 MM v[180:183], a[172:175], v[204:207], v[180:183]
 s_add_u32 s4, s16, s94
 s_addc_u32 s5, s17, 0
 MM v[180:183], a[168:171], v[200:203], v[180:183]
 s_add_u32 s94, s92, 20971520
 v_cvt_pk_bf16_f32 v170, v172, v173
 v_cvt_pk_bf16_f32 v171, v174, v175
 MM v[180:183], a[164:167], v[196:199], v[180:183]
 s_add_u32 s8, s16, s94
 s_addc_u32 s9, s17, 0
 MM v[180:183], a[160:163], v[192:195], v[180:183]
 s_add_u32 s93, s93, 1
 s_lshl_b32 s6, s93, 15
 s_mov_b32 s10, s6
 MM v[184:187], a[192:195], v[192:195], 0
 buffer_store_dwordx4 v[32:35], v1, s[16:19], s84 offen offset:0 sc1
 MM v[184:187], a[196:199], v[196:199], v[184:187]
 s_mov_b32 s28, s47
 s_mov_b32 s29, s47
 s_mov_b32 s31, s47
 MM v[184:187], a[200:203], v[200:203], v[184:187]
 s_add_u32 s30, s47, 0x10000
 v_lshrrev_b32 v26, 3, v25
 v_mul_u32_u24 v26, 3456, v26
 MM v[184:187], a[204:207], v[204:207], v[184:187]
 v_and_b32 v27, 0x7f, v7
 v_add_u32 v9, v26, v27
 MM v[184:187], a[208:211], v[208:211], v[184:187]
 v_xor_b32 v27, 64, v27
 v_add_u32 v10, v26, v27
 MM v[184:187], a[212:215], v[212:215], v[184:187]
 v_mov_b32 v3, v1
 v_add_u32 v2, 0x10000, v1
 MM v[184:187], a[216:219], v[216:219], v[184:187]
 v_mov_b32 v4, 0xf149f2ca
 v_and_b32 v26, 15, v25
 MM v[184:187], a[220:223], v[220:223], v[184:187]
 v_lshrrev_b32 v27, 4, v25
 v_lshlrev_b32 v27, 2, v27
 MM v[188:191], a[252:255], v[220:223], 0
 s_lshl_b32 s92, s24, 4
 v_add_u32 v5, s92, v26
 v_sub_u32 v5, v5, v27
 MM v[188:191], a[248:251], v[216:219], v[188:191]
 v_lshrrev_b32 v6, 2, v26
 v_add_u32 v6, v27, v6
 MM v[188:191], a[244:247], v[212:215], v[188:191]
 v_mul_u32_u24 v6, 640, v6
 v_and_b32 v26, 3, v26
 MM v[188:191], a[240:243], v[208:211], v[188:191]
 v_lshl_add_u32 v6, v26, 3, v6
 s_mul_i32 s92, s24, 160
 MM v[188:191], a[236:239], v[204:207], v[188:191]
 s_add_u32 s92, s92, 0x20000
 v_add_u32 v0, s92, v6
 v_and_b32 v26, 15, v25
 MM v[188:191], a[232:235], v[200:203], v[188:191]
 s_waitcnt lgkmcnt(0)
 v_lshlrev_b32 v26, 2, v26
 v_bfe_u32 v27, v25, 4, 1
 MM v[188:191], a[228:231], v[196:199], v[188:191]
 s_waitcnt vmcnt(5)
 s_barrier
 s_lshl_b32 s92, s26, 1
 MM v[188:191], a[224:227], v[192:195], v[188:191]
 s_sub_u32 s92, 15, s92
 v_mul_u32_u24 v27, s92, v27
 v_add_u32 v27, s26, v27
 MM v[188:191], a[96:99], v[224:227], v[188:191]
 v_lshl_add_u32 v26, v27, 8, v26
 v_add_u32 v26, 70713344, v26
 MM v[188:191], a[100:103], v[228:231], v[188:191]
 v_and_b32 v23, 7, v25
 v_lshlrev_b32 v23, 2, v23
 MM v[188:191], a[104:107], v[232:235], v[188:191]
 s_lshl_b32 s92, s25, 8
 s_add_u32 s92, s92, 70717440
 ds_read_b64_tr_b16 v[192:193], v15 offset:0
 MM v[188:191], a[108:111], v[236:239], v[188:191]
 ds_read_b64_tr_b16 v[194:195], v15 offset:512
 v_add_u32 v23, s92, v23
 MM v[188:191], a[112:115], v[240:243], v[188:191]
 s_mov_b32 s67, 0x20000
 ds_read_b64_tr_b16 v[196:197], v15 offset:4096
 ds_read_b64_tr_b16 v[198:199], v15 offset:4608
 MM v[188:191], a[116:119], v[244:247], v[188:191]
 s_mov_b32 s71, 0x20000
 ds_read_b64_tr_b16 v[200:201], v15 offset:8192
 ds_read_b64_tr_b16 v[202:203], v15 offset:8704
 MM v[188:191], a[120:123], v[248:251], v[188:191]
 s_mov_b32 s75, 26624
 ds_read_b64_tr_b16 v[204:205], v15 offset:12288
 ds_read_b64_tr_b16 v[206:207], v15 offset:12800
 MM v[188:191], a[124:127], v[252:255], v[188:191]
 ds_read_b64_tr_b16 v[208:209], v15 offset:16384
 ds_read_b64_tr_b16 v[210:211], v15 offset:16896
 MM v[184:187], a[92:95], v[252:255], v[184:187]
 ds_read_b64_tr_b16 v[212:213], v15 offset:20480
 ds_read_b64_tr_b16 v[214:215], v15 offset:20992
 MM v[184:187], a[88:91], v[248:251], v[184:187]
 ds_read_b64_tr_b16 v[216:217], v15 offset:24576
 ds_read_b64_tr_b16 v[218:219], v15 offset:25088
 MM v[184:187], a[84:87], v[244:247], v[184:187]
 ds_read_b64_tr_b16 v[220:221], v15 offset:28672
 ds_read_b64_tr_b16 v[222:223], v15 offset:29184
 MM v[184:187], a[80:83], v[240:243], v[184:187]
 ds_write_b128 v22, v[160:163] offset:4096
 MM v[184:187], a[76:79], v[236:239], v[184:187]
 ds_write_b128 v22, v[168:171] offset:5120
 MM v[184:187], a[72:75], v[232:235], v[184:187]
 MM v[184:187], a[68:71], v[228:231], v[184:187]
 s_cmp_lt_u32 s62, 5
 s_cselect_b32 s64, s48, s20
 s_cselect_b32 s68, s48, s52
 s_cselect_b32 s65, s49, s21
 s_cselect_b32 s69, s49, s53
 s_cselect_b32 s66, s50, s22
 s_cselect_b32 s70, s50, s54
 s_cselect_b32 s72, s45, s46
 s_cselect_b32 s73, 64512, s75
 s_cselect_b32 s74, 64, 0
 s_cselect_b64 vcc, -1, 0
 v_cndmask_b32 v20, v9, v7, vcc
 v_cndmask_b32 v21, v10, v8, vcc
 MM v[184:187], a[64:67], v[224:227], v[184:187]
 MM v[180:183], a[32:35], v[224:227], v[180:183]
 buffer_store_dwordx4 v[36:39], v1, s[16:19], s85 offen offset:0 sc1
 MM v[180:183], a[36:39], v[228:231], v[180:183]
 s_lshl_b32 s74, s74, 1
 s_add_u32 s74, s74, s72
 MM v[180:183], a[40:43], v[232:235], v[180:183]
 MM v[180:183], a[44:47], v[236:239], v[180:183]
 MM v[180:183], a[48:51], v[240:243], v[180:183]
 MM v[180:183], a[52:55], v[244:247], v[180:183]
 MM v[180:183], a[56:59], v[248:251], v[180:183]
 MM v[180:183], a[60:63], v[252:255], v[180:183]
 v_cvt_pk_bf16_f32 v184, v184, v185
 v_cvt_pk_bf16_f32 v185, v186, v187
 MM v[176:179], a[28:31], v[252:255], v[176:179]
 v_cvt_pk_bf16_f32 v186, v188, v189
 v_cvt_pk_bf16_f32 v187, v190, v191
 MM v[176:179], a[24:27], v[248:251], v[176:179]
 ds_write_b128 v22, v[184:187] offset:7168
 MM v[176:179], a[20:23], v[244:247], v[176:179]
 MM v[176:179], a[16:19], v[240:243], v[176:179]
 MM v[176:179], a[12:15], v[236:239], v[176:179]
 ds_read_b64_tr_b16 v[236:237], v16 offset:12288
 ds_read_b64_tr_b16 v[238:239], v16 offset:12800
 MM v[176:179], a[8:11], v[232:235], v[176:179]
 ds_read_b64_tr_b16 v[232:233], v16 offset:8192
 ds_read_b64_tr_b16 v[234:235], v16 offset:8704
 MM v[176:179], a[4:7], v[228:231], v[176:179]
 ds_read_b64_tr_b16 v[228:229], v16 offset:4096
 ds_read_b64_tr_b16 v[230:231], v16 offset:4608
 MM v[176:179], a[0:3], v[224:227], v[176:179]
 s_waitcnt lgkmcnt(7)
 ds_read_b64_tr_b16 v[224:225], v16 offset:0
 ds_read_b64_tr_b16 v[226:227], v16 offset:512
 MM v[80:83], a[128:131], v[192:195], 0
 ds_read_b64_tr_b16 v[240:241], v16 offset:16384
 ds_read_b64_tr_b16 v[242:243], v16 offset:16896
 MM v[80:83], a[132:135], v[196:199], v[80:83]
 ds_read_b64_tr_b16 v[244:245], v16 offset:20480
 ds_read_b64_tr_b16 v[246:247], v16 offset:20992
 MM v[80:83], a[136:139], v[200:203], v[80:83]
 ds_read_b64_tr_b16 v[248:249], v16 offset:24576
 ds_read_b64_tr_b16 v[250:251], v16 offset:25088
 MM v[80:83], a[140:143], v[204:207], v[80:83]
 ds_read_b64_tr_b16 v[252:253], v16 offset:28672
 ds_read_b64_tr_b16 v[254:255], v16 offset:29184
 MM v[80:83], a[144:147], v[208:211], v[80:83]
 MM v[80:83], a[148:151], v[212:215], v[80:83]
 MM v[80:83], a[152:155], v[216:219], v[80:83]
 MM v[80:83], a[156:159], v[220:223], v[80:83]
 v_cvt_pk_bf16_f32 v176, v176, v177
 v_cvt_pk_bf16_f32 v177, v178, v179
 MM v[84:87], a[188:191], v[220:223], 0
 s_barrier
 v_cvt_pk_bf16_f32 v178, v180, v181
 v_cvt_pk_bf16_f32 v179, v182, v183
 MM v[84:87], a[184:187], v[216:219], v[84:87]
 ds_write_b128 v22, v[176:179] offset:6144
 MM v[84:87], a[180:183], v[212:215], v[84:87]
 MM v[84:87], a[176:179], v[208:211], v[84:87]
 MM v[84:87], a[172:175], v[204:207], v[84:87]
 MM v[84:87], a[168:171], v[200:203], v[84:87]
 MM v[84:87], a[164:167], v[196:199], v[84:87]
 s_add_u32 m0, s47, 0
 MM v[84:87], a[160:163], v[192:195], v[84:87]
 MM v[88:91], a[192:195], v[192:195], 0
 buffer_store_dwordx4 v[40:43], v1, s[16:19], s86 offen offset:0 sc1
 MM v[88:91], a[196:199], v[196:199], v[88:91]
 MM v[88:91], a[200:203], v[200:203], v[88:91]
 buffer_load_dwordx4 v20, s[64:67], s72 offen offset:0 lds
 MM v[88:91], a[204:207], v[204:207], v[88:91]
 MM v[88:91], a[208:211], v[208:211], v[88:91]
 s_add_u32 s72, s72, s73
 MM v[88:91], a[212:215], v[212:215], v[88:91]
 MM v[88:91], a[216:219], v[216:219], v[88:91]
 MM v[88:91], a[220:223], v[220:223], v[88:91]
 MM v[92:95], a[252:255], v[220:223], 0
 buffer_load_dwordx4 v21, s[64:67], s72 offen offset:1024 lds
 MM v[92:95], a[248:251], v[216:219], v[92:95]
 MM v[92:95], a[244:247], v[212:215], v[92:95]
 s_add_u32 s72, s72, s73
 MM v[92:95], a[240:243], v[208:211], v[92:95]
 MM v[92:95], a[236:239], v[204:207], v[92:95]
 ds_read_b64_tr_b16 v[204:205], v17 offset:12288
 ds_read_b64_tr_b16 v[206:207], v17 offset:12800
 MM v[92:95], a[232:235], v[200:203], v[92:95]
 ds_read_b64_tr_b16 v[200:201], v17 offset:8192
 ds_read_b64_tr_b16 v[202:203], v17 offset:8704
 MM v[92:95], a[228:231], v[196:199], v[92:95]
 buffer_load_dwordx4 v20, s[64:67], s72 offen offset:2048 lds
 MM v[92:95], a[224:227], v[192:195], v[92:95]
 s_waitcnt lgkmcnt(4)
 ds_read_b64_tr_b16 v[192:193], v17 offset:0
 ds_read_b64_tr_b16 v[194:195], v17 offset:512
 MM v[124:127], a[224:227], v[224:227], 0
 buffer_load_dword v24, v26, s[16:19], 0 offen sc1
 MM v[124:127], a[228:231], v[228:231], v[124:127]
 s_add_u32 s72, s72, s73
 ds_read_b64_tr_b16 v[196:197], v17 offset:4096
 ds_read_b64_tr_b16 v[198:199], v17 offset:4608
 MM v[124:127], a[232:235], v[232:235], v[124:127]
 ds_read_b64_tr_b16 v[208:209], v17 offset:16384
 ds_read_b64_tr_b16 v[210:211], v17 offset:16896
 MM v[124:127], a[236:239], v[236:239], v[124:127]
 ds_read_b64_tr_b16 v[212:213], v17 offset:20480
 ds_read_b64_tr_b16 v[214:215], v17 offset:20992
 MM v[124:127], a[240:243], v[240:243], v[124:127]
 buffer_load_dwordx4 v21, s[64:67], s72 offen offset:3072 lds
 MM v[124:127], a[244:247], v[244:247], v[124:127]
 ds_read_b64_tr_b16 v[216:217], v17 offset:24576
 ds_read_b64_tr_b16 v[218:219], v17 offset:25088
 MM v[124:127], a[248:251], v[248:251], v[124:127]
 s_add_u32 m0, s47, 16384
 ds_read_b64_tr_b16 v[220:221], v17 offset:28672
 ds_read_b64_tr_b16 v[222:223], v17 offset:29184
 MM v[124:127], a[252:255], v[252:255], v[124:127]
 MM v[120:123], a[220:223], v[252:255], 0
 MM v[120:123], a[216:219], v[248:251], v[120:123]
 MM v[120:123], a[212:215], v[244:247], v[120:123]
 buffer_load_dwordx4 v20, s[68:71], s74 offen offset:0 lds
 MM v[120:123], a[208:211], v[240:243], v[120:123]
 MM v[120:123], a[204:207], v[236:239], v[120:123]
 s_add_u32 s74, s74, s73
 MM v[120:123], a[200:203], v[232:235], v[120:123]
 MM v[120:123], a[196:199], v[228:231], v[120:123]
 MM v[120:123], a[192:195], v[224:227], v[120:123]
 MM v[116:119], a[160:163], v[224:227], 0
 buffer_store_dwordx4 v[44:47], v1, s[16:19], s87 offen offset:0 sc1
 MM v[116:119], a[164:167], v[228:231], v[116:119]
 buffer_load_dwordx4 v21, s[68:71], s74 offen offset:1024 lds
 MM v[116:119], a[168:171], v[232:235], v[116:119]
 s_add_u32 s74, s74, s73
 MM v[116:119], a[172:175], v[236:239], v[116:119]
 MM v[116:119], a[176:179], v[240:243], v[116:119]
 MM v[116:119], a[180:183], v[244:247], v[116:119]
 MM v[116:119], a[184:187], v[248:251], v[116:119]
 buffer_load_dwordx4 v20, s[68:71], s74 offen offset:2048 lds
 MM v[116:119], a[188:191], v[252:255], v[116:119]
 MM v[112:115], a[156:159], v[252:255], 0
 s_add_u32 s74, s74, s73
 MM v[112:115], a[152:155], v[248:251], v[112:115]
 MM v[112:115], a[148:151], v[244:247], v[112:115]
 MM v[112:115], a[144:147], v[240:243], v[112:115]
 MM v[112:115], a[140:143], v[236:239], v[112:115]
 buffer_load_dwordx4 v21, s[68:71], s74 offen offset:3072 lds
 MM v[112:115], a[136:139], v[232:235], v[112:115]
 ds_read_b64_tr_b16 v[232:233], v18 offset:8192
 ds_read_b64_tr_b16 v[234:235], v18 offset:8704
 MM v[112:115], a[132:135], v[228:231], v[112:115]
 ds_read_b64_tr_b16 v[228:229], v18 offset:4096
 ds_read_b64_tr_b16 v[230:231], v18 offset:4608
 MM v[112:115], a[128:131], v[224:227], v[112:115]
 s_waitcnt lgkmcnt(4)
 ds_read_b64_tr_b16 v[224:225], v18 offset:0
 ds_read_b64_tr_b16 v[226:227], v18 offset:512
 MM v[160:163], a[128:131], v[192:195], 0
 ds_read_b64_tr_b16 v[236:237], v18 offset:12288
 ds_read_b64_tr_b16 v[238:239], v18 offset:12800
 MM v[160:163], a[132:135], v[196:199], v[160:163]
 ds_read_b64_tr_b16 v[240:241], v18 offset:16384
 ds_read_b64_tr_b16 v[242:243], v18 offset:16896
 MM v[160:163], a[136:139], v[200:203], v[160:163]
 ds_read_b64_tr_b16 v[244:245], v18 offset:20480
 ds_read_b64_tr_b16 v[246:247], v18 offset:20992
 MM v[160:163], a[140:143], v[204:207], v[160:163]
 ds_read_b64_tr_b16 v[248:249], v18 offset:24576
 ds_read_b64_tr_b16 v[250:251], v18 offset:25088
 MM v[160:163], a[144:147], v[208:211], v[160:163]
 ds_read_b64_tr_b16 v[252:253], v18 offset:28672
 ds_read_b64_tr_b16 v[254:255], v18 offset:29184
 MM v[160:163], a[148:151], v[212:215], v[160:163]
 MM v[160:163], a[152:155], v[216:219], v[160:163]
 MM v[160:163], a[156:159], v[220:223], v[160:163]
 MM v[164:167], a[188:191], v[220:223], 0
 MM v[164:167], a[184:187], v[216:219], v[164:167]
 MM v[164:167], a[180:183], v[212:215], v[164:167]
 MM v[164:167], a[176:179], v[208:211], v[164:167]
 MM v[164:167], a[172:175], v[204:207], v[164:167]
 MM v[164:167], a[168:171], v[200:203], v[164:167]
 MM v[164:167], a[164:167], v[196:199], v[164:167]
 MM v[164:167], a[160:163], v[192:195], v[164:167]
 MM v[168:171], a[192:195], v[192:195], 0
 buffer_store_dwordx4 v[64:67], v1, s[16:19], s84 offen offset:1024 sc1
 MM v[168:171], a[196:199], v[196:199], v[168:171]
 MM v[168:171], a[200:203], v[200:203], v[168:171]
 MM v[168:171], a[204:207], v[204:207], v[168:171]
 MM v[168:171], a[208:211], v[208:211], v[168:171]
 MM v[168:171], a[212:215], v[212:215], v[168:171]
 MM v[168:171], a[216:219], v[216:219], v[168:171]
 MM v[168:171], a[220:223], v[220:223], v[168:171]
 MM v[172:175], a[252:255], v[220:223], 0
 MM v[172:175], a[248:251], v[216:219], v[172:175]
 MM v[172:175], a[244:247], v[212:215], v[172:175]
 MM v[172:175], a[240:243], v[208:211], v[172:175]
 MM v[172:175], a[236:239], v[204:207], v[172:175]
 ds_read_b64_tr_b16 v[204:205], v15 offset:45056
 ds_read_b64_tr_b16 v[206:207], v15 offset:45568
 MM v[172:175], a[232:235], v[200:203], v[172:175]
 ds_read_b64_tr_b16 v[200:201], v15 offset:40960
 ds_read_b64_tr_b16 v[202:203], v15 offset:41472
 MM v[172:175], a[228:231], v[196:199], v[172:175]
 ds_read_b64_tr_b16 v[196:197], v15 offset:36864
 ds_read_b64_tr_b16 v[198:199], v15 offset:37376
 MM v[172:175], a[224:227], v[192:195], v[172:175]
 s_waitcnt lgkmcnt(6)
 ds_read_b64_tr_b16 v[192:193], v15 offset:32768
 ds_read_b64_tr_b16 v[194:195], v15 offset:33280
 MM v[188:191], a[224:227], v[224:227], 0
 ds_read_b64_tr_b16 v[208:209], v15 offset:49152
 ds_read_b64_tr_b16 v[210:211], v15 offset:49664
 MM v[188:191], a[228:231], v[228:231], v[188:191]
 ds_read_b64_tr_b16 v[212:213], v15 offset:53248
 ds_read_b64_tr_b16 v[214:215], v15 offset:53760
 MM v[188:191], a[232:235], v[232:235], v[188:191]
 ds_read_b64_tr_b16 v[216:217], v15 offset:57344
 ds_read_b64_tr_b16 v[218:219], v15 offset:57856
 MM v[188:191], a[236:239], v[236:239], v[188:191]
 ds_read_b64_tr_b16 v[220:221], v15 offset:61440
 ds_read_b64_tr_b16 v[222:223], v15 offset:61952
 MM v[188:191], a[240:243], v[240:243], v[188:191]
 MM v[188:191], a[244:247], v[244:247], v[188:191]
 MM v[188:191], a[248:251], v[248:251], v[188:191]
 MM v[188:191], a[252:255], v[252:255], v[188:191]
 MM v[184:187], a[220:223], v[252:255], 0
 MM v[184:187], a[216:219], v[248:251], v[184:187]
 MM v[184:187], a[212:215], v[244:247], v[184:187]
 MM v[184:187], a[208:211], v[240:243], v[184:187]
 MM v[184:187], a[204:207], v[236:239], v[184:187]
 MM v[184:187], a[200:203], v[232:235], v[184:187]
 MM v[184:187], a[196:199], v[228:231], v[184:187]
 MM v[184:187], a[192:195], v[224:227], v[184:187]
 MM v[180:183], a[160:163], v[224:227], 0
 buffer_store_dwordx4 v[68:71], v1, s[16:19], s85 offen offset:1024 sc1
 MM v[180:183], a[164:167], v[228:231], v[180:183]
 MM v[180:183], a[168:171], v[232:235], v[180:183]
 MM v[180:183], a[172:175], v[236:239], v[180:183]
 MM v[180:183], a[176:179], v[240:243], v[180:183]
 MM v[180:183], a[180:183], v[244:247], v[180:183]
 MM v[180:183], a[184:187], v[248:251], v[180:183]
 MM v[180:183], a[188:191], v[252:255], v[180:183]
 MM v[176:179], a[156:159], v[252:255], 0
 s_waitcnt vmcnt(8)
 v_cmp_ne_u32 vcc, s61, v24
 s_cbranch_vccnz spin1
spun1:
 MM v[176:179], a[152:155], v[248:251], v[176:179]
 MM v[176:179], a[148:151], v[244:247], v[176:179]
 MM v[176:179], a[144:147], v[240:243], v[176:179]
 MM v[176:179], a[140:143], v[236:239], v[176:179]
 ds_read_b64_tr_b16 v[236:237], v16 offset:45056
 ds_read_b64_tr_b16 v[238:239], v16 offset:45568
 MM v[176:179], a[136:139], v[232:235], v[176:179]
 ds_read_b64_tr_b16 v[232:233], v16 offset:40960
 ds_read_b64_tr_b16 v[234:235], v16 offset:41472
 MM v[176:179], a[132:135], v[228:231], v[176:179]
 ds_read_b64_tr_b16 v[228:229], v16 offset:36864
 ds_read_b64_tr_b16 v[230:231], v16 offset:37376
 MM v[176:179], a[128:131], v[224:227], v[176:179]
 s_waitcnt lgkmcnt(6)
 ds_read_b64_tr_b16 v[224:225], v16 offset:32768
 ds_read_b64_tr_b16 v[226:227], v16 offset:33280
 MM v[80:83], a[0:3], v[192:195], v[80:83]
 ds_read_b64_tr_b16 v[240:241], v16 offset:49152
 ds_read_b64_tr_b16 v[242:243], v16 offset:49664
 MM v[80:83], a[4:7], v[196:199], v[80:83]
 ds_read_b64_tr_b16 v[244:245], v16 offset:53248
 ds_read_b64_tr_b16 v[246:247], v16 offset:53760
 MM v[80:83], a[8:11], v[200:203], v[80:83]
 buffer_load_dwordx4 a[192:195], v1, s[16:19], s36 offen offset:0 sc1
 MM v[80:83], a[12:15], v[204:207], v[80:83]
 ds_read_b64_tr_b16 v[248:249], v16 offset:57344
 ds_read_b64_tr_b16 v[250:251], v16 offset:57856
 MM v[80:83], a[16:19], v[208:211], v[80:83]
 ds_read_b64_tr_b16 v[252:253], v16 offset:61440
 ds_read_b64_tr_b16 v[254:255], v16 offset:61952
 MM v[80:83], a[20:23], v[212:215], v[80:83]
 buffer_load_dwordx4 a[196:199], v1, s[16:19], s36 offen offset:1024 sc1
 MM v[80:83], a[24:27], v[216:219], v[80:83]
 MM v[80:83], a[28:31], v[220:223], v[80:83]
 MM v[84:87], a[60:63], v[220:223], v[84:87]
 MM v[84:87], a[56:59], v[216:219], v[84:87]
 buffer_load_dwordx4 a[200:203], v1, s[16:19], s36 offen offset:2048 sc1
 MM v[84:87], a[52:55], v[212:215], v[84:87]
 MM v[84:87], a[48:51], v[208:211], v[84:87]
 MM v[84:87], a[44:47], v[204:207], v[84:87]
 MM v[84:87], a[40:43], v[200:203], v[84:87]
 buffer_load_dwordx4 a[204:207], v1, s[16:19], s36 offen offset:3072 sc1
 MM v[84:87], a[36:39], v[196:199], v[84:87]
 s_add_u32 s36, s36, 0x1000
 MM v[84:87], a[32:35], v[192:195], v[84:87]
 MM v[88:91], a[64:67], v[192:195], v[88:91]
 buffer_load_dwordx4 a[208:211], v1, s[16:19], s37 offen offset:0 sc1
 MM v[88:91], a[68:71], v[196:199], v[88:91]
 MM v[88:91], a[72:75], v[200:203], v[88:91]
 MM v[88:91], a[76:79], v[204:207], v[88:91]
 MM v[88:91], a[80:83], v[208:211], v[88:91]
 buffer_load_dwordx4 a[212:215], v1, s[16:19], s37 offen offset:1024 sc1
 MM v[88:91], a[84:87], v[212:215], v[88:91]
 MM v[88:91], a[88:91], v[216:219], v[88:91]
 MM v[88:91], a[92:95], v[220:223], v[88:91]
 v_cvt_pk_bf16_f32 v32, v80, v81
 v_cvt_pk_bf16_f32 v33, v82, v83
 MM v[92:95], a[124:127], v[220:223], v[92:95]
 buffer_load_dwordx4 a[216:219], v1, s[16:19], s37 offen offset:2048 sc1
 MM v[92:95], a[120:123], v[216:219], v[92:95]
 v_cvt_pk_bf16_f32 v34, v84, v85
 v_cvt_pk_bf16_f32 v35, v86, v87
 MM v[92:95], a[116:119], v[212:215], v[92:95]
 MM v[92:95], a[112:115], v[208:211], v[92:95]
 buffer_load_dwordx4 a[220:223], v1, s[16:19], s37 offen offset:3072 sc1
 MM v[92:95], a[108:111], v[204:207], v[92:95]
 s_add_u32 s37, s37, 0x1000
 ds_read_b64_tr_b16 v[204:205], v17 offset:45056
 ds_read_b64_tr_b16 v[206:207], v17 offset:45568
 MM v[92:95], a[104:107], v[200:203], v[92:95]
 ds_read_b64_tr_b16 v[200:201], v17 offset:40960
 ds_read_b64_tr_b16 v[202:203], v17 offset:41472
 MM v[92:95], a[100:103], v[196:199], v[92:95]
 s_waitcnt lgkmcnt(4)
 ds_read_b64_tr_b16 v[196:197], v17 offset:36864
 ds_read_b64_tr_b16 v[198:199], v17 offset:37376
 MM v[92:95], a[96:99], v[192:195], v[92:95]
 buffer_load_dwordx4 a[224:227], v1, s[16:19], s38 offen offset:0 sc1
 MM v[124:127], a[96:99], v[224:227], v[124:127]
 ds_read_b64_tr_b16 v[192:193], v17 offset:32768
 ds_read_b64_tr_b16 v[194:195], v17 offset:33280
 MM v[124:127], a[100:103], v[228:231], v[124:127]
 ds_read_b64_tr_b16 v[208:209], v17 offset:49152
 ds_read_b64_tr_b16 v[210:211], v17 offset:49664
 MM v[124:127], a[104:107], v[232:235], v[124:127]
 ds_read_b64_tr_b16 v[212:213], v17 offset:53248
 ds_read_b64_tr_b16 v[214:215], v17 offset:53760
 MM v[124:127], a[108:111], v[236:239], v[124:127]
 buffer_load_dwordx4 a[228:231], v1, s[16:19], s38 offen offset:1024 sc1
 MM v[124:127], a[112:115], v[240:243], v[124:127]
 ds_read_b64_tr_b16 v[216:217], v17 offset:57344
 ds_read_b64_tr_b16 v[218:219], v17 offset:57856
 MM v[124:127], a[116:119], v[244:247], v[124:127]
 ds_read_b64_tr_b16 v[220:221], v17 offset:61440
 ds_read_b64_tr_b16 v[222:223], v17 offset:61952
 MM v[124:127], a[120:123], v[248:251], v[124:127]
 buffer_load_dwordx4 a[232:235], v1, s[16:19], s38 offen offset:2048 sc1
 MM v[124:127], a[124:127], v[252:255], v[124:127]
 v_cvt_pk_bf16_f32 v36, v88, v89
 v_cvt_pk_bf16_f32 v37, v90, v91
 MM v[120:123], a[92:95], v[252:255], v[120:123]
 v_cvt_pk_bf16_f32 v38, v92, v93
 v_cvt_pk_bf16_f32 v39, v94, v95
 MM v[120:123], a[88:91], v[248:251], v[120:123]
 MM v[120:123], a[84:87], v[244:247], v[120:123]
 buffer_load_dwordx4 a[236:239], v1, s[16:19], s38 offen offset:3072 sc1
 MM v[120:123], a[80:83], v[240:243], v[120:123]
 s_add_u32 s38, s38, 0x1000
 MM v[120:123], a[76:79], v[236:239], v[120:123]
 MM v[120:123], a[72:75], v[232:235], v[120:123]
 MM v[120:123], a[68:71], v[228:231], v[120:123]
 buffer_load_dwordx4 a[240:243], v1, s[16:19], s39 offen offset:0 sc1
 MM v[120:123], a[64:67], v[224:227], v[120:123]
 MM v[116:119], a[32:35], v[224:227], v[116:119]
 MM v[116:119], a[36:39], v[228:231], v[116:119]
 buffer_load_dwordx4 a[244:247], v1, s[16:19], s39 offen offset:1024 sc1
 MM v[116:119], a[40:43], v[232:235], v[116:119]
 MM v[116:119], a[44:47], v[236:239], v[116:119]
 MM v[116:119], a[48:51], v[240:243], v[116:119]
 MM v[116:119], a[52:55], v[244:247], v[116:119]
 buffer_load_dwordx4 a[248:251], v1, s[16:19], s39 offen offset:2048 sc1
 MM v[116:119], a[56:59], v[248:251], v[116:119]
 MM v[116:119], a[60:63], v[252:255], v[116:119]
 v_cvt_pk_bf16_f32 v44, v120, v121
 v_cvt_pk_bf16_f32 v45, v122, v123
 MM v[112:115], a[28:31], v[252:255], v[112:115]
 v_cvt_pk_bf16_f32 v46, v124, v125
 v_cvt_pk_bf16_f32 v47, v126, v127
 MM v[112:115], a[24:27], v[248:251], v[112:115]
 buffer_load_dwordx4 a[252:255], v1, s[16:19], s39 offen offset:3072 sc1
 MM v[112:115], a[20:23], v[244:247], v[112:115]
 s_add_u32 s39, s39, 0x1000
 MM v[112:115], a[16:19], v[240:243], v[112:115]
 MM v[112:115], a[12:15], v[236:239], v[112:115]
 ds_read_b64_tr_b16 v[236:237], v18 offset:45056
 ds_read_b64_tr_b16 v[238:239], v18 offset:45568
 MM v[112:115], a[8:11], v[232:235], v[112:115]
 buffer_load_dwordx4 a[128:131], v1, s[16:19], s36 offen offset:0 sc1
 MM v[112:115], a[4:7], v[228:231], v[112:115]
 ds_read_b64_tr_b16 v[228:229], v18 offset:36864
 ds_read_b64_tr_b16 v[230:231], v18 offset:37376
 MM v[112:115], a[0:3], v[224:227], v[112:115]
 s_waitcnt lgkmcnt(4)
 ds_read_b64_tr_b16 v[224:225], v18 offset:32768
 ds_read_b64_tr_b16 v[226:227], v18 offset:33280
 MM v[160:163], a[0:3], v[192:195], v[160:163]
 buffer_load_dwordx4 a[132:135], v1, s[16:19], s36 offen offset:1024 sc1
 MM v[160:163], a[4:7], v[196:199], v[160:163]
 ds_read_b64_tr_b16 v[232:233], v18 offset:40960
 ds_read_b64_tr_b16 v[234:235], v18 offset:41472
 MM v[160:163], a[8:11], v[200:203], v[160:163]
 ds_read_b64_tr_b16 v[240:241], v18 offset:49152
 ds_read_b64_tr_b16 v[242:243], v18 offset:49664
 MM v[160:163], a[12:15], v[204:207], v[160:163]
 ds_read_b64_tr_b16 v[244:245], v18 offset:53248
 ds_read_b64_tr_b16 v[246:247], v18 offset:53760
 MM v[160:163], a[16:19], v[208:211], v[160:163]
 buffer_load_dwordx4 a[136:139], v1, s[16:19], s36 offen offset:2048 sc1
 MM v[160:163], a[20:23], v[212:215], v[160:163]
 ds_read_b64_tr_b16 v[248:249], v18 offset:57344
 ds_read_b64_tr_b16 v[250:251], v18 offset:57856
 MM v[160:163], a[24:27], v[216:219], v[160:163]
 ds_read_b64_tr_b16 v[252:253], v18 offset:61440
 ds_read_b64_tr_b16 v[254:255], v18 offset:61952
 MM v[160:163], a[28:31], v[220:223], v[160:163]
 v_cvt_pk_bf16_f32 v40, v112, v113
 v_cvt_pk_bf16_f32 v41, v114, v115
 MM v[164:167], a[60:63], v[220:223], v[164:167]
 buffer_load_dwordx4 a[140:143], v1, s[16:19], s36 offen offset:3072 sc1
 MM v[164:167], a[56:59], v[216:219], v[164:167]
 s_add_u32 s36, s36, 0x1000
 v_cvt_pk_bf16_f32 v42, v116, v117
 v_cvt_pk_bf16_f32 v43, v118, v119
 MM v[164:167], a[52:55], v[212:215], v[164:167]
 MM v[164:167], a[48:51], v[208:211], v[164:167]
 buffer_load_dwordx4 a[144:147], v1, s[16:19], s37 offen offset:0 sc1
 MM v[164:167], a[44:47], v[204:207], v[164:167]
 MM v[164:167], a[40:43], v[200:203], v[164:167]
 MM v[164:167], a[36:39], v[196:199], v[164:167]
 MM v[164:167], a[32:35], v[192:195], v[164:167]
 buffer_load_dwordx4 a[148:151], v1, s[16:19], s37 offen offset:1024 sc1
 MM v[168:171], a[64:67], v[192:195], v[168:171]
 MM v[168:171], a[68:71], v[196:199], v[168:171]
 MM v[168:171], a[72:75], v[200:203], v[168:171]
 MM v[168:171], a[76:79], v[204:207], v[168:171]
 buffer_load_dwordx4 a[152:155], v1, s[16:19], s37 offen offset:2048 sc1
 MM v[168:171], a[80:83], v[208:211], v[168:171]
 MM v[168:171], a[84:87], v[212:215], v[168:171]
 MM v[168:171], a[88:91], v[216:219], v[168:171]
 buffer_load_dwordx4 a[156:159], v1, s[16:19], s37 offen offset:3072 sc1
 MM v[168:171], a[92:95], v[220:223], v[168:171]
 s_add_u32 s37, s37, 0x1000
 v_cvt_pk_bf16_f32 v48, v160, v161
 v_cvt_pk_bf16_f32 v49, v162, v163
 MM v[172:175], a[124:127], v[220:223], v[172:175]
 s_waitcnt vmcnt(26)
 s_barrier
 ds_read_b64_tr_b16 v[220:221], v12 offset:12288
 MM v[172:175], a[120:123], v[216:219], v[172:175]
 ds_read_b64_tr_b16 v[216:217], v12 offset:8192
 v_cvt_pk_bf16_f32 v50, v164, v165
 MM v[172:175], a[116:119], v[212:215], v[172:175]
 buffer_load_dwordx4 a[160:163], v1, s[16:19], s38 offen offset:0 sc1
 MM v[172:175], a[112:115], v[208:211], v[172:175]
 ds_read_b64_tr_b16 v[208:209], v12 offset:0
 v_cvt_pk_bf16_f32 v51, v166, v167
 MM v[172:175], a[108:111], v[204:207], v[172:175]
 ds_read_b64_tr_b16 v[204:205], v11 offset:12288
 ds_read_b64_tr_b16 v[206:207], v11 offset:12800
 MM v[172:175], a[104:107], v[200:203], v[172:175]
 ds_read_b64_tr_b16 v[200:201], v11 offset:8192
 ds_read_b64_tr_b16 v[202:203], v11 offset:8704
 MM v[172:175], a[100:103], v[196:199], v[172:175]
 buffer_load_dwordx4 a[164:167], v1, s[16:19], s38 offen offset:1024 sc1
 MM v[172:175], a[96:99], v[192:195], v[172:175]
 s_waitcnt lgkmcnt(6)
 ds_read_b64_tr_b16 v[192:193], v11 offset:0
 ds_read_b64_tr_b16 v[194:195], v11 offset:512
 MM v[188:191], a[96:99], v[224:227], v[188:191]
 ds_read_b64_tr_b16 v[196:197], v11 offset:4096
 ds_read_b64_tr_b16 v[198:199], v11 offset:4608
 MM v[188:191], a[100:103], v[228:231], v[188:191]
 buffer_load_dwordx4 a[168:171], v1, s[16:19], s38 offen offset:2048 sc1
 MM v[188:191], a[104:107], v[232:235], v[188:191]
 ds_read_b64_tr_b16 v[210:211], v12 offset:512
 ds_read_b64_tr_b16 v[212:213], v12 offset:4096
 MM v[188:191], a[108:111], v[236:239], v[188:191]
 ds_read_b64_tr_b16 v[214:215], v12 offset:4608
 ds_read_b64_tr_b16 v[218:219], v12 offset:8704
 MM v[188:191], a[112:115], v[240:243], v[188:191]
 ds_read_b64_tr_b16 v[222:223], v12 offset:12800
 MM v[188:191], a[116:119], v[244:247], v[188:191]
 buffer_load_dwordx4 a[172:175], v1, s[16:19], s38 offen offset:3072 sc1
 MM v[188:191], a[120:123], v[248:251], v[188:191]
 s_add_u32 s38, s38, 0x1000
 MM v[188:191], a[124:127], v[252:255], v[188:191]
 v_cvt_pk_bf16_f32 v52, v168, v169
 v_cvt_pk_bf16_f32 v53, v170, v171
 MM v[184:187], a[92:95], v[252:255], v[184:187]
 v_cvt_pk_bf16_f32 v54, v172, v173
 v_cvt_pk_bf16_f32 v55, v174, v175
 MM v[184:187], a[88:91], v[248:251], v[184:187]
 buffer_load_dwordx4 a[176:179], v1, s[16:19], s39 offen offset:0 sc1
 MM v[184:187], a[84:87], v[244:247], v[184:187]
 MM v[184:187], a[80:83], v[240:243], v[184:187]
 MM v[184:187], a[76:79], v[236:239], v[184:187]
 buffer_load_dwordx4 a[180:183], v1, s[16:19], s39 offen offset:1024 sc1
 MM v[184:187], a[72:75], v[232:235], v[184:187]
 MM v[184:187], a[68:71], v[228:231], v[184:187]
 MM v[184:187], a[64:67], v[224:227], v[184:187]
 MM v[180:183], a[32:35], v[224:227], v[180:183]
 buffer_load_dwordx4 a[184:187], v1, s[16:19], s39 offen offset:2048 sc1
 MM v[180:183], a[36:39], v[228:231], v[180:183]
 MM v[180:183], a[40:43], v[232:235], v[180:183]
 MM v[180:183], a[44:47], v[236:239], v[180:183]
 MM v[180:183], a[48:51], v[240:243], v[180:183]
 buffer_load_dwordx4 a[188:191], v1, s[16:19], s39 offen offset:3072 sc1
 MM v[180:183], a[52:55], v[244:247], v[180:183]
 s_add_u32 s39, s39, 0x1000
 MM v[180:183], a[56:59], v[248:251], v[180:183]
 MM v[180:183], a[60:63], v[252:255], v[180:183]
 v_cvt_pk_bf16_f32 v60, v184, v185
 v_cvt_pk_bf16_f32 v61, v186, v187
 MM v[176:179], a[28:31], v[252:255], v[176:179]
 v_cvt_pk_bf16_f32 v62, v188, v189
 v_cvt_pk_bf16_f32 v63, v190, v191
 MM v[176:179], a[24:27], v[248:251], v[176:179]
 MM v[176:179], a[20:23], v[244:247], v[176:179]
 MM v[176:179], a[16:19], v[240:243], v[176:179]
 MM v[176:179], a[12:15], v[236:239], v[176:179]
 MM v[176:179], a[8:11], v[232:235], v[176:179]
 MM v[176:179], a[4:7], v[228:231], v[176:179]
 MM v[176:179], a[0:3], v[224:227], v[176:179]
 s_cmp_lt_u32 s62, 5
 s_cbranch_scc1 k_spare
 s_waitcnt vmcnt(31) lgkmcnt(0)
 MM a[0:3], v[192:195], a[192:195], 0
 s_add_u32 m0, s47, 32768
 s_add_u32 s41, s45, 0
 ds_read_b64_tr_b16 v[224:225], v13 offset:0
 s_waitcnt vmcnt(30)
 MM a[0:3], v[196:199], a[196:199], a[0:3]
 buffer_load_dwordx4 v7, s[48:51], s41 offen offset:0 lds
 s_waitcnt vmcnt(30)
 MM a[0:3], v[200:203], a[200:203], a[0:3]
 s_add_u32 s42, s45, 64512
 ds_read_b64_tr_b16 v[226:227], v13 offset:512
 ds_read_b64_tr_b16 v[228:229], v13 offset:4096
 s_waitcnt vmcnt(29)
 MM a[0:3], v[204:207], a[204:207], a[0:3]
 s_waitcnt vmcnt(25)
 ds_read_b64_tr_b16 v[230:231], v13 offset:4608
 ds_read_b64_tr_b16 v[232:233], v13 offset:8192
 MM a[4:7], v[204:207], a[220:223], 0
 ds_read_b64_tr_b16 v[234:235], v13 offset:8704
 ds_read_b64_tr_b16 v[236:237], v13 offset:12288
 MM a[4:7], v[200:203], a[216:219], a[4:7]
 ds_read_b64_tr_b16 v[238:239], v13 offset:12800
 MM a[4:7], v[196:199], a[212:215], a[4:7]
 buffer_load_dwordx4 v8, s[48:51], s42 offen offset:1024 lds
 MM a[4:7], v[192:195], a[208:211], a[4:7]
 s_waitcnt vmcnt(25)
 s_add_u32 s43, s45, 129024
 MM a[8:11], v[192:195], a[224:227], 0
 s_waitcnt vmcnt(24)
 v_cvt_pk_bf16_f32 v56, v176, v177
 v_cvt_pk_bf16_f32 v57, v178, v179
 MM a[8:11], v[196:199], a[228:231], a[8:11]
 s_waitcnt vmcnt(23)
 v_cvt_pk_bf16_f32 v58, v180, v181
 v_cvt_pk_bf16_f32 v59, v182, v183
 MM a[8:11], v[200:203], a[232:235], a[8:11]
 s_waitcnt vmcnt(18)
 s_waitcnt vmcnt(22)
 MM a[8:11], v[204:207], a[236:239], a[8:11]
 buffer_load_dwordx4 v7, s[48:51], s43 offen offset:2048 lds
 MM a[12:15], v[204:207], a[252:255], 0
 s_add_u32 s40, s45, 193536
 ds_read_b64_tr_b16 v[240:241], v14 offset:0
 ds_read_b64_tr_b16 v[242:243], v14 offset:512
 MM a[12:15], v[200:203], a[248:251], a[12:15]
 ds_read_b64_tr_b16 v[244:245], v14 offset:4096
 ds_read_b64_tr_b16 v[246:247], v14 offset:4608
 MM a[12:15], v[196:199], a[244:247], a[12:15]
 ds_read_b64_tr_b16 v[248:249], v14 offset:8192
 ds_read_b64_tr_b16 v[250:251], v14 offset:8704
 MM a[12:15], v[192:195], a[240:243], a[12:15]
 ds_read_b64_tr_b16 v[252:253], v14 offset:12288
 ds_read_b64_tr_b16 v[254:255], v14 offset:12800
 MM a[28:31], v[208:211], a[240:243], 0
 buffer_load_dwordx4 v8, s[48:51], s40 offen offset:3072 lds
 MM a[28:31], v[212:215], a[244:247], a[28:31]
 s_add_u32 m0, s47, 49152
 s_add_u32 s41, s45, 128
 MM a[28:31], v[216:219], a[248:251], a[28:31]
 MM a[28:31], v[220:223], a[252:255], a[28:31]
 MM a[24:27], v[220:223], a[236:239], 0
 MM a[24:27], v[216:219], a[232:235], a[24:27]
 buffer_load_dwordx4 v7, s[48:51], s41 offen offset:0 lds
 MM a[24:27], v[212:215], a[228:231], a[24:27]
 s_add_u32 s42, s45, 64640
 MM a[24:27], v[208:211], a[224:227], a[24:27]
 MM a[20:23], v[208:211], a[208:211], 0
 MM a[20:23], v[212:215], a[212:215], a[20:23]
 MM a[20:23], v[216:219], a[216:219], a[20:23]
 buffer_load_dwordx4 v8, s[48:51], s42 offen offset:1024 lds
 MM a[20:23], v[220:223], a[220:223], a[20:23]
 s_add_u32 s43, s45, 129152
 MM a[16:19], v[220:223], a[204:207], 0
 ds_read_b64_tr_b16 v[192:193], v11 offset:16384
 ds_read_b64_tr_b16 v[194:195], v11 offset:16896
 MM a[16:19], v[216:219], a[200:203], a[16:19]
 s_waitcnt lgkmcnt(2)
 ds_read_b64_tr_b16 v[196:197], v11 offset:20480
 ds_read_b64_tr_b16 v[198:199], v11 offset:20992
 MM a[16:19], v[212:215], a[196:199], a[16:19]
 s_barrier
 ds_read_b64_tr_b16 v[200:201], v11 offset:24576
 ds_read_b64_tr_b16 v[202:203], v11 offset:25088
 MM a[16:19], v[208:211], a[192:195], a[16:19]
 buffer_load_dwordx4 v7, s[48:51], s43 offen offset:2048 lds
 MM a[32:35], v[224:227], a[192:195], 0
 s_add_u32 s40, s45, 193664
 ds_read_b64_tr_b16 v[204:205], v11 offset:28672
 ds_read_b64_tr_b16 v[206:207], v11 offset:29184
 MM a[32:35], v[228:231], a[196:199], a[32:35]
 buffer_store_dwordx4 v[72:75], v1, s[16:19], s86 offen offset:1024 sc1
 MM a[32:35], v[232:235], a[200:203], a[32:35]
 MM a[32:35], v[236:239], a[204:207], a[32:35]
 MM a[36:39], v[236:239], a[220:223], 0
 buffer_load_dwordx4 v8, s[48:51], s40 offen offset:3072 lds
 MM a[36:39], v[232:235], a[216:219], a[36:39]
 MM a[36:39], v[228:231], a[212:215], a[36:39]
 MM a[36:39], v[224:227], a[208:211], a[36:39]
 MM a[40:43], v[224:227], a[224:227], 0
 MM a[40:43], v[228:231], a[228:231], a[40:43]
 MM a[40:43], v[232:235], a[232:235], a[40:43]
 MM a[40:43], v[236:239], a[236:239], a[40:43]
 MM a[44:47], v[236:239], a[252:255], 0
 ds_read_b64_tr_b16 v[208:209], v12 offset:16384
 ds_read_b64_tr_b16 v[210:211], v12 offset:16896
 MM a[44:47], v[232:235], a[248:251], a[44:47]
 ds_read_b64_tr_b16 v[212:213], v12 offset:20480
 ds_read_b64_tr_b16 v[214:215], v12 offset:20992
 MM a[44:47], v[228:231], a[244:247], a[44:47]
 ds_read_b64_tr_b16 v[216:217], v12 offset:24576
 ds_read_b64_tr_b16 v[218:219], v12 offset:25088
 MM a[44:47], v[224:227], a[240:243], a[44:47]
 ds_read_b64_tr_b16 v[220:221], v12 offset:28672
 ds_read_b64_tr_b16 v[222:223], v12 offset:29184
 MM a[60:63], v[240:243], a[240:243], 0
 buffer_store_dwordx4 v[76:79], v1, s[16:19], s87 offen offset:1024 sc1
 MM a[60:63], v[244:247], a[244:247], a[60:63]
 MM a[60:63], v[248:251], a[248:251], a[60:63]
 MM a[60:63], v[252:255], a[252:255], a[60:63]
 MM a[56:59], v[252:255], a[236:239], 0
 s_add_u32 m0, s47, 65536
 s_add_u32 s41, s46, 442368
 MM a[56:59], v[248:251], a[232:235], a[56:59]
 MM a[56:59], v[244:247], a[228:231], a[56:59]
 MM a[56:59], v[240:243], a[224:227], a[56:59]
 MM a[52:55], v[240:243], a[208:211], 0
 buffer_load_dwordx4 v9, s[20:23], s41 offen offset:0 lds
 MM a[52:55], v[244:247], a[212:215], a[52:55]
 MM a[52:55], v[248:251], a[216:219], a[52:55]
 MM a[52:55], v[252:255], a[220:223], a[52:55]
 MM a[48:51], v[252:255], a[204:207], 0
 s_add_u32 s42, s46, 468992
 ds_read_b64_tr_b16 v[224:225], v13 offset:16384
 ds_read_b64_tr_b16 v[226:227], v13 offset:16896
 MM a[48:51], v[248:251], a[200:203], a[48:51]
 ds_read_b64_tr_b16 v[228:229], v13 offset:20480
 ds_read_b64_tr_b16 v[230:231], v13 offset:20992
 MM a[48:51], v[244:247], a[196:199], a[48:51]
 ds_read_b64_tr_b16 v[232:233], v13 offset:24576
 ds_read_b64_tr_b16 v[234:235], v13 offset:25088
 MM a[48:51], v[240:243], a[192:195], a[48:51]
 s_waitcnt lgkmcnt(6)
 ds_read_b64_tr_b16 v[236:237], v13 offset:28672
 ds_read_b64_tr_b16 v[238:239], v13 offset:29184
 MM a[64:67], v[192:195], a[192:195], 0
 buffer_load_dwordx4 v10, s[20:23], s42 offen offset:1024 lds
 MM a[64:67], v[196:199], a[196:199], a[64:67]
 MM a[64:67], v[200:203], a[200:203], a[64:67]
 buffer_store_dwordx4 v[96:99], v1, s[16:19], s84 offen offset:2048 sc1
 MM a[64:67], v[204:207], a[204:207], a[64:67]
 MM a[68:71], v[204:207], a[220:223], 0
 s_add_u32 s43, s46, 495616
 MM a[68:71], v[200:203], a[216:219], a[68:71]
 MM a[68:71], v[196:199], a[212:215], a[68:71]
 MM a[68:71], v[192:195], a[208:211], a[68:71]
 MM a[72:75], v[192:195], a[224:227], 0
 buffer_load_dwordx4 v9, s[20:23], s43 offen offset:2048 lds
 MM a[72:75], v[196:199], a[228:231], a[72:75]
 MM a[72:75], v[200:203], a[232:235], a[72:75]
 MM a[72:75], v[204:207], a[236:239], a[72:75]
 MM a[76:79], v[204:207], a[252:255], 0
 s_add_u32 s40, s46, 522240
 ds_read_b64_tr_b16 v[240:241], v14 offset:16384
 ds_read_b64_tr_b16 v[242:243], v14 offset:16896
 MM a[76:79], v[200:203], a[248:251], a[76:79]
 ds_read_b64_tr_b16 v[244:245], v14 offset:20480
 ds_read_b64_tr_b16 v[246:247], v14 offset:20992
 MM a[76:79], v[196:199], a[244:247], a[76:79]
 ds_read_b64_tr_b16 v[248:249], v14 offset:24576
 ds_read_b64_tr_b16 v[250:251], v14 offset:25088
 MM a[76:79], v[192:195], a[240:243], a[76:79]
 ds_read_b64_tr_b16 v[252:253], v14 offset:28672
 ds_read_b64_tr_b16 v[254:255], v14 offset:29184
 MM a[92:95], v[208:211], a[240:243], 0
 buffer_load_dwordx4 v10, s[20:23], s40 offen offset:3072 lds
 MM a[92:95], v[212:215], a[244:247], a[92:95]
 MM a[92:95], v[216:219], a[248:251], a[92:95]
 MM a[92:95], v[220:223], a[252:255], a[92:95]
 MM a[88:91], v[220:223], a[236:239], 0
 s_add_u32 m0, s47, 81920
 s_add_u32 s41, s46, 442368
 MM a[88:91], v[216:219], a[232:235], a[88:91]
 buffer_store_dwordx4 v[100:103], v1, s[16:19], s85 offen offset:2048 sc1
 MM a[88:91], v[212:215], a[228:231], a[88:91]
 MM a[88:91], v[208:211], a[224:227], a[88:91]
 MM a[84:87], v[208:211], a[208:211], 0
 buffer_load_dwordx4 v9, s[52:55], s41 offen offset:0 lds
 MM a[84:87], v[212:215], a[212:215], a[84:87]
 MM a[84:87], v[216:219], a[216:219], a[84:87]
 s_mul_i32 s12, s24, 5120
 MM a[84:87], v[220:223], a[220:223], a[84:87]
 MM a[80:83], v[220:223], a[204:207], 0
 s_add_u32 s42, s46, 468992
 MM a[80:83], v[216:219], a[200:203], a[80:83]
 MM a[80:83], v[212:215], a[196:199], a[80:83]
 s_add_u32 s12, s12, 0x20000
 MM a[80:83], v[208:211], a[192:195], a[80:83]
 s_waitcnt lgkmcnt(0)
 MM a[96:99], v[224:227], a[192:195], 0
 buffer_load_dwordx4 v10, s[52:55], s42 offen offset:1024 lds
 MM a[96:99], v[228:231], a[196:199], a[96:99]
 MM a[96:99], v[232:235], a[200:203], a[96:99]
 s_lshr_b32 s92, s2, 1
 MM a[96:99], v[236:239], a[204:207], a[96:99]
 MM a[100:103], v[236:239], a[220:223], 0
 s_add_u32 s43, s46, 495616
 MM a[100:103], v[232:235], a[216:219], a[100:103]
 MM a[100:103], v[228:231], a[212:215], a[100:103]
 buffer_store_dwordx4 v[104:107], v1, s[16:19], s86 offen offset:2048 sc1
 MM a[100:103], v[224:227], a[208:211], a[100:103]
 s_and_b32 s93, s2, 1
 MM a[104:107], v[224:227], a[224:227], 0
 buffer_load_dwordx4 v9, s[52:55], s43 offen offset:2048 lds
 MM a[104:107], v[228:231], a[228:231], a[104:107]
 MM a[104:107], v[232:235], a[232:235], a[104:107]
 s_waitcnt vmcnt(11)
 s_barrier
 ds_read_b64_tr_b16 v[192:193], v11 offset:32768
 MM a[104:107], v[236:239], a[236:239], a[104:107]
 s_mul_i32 s13, s92, 40960
 ds_read_b64_tr_b16 v[194:195], v11 offset:33280
 ds_read_b64_tr_b16 v[196:197], v11 offset:36864
 MM a[108:111], v[236:239], a[252:255], 0
 s_add_u32 s40, s46, 522240
 ds_read_b64_tr_b16 v[198:199], v11 offset:37376
 ds_read_b64_tr_b16 v[200:201], v11 offset:40960
 MM a[108:111], v[232:235], a[248:251], a[108:111]
 ds_read_b64_tr_b16 v[202:203], v11 offset:41472
 ds_read_b64_tr_b16 v[204:205], v11 offset:45056
 MM a[108:111], v[228:231], a[244:247], a[108:111]
 ds_read_b64_tr_b16 v[206:207], v11 offset:45568
 ds_read_b64_tr_b16 v[208:209], v12 offset:32768
 MM a[108:111], v[224:227], a[240:243], a[108:111]
 s_mul_i32 s94, s93, 640
 ds_read_b64_tr_b16 v[210:211], v12 offset:33280
 ds_read_b64_tr_b16 v[212:213], v12 offset:36864
 MM a[124:127], v[240:243], a[240:243], 0
 buffer_load_dwordx4 v10, s[52:55], s40 offen offset:3072 lds
 MM a[124:127], v[244:247], a[244:247], a[124:127]
 ds_read_b64_tr_b16 v[214:215], v12 offset:37376
 ds_read_b64_tr_b16 v[216:217], v12 offset:40960
 MM a[124:127], v[248:251], a[248:251], a[124:127]
 ds_read_b64_tr_b16 v[218:219], v12 offset:41472
 ds_read_b64_tr_b16 v[220:221], v12 offset:45056
 MM a[124:127], v[252:255], a[252:255], a[124:127]
 s_add_u32 s13, s13, s94
 ds_read_b64_tr_b16 v[222:223], v12 offset:45568
 MM a[120:123], v[252:255], a[236:239], 0
 MM a[120:123], v[248:251], a[232:235], a[120:123]
 MM a[120:123], v[244:247], a[228:231], a[120:123]
 MM a[120:123], v[240:243], a[224:227], a[120:123]
 MM a[116:119], v[240:243], a[208:211], 0
 buffer_store_dwordx4 v[108:111], v1, s[16:19], s87 offen offset:2048 sc1
 MM a[116:119], v[244:247], a[212:215], a[116:119]
 s_lshl_b32 s93, s93, 2
 MM a[116:119], v[248:251], a[216:219], a[116:119]
 MM a[116:119], v[252:255], a[220:223], a[116:119]
 MM a[112:115], v[252:255], a[204:207], 0
 s_add_u32 s93, s93, s24
 ds_read_b64_tr_b16 v[224:225], v13 offset:32768
 ds_read_b64_tr_b16 v[226:227], v13 offset:33280
 MM a[112:115], v[248:251], a[200:203], a[112:115]
 ds_read_b64_tr_b16 v[228:229], v13 offset:36864
 ds_read_b64_tr_b16 v[230:231], v13 offset:37376
 MM a[112:115], v[244:247], a[196:199], a[112:115]
 s_add_u32 m0, s47, 98304
 s_add_u32 s41, s45, 1048576
 ds_read_b64_tr_b16 v[232:233], v13 offset:40960
 MM a[112:115], v[240:243], a[192:195], a[112:115]
 s_waitcnt lgkmcnt(5)
 ds_read_b64_tr_b16 v[234:235], v13 offset:41472
 ds_read_b64_tr_b16 v[236:237], v13 offset:45056
 MM v[64:67], v[192:195], a[192:195], 0
 s_mul_i32 s93, s93, 182
 ds_read_b64_tr_b16 v[238:239], v13 offset:45568
 MM v[64:67], v[196:199], a[196:199], v[64:67]
 MM v[64:67], v[200:203], a[200:203], v[64:67]
 buffer_load_dwordx4 v7, s[48:51], s41 offen offset:0 lds
 MM v[64:67], v[204:207], a[204:207], v[64:67]
 MM v[68:71], v[204:207], a[220:223], 0
 s_add_u32 s93, s93, s92
 MM v[68:71], v[200:203], a[216:219], v[68:71]
 MM v[68:71], v[196:199], a[212:215], v[68:71]
 MM v[68:71], v[192:195], a[208:211], v[68:71]
 MM v[72:75], v[192:195], a[224:227], 0
 MM v[72:75], v[196:199], a[228:231], v[72:75]
 s_mul_i32 s14, s93, 5120
 MM v[72:75], v[200:203], a[232:235], v[72:75]
 buffer_store_dwordx4 v[128:131], v1, s[16:19], s84 offen offset:3072 sc1
 MM v[72:75], v[204:207], a[236:239], v[72:75]
 s_add_u32 s42, s45, 1113088
 MM v[76:79], v[204:207], a[252:255], 0
 ds_read_b64_tr_b16 v[240:241], v14 offset:32768
 ds_read_b64_tr_b16 v[242:243], v14 offset:33280
 MM v[76:79], v[200:203], a[248:251], v[76:79]
 s_add_u32 s14, s14, 62914560
 ds_read_b64_tr_b16 v[244:245], v14 offset:36864
 ds_read_b64_tr_b16 v[246:247], v14 offset:37376
 MM v[76:79], v[196:199], a[244:247], v[76:79]
 ds_read_b64_tr_b16 v[248:249], v14 offset:40960
 ds_read_b64_tr_b16 v[250:251], v14 offset:41472
 MM v[76:79], v[192:195], a[240:243], v[76:79]
 buffer_load_dwordx4 v8, s[48:51], s42 offen offset:1024 lds
 MM v[92:95], v[208:211], a[240:243], 0
 ds_read_b64_tr_b16 v[252:253], v14 offset:45056
 ds_read_b64_tr_b16 v[254:255], v14 offset:45568
 MM v[92:95], v[212:215], a[244:247], v[92:95]
 v_add_u32 v27, 0x1000, v1
 MM v[92:95], v[216:219], a[248:251], v[92:95]
 MM v[92:95], v[220:223], a[252:255], v[92:95]
 MM v[88:91], v[220:223], a[236:239], 0
 MM v[88:91], v[216:219], a[232:235], v[88:91]
 MM v[88:91], v[212:215], a[228:231], v[88:91]
 MM v[88:91], v[208:211], a[224:227], v[88:91]
 MM v[84:87], v[208:211], a[208:211], 0
 s_add_u32 s43, s45, 1177600
 MM v[84:87], v[212:215], a[212:215], v[84:87]
 MM v[84:87], v[216:219], a[216:219], v[84:87]
 MM v[84:87], v[220:223], a[220:223], v[84:87]
 MM v[80:83], v[220:223], a[204:207], 0
 buffer_load_dwordx4 v7, s[48:51], s43 offen offset:2048 lds
 MM v[80:83], v[216:219], a[200:203], v[80:83]
 ds_read_b64_tr_b16 v[192:193], v11 offset:49152
 ds_read_b64_tr_b16 v[194:195], v11 offset:49664
 MM v[80:83], v[212:215], a[196:199], v[80:83]
 ds_read_b64_tr_b16 v[196:197], v11 offset:53248
 ds_read_b64_tr_b16 v[198:199], v11 offset:53760
 MM v[80:83], v[208:211], a[192:195], v[80:83]
 s_waitcnt lgkmcnt(4)
 ds_read_b64_tr_b16 v[200:201], v11 offset:57344
 ds_read_b64_tr_b16 v[202:203], v11 offset:57856
 MM v[96:99], v[224:227], a[192:195], 0
 ds_read_b64_tr_b16 v[204:205], v11 offset:61440
 ds_read_b64_tr_b16 v[206:207], v11 offset:61952
 MM v[96:99], v[228:231], a[196:199], v[96:99]
 buffer_store_dwordx4 v[132:135], v1, s[16:19], s85 offen offset:3072 sc1
 MM v[96:99], v[232:235], a[200:203], v[96:99]
 MM v[96:99], v[236:239], a[204:207], v[96:99]
 MM v[100:103], v[236:239], a[220:223], 0
 MM v[100:103], v[232:235], a[216:219], v[100:103]
 s_add_u32 s40, s45, 1242112
 MM v[100:103], v[228:231], a[212:215], v[100:103]
 MM v[100:103], v[224:227], a[208:211], v[100:103]
 MM v[104:107], v[224:227], a[224:227], 0
 MM v[104:107], v[228:231], a[228:231], v[104:107]
 buffer_load_dwordx4 v8, s[48:51], s40 offen offset:3072 lds
 MM v[104:107], v[232:235], a[232:235], v[104:107]
 MM v[104:107], v[236:239], a[236:239], v[104:107]
 MM v[108:111], v[236:239], a[252:255], 0
 ds_read_b64_tr_b16 v[208:209], v12 offset:49152
 ds_read_b64_tr_b16 v[210:211], v12 offset:49664
 MM v[108:111], v[232:235], a[248:251], v[108:111]
 ds_read_b64_tr_b16 v[212:213], v12 offset:53248
 ds_read_b64_tr_b16 v[214:215], v12 offset:53760
 MM v[108:111], v[228:231], a[244:247], v[108:111]
 buffer_store_dwordx4 v[136:139], v1, s[16:19], s86 offen offset:3072 sc1
 MM v[108:111], v[224:227], a[240:243], v[108:111]
 ds_read_b64_tr_b16 v[216:217], v12 offset:57344
 ds_read_b64_tr_b16 v[218:219], v12 offset:57856
 MM v[124:127], v[240:243], a[240:243], 0
 ds_read_b64_tr_b16 v[220:221], v12 offset:61440
 ds_read_b64_tr_b16 v[222:223], v12 offset:61952
 MM v[124:127], v[244:247], a[244:247], v[124:127]
 MM v[124:127], v[248:251], a[248:251], v[124:127]
 s_add_u32 m0, s47, 114688
 s_add_u32 s41, s45, 1048704
 MM v[124:127], v[252:255], a[252:255], v[124:127]
 MM v[120:123], v[252:255], a[236:239], 0
 MM v[120:123], v[248:251], a[232:235], v[120:123]
 MM v[120:123], v[244:247], a[228:231], v[120:123]
 buffer_load_dwordx4 v7, s[48:51], s41 offen offset:0 lds
 MM v[120:123], v[240:243], a[224:227], v[120:123]
 MM v[116:119], v[240:243], a[208:211], 0
 MM v[116:119], v[244:247], a[212:215], v[116:119]
 MM v[116:119], v[248:251], a[216:219], v[116:119]
 MM v[116:119], v[252:255], a[220:223], v[116:119]
 MM v[112:115], v[252:255], a[204:207], 0
 ds_read_b64_tr_b16 v[224:225], v13 offset:49152
 ds_read_b64_tr_b16 v[226:227], v13 offset:49664
 MM v[112:115], v[248:251], a[200:203], v[112:115]
 ds_read_b64_tr_b16 v[228:229], v13 offset:53248
 ds_read_b64_tr_b16 v[230:231], v13 offset:53760
 MM v[112:115], v[244:247], a[196:199], v[112:115]
 s_waitcnt lgkmcnt(4)
 ds_read_b64_tr_b16 v[232:233], v13 offset:57344
 ds_read_b64_tr_b16 v[234:235], v13 offset:57856
 MM v[112:115], v[240:243], a[192:195], v[112:115]
 s_add_u32 s42, s45, 1113216
 ds_read_b64_tr_b16 v[236:237], v13 offset:61440
 ds_read_b64_tr_b16 v[238:239], v13 offset:61952
 MM v[128:131], v[192:195], a[192:195], 0
 buffer_store_dwordx4 v[140:143], v1, s[16:19], s87 offen offset:3072 sc1
 MM v[128:131], v[196:199], a[196:199], v[128:131]
 MM v[128:131], v[200:203], a[200:203], v[128:131]
 MM v[128:131], v[204:207], a[204:207], v[128:131]
 buffer_load_dwordx4 v8, s[48:51], s42 offen offset:1024 lds
 MM v[132:135], v[204:207], a[220:223], 0
 MM v[132:135], v[200:203], a[216:219], v[132:135]
 MM v[132:135], v[196:199], a[212:215], v[132:135]
 MM v[132:135], v[192:195], a[208:211], v[132:135]
 MM v[136:139], v[192:195], a[224:227], 0
 MM v[136:139], v[196:199], a[228:231], v[136:139]
 MM v[136:139], v[200:203], a[232:235], v[136:139]
 MM v[136:139], v[204:207], a[236:239], v[136:139]
 MM v[140:143], v[204:207], a[252:255], 0
 s_add_u32 s43, s45, 1177728
 ds_read_b128 v[28:31], v22 offset:0
 ds_read_b64_tr_b16 v[240:241], v14 offset:49152
 MM v[140:143], v[200:203], a[248:251], v[140:143]
 ds_read_b64_tr_b16 v[242:243], v14 offset:49664
 ds_read_b64_tr_b16 v[244:245], v14 offset:53248
 MM v[140:143], v[196:199], a[244:247], v[140:143]
 ds_read_b64_tr_b16 v[246:247], v14 offset:53760
 ds_read_b64_tr_b16 v[248:249], v14 offset:57344
 MM v[140:143], v[192:195], a[240:243], v[140:143]
 ds_read_b64_tr_b16 v[250:251], v14 offset:57856
 ds_read_b64_tr_b16 v[252:253], v14 offset:61440
 MM v[156:159], v[208:211], a[240:243], 0
 buffer_load_dwordx4 v7, s[48:51], s43 offen offset:2048 lds
 MM v[156:159], v[212:215], a[244:247], v[156:159]
 ds_read_b64_tr_b16 v[254:255], v14 offset:61952
 MM v[156:159], v[216:219], a[248:251], v[156:159]
 MM v[156:159], v[220:223], a[252:255], v[156:159]
 MM v[152:155], v[220:223], a[236:239], 0
 MM v[152:155], v[216:219], a[232:235], v[152:155]
 MM v[152:155], v[212:215], a[228:231], v[152:155]
 MM v[152:155], v[208:211], a[224:227], v[152:155]
 MM v[148:151], v[208:211], a[208:211], 0
 MM v[148:151], v[212:215], a[212:215], v[148:151]
 s_add_u32 s40, s45, 1242240
 MM v[148:151], v[216:219], a[216:219], v[148:151]
 MM v[148:151], v[220:223], a[220:223], v[148:151]
 MM v[144:147], v[220:223], a[204:207], 0
 s_waitcnt lgkmcnt(0)
 buffer_store_dwordx4 v[28:31], v1, s[16:19], s88 offen offset:0 sc1
 MM v[144:147], v[216:219], a[200:203], v[144:147]
 buffer_load_dwordx4 v8, s[48:51], s40 offen offset:3072 lds
 MM v[144:147], v[212:215], a[196:199], v[144:147]
 MM v[144:147], v[208:211], a[192:195], v[144:147]
 MM v[160:163], v[224:227], a[192:195], 0
 MM v[160:163], v[228:231], a[196:199], v[160:163]
 MM v[160:163], v[232:235], a[200:203], v[160:163]
 MM v[160:163], v[236:239], a[204:207], v[160:163]
 MM v[164:167], v[236:239], a[220:223], 0
 MM v[164:167], v[232:235], a[216:219], v[164:167]
 MM v[164:167], v[228:231], a[212:215], v[164:167]
 MM v[164:167], v[224:227], a[208:211], v[164:167]
 MM v[168:171], v[224:227], a[224:227], 0
 MM v[168:171], v[228:231], a[228:231], v[168:171]
 MM v[168:171], v[232:235], a[232:235], v[168:171]
 s_waitcnt vmcnt(14)
 s_barrier
 ds_read_b64_tr_b16 v[192:193], v15 offset:0
 MM v[168:171], v[236:239], a[236:239], v[168:171]
 ds_read_b64_tr_b16 v[194:195], v15 offset:512
 ds_read_b64_tr_b16 v[196:197], v15 offset:4096
 MM v[172:175], v[236:239], a[252:255], 0
 ds_read_b64_tr_b16 v[198:199], v15 offset:4608
 ds_read_b64_tr_b16 v[200:201], v15 offset:8192
 MM v[172:175], v[232:235], a[248:251], v[172:175]
 ds_read_b64_tr_b16 v[202:203], v15 offset:8704
 ds_read_b64_tr_b16 v[204:205], v15 offset:12288
 MM v[172:175], v[228:231], a[244:247], v[172:175]
 ds_read_b128 v[28:31], v22 offset:1024
 ds_read_b64_tr_b16 v[206:207], v15 offset:12800
 MM v[172:175], v[224:227], a[240:243], v[172:175]
 ds_read_b64_tr_b16 v[208:209], v16 offset:0
 ds_read_b64_tr_b16 v[210:211], v16 offset:512
 MM v[188:191], v[240:243], a[240:243], 0
 ds_read_b64_tr_b16 v[212:213], v16 offset:4096
 ds_read_b64_tr_b16 v[214:215], v16 offset:4608
 MM v[188:191], v[244:247], a[244:247], v[188:191]
 ds_read_b64_tr_b16 v[216:217], v16 offset:8192
 ds_read_b64_tr_b16 v[218:219], v16 offset:8704
 MM v[188:191], v[248:251], a[248:251], v[188:191]
 ds_read_b64_tr_b16 v[220:221], v16 offset:12288
 ds_read_b64_tr_b16 v[222:223], v16 offset:12800
 MM v[188:191], v[252:255], a[252:255], v[188:191]
 MM v[184:187], v[252:255], a[236:239], 0
 MM v[184:187], v[248:251], a[232:235], v[184:187]
 MM v[184:187], v[244:247], a[228:231], v[184:187]
 MM v[184:187], v[240:243], a[224:227], v[184:187]
 MM v[180:183], v[240:243], a[208:211], 0
 MM v[180:183], v[244:247], a[212:215], v[180:183]
 MM v[180:183], v[248:251], a[216:219], v[180:183]
 MM v[180:183], v[252:255], a[220:223], v[180:183]
 MM v[176:179], v[252:255], a[204:207], 0
 ds_read_b64_tr_b16 v[224:225], v17 offset:0
 ds_read_b64_tr_b16 v[226:227], v17 offset:512
 MM v[176:179], v[248:251], a[200:203], v[176:179]
 ds_read_b64_tr_b16 v[228:229], v17 offset:4096
 ds_read_b64_tr_b16 v[230:231], v17 offset:4608
 MM v[176:179], v[244:247], a[196:199], v[176:179]
 s_waitcnt lgkmcnt(4)
 buffer_store_dwordx4 v[28:31], v1, s[16:19], s90 offen offset:0 sc1
 MM v[176:179], v[240:243], a[192:195], v[176:179]
 s_add_u32 m0, s47, 0
 s_add_u32 s41, s46, 884736
 ds_read_b64_tr_b16 v[232:233], v17 offset:8192
 MM a[0:3], v[192:195], a[128:131], a[0:3]
 ds_read_b64_tr_b16 v[234:235], v17 offset:8704
 ds_read_b64_tr_b16 v[236:237], v17 offset:12288
 MM a[0:3], v[196:199], a[132:135], a[0:3]
 ds_read_b64_tr_b16 v[238:239], v17 offset:12800
 MM a[0:3], v[200:203], a[136:139], a[0:3]
 buffer_load_dwordx4 v9, s[20:23], s41 offen offset:0 lds
 MM a[0:3], v[204:207], a[140:143], a[0:3]
 buffer_load_dwordx4 a[192:195], v1, s[16:19], s36 offen offset:0 sc1
 MM a[4:7], v[204:207], a[156:159], a[4:7]
 MM a[4:7], v[200:203], a[152:155], a[4:7]
 MM a[4:7], v[196:199], a[148:151], a[4:7]
 MM a[4:7], v[192:195], a[144:147], a[4:7]
 MM a[8:11], v[192:195], a[160:163], a[8:11]
 MM a[8:11], v[196:199], a[164:167], a[8:11]
 MM a[8:11], v[200:203], a[168:171], a[8:11]
 MM a[8:11], v[204:207], a[172:175], a[8:11]
 s_add_u32 s42, s46, 911360
 MM a[12:15], v[204:207], a[188:191], a[12:15]
 ds_read_b64_tr_b16 v[240:241], v18 offset:0
 ds_read_b64_tr_b16 v[242:243], v18 offset:512
 MM a[12:15], v[200:203], a[184:187], a[12:15]
 ds_read_b64_tr_b16 v[244:245], v18 offset:4096
 ds_read_b64_tr_b16 v[246:247], v18 offset:4608
 MM a[12:15], v[196:199], a[180:183], a[12:15]
 buffer_load_dwordx4 a[196:199], v1, s[16:19], s36 offen offset:1024 sc1
 MM a[12:15], v[192:195], a[176:179], a[12:15]
 buffer_load_dwordx4 v10, s[20:23], s42 offen offset:1024 lds
 MM a[28:31], v[208:211], a[176:179], a[28:31]
 ds_read_b128 v[28:31], v22 offset:2048
 ds_read_b64_tr_b16 v[248:249], v18 offset:8192
 MM a[28:31], v[212:215], a[180:183], a[28:31]
 ds_read_b64_tr_b16 v[250:251], v18 offset:8704
 ds_read_b64_tr_b16 v[252:253], v18 offset:12288
 MM a[28:31], v[216:219], a[184:187], a[28:31]
 ds_read_b64_tr_b16 v[254:255], v18 offset:12800
 MM a[28:31], v[220:223], a[188:191], a[28:31]
 MM a[24:27], v[220:223], a[172:175], a[24:27]
 MM a[24:27], v[216:219], a[168:171], a[24:27]
 MM a[24:27], v[212:215], a[164:167], a[24:27]
 MM a[24:27], v[208:211], a[160:163], a[24:27]
 MM a[20:23], v[208:211], a[144:147], a[20:23]
 s_add_u32 s43, s46, 937984
 MM a[20:23], v[212:215], a[148:151], a[20:23]
 MM a[20:23], v[216:219], a[152:155], a[20:23]
 buffer_load_dwordx4 a[200:203], v1, s[16:19], s36 offen offset:2048 sc1
 MM a[20:23], v[220:223], a[156:159], a[20:23]
 MM a[16:19], v[220:223], a[140:143], a[16:19]
 buffer_load_dwordx4 v9, s[20:23], s43 offen offset:2048 lds
 MM a[16:19], v[216:219], a[136:139], a[16:19]
 ds_read_b64_tr_b16 v[192:193], v15 offset:16384
 ds_read_b64_tr_b16 v[194:195], v15 offset:16896
 MM a[16:19], v[212:215], a[132:135], a[16:19]
 ds_read_b64_tr_b16 v[196:197], v15 offset:20480
 ds_read_b64_tr_b16 v[198:199], v15 offset:20992
 MM a[16:19], v[208:211], a[128:131], a[16:19]
 s_waitcnt lgkmcnt(4)
 ds_read_b64_tr_b16 v[200:201], v15 offset:24576
 ds_read_b64_tr_b16 v[202:203], v15 offset:25088
 MM a[32:35], v[224:227], a[128:131], a[32:35]
 buffer_store_dwordx4 v[28:31], v1, s[16:19], s88 offen offset:1024 sc1
 MM a[32:35], v[228:231], a[132:135], a[32:35]
 ds_read_b64_tr_b16 v[204:205], v15 offset:28672
 ds_read_b64_tr_b16 v[206:207], v15 offset:29184
 MM a[32:35], v[232:235], a[136:139], a[32:35]
 MM a[32:35], v[236:239], a[140:143], a[32:35]
 MM a[36:39], v[236:239], a[156:159], a[36:39]
 MM a[36:39], v[232:235], a[152:155], a[36:39]
 s_add_u32 s40, s46, 964608
 MM a[36:39], v[228:231], a[148:151], a[36:39]
 buffer_load_dwordx4 a[204:207], v1, s[16:19], s36 offen offset:3072 sc1
 MM a[36:39], v[224:227], a[144:147], a[36:39]
 s_add_u32 s36, s36, 0x1000
 MM a[40:43], v[224:227], a[160:163], a[40:43]
 MM a[40:43], v[228:231], a[164:167], a[40:43]
 buffer_load_dwordx4 v10, s[20:23], s40 offen offset:3072 lds
 MM a[40:43], v[232:235], a[168:171], a[40:43]
 MM a[40:43], v[236:239], a[172:175], a[40:43]
 MM a[44:47], v[236:239], a[188:191], a[44:47]
 ds_read_b64_tr_b16 v[208:209], v16 offset:16384
 ds_read_b64_tr_b16 v[210:211], v16 offset:16896
 MM a[44:47], v[232:235], a[184:187], a[44:47]
 ds_read_b64_tr_b16 v[212:213], v16 offset:20480
 ds_read_b64_tr_b16 v[214:215], v16 offset:20992
 MM a[44:47], v[228:231], a[180:183], a[44:47]
 ds_read_b64_tr_b16 v[216:217], v16 offset:24576
 ds_read_b64_tr_b16 v[218:219], v16 offset:25088
 MM a[44:47], v[224:227], a[176:179], a[44:47]
 ds_read_b64_tr_b16 v[220:221], v16 offset:28672
 ds_read_b64_tr_b16 v[222:223], v16 offset:29184
 MM a[60:63], v[240:243], a[176:179], a[60:63]
 MM a[60:63], v[244:247], a[180:183], a[60:63]
 MM a[60:63], v[248:251], a[184:187], a[60:63]
 s_add_u32 m0, s47, 16384
 s_add_u32 s41, s46, 884736
 ds_read_b128 v[28:31], v22 offset:3072
 MM a[60:63], v[252:255], a[188:191], a[60:63]
 buffer_load_dwordx4 a[208:211], v1, s[16:19], s37 offen offset:0 sc1
 MM a[56:59], v[252:255], a[172:175], a[56:59]
 MM a[56:59], v[248:251], a[168:171], a[56:59]
 MM a[56:59], v[244:247], a[164:167], a[56:59]
 buffer_load_dwordx4 v9, s[52:55], s41 offen offset:0 lds
 MM a[56:59], v[240:243], a[160:163], a[56:59]
 MM a[52:55], v[240:243], a[144:147], a[52:55]
 MM a[52:55], v[244:247], a[148:151], a[52:55]
 MM a[52:55], v[248:251], a[152:155], a[52:55]
 MM a[52:55], v[252:255], a[156:159], a[52:55]
 MM a[48:51], v[252:255], a[140:143], a[48:51]
 ds_read_b64_tr_b16 v[224:225], v17 offset:16384
 ds_read_b64_tr_b16 v[226:227], v17 offset:16896
 MM a[48:51], v[248:251], a[136:139], a[48:51]
 s_waitcnt lgkmcnt(2)
 ds_read_b64_tr_b16 v[228:229], v17 offset:20480
 ds_read_b64_tr_b16 v[230:231], v17 offset:20992
 MM a[48:51], v[244:247], a[132:135], a[48:51]
 buffer_load_dwordx4 a[212:215], v1, s[16:19], s37 offen offset:1024 sc1
 MM a[48:51], v[240:243], a[128:131], a[48:51]
 s_add_u32 s42, s46, 911360
 ds_read_b64_tr_b16 v[232:233], v17 offset:24576
 ds_read_b64_tr_b16 v[234:235], v17 offset:25088
 MM a[64:67], v[192:195], a[128:131], a[64:67]
 ds_read_b64_tr_b16 v[236:237], v17 offset:28672
 ds_read_b64_tr_b16 v[238:239], v17 offset:29184
 MM a[64:67], v[196:199], a[132:135], a[64:67]
 MM a[64:67], v[200:203], a[136:139], a[64:67]
 buffer_store_dwordx4 v[28:31], v1, s[16:19], s90 offen offset:1024 sc1
 MM a[64:67], v[204:207], a[140:143], a[64:67]
 buffer_load_dwordx4 v10, s[52:55], s42 offen offset:1024 lds
 MM a[68:71], v[204:207], a[156:159], a[68:71]
 MM a[68:71], v[200:203], a[152:155], a[68:71]
 MM a[68:71], v[196:199], a[148:151], a[68:71]
 MM a[68:71], v[192:195], a[144:147], a[68:71]
 MM a[72:75], v[192:195], a[160:163], a[72:75]
 MM a[72:75], v[196:199], a[164:167], a[72:75]
 MM a[72:75], v[200:203], a[168:171], a[72:75]
 buffer_load_dwordx4 a[216:219], v1, s[16:19], s37 offen offset:2048 sc1
 MM a[72:75], v[204:207], a[172:175], a[72:75]
 s_mov_b32 s3, s60
 s_add_u32 s3, s3, s100
 v_mov_b32 v21, s61
 MM a[76:79], v[204:207], a[188:191], a[76:79]
 s_add_u32 s43, s46, 937984
 ds_read_b64_tr_b16 v[240:241], v18 offset:16384
 ds_read_b64_tr_b16 v[242:243], v18 offset:16896
 MM a[76:79], v[200:203], a[184:187], a[76:79]
 ds_read_b64_tr_b16 v[244:245], v18 offset:20480
 ds_read_b64_tr_b16 v[246:247], v18 offset:20992
 MM a[76:79], v[196:199], a[180:183], a[76:79]
 ds_read_b64_tr_b16 v[248:249], v18 offset:24576
 ds_read_b64_tr_b16 v[250:251], v18 offset:25088
 MM a[76:79], v[192:195], a[176:179], a[76:79]
 ds_read_b64_tr_b16 v[252:253], v18 offset:28672
 ds_read_b64_tr_b16 v[254:255], v18 offset:29184
 MM a[92:95], v[208:211], a[176:179], a[92:95]
 buffer_load_dwordx4 v9, s[52:55], s43 offen offset:2048 lds
 MM a[92:95], v[212:215], a[180:183], a[92:95]
 MM a[92:95], v[216:219], a[184:187], a[92:95]
 MM a[92:95], v[220:223], a[188:191], a[92:95]
 MM a[88:91], v[220:223], a[172:175], a[88:91]
 ds_read_b128 v[28:31], v22 offset:4096
 MM a[88:91], v[216:219], a[168:171], a[88:91]
 MM a[88:91], v[212:215], a[164:167], a[88:91]
 buffer_load_dwordx4 a[220:223], v1, s[16:19], s37 offen offset:3072 sc1
 MM a[88:91], v[208:211], a[160:163], a[88:91]
 s_add_u32 s37, s37, 0x1000
 MM a[84:87], v[208:211], a[144:147], a[84:87]
 MM a[84:87], v[212:215], a[148:151], a[84:87]
 s_add_u32 s40, s46, 964608
 MM a[84:87], v[216:219], a[152:155], a[84:87]
 MM a[84:87], v[220:223], a[156:159], a[84:87]
 MM a[80:83], v[220:223], a[140:143], a[80:83]
 MM a[80:83], v[216:219], a[136:139], a[80:83]
 buffer_load_dwordx4 v10, s[52:55], s40 offen offset:3072 lds
 MM a[80:83], v[212:215], a[132:135], a[80:83]
 MM a[80:83], v[208:211], a[128:131], a[80:83]
 s_waitcnt lgkmcnt(0)
 MM a[96:99], v[224:227], a[128:131], a[96:99]
 MM a[96:99], v[228:231], a[132:135], a[96:99]
 MM a[96:99], v[232:235], a[136:139], a[96:99]
 buffer_load_dwordx4 a[224:227], v1, s[16:19], s38 offen offset:0 sc1
 MM a[96:99], v[236:239], a[140:143], a[96:99]
 MM a[100:103], v[236:239], a[156:159], a[100:103]
 buffer_store_dwordx4 v[28:31], v1, s[16:19], s88 offen offset:2048 sc1
 MM a[100:103], v[232:235], a[152:155], a[100:103]
 MM a[100:103], v[228:231], a[148:151], a[100:103]
 MM a[100:103], v[224:227], a[144:147], a[100:103]
 MM a[104:107], v[224:227], a[160:163], a[104:107]
 MM a[104:107], v[228:231], a[164:167], a[104:107]
 MM a[104:107], v[232:235], a[168:171], a[104:107]
 s_waitcnt vmcnt(21)
 s_barrier
 ds_read_b64_tr_b16 v[192:193], v15 offset:32768
 MM a[104:107], v[236:239], a[172:175], a[104:107]
 ds_read_b64_tr_b16 v[194:195], v15 offset:33280
 ds_read_b64_tr_b16 v[196:197], v15 offset:36864
 MM a[108:111], v[236:239], a[188:191], a[108:111]
 s_mov_b64 exec, 1
 buffer_store_dword v21, off, s[16:19], s3 sc1
 s_mov_b64 exec, -1
 MM a[108:111], v[232:235], a[184:187], a[108:111]
 buffer_load_dwordx4 a[228:231], v1, s[16:19], s38 offen offset:1024 sc1
 MM a[108:111], v[228:231], a[180:183], a[108:111]
 ds_read_b64_tr_b16 v[198:199], v15 offset:37376
 ds_read_b64_tr_b16 v[200:201], v15 offset:40960
 MM a[108:111], v[224:227], a[176:179], a[108:111]
 ds_read_b64_tr_b16 v[202:203], v15 offset:41472
 ds_read_b64_tr_b16 v[204:205], v15 offset:45056
 MM a[124:127], v[240:243], a[176:179], a[124:127]
 ds_read_b64_tr_b16 v[206:207], v15 offset:45568
 ds_read_b64_tr_b16 v[208:209], v16 offset:32768
 MM a[124:127], v[244:247], a[180:183], a[124:127]
 ds_read_b64_tr_b16 v[210:211], v16 offset:33280
 ds_read_b64_tr_b16 v[212:213], v16 offset:36864
 MM a[124:127], v[248:251], a[184:187], a[124:127]
 ds_read_b64_tr_b16 v[214:215], v16 offset:37376
 ds_read_b64_tr_b16 v[216:217], v16 offset:40960
 MM a[124:127], v[252:255], a[188:191], a[124:127]
 ds_read_b64_tr_b16 v[218:219], v16 offset:41472
 ds_read_b64_tr_b16 v[220:221], v16 offset:45056
 MM a[120:123], v[252:255], a[172:175], a[120:123]
 ds_read_b64_tr_b16 v[222:223], v16 offset:45568
 MM a[120:123], v[248:251], a[168:171], a[120:123]
 MM a[120:123], v[244:247], a[164:167], a[120:123]
 ds_read_b128 v[28:31], v22 offset:5120
 MM a[120:123], v[240:243], a[160:163], a[120:123]
 MM a[116:119], v[240:243], a[144:147], a[116:119]
 MM a[116:119], v[244:247], a[148:151], a[116:119]
 buffer_load_dwordx4 a[232:235], v1, s[16:19], s38 offen offset:2048 sc1
 MM a[116:119], v[248:251], a[152:155], a[116:119]
 MM a[116:119], v[252:255], a[156:159], a[116:119]
 MM a[112:115], v[252:255], a[140:143], a[112:115]
 ds_read_b64_tr_b16 v[224:225], v17 offset:32768
 ds_read_b64_tr_b16 v[226:227], v17 offset:33280
 MM a[112:115], v[248:251], a[136:139], a[112:115]
 ds_read_b64_tr_b16 v[228:229], v17 offset:36864
 ds_read_b64_tr_b16 v[230:231], v17 offset:37376
 MM a[112:115], v[244:247], a[132:135], a[112:115]
 s_add_u32 m0, s47, 32768
 s_add_u32 s41, s45, 2097152
 ds_read_b64_tr_b16 v[232:233], v17 offset:40960
 MM a[112:115], v[240:243], a[128:131], a[112:115]
 s_waitcnt lgkmcnt(5)
 ds_read_b64_tr_b16 v[234:235], v17 offset:41472
 ds_read_b64_tr_b16 v[236:237], v17 offset:45056
 MM v[64:67], v[192:195], a[128:131], v[64:67]
 ds_read_b64_tr_b16 v[238:239], v17 offset:45568
 MM v[64:67], v[196:199], a[132:135], v[64:67]
 MM v[64:67], v[200:203], a[136:139], v[64:67]
 buffer_load_dwordx4 v7, s[48:51], s41 offen offset:0 lds
 MM v[64:67], v[204:207], a[140:143], v[64:67]
 MM v[68:71], v[204:207], a[156:159], v[68:71]
 MM v[68:71], v[200:203], a[152:155], v[68:71]
 buffer_load_dwordx4 a[236:239], v1, s[16:19], s38 offen offset:3072 sc1
 MM v[68:71], v[196:199], a[148:151], v[68:71]
 buffer_store_dwordx4 v[28:31], v1, s[16:19], s90 offen offset:2048 sc1
 MM v[68:71], v[192:195], a[144:147], v[68:71]
 s_add_u32 s38, s38, 0x1000
 MM v[72:75], v[192:195], a[160:163], v[72:75]
 MM v[72:75], v[196:199], a[164:167], v[72:75]
 MM v[72:75], v[200:203], a[168:171], v[72:75]
 MM v[72:75], v[204:207], a[172:175], v[72:75]
 s_add_u32 s42, s45, 2161664
 MM v[76:79], v[204:207], a[188:191], v[76:79]
 ds_read_b64_tr_b16 v[240:241], v18 offset:32768
 ds_read_b64_tr_b16 v[242:243], v18 offset:33280
 MM v[76:79], v[200:203], a[184:187], v[76:79]
 ds_read_b64_tr_b16 v[244:245], v18 offset:36864
 ds_read_b64_tr_b16 v[246:247], v18 offset:37376
 MM v[76:79], v[196:199], a[180:183], v[76:79]
 ds_read_b64_tr_b16 v[248:249], v18 offset:40960
 ds_read_b64_tr_b16 v[250:251], v18 offset:41472
 MM v[76:79], v[192:195], a[176:179], v[76:79]
 buffer_load_dwordx4 v8, s[48:51], s42 offen offset:1024 lds
 MM v[92:95], v[208:211], a[176:179], v[92:95]
 ds_read_b64_tr_b16 v[252:253], v18 offset:45056
 ds_read_b64_tr_b16 v[254:255], v18 offset:45568
 MM v[92:95], v[212:215], a[180:183], v[92:95]
 buffer_load_dwordx4 a[240:243], v1, s[16:19], s39 offen offset:0 sc1
 MM v[92:95], v[216:219], a[184:187], v[92:95]
 MM v[92:95], v[220:223], a[188:191], v[92:95]
 MM v[88:91], v[220:223], a[172:175], v[88:91]
 MM v[88:91], v[216:219], a[168:171], v[88:91]
 MM v[88:91], v[212:215], a[164:167], v[88:91]
 MM v[88:91], v[208:211], a[160:163], v[88:91]
 MM v[84:87], v[208:211], a[144:147], v[84:87]
 s_add_u32 s43, s45, 2226176
 ds_read_b128 v[28:31], v22 offset:6144
 MM v[84:87], v[212:215], a[148:151], v[84:87]
 MM v[84:87], v[216:219], a[152:155], v[84:87]
 MM v[84:87], v[220:223], a[156:159], v[84:87]
 MM v[80:83], v[220:223], a[140:143], v[80:83]
 buffer_load_dwordx4 v7, s[48:51], s43 offen offset:2048 lds
 MM v[80:83], v[216:219], a[136:139], v[80:83]
 buffer_load_dwordx4 a[244:247], v1, s[16:19], s39 offen offset:1024 sc1
 MM v[80:83], v[212:215], a[132:135], v[80:83]
 ds_read_b64_tr_b16 v[192:193], v15 offset:49152
 ds_read_b64_tr_b16 v[194:195], v15 offset:49664
 MM v[80:83], v[208:211], a[128:131], v[80:83]
 s_waitcnt lgkmcnt(2)
 ds_read_b64_tr_b16 v[196:197], v15 offset:53248
 ds_read_b64_tr_b16 v[198:199], v15 offset:53760
 MM v[96:99], v[224:227], a[128:131], v[96:99]
 ds_read_b64_tr_b16 v[200:201], v15 offset:57344
 ds_read_b64_tr_b16 v[202:203], v15 offset:57856
 MM v[96:99], v[228:231], a[132:135], v[96:99]
 ds_read_b64_tr_b16 v[204:205], v15 offset:61440
 ds_read_b64_tr_b16 v[206:207], v15 offset:61952
 MM v[96:99], v[232:235], a[136:139], v[96:99]
 MM v[96:99], v[236:239], a[140:143], v[96:99]
 MM v[100:103], v[236:239], a[156:159], v[100:103]
 MM v[100:103], v[232:235], a[152:155], v[100:103]
 s_add_u32 s40, s45, 2290688
 MM v[100:103], v[228:231], a[148:151], v[100:103]
 MM v[100:103], v[224:227], a[144:147], v[100:103]
 MM v[104:107], v[224:227], a[160:163], v[104:107]
 buffer_store_dwordx4 v[28:31], v1, s[16:19], s88 offen offset:3072 sc1
 MM v[104:107], v[228:231], a[164:167], v[104:107]
 buffer_load_dwordx4 a[248:251], v1, s[16:19], s39 offen offset:2048 sc1
 MM v[104:107], v[232:235], a[168:171], v[104:107]
 buffer_load_dwordx4 v8, s[48:51], s40 offen offset:3072 lds
 MM v[104:107], v[236:239], a[172:175], v[104:107]
 MM v[108:111], v[236:239], a[188:191], v[108:111]
 ds_read_b64_tr_b16 v[208:209], v16 offset:49152
 ds_read_b64_tr_b16 v[210:211], v16 offset:49664
 MM v[108:111], v[232:235], a[184:187], v[108:111]
 ds_read_b64_tr_b16 v[212:213], v16 offset:53248
 ds_read_b64_tr_b16 v[214:215], v16 offset:53760
 MM v[108:111], v[228:231], a[180:183], v[108:111]
 ds_read_b64_tr_b16 v[216:217], v16 offset:57344
 ds_read_b64_tr_b16 v[218:219], v16 offset:57856
 MM v[108:111], v[224:227], a[176:179], v[108:111]
 ds_read_b64_tr_b16 v[220:221], v16 offset:61440
 ds_read_b64_tr_b16 v[222:223], v16 offset:61952
 MM v[124:127], v[240:243], a[176:179], v[124:127]
 MM v[124:127], v[244:247], a[180:183], v[124:127]
 MM v[124:127], v[248:251], a[184:187], v[124:127]
 s_add_u32 m0, s47, 49152
 s_add_u32 s41, s45, 2097280
 v_lshrrev_b32 v19, 4, v1
 MM v[124:127], v[252:255], a[188:191], v[124:127]
 s_mul_i32 s92, s24, 320
 v_add_u32 v19, s92, v19
 MM v[120:123], v[252:255], a[172:175], v[120:123]
 MM v[120:123], v[248:251], a[168:171], v[120:123]
 buffer_load_dwordx4 a[252:255], v1, s[16:19], s39 offen offset:3072 sc1
 MM v[120:123], v[244:247], a[164:167], v[120:123]
 buffer_load_dwordx4 v7, s[48:51], s41 offen offset:0 lds
 MM v[120:123], v[240:243], a[160:163], v[120:123]
 s_add_u32 s39, s39, 0x1000
 MM v[116:119], v[240:243], a[144:147], v[116:119]
 MM v[116:119], v[244:247], a[148:151], v[116:119]
 MM v[116:119], v[248:251], a[152:155], v[116:119]
 ds_read_b128 v[28:31], v22 offset:7168
 MM v[116:119], v[252:255], a[156:159], v[116:119]
 MM v[112:115], v[252:255], a[140:143], v[112:115]
 ds_read_b64_tr_b16 v[224:225], v17 offset:49152
 ds_read_b64_tr_b16 v[226:227], v17 offset:49664
 MM v[112:115], v[248:251], a[136:139], v[112:115]
 ds_read_b64_tr_b16 v[228:229], v17 offset:53248
 ds_read_b64_tr_b16 v[230:231], v17 offset:53760
 MM v[112:115], v[244:247], a[132:135], v[112:115]
 s_waitcnt lgkmcnt(5)
 ds_read_b64_tr_b16 v[232:233], v17 offset:57344
 ds_read_b64_tr_b16 v[234:235], v17 offset:57856
 MM v[112:115], v[240:243], a[128:131], v[112:115]
 s_add_u32 s42, s45, 2161792
 ds_read_b64_tr_b16 v[236:237], v17 offset:61440
 ds_read_b64_tr_b16 v[238:239], v17 offset:61952
 MM v[128:131], v[192:195], a[128:131], v[128:131]
 MM v[128:131], v[196:199], a[132:135], v[128:131]
 MM v[128:131], v[200:203], a[136:139], v[128:131]
 MM v[128:131], v[204:207], a[140:143], v[128:131]
 buffer_load_dwordx4 v8, s[48:51], s42 offen offset:1024 lds
 MM v[132:135], v[204:207], a[156:159], v[132:135]
 MM v[132:135], v[200:203], a[152:155], v[132:135]
 MM v[132:135], v[196:199], a[148:151], v[132:135]
 MM v[132:135], v[192:195], a[144:147], v[132:135]
 MM v[136:139], v[192:195], a[160:163], v[136:139]
 MM v[136:139], v[196:199], a[164:167], v[136:139]
 MM v[136:139], v[200:203], a[168:171], v[136:139]
 s_waitcnt lgkmcnt(0)
 buffer_store_dwordx4 v[28:31], v1, s[16:19], s90 offen offset:3072 sc1
 MM v[136:139], v[204:207], a[172:175], v[136:139]
 MM v[140:143], v[204:207], a[188:191], v[140:143]
 s_add_u32 s43, s45, 2226304
 ds_read_b64_tr_b16 v[240:241], v18 offset:49152
 v_mov_b32 v28, 0x3f803f80
 MM v[140:143], v[200:203], a[184:187], v[140:143]
 ds_read_b64_tr_b16 v[242:243], v18 offset:49664
 v_mov_b32 v29, 0x3f803f80
 MM v[140:143], v[196:199], a[180:183], v[140:143]
 ds_read_b64_tr_b16 v[244:245], v18 offset:53248
 v_mov_b32 v30, 0x3f803f80
 MM v[140:143], v[192:195], a[176:179], v[140:143]
 ds_read_b64_tr_b16 v[246:247], v18 offset:53760
 v_mov_b32 v31, 0x3f803f80
 MM v[156:159], v[208:211], a[176:179], v[156:159]
 buffer_load_dwordx4 v7, s[48:51], s43 offen offset:2048 lds
 MM v[156:159], v[212:215], a[180:183], v[156:159]
 ds_read_b64_tr_b16 v[248:249], v18 offset:57344
 ds_read_b64_tr_b16 v[250:251], v18 offset:57856
 MM v[156:159], v[216:219], a[184:187], v[156:159]
 ds_read_b64_tr_b16 v[252:253], v18 offset:61440
 ds_read_b64_tr_b16 v[254:255], v18 offset:61952
 MM v[156:159], v[220:223], a[188:191], v[156:159]
 MM v[152:155], v[220:223], a[172:175], v[152:155]
 MM v[152:155], v[216:219], a[168:171], v[152:155]
 MM v[152:155], v[212:215], a[164:167], v[152:155]
 MM v[152:155], v[208:211], a[160:163], v[152:155]
 MM v[148:151], v[208:211], a[144:147], v[148:151]
 MM v[148:151], v[212:215], a[148:151], v[148:151]
 s_add_u32 s40, s45, 2290816
 MM v[148:151], v[216:219], a[152:155], v[148:151]
 MM v[148:151], v[220:223], a[156:159], v[148:151]
 MM v[144:147], v[220:223], a[140:143], v[144:147]
 MM v[144:147], v[216:219], a[136:139], v[144:147]
 buffer_load_dwordx4 v8, s[48:51], s40 offen offset:3072 lds
 MM v[144:147], v[212:215], a[132:135], v[144:147]
 MM v[144:147], v[208:211], a[128:131], v[144:147]
 MM v[160:163], v[224:227], a[128:131], v[160:163]
 MM v[160:163], v[228:231], a[132:135], v[160:163]
 MM v[160:163], v[232:235], a[136:139], v[160:163]
 MM v[160:163], v[236:239], a[140:143], v[160:163]
 MM v[164:167], v[236:239], a[156:159], v[164:167]
 MM v[164:167], v[232:235], a[152:155], v[164:167]
 MM v[164:167], v[228:231], a[148:151], v[164:167]
 MM v[164:167], v[224:227], a[144:147], v[164:167]
 MM v[168:171], v[224:227], a[160:163], v[168:171]
 MM v[168:171], v[228:231], a[164:167], v[168:171]
 MM v[168:171], v[232:235], a[168:171], v[168:171]
 s_waitcnt vmcnt(21)
 s_barrier
 ds_read_b64_tr_b16 v[192:193], v11 offset:0
 MM v[168:171], v[236:239], a[172:175], v[168:171]
 ds_read_b64_tr_b16 v[194:195], v11 offset:512
 v_add_u32 v24, 0, v19
 MM v[172:175], v[236:239], a[188:191], v[172:175]
 v_mul_u32_u24 v20, 1639, v24
 v_lshrrev_b32 v20, 16, v20
 MM v[172:175], v[232:235], a[184:187], v[172:175]
 s_waitcnt lgkmcnt(2)
 v_mul_u32_u24 v20, 640, v20
 v_lshl_add_u32 v24, v24, 4, v20
 MM v[172:175], v[228:231], a[180:183], v[172:175]
 s_add_u32 m0, s12, 0
 ds_read_b64_tr_b16 v[196:197], v11 offset:4096
 ds_read_b64_tr_b16 v[198:199], v11 offset:4608
 MM v[172:175], v[224:227], a[176:179], v[172:175]
 buffer_load_dwordx4 v24, s[56:59], s13 offen nt lds
 MM v[188:191], v[240:243], a[176:179], v[188:191]
 ds_read_b64_tr_b16 v[200:201], v11 offset:8192
 v_add_u32 v25, 64, v19
 MM v[188:191], v[244:247], a[180:183], v[188:191]
 ds_read_b64_tr_b16 v[202:203], v11 offset:8704
 v_mul_u32_u24 v20, 1639, v25
 MM v[188:191], v[248:251], a[184:187], v[188:191]
 ds_read_b64_tr_b16 v[204:205], v11 offset:12288
 v_lshrrev_b32 v20, 16, v20
 MM v[188:191], v[252:255], a[188:191], v[188:191]
 ds_read_b64_tr_b16 v[206:207], v11 offset:12800
 v_mul_u32_u24 v20, 640, v20
 MM v[184:187], v[252:255], a[172:175], v[184:187]
 v_lshl_add_u32 v25, v25, 4, v20
 s_add_u32 m0, s12, 1024
 MM v[184:187], v[248:251], a[168:171], v[184:187]
 buffer_load_dwordx4 v25, s[56:59], s13 offen nt lds
 MM v[184:187], v[244:247], a[164:167], v[184:187]
 v_add_u32 v24, 128, v19
 v_mul_u32_u24 v20, 1639, v24
 MM v[184:187], v[240:243], a[160:163], v[184:187]
 v_lshrrev_b32 v20, 16, v20
 v_mul_u32_u24 v20, 640, v20
 MM v[180:183], v[240:243], a[144:147], v[180:183]
 v_lshl_add_u32 v24, v24, 4, v20
 s_add_u32 m0, s12, 2048
 MM v[180:183], v[244:247], a[148:151], v[180:183]
 buffer_load_dwordx4 v24, s[56:59], s13 offen nt lds
 MM v[180:183], v[248:251], a[152:155], v[180:183]
 v_add_u32 v25, 192, v19
 v_mul_u32_u24 v20, 1639, v25
 MM v[180:183], v[252:255], a[156:159], v[180:183]
 v_lshrrev_b32 v20, 16, v20
 v_mul_u32_u24 v20, 640, v20
 MM v[176:179], v[252:255], a[140:143], v[176:179]
 v_lshl_add_u32 v25, v25, 4, v20
 s_add_u32 m0, s12, 3072
 MM v[176:179], v[248:251], a[136:139], v[176:179]
 buffer_load_dwordx4 v25, s[56:59], s13 offen nt lds
 MM v[176:179], v[244:247], a[132:135], v[176:179]
 v_add_u32 v24, 256, v19
 v_mul_u32_u24 v20, 1639, v24
 MM v[176:179], v[240:243], a[128:131], v[176:179]
 s_waitcnt lgkmcnt(0)
 v_lshrrev_b32 v20, 16, v20
 v_mul_u32_u24 v20, 640, v20
 MM a[0:3], v[192:195], a[192:195], a[0:3]
 v_lshl_add_u32 v24, v24, 4, v20
 s_add_u32 m0, s12, 4096
 MM a[0:3], v[196:199], a[196:199], a[0:3]
 buffer_load_dwordx4 v24, s[56:59], s13 offen nt lds
 MM a[0:3], v[200:203], a[200:203], a[0:3]
 s_add_u32 m0, s47, 65536
 ds_read_b64_tr_b16 v[208:209], v12 offset:0
 ds_read_b64_tr_b16 v[210:211], v12 offset:512
 MM a[0:3], v[204:207], a[204:207], a[0:3]
 s_add_u32 s41, s46, 1327104
 ds_read_b64_tr_b16 v[212:213], v12 offset:4096
 ds_read_b64_tr_b16 v[214:215], v12 offset:4608
 MM a[4:7], v[204:207], a[220:223], a[4:7]
 ds_read_b64_tr_b16 v[216:217], v12 offset:8192
 ds_read_b64_tr_b16 v[218:219], v12 offset:8704
 MM a[4:7], v[200:203], a[216:219], a[4:7]
 s_waitcnt vmcnt(25)
 ds_read_b64_tr_b16 v[220:221], v12 offset:12288
 ds_read_b64_tr_b16 v[222:223], v12 offset:12800
 MM a[4:7], v[196:199], a[212:215], a[4:7]
 buffer_load_dwordx4 v9, s[20:23], s41 offen offset:0 lds
 MM a[4:7], v[192:195], a[208:211], a[4:7]
 buffer_load_dwordx4 a[128:131], v1, s[16:19], s36 offen offset:0 sc1
 MM a[8:11], v[192:195], a[224:227], a[8:11]
 s_waitcnt vmcnt(24)
 ds_read_b64_tr_b16 v[224:225], v13 offset:0
 ds_read_b64_tr_b16 v[226:227], v13 offset:512
 MM a[8:11], v[196:199], a[228:231], a[8:11]
 s_waitcnt vmcnt(23)
 ds_read_b64_tr_b16 v[228:229], v13 offset:4096
 ds_read_b64_tr_b16 v[230:231], v13 offset:4608
 MM a[8:11], v[200:203], a[232:235], a[8:11]
 s_waitcnt vmcnt(21)
 ds_read_b64_tr_b16 v[232:233], v13 offset:8192
 ds_read_b64_tr_b16 v[234:235], v13 offset:8704
 MM a[8:11], v[204:207], a[236:239], a[8:11]
 s_add_u32 s42, s46, 1353728
 ds_read_b64_tr_b16 v[236:237], v13 offset:12288
 ds_read_b64_tr_b16 v[238:239], v13 offset:12800
 s_waitcnt vmcnt(12)
 MM a[12:15], v[204:207], a[252:255], a[12:15]
 ds_read_b64_tr_b16 v[240:241], v14 offset:0
 ds_read_b64_tr_b16 v[242:243], v14 offset:512
 MM a[12:15], v[200:203], a[248:251], a[12:15]
 s_waitcnt lgkmcnt(10)
 ds_read_b64_tr_b16 v[244:245], v14 offset:4096
 ds_read_b64_tr_b16 v[246:247], v14 offset:4608
 MM a[12:15], v[196:199], a[244:247], a[12:15]
 buffer_load_dwordx4 a[132:135], v1, s[16:19], s36 offen offset:1024 sc1
 MM a[12:15], v[192:195], a[240:243], a[12:15]
 buffer_load_dwordx4 v10, s[20:23], s42 offen offset:1024 lds
 MM a[28:31], v[208:211], a[240:243], a[28:31]
 ds_read_b64_tr_b16 v[248:249], v14 offset:8192
 ds_read_b64_tr_b16 v[250:251], v14 offset:8704
 MM a[28:31], v[212:215], a[244:247], a[28:31]
 ds_read_b64_tr_b16 v[252:253], v14 offset:12288
 ds_read_b64_tr_b16 v[254:255], v14 offset:12800
 MM a[28:31], v[216:219], a[248:251], a[28:31]
 MM a[28:31], v[220:223], a[252:255], a[28:31]
 MM a[24:27], v[220:223], a[236:239], a[24:27]
 MM a[24:27], v[216:219], a[232:235], a[24:27]
 MM a[24:27], v[212:215], a[228:231], a[24:27]
 MM a[24:27], v[208:211], a[224:227], a[24:27]
 MM a[20:23], v[208:211], a[208:211], a[20:23]
 s_add_u32 s43, s46, 1380352
 MM a[20:23], v[212:215], a[212:215], a[20:23]
 MM a[20:23], v[216:219], a[216:219], a[20:23]
 buffer_load_dwordx4 a[136:139], v1, s[16:19], s36 offen offset:2048 sc1
 MM a[20:23], v[220:223], a[220:223], a[20:23]
 MM a[16:19], v[220:223], a[204:207], a[16:19]
 buffer_load_dwordx4 v9, s[20:23], s43 offen offset:2048 lds
 MM a[16:19], v[216:219], a[200:203], a[16:19]
 ds_read_b64_tr_b16 v[192:193], v11 offset:16384
 ds_read_b64_tr_b16 v[194:195], v11 offset:16896
 MM a[16:19], v[212:215], a[196:199], a[16:19]
 ds_read_b64_tr_b16 v[196:197], v11 offset:20480
 ds_read_b64_tr_b16 v[198:199], v11 offset:20992
 MM a[16:19], v[208:211], a[192:195], a[16:19]
 s_waitcnt lgkmcnt(4)
 ds_read_b64_tr_b16 v[200:201], v11 offset:24576
 ds_read_b64_tr_b16 v[202:203], v11 offset:25088
 MM a[32:35], v[224:227], a[192:195], a[32:35]
 ds_read_b64_tr_b16 v[204:205], v11 offset:28672
 ds_read_b64_tr_b16 v[206:207], v11 offset:29184
 MM a[32:35], v[228:231], a[196:199], a[32:35]
 MM a[32:35], v[232:235], a[200:203], a[32:35]
 MM a[32:35], v[236:239], a[204:207], a[32:35]
 MM a[36:39], v[236:239], a[220:223], a[36:39]
 MM a[36:39], v[232:235], a[216:219], a[36:39]
 s_add_u32 s40, s46, 1406976
 MM a[36:39], v[228:231], a[212:215], a[36:39]
 buffer_load_dwordx4 a[140:143], v1, s[16:19], s36 offen offset:3072 sc1
 MM a[36:39], v[224:227], a[208:211], a[36:39]
 s_add_u32 s36, s36, 0x1000
 MM a[40:43], v[224:227], a[224:227], a[40:43]
 MM a[40:43], v[228:231], a[228:231], a[40:43]
 buffer_load_dwordx4 v10, s[20:23], s40 offen offset:3072 lds
 MM a[40:43], v[232:235], a[232:235], a[40:43]
 MM a[40:43], v[236:239], a[236:239], a[40:43]
 MM a[44:47], v[236:239], a[252:255], a[44:47]
 ds_read_b64_tr_b16 v[208:209], v12 offset:16384
 ds_read_b64_tr_b16 v[210:211], v12 offset:16896
 MM a[44:47], v[232:235], a[248:251], a[44:47]
 ds_read_b64_tr_b16 v[212:213], v12 offset:20480
 ds_read_b64_tr_b16 v[214:215], v12 offset:20992
 MM a[44:47], v[228:231], a[244:247], a[44:47]
 ds_read_b64_tr_b16 v[216:217], v12 offset:24576
 ds_read_b64_tr_b16 v[218:219], v12 offset:25088
 MM a[44:47], v[224:227], a[240:243], a[44:47]
 ds_read_b64_tr_b16 v[220:221], v12 offset:28672
 ds_read_b64_tr_b16 v[222:223], v12 offset:29184
 MM a[60:63], v[240:243], a[240:243], a[60:63]
 MM a[60:63], v[244:247], a[244:247], a[60:63]
 MM a[60:63], v[248:251], a[248:251], a[60:63]
 buffer_load_dwordx4 a[144:147], v1, s[16:19], s37 offen offset:0 sc1
 MM a[60:63], v[252:255], a[252:255], a[60:63]
 s_add_u32 m0, s47, 81920
 s_add_u32 s41, s46, 1327104
 MM a[56:59], v[252:255], a[236:239], a[56:59]
 MM a[56:59], v[248:251], a[232:235], a[56:59]
 MM a[56:59], v[244:247], a[228:231], a[56:59]
 buffer_load_dwordx4 v9, s[52:55], s41 offen offset:0 lds
 MM a[56:59], v[240:243], a[224:227], a[56:59]
 MM a[52:55], v[240:243], a[208:211], a[52:55]
 MM a[52:55], v[244:247], a[212:215], a[52:55]
 MM a[52:55], v[248:251], a[216:219], a[52:55]
 MM a[52:55], v[252:255], a[220:223], a[52:55]
 MM a[48:51], v[252:255], a[204:207], a[48:51]
 ds_read_b64_tr_b16 v[224:225], v13 offset:16384
 ds_read_b64_tr_b16 v[226:227], v13 offset:16896
 MM a[48:51], v[248:251], a[200:203], a[48:51]
 s_waitcnt lgkmcnt(2)
 ds_read_b64_tr_b16 v[228:229], v13 offset:20480
 ds_read_b64_tr_b16 v[230:231], v13 offset:20992
 MM a[48:51], v[244:247], a[196:199], a[48:51]
 buffer_load_dwordx4 a[148:151], v1, s[16:19], s37 offen offset:1024 sc1
 MM a[48:51], v[240:243], a[192:195], a[48:51]
 s_add_u32 s42, s46, 1353728
 ds_read_b64_tr_b16 v[232:233], v13 offset:24576
 ds_read_b64_tr_b16 v[234:235], v13 offset:25088
 MM a[64:67], v[192:195], a[192:195], a[64:67]
 ds_read_b64_tr_b16 v[236:237], v13 offset:28672
 ds_read_b64_tr_b16 v[238:239], v13 offset:29184
 MM a[64:67], v[196:199], a[196:199], a[64:67]
 MM a[64:67], v[200:203], a[200:203], a[64:67]
 MM a[64:67], v[204:207], a[204:207], a[64:67]
 buffer_load_dwordx4 v10, s[52:55], s42 offen offset:1024 lds
 MM a[68:71], v[204:207], a[220:223], a[68:71]
 MM a[68:71], v[200:203], a[216:219], a[68:71]
 MM a[68:71], v[196:199], a[212:215], a[68:71]
 MM a[68:71], v[192:195], a[208:211], a[68:71]
 MM a[72:75], v[192:195], a[224:227], a[72:75]
 MM a[72:75], v[196:199], a[228:231], a[72:75]
 MM a[72:75], v[200:203], a[232:235], a[72:75]
 buffer_load_dwordx4 a[152:155], v1, s[16:19], s37 offen offset:2048 sc1
 MM a[72:75], v[204:207], a[236:239], a[72:75]
 MM a[76:79], v[204:207], a[252:255], a[76:79]
 s_add_u32 s43, s46, 1380352
 ds_read_b64_tr_b16 v[240:241], v14 offset:16384
 ds_read_b64_tr_b16 v[242:243], v14 offset:16896
 MM a[76:79], v[200:203], a[248:251], a[76:79]
 ds_read_b64_tr_b16 v[244:245], v14 offset:20480
 ds_read_b64_tr_b16 v[246:247], v14 offset:20992
 MM a[76:79], v[196:199], a[244:247], a[76:79]
 ds_read_b64_tr_b16 v[248:249], v14 offset:24576
 ds_read_b64_tr_b16 v[250:251], v14 offset:25088
 MM a[76:79], v[192:195], a[240:243], a[76:79]
 ds_read_b64_tr_b16 v[252:253], v14 offset:28672
 ds_read_b64_tr_b16 v[254:255], v14 offset:29184
 MM a[92:95], v[208:211], a[240:243], a[92:95]
 buffer_load_dwordx4 v9, s[52:55], s43 offen offset:2048 lds
 MM a[92:95], v[212:215], a[244:247], a[92:95]
 MM a[92:95], v[216:219], a[248:251], a[92:95]
 MM a[92:95], v[220:223], a[252:255], a[92:95]
 MM a[88:91], v[220:223], a[236:239], a[88:91]
 MM a[88:91], v[216:219], a[232:235], a[88:91]
 MM a[88:91], v[212:215], a[228:231], a[88:91]
 buffer_load_dwordx4 a[156:159], v1, s[16:19], s37 offen offset:3072 sc1
 MM a[88:91], v[208:211], a[224:227], a[88:91]
 s_add_u32 s37, s37, 0x1000
 MM a[84:87], v[208:211], a[208:211], a[84:87]
 buffer_store_dwordx4 v[32:35], v1, s[16:19], s89 offen offset:0 sc1
 MM a[84:87], v[212:215], a[212:215], a[84:87]
 s_add_u32 s40, s46, 1406976
 MM a[84:87], v[216:219], a[216:219], a[84:87]
 MM a[84:87], v[220:223], a[220:223], a[84:87]
 MM a[80:83], v[220:223], a[204:207], a[80:83]
 MM a[80:83], v[216:219], a[200:203], a[80:83]
 buffer_load_dwordx4 v10, s[52:55], s40 offen offset:3072 lds
 MM a[80:83], v[212:215], a[196:199], a[80:83]
 MM a[80:83], v[208:211], a[192:195], a[80:83]
 s_waitcnt lgkmcnt(0)
 MM a[96:99], v[224:227], a[192:195], a[96:99]
 MM a[96:99], v[228:231], a[196:199], a[96:99]
 MM a[96:99], v[232:235], a[200:203], a[96:99]
 buffer_load_dwordx4 a[160:163], v1, s[16:19], s38 offen offset:0 sc1
 MM a[96:99], v[236:239], a[204:207], a[96:99]
 MM a[100:103], v[236:239], a[220:223], a[100:103]
 MM a[100:103], v[232:235], a[216:219], a[100:103]
 MM a[100:103], v[228:231], a[212:215], a[100:103]
 MM a[100:103], v[224:227], a[208:211], a[100:103]
 MM a[104:107], v[224:227], a[224:227], a[104:107]
 MM a[104:107], v[228:231], a[228:231], a[104:107]
 MM a[104:107], v[232:235], a[232:235], a[104:107]
 s_waitcnt vmcnt(23)
 s_barrier
 ds_read_b64_tr_b16 v[192:193], v11 offset:32768
 MM a[104:107], v[236:239], a[236:239], a[104:107]
 ds_read_b64_tr_b16 v[194:195], v11 offset:33280
 ds_read_b64_tr_b16 v[196:197], v11 offset:36864
 MM a[108:111], v[236:239], a[252:255], a[108:111]
 ds_read_b64_tr_b16 v[198:199], v11 offset:37376
 ds_read_b64_tr_b16 v[200:201], v11 offset:40960
 MM a[108:111], v[232:235], a[248:251], a[108:111]
 buffer_load_dwordx4 a[164:167], v1, s[16:19], s38 offen offset:1024 sc1
 MM a[108:111], v[228:231], a[244:247], a[108:111]
 buffer_store_dwordx4 v[36:39], v1, s[16:19], s91 offen offset:0 sc1
 MM a[108:111], v[224:227], a[240:243], a[108:111]
 ds_read_b64_tr_b16 v[202:203], v11 offset:41472
 ds_read_b64_tr_b16 v[204:205], v11 offset:45056
 MM a[124:127], v[240:243], a[240:243], a[124:127]
 ds_read_b64_tr_b16 v[206:207], v11 offset:45568
 ds_read_b64_tr_b16 v[208:209], v12 offset:32768
 MM a[124:127], v[244:247], a[244:247], a[124:127]
 ds_read_b64_tr_b16 v[210:211], v12 offset:33280
 ds_read_b64_tr_b16 v[212:213], v12 offset:36864
 MM a[124:127], v[248:251], a[248:251], a[124:127]
 ds_read_b64_tr_b16 v[214:215], v12 offset:37376
 ds_read_b64_tr_b16 v[216:217], v12 offset:40960
 MM a[124:127], v[252:255], a[252:255], a[124:127]
 ds_read_b64_tr_b16 v[218:219], v12 offset:41472
 ds_read_b64_tr_b16 v[220:221], v12 offset:45056
 MM a[120:123], v[252:255], a[236:239], a[120:123]
 ds_read_b64_tr_b16 v[222:223], v12 offset:45568
 MM a[120:123], v[248:251], a[232:235], a[120:123]
 MM a[120:123], v[244:247], a[228:231], a[120:123]
 MM a[120:123], v[240:243], a[224:227], a[120:123]
 MM a[116:119], v[240:243], a[208:211], a[116:119]
 MM a[116:119], v[244:247], a[212:215], a[116:119]
 buffer_load_dwordx4 a[168:171], v1, s[16:19], s38 offen offset:2048 sc1
 MM a[116:119], v[248:251], a[216:219], a[116:119]
 MM a[116:119], v[252:255], a[220:223], a[116:119]
 MM a[112:115], v[252:255], a[204:207], a[112:115]
 ds_read_b64_tr_b16 v[224:225], v13 offset:32768
 ds_read_b64_tr_b16 v[226:227], v13 offset:33280
 MM a[112:115], v[248:251], a[200:203], a[112:115]
 ds_read_b64_tr_b16 v[228:229], v13 offset:36864
 ds_read_b64_tr_b16 v[230:231], v13 offset:37376
 MM a[112:115], v[244:247], a[196:199], a[112:115]
 s_add_u32 m0, s47, 98304
 s_add_u32 s41, s46, 1769472
 ds_read_b64_tr_b16 v[232:233], v13 offset:40960
 MM a[112:115], v[240:243], a[192:195], a[112:115]
 s_waitcnt lgkmcnt(5)
 ds_read_b64_tr_b16 v[234:235], v13 offset:41472
 ds_read_b64_tr_b16 v[236:237], v13 offset:45056
 MM v[64:67], v[192:195], a[192:195], v[64:67]
 ds_read_b64_tr_b16 v[238:239], v13 offset:45568
 MM v[64:67], v[196:199], a[196:199], v[64:67]
 MM v[64:67], v[200:203], a[200:203], v[64:67]
 buffer_load_dwordx4 v9, s[20:23], s41 offen offset:0 lds
 MM v[64:67], v[204:207], a[204:207], v[64:67]
 MM v[68:71], v[204:207], a[220:223], v[68:71]
 buffer_store_dwordx4 v[40:43], v1, s[16:19], s89 offen offset:1024 sc1
 MM v[68:71], v[200:203], a[216:219], v[68:71]
 buffer_load_dwordx4 a[172:175], v1, s[16:19], s38 offen offset:3072 sc1
 MM v[68:71], v[196:199], a[212:215], v[68:71]
 s_add_u32 s38, s38, 0x1000
 MM v[68:71], v[192:195], a[208:211], v[68:71]
 MM v[72:75], v[192:195], a[224:227], v[72:75]
 MM v[72:75], v[196:199], a[228:231], v[72:75]
 MM v[72:75], v[200:203], a[232:235], v[72:75]
 MM v[72:75], v[204:207], a[236:239], v[72:75]
 s_add_u32 s42, s46, 1796096
 MM v[76:79], v[204:207], a[252:255], v[76:79]
 ds_read_b64_tr_b16 v[240:241], v14 offset:32768
 ds_read_b64_tr_b16 v[242:243], v14 offset:33280
 MM v[76:79], v[200:203], a[248:251], v[76:79]
 ds_read_b64_tr_b16 v[244:245], v14 offset:36864
 ds_read_b64_tr_b16 v[246:247], v14 offset:37376
 MM v[76:79], v[196:199], a[244:247], v[76:79]
 ds_read_b64_tr_b16 v[248:249], v14 offset:40960
 ds_read_b64_tr_b16 v[250:251], v14 offset:41472
 MM v[76:79], v[192:195], a[240:243], v[76:79]
 buffer_load_dwordx4 v10, s[20:23], s42 offen offset:1024 lds
 MM v[92:95], v[208:211], a[240:243], v[92:95]
 ds_read_b64_tr_b16 v[252:253], v14 offset:45056
 ds_read_b64_tr_b16 v[254:255], v14 offset:45568
 MM v[92:95], v[212:215], a[244:247], v[92:95]
 buffer_load_dwordx4 a[176:179], v1, s[16:19], s39 offen offset:0 sc1
 MM v[92:95], v[216:219], a[248:251], v[92:95]
 MM v[92:95], v[220:223], a[252:255], v[92:95]
 MM v[88:91], v[220:223], a[236:239], v[88:91]
 MM v[88:91], v[216:219], a[232:235], v[88:91]
 MM v[88:91], v[212:215], a[228:231], v[88:91]
 MM v[88:91], v[208:211], a[224:227], v[88:91]
 MM v[84:87], v[208:211], a[208:211], v[84:87]
 s_add_u32 s43, s46, 1822720
 MM v[84:87], v[212:215], a[212:215], v[84:87]
 MM v[84:87], v[216:219], a[216:219], v[84:87]
 buffer_store_dwordx4 v[44:47], v1, s[16:19], s91 offen offset:1024 sc1
 MM v[84:87], v[220:223], a[220:223], v[84:87]
 MM v[80:83], v[220:223], a[204:207], v[80:83]
 buffer_load_dwordx4 v9, s[20:23], s43 offen offset:2048 lds
 MM v[80:83], v[216:219], a[200:203], v[80:83]
 buffer_load_dwordx4 a[180:183], v1, s[16:19], s39 offen offset:1024 sc1
 MM v[80:83], v[212:215], a[196:199], v[80:83]
 ds_read_b64_tr_b16 v[192:193], v11 offset:49152
 ds_read_b64_tr_b16 v[194:195], v11 offset:49664
 MM v[80:83], v[208:211], a[192:195], v[80:83]
 s_waitcnt lgkmcnt(2)
 ds_read_b64_tr_b16 v[196:197], v11 offset:53248
 ds_read_b64_tr_b16 v[198:199], v11 offset:53760
 MM v[96:99], v[224:227], a[192:195], v[96:99]
 ds_read_b64_tr_b16 v[200:201], v11 offset:57344
 ds_read_b64_tr_b16 v[202:203], v11 offset:57856
 MM v[96:99], v[228:231], a[196:199], v[96:99]
 ds_read_b64_tr_b16 v[204:205], v11 offset:61440
 ds_read_b64_tr_b16 v[206:207], v11 offset:61952
 MM v[96:99], v[232:235], a[200:203], v[96:99]
 MM v[96:99], v[236:239], a[204:207], v[96:99]
 MM v[100:103], v[236:239], a[220:223], v[100:103]
 MM v[100:103], v[232:235], a[216:219], v[100:103]
 s_add_u32 s40, s46, 1849344
 MM v[100:103], v[228:231], a[212:215], v[100:103]
 MM v[100:103], v[224:227], a[208:211], v[100:103]
 MM v[104:107], v[224:227], a[224:227], v[104:107]
 MM v[104:107], v[228:231], a[228:231], v[104:107]
 buffer_load_dwordx4 a[184:187], v1, s[16:19], s39 offen offset:2048 sc1
 MM v[104:107], v[232:235], a[232:235], v[104:107]
 buffer_load_dwordx4 v10, s[20:23], s40 offen offset:3072 lds
 MM v[104:107], v[236:239], a[236:239], v[104:107]
 MM v[108:111], v[236:239], a[252:255], v[108:111]
 ds_read_b64_tr_b16 v[208:209], v12 offset:49152
 ds_read_b64_tr_b16 v[210:211], v12 offset:49664
 MM v[108:111], v[232:235], a[248:251], v[108:111]
 ds_read_b64_tr_b16 v[212:213], v12 offset:53248
 ds_read_b64_tr_b16 v[214:215], v12 offset:53760
 MM v[108:111], v[228:231], a[244:247], v[108:111]
 ds_read_b64_tr_b16 v[216:217], v12 offset:57344
 ds_read_b64_tr_b16 v[218:219], v12 offset:57856
 MM v[108:111], v[224:227], a[240:243], v[108:111]
 ds_read_b64_tr_b16 v[220:221], v12 offset:61440
 ds_read_b64_tr_b16 v[222:223], v12 offset:61952
 MM v[124:127], v[240:243], a[240:243], v[124:127]
 buffer_store_dwordx4 v[48:51], v1, s[16:19], s89 offen offset:2048 sc1
 MM v[124:127], v[244:247], a[244:247], v[124:127]
 MM v[124:127], v[248:251], a[248:251], v[124:127]
 s_add_u32 m0, s47, 114688
 s_add_u32 s41, s46, 1769472
 MM v[124:127], v[252:255], a[252:255], v[124:127]
 MM v[120:123], v[252:255], a[236:239], v[120:123]
 MM v[120:123], v[248:251], a[232:235], v[120:123]
 buffer_load_dwordx4 a[188:191], v1, s[16:19], s39 offen offset:3072 sc1
 MM v[120:123], v[244:247], a[228:231], v[120:123]
 buffer_load_dwordx4 v9, s[52:55], s41 offen offset:0 lds
 MM v[120:123], v[240:243], a[224:227], v[120:123]
 s_add_u32 s39, s39, 0x1000
 MM v[116:119], v[240:243], a[208:211], v[116:119]
 MM v[116:119], v[244:247], a[212:215], v[116:119]
 MM v[116:119], v[248:251], a[216:219], v[116:119]
 MM v[116:119], v[252:255], a[220:223], v[116:119]
 MM v[112:115], v[252:255], a[204:207], v[112:115]
 ds_read_b64_tr_b16 v[224:225], v13 offset:49152
 ds_read_b64_tr_b16 v[226:227], v13 offset:49664
 MM v[112:115], v[248:251], a[200:203], v[112:115]
 ds_read_b64_tr_b16 v[228:229], v13 offset:53248
 ds_read_b64_tr_b16 v[230:231], v13 offset:53760
 MM v[112:115], v[244:247], a[196:199], v[112:115]
 s_waitcnt lgkmcnt(4)
 ds_read_b64_tr_b16 v[232:233], v13 offset:57344
 ds_read_b64_tr_b16 v[234:235], v13 offset:57856
 MM v[112:115], v[240:243], a[192:195], v[112:115]
 s_add_u32 s42, s46, 1796096
 ds_read_b64_tr_b16 v[236:237], v13 offset:61440
 ds_read_b64_tr_b16 v[238:239], v13 offset:61952
 MM v[128:131], v[192:195], a[192:195], v[128:131]
 MM v[128:131], v[196:199], a[196:199], v[128:131]
 MM v[128:131], v[200:203], a[200:203], v[128:131]
 MM v[128:131], v[204:207], a[204:207], v[128:131]
 buffer_load_dwordx4 v10, s[52:55], s42 offen offset:1024 lds
 MM v[132:135], v[204:207], a[220:223], v[132:135]
 MM v[132:135], v[200:203], a[216:219], v[132:135]
 MM v[132:135], v[196:199], a[212:215], v[132:135]
 buffer_store_dwordx4 v[52:55], v1, s[16:19], s91 offen offset:2048 sc1
 MM v[132:135], v[192:195], a[208:211], v[132:135]
 MM v[136:139], v[192:195], a[224:227], v[136:139]
 MM v[136:139], v[196:199], a[228:231], v[136:139]
 MM v[136:139], v[200:203], a[232:235], v[136:139]
 MM v[136:139], v[204:207], a[236:239], v[136:139]
 MM v[140:143], v[204:207], a[252:255], v[140:143]
 s_add_u32 s43, s46, 1822720
 ds_read_b64_tr_b16 v[240:241], v14 offset:49152
 ds_read_b64_tr_b16 v[242:243], v14 offset:49664
 MM v[140:143], v[200:203], a[248:251], v[140:143]
 ds_read_b64_tr_b16 v[244:245], v14 offset:53248
 ds_read_b64_tr_b16 v[246:247], v14 offset:53760
 MM v[140:143], v[196:199], a[244:247], v[140:143]
 ds_read_b64_tr_b16 v[248:249], v14 offset:57344
 ds_read_b64_tr_b16 v[250:251], v14 offset:57856
 MM v[140:143], v[192:195], a[240:243], v[140:143]
 ds_read_b64_tr_b16 v[252:253], v14 offset:61440
 ds_read_b64_tr_b16 v[254:255], v14 offset:61952
 MM v[156:159], v[208:211], a[240:243], v[156:159]
 buffer_load_dwordx4 v9, s[52:55], s43 offen offset:2048 lds
 MM v[156:159], v[212:215], a[244:247], v[156:159]
 MM v[156:159], v[216:219], a[248:251], v[156:159]
 MM v[156:159], v[220:223], a[252:255], v[156:159]
 MM v[152:155], v[220:223], a[236:239], v[152:155]
 MM v[152:155], v[216:219], a[232:235], v[152:155]
 MM v[152:155], v[212:215], a[228:231], v[152:155]
 MM v[152:155], v[208:211], a[224:227], v[152:155]
 MM v[148:151], v[208:211], a[208:211], v[148:151]
 MM v[148:151], v[212:215], a[212:215], v[148:151]
 s_add_u32 s40, s46, 1849344
 MM v[148:151], v[216:219], a[216:219], v[148:151]
 MM v[148:151], v[220:223], a[220:223], v[148:151]
 MM v[144:147], v[220:223], a[204:207], v[144:147]
 buffer_store_dwordx4 v[56:59], v1, s[16:19], s89 offen offset:3072 sc1
 MM v[144:147], v[216:219], a[200:203], v[144:147]
 buffer_load_dwordx4 v10, s[52:55], s40 offen offset:3072 lds
 MM v[144:147], v[212:215], a[196:199], v[144:147]
 MM v[144:147], v[208:211], a[192:195], v[144:147]
 s_waitcnt lgkmcnt(0)
 MM v[160:163], v[224:227], a[192:195], v[160:163]
 MM v[160:163], v[228:231], a[196:199], v[160:163]
 MM v[160:163], v[232:235], a[200:203], v[160:163]
 MM v[160:163], v[236:239], a[204:207], v[160:163]
 MM v[164:167], v[236:239], a[220:223], v[164:167]
 MM v[164:167], v[232:235], a[216:219], v[164:167]
 MM v[164:167], v[228:231], a[212:215], v[164:167]
 MM v[164:167], v[224:227], a[208:211], v[164:167]
 MM v[168:171], v[224:227], a[224:227], v[168:171]
 MM v[168:171], v[228:231], a[228:231], v[168:171]
 MM v[168:171], v[232:235], a[232:235], v[168:171]
 s_waitcnt vmcnt(22)
 s_barrier
 ds_read_b64_tr_b16 v[192:193], v15 offset:0
 MM v[168:171], v[236:239], a[236:239], v[168:171]
 ds_read_b64_tr_b16 v[194:195], v15 offset:512
 ds_read_b64_tr_b16 v[196:197], v15 offset:4096
 MM v[172:175], v[236:239], a[252:255], v[172:175]
 ds_read_b64_tr_b16 v[198:199], v15 offset:4608
 ds_read_b64_tr_b16 v[200:201], v15 offset:8192
 MM v[172:175], v[232:235], a[248:251], v[172:175]
 ds_read_b64_tr_b16 v[202:203], v15 offset:8704
 ds_read_b64_tr_b16 v[204:205], v15 offset:12288
 MM v[172:175], v[228:231], a[244:247], v[172:175]
 ds_read_b64_tr_b16 v[206:207], v15 offset:12800
 ds_read_b64_tr_b16 v[208:209], v16 offset:0
 MM v[172:175], v[224:227], a[240:243], v[172:175]
 ds_read_b64_tr_b16 v[210:211], v16 offset:512
 ds_read_b64_tr_b16 v[212:213], v16 offset:4096
 MM v[188:191], v[240:243], a[240:243], v[188:191]
 ds_read_b64_tr_b16 v[214:215], v16 offset:4608
 ds_read_b64_tr_b16 v[216:217], v16 offset:8192
 MM v[188:191], v[244:247], a[244:247], v[188:191]
 ds_read_b64_tr_b16 v[218:219], v16 offset:8704
 ds_read_b64_tr_b16 v[220:221], v16 offset:12288
 MM v[188:191], v[248:251], a[248:251], v[188:191]
 buffer_store_dwordx4 v[60:63], v1, s[16:19], s91 offen offset:3072 sc1
 MM v[188:191], v[252:255], a[252:255], v[188:191]
 ds_read_b64_tr_b16 v[222:223], v16 offset:12800
 MM v[184:187], v[252:255], a[236:239], v[184:187]
 MM v[184:187], v[248:251], a[232:235], v[184:187]
 MM v[184:187], v[244:247], a[228:231], v[184:187]
 MM v[184:187], v[240:243], a[224:227], v[184:187]
 MM v[180:183], v[240:243], a[208:211], v[180:183]
 MM v[180:183], v[244:247], a[212:215], v[180:183]
 MM v[180:183], v[248:251], a[216:219], v[180:183]
 MM v[180:183], v[252:255], a[220:223], v[180:183]
 MM v[176:179], v[252:255], a[204:207], v[176:179]
 ds_read_b64_tr_b16 v[224:225], v17 offset:0
 ds_read_b64_tr_b16 v[226:227], v17 offset:512
 MM v[176:179], v[248:251], a[200:203], v[176:179]
 ds_read_b64_tr_b16 v[228:229], v17 offset:4096
 ds_read_b64_tr_b16 v[230:231], v17 offset:4608
 MM v[176:179], v[244:247], a[196:199], v[176:179]
 s_add_u32 m0, s47, 0
 s_add_u32 s41, s45, 3145728
 ds_read_b64_tr_b16 v[232:233], v17 offset:8192
 MM v[176:179], v[240:243], a[192:195], v[176:179]
 s_waitcnt lgkmcnt(5)
 ds_read_b64_tr_b16 v[234:235], v17 offset:8704
 ds_read_b64_tr_b16 v[236:237], v17 offset:12288
 MM a[0:3], v[192:195], a[128:131], a[0:3]
 ds_read_b64_tr_b16 v[238:239], v17 offset:12800
 MM a[0:3], v[196:199], a[132:135], a[0:3]
 MM a[0:3], v[200:203], a[136:139], a[0:3]
 buffer_load_dwordx4 v7, s[48:51], s41 offen offset:0 lds
 MM a[0:3], v[204:207], a[140:143], a[0:3]
 buffer_load_dwordx4 a[192:195], v1, s[16:19], s36 offen offset:0 sc1
 MM a[4:7], v[204:207], a[156:159], a[4:7]
 MM a[4:7], v[200:203], a[152:155], a[4:7]
 MM a[4:7], v[196:199], a[148:151], a[4:7]
 s_waitcnt vmcnt(24)
 MM a[4:7], v[192:195], a[144:147], a[4:7]
 buffer_load_dwordx4 a[196:199], v1, s[16:19], s36 offen offset:1024 sc1
 MM a[8:11], v[192:195], a[160:163], a[8:11]
 s_waitcnt vmcnt(24)
 MM a[8:11], v[196:199], a[164:167], a[8:11]
 s_waitcnt vmcnt(22)
 MM a[8:11], v[200:203], a[168:171], a[8:11]
 s_waitcnt vmcnt(19)
 MM a[8:11], v[204:207], a[172:175], a[8:11]
 s_waitcnt vmcnt(10)
 s_add_u32 s42, s45, 3210240
 MM a[12:15], v[204:207], a[188:191], a[12:15]
 buffer_load_dwordx4 a[200:203], v1, s[16:19], s36 offen offset:2048 sc1
 MM a[12:15], v[200:203], a[184:187], a[12:15]
 ds_read_b64_tr_b16 v[240:241], v18 offset:0
 ds_read_b64_tr_b16 v[242:243], v18 offset:512
 MM a[12:15], v[196:199], a[180:183], a[12:15]
 ds_read_b64_tr_b16 v[244:245], v18 offset:4096
 ds_read_b64_tr_b16 v[246:247], v18 offset:4608
 MM a[12:15], v[192:195], a[176:179], a[12:15]
 buffer_load_dwordx4 v8, s[48:51], s42 offen offset:1024 lds
 MM a[28:31], v[208:211], a[176:179], a[28:31]
 ds_read_b64_tr_b16 v[248:249], v18 offset:8192
 ds_read_b64_tr_b16 v[250:251], v18 offset:8704
 MM a[28:31], v[212:215], a[180:183], a[28:31]
 buffer_load_dwordx4 a[204:207], v1, s[16:19], s36 offen offset:3072 sc1
 MM a[28:31], v[216:219], a[184:187], a[28:31]
 s_add_u32 s36, s36, 0x1000
 ds_read_b64_tr_b16 v[252:253], v18 offset:12288
 ds_read_b64_tr_b16 v[254:255], v18 offset:12800
 MM a[28:31], v[220:223], a[188:191], a[28:31]
 MM a[24:27], v[220:223], a[172:175], a[24:27]
 MM a[24:27], v[216:219], a[168:171], a[24:27]
 buffer_load_dwordx4 a[208:211], v1, s[16:19], s37 offen offset:0 sc1
 MM a[24:27], v[212:215], a[164:167], a[24:27]
 MM a[24:27], v[208:211], a[160:163], a[24:27]
 MM a[20:23], v[208:211], a[144:147], a[20:23]
 s_add_u32 s43, s45, 3274752
 MM a[20:23], v[212:215], a[148:151], a[20:23]
 MM a[20:23], v[216:219], a[152:155], a[20:23]
 buffer_load_dwordx4 a[212:215], v1, s[16:19], s37 offen offset:1024 sc1
 MM a[20:23], v[220:223], a[156:159], a[20:23]
 MM a[16:19], v[220:223], a[140:143], a[16:19]
 buffer_load_dwordx4 v7, s[48:51], s43 offen offset:2048 lds
 MM a[16:19], v[216:219], a[136:139], a[16:19]
 ds_read_b64_tr_b16 v[192:193], v15 offset:16384
 ds_read_b64_tr_b16 v[194:195], v15 offset:16896
 MM a[16:19], v[212:215], a[132:135], a[16:19]
 s_waitcnt lgkmcnt(2)
 ds_read_b64_tr_b16 v[196:197], v15 offset:20480
 ds_read_b64_tr_b16 v[198:199], v15 offset:20992
 MM a[16:19], v[208:211], a[128:131], a[16:19]
 buffer_load_dwordx4 a[216:219], v1, s[16:19], s37 offen offset:2048 sc1
 MM a[32:35], v[224:227], a[128:131], a[32:35]
 ds_read_b64_tr_b16 v[200:201], v15 offset:24576
 ds_read_b64_tr_b16 v[202:203], v15 offset:25088
 MM a[32:35], v[228:231], a[132:135], a[32:35]
 ds_read_b64_tr_b16 v[204:205], v15 offset:28672
 ds_read_b64_tr_b16 v[206:207], v15 offset:29184
 MM a[32:35], v[232:235], a[136:139], a[32:35]
 MM a[32:35], v[236:239], a[140:143], a[32:35]
 buffer_load_dwordx4 a[220:223], v1, s[16:19], s37 offen offset:3072 sc1
 MM a[36:39], v[236:239], a[156:159], a[36:39]
 s_add_u32 s37, s37, 0x1000
 MM a[36:39], v[232:235], a[152:155], a[36:39]
 s_add_u32 s40, s45, 3339264
 MM a[36:39], v[228:231], a[148:151], a[36:39]
 MM a[36:39], v[224:227], a[144:147], a[36:39]
 MM a[40:43], v[224:227], a[160:163], a[40:43]
 buffer_load_dwordx4 a[224:227], v1, s[16:19], s38 offen offset:0 sc1
 MM a[40:43], v[228:231], a[164:167], a[40:43]
 buffer_load_dwordx4 v8, s[48:51], s40 offen offset:3072 lds
 MM a[40:43], v[232:235], a[168:171], a[40:43]
 MM a[40:43], v[236:239], a[172:175], a[40:43]
 MM a[44:47], v[236:239], a[188:191], a[44:47]
 ds_read_b64_tr_b16 v[208:209], v16 offset:16384
 ds_read_b64_tr_b16 v[210:211], v16 offset:16896
 MM a[44:47], v[232:235], a[184:187], a[44:47]
 buffer_load_dwordx4 a[228:231], v1, s[16:19], s38 offen offset:1024 sc1
 MM a[44:47], v[228:231], a[180:183], a[44:47]
 ds_read_b64_tr_b16 v[212:213], v16 offset:20480
 ds_read_b64_tr_b16 v[214:215], v16 offset:20992
 MM a[44:47], v[224:227], a[176:179], a[44:47]
 ds_read_b64_tr_b16 v[216:217], v16 offset:24576
 ds_read_b64_tr_b16 v[218:219], v16 offset:25088
 MM a[60:63], v[240:243], a[176:179], a[60:63]
 ds_read_b64_tr_b16 v[220:221], v16 offset:28672
 ds_read_b64_tr_b16 v[222:223], v16 offset:29184
 MM a[60:63], v[244:247], a[180:183], a[60:63]
 buffer_load_dwordx4 a[232:235], v1, s[16:19], s38 offen offset:2048 sc1
 MM a[60:63], v[248:251], a[184:187], a[60:63]
 s_add_u32 m0, s47, 16384
 s_add_u32 s41, s45, 3145856
 MM a[60:63], v[252:255], a[188:191], a[60:63]
 MM a[56:59], v[252:255], a[172:175], a[56:59]
 MM a[56:59], v[248:251], a[168:171], a[56:59]
 MM a[56:59], v[244:247], a[164:167], a[56:59]
 buffer_load_dwordx4 a[236:239], v1, s[16:19], s38 offen offset:3072 sc1
 MM a[56:59], v[240:243], a[160:163], a[56:59]
 buffer_load_dwordx4 v7, s[48:51], s41 offen offset:0 lds
 MM a[52:55], v[240:243], a[144:147], a[52:55]
 s_add_u32 s38, s38, 0x1000
 MM a[52:55], v[244:247], a[148:151], a[52:55]
 MM a[52:55], v[248:251], a[152:155], a[52:55]
 MM a[52:55], v[252:255], a[156:159], a[52:55]
 buffer_load_dwordx4 a[240:243], v1, s[16:19], s39 offen offset:0 sc1
 MM a[48:51], v[252:255], a[140:143], a[48:51]
 ds_read_b64_tr_b16 v[224:225], v17 offset:16384
 ds_read_b64_tr_b16 v[226:227], v17 offset:16896
 MM a[48:51], v[248:251], a[136:139], a[48:51]
 ds_read_b64_tr_b16 v[228:229], v17 offset:20480
 ds_read_b64_tr_b16 v[230:231], v17 offset:20992
 MM a[48:51], v[244:247], a[132:135], a[48:51]
 s_waitcnt lgkmcnt(4)
 ds_read_b64_tr_b16 v[232:233], v17 offset:24576
 ds_read_b64_tr_b16 v[234:235], v17 offset:25088
 MM a[48:51], v[240:243], a[128:131], a[48:51]
 buffer_load_dwordx4 a[244:247], v1, s[16:19], s39 offen offset:1024 sc1
 MM a[64:67], v[192:195], a[128:131], a[64:67]
 s_add_u32 s42, s45, 3210368
 ds_read_b64_tr_b16 v[236:237], v17 offset:28672
 ds_read_b64_tr_b16 v[238:239], v17 offset:29184
 MM a[64:67], v[196:199], a[132:135], a[64:67]
 MM a[64:67], v[200:203], a[136:139], a[64:67]
 s_waitcnt vmcnt(19)
 s_barrier
 MM a[64:67], v[204:207], a[140:143], a[64:67]
 s_mov_b64 exec, 1
 buffer_store_dword v21, off, s[16:19], s3 offset:32 sc1
 s_mov_b64 exec, -1
 MM a[68:71], v[204:207], a[156:159], a[68:71]
 buffer_load_dwordx4 v8, s[48:51], s42 offen offset:1024 lds
 MM a[68:71], v[200:203], a[152:155], a[68:71]
 buffer_load_dwordx4 a[248:251], v1, s[16:19], s39 offen offset:2048 sc1
 MM a[68:71], v[196:199], a[148:151], a[68:71]
 MM a[68:71], v[192:195], a[144:147], a[68:71]
 MM a[72:75], v[192:195], a[160:163], a[72:75]
 MM a[72:75], v[196:199], a[164:167], a[72:75]
 buffer_load_dwordx4 a[252:255], v1, s[16:19], s39 offen offset:3072 sc1
 MM a[72:75], v[200:203], a[168:171], a[72:75]
 s_add_u32 s39, s39, 0x1000
 MM a[72:75], v[204:207], a[172:175], a[72:75]
 MM a[76:79], v[204:207], a[188:191], a[76:79]
 s_add_u32 s43, s45, 3274880
 ds_read_b64_tr_b16 v[240:241], v18 offset:16384
 ds_read_b64_tr_b16 v[242:243], v18 offset:16896
 MM a[76:79], v[200:203], a[184:187], a[76:79]
 ds_read_b64_tr_b16 v[244:245], v18 offset:20480
 ds_read_b64_tr_b16 v[246:247], v18 offset:20992
 MM a[76:79], v[196:199], a[180:183], a[76:79]
 ds_read_b64_tr_b16 v[248:249], v18 offset:24576
 ds_read_b64_tr_b16 v[250:251], v18 offset:25088
 MM a[76:79], v[192:195], a[176:179], a[76:79]
 ds_read_b64_tr_b16 v[252:253], v18 offset:28672
 ds_read_b64_tr_b16 v[254:255], v18 offset:29184
 MM a[92:95], v[208:211], a[176:179], a[92:95]
 buffer_load_dwordx4 v7, s[48:51], s43 offen offset:2048 lds
 MM a[92:95], v[212:215], a[180:183], a[92:95]
 ds_read_b64_tr_b16 v[32:33], v0 offset:0
 ds_read_b64_tr_b16 v[34:35], v0 offset:10240
 MM a[92:95], v[216:219], a[184:187], a[92:95]
 ds_read_b64_tr_b16 v[36:37], v0 offset:32
 ds_read_b64_tr_b16 v[38:39], v0 offset:10272
 MM a[92:95], v[220:223], a[188:191], a[92:95]
 ds_read_b64_tr_b16 v[40:41], v0 offset:64
 ds_read_b64_tr_b16 v[42:43], v0 offset:10304
 MM a[88:91], v[220:223], a[172:175], a[88:91]
 ds_read_b64_tr_b16 v[44:45], v0 offset:96
 ds_read_b64_tr_b16 v[46:47], v0 offset:10336
 MM a[88:91], v[216:219], a[168:171], a[88:91]
 ds_read_b64_tr_b16 v[48:49], v0 offset:128
 ds_read_b64_tr_b16 v[50:51], v0 offset:10368
 MM a[88:91], v[212:215], a[164:167], a[88:91]
 MM a[88:91], v[208:211], a[160:163], a[88:91]
 MM a[84:87], v[208:211], a[144:147], a[84:87]
 MM a[84:87], v[212:215], a[148:151], a[84:87]
 s_add_u32 s40, s45, 3339392
 MM a[84:87], v[216:219], a[152:155], a[84:87]
 MM a[84:87], v[220:223], a[156:159], a[84:87]
 MM a[80:83], v[220:223], a[140:143], a[80:83]
 MM a[80:83], v[216:219], a[136:139], a[80:83]
 buffer_load_dwordx4 v8, s[48:51], s40 offen offset:3072 lds
 MM a[80:83], v[212:215], a[132:135], a[80:83]
 MM a[80:83], v[208:211], a[128:131], a[80:83]
 s_waitcnt lgkmcnt(0)
 MM a[96:99], v[224:227], a[128:131], a[96:99]
 MM a[96:99], v[228:231], a[132:135], a[96:99]
 MM a[96:99], v[232:235], a[136:139], a[96:99]
 MM a[96:99], v[236:239], a[140:143], a[96:99]
 MM a[100:103], v[236:239], a[156:159], a[100:103]
 buffer_store_dwordx4 v[32:35], v1, s[16:19], s14 offen offset:0 sc1
 MM a[100:103], v[232:235], a[152:155], a[100:103]
 MM a[100:103], v[228:231], a[148:151], a[100:103]
 MM a[100:103], v[224:227], a[144:147], a[100:103]
 MM a[104:107], v[224:227], a[160:163], a[104:107]
 MM a[104:107], v[228:231], a[164:167], a[104:107]
 MM a[104:107], v[232:235], a[168:171], a[104:107]
 s_barrier
 ds_read_b64_tr_b16 v[192:193], v15 offset:32768
 MM a[104:107], v[236:239], a[172:175], a[104:107]
 ds_read_b64_tr_b16 v[194:195], v15 offset:33280
 ds_read_b64_tr_b16 v[196:197], v15 offset:36864
 MM a[108:111], v[236:239], a[188:191], a[108:111]
 ds_read_b64_tr_b16 v[198:199], v15 offset:37376
 ds_read_b64_tr_b16 v[200:201], v15 offset:40960
 MM a[108:111], v[232:235], a[184:187], a[108:111]
 ds_read_b64_tr_b16 v[202:203], v15 offset:41472
 ds_read_b64_tr_b16 v[204:205], v15 offset:45056
 MM a[108:111], v[228:231], a[180:183], a[108:111]
 ds_read_b64_tr_b16 v[206:207], v15 offset:45568
 ds_read_b64_tr_b16 v[208:209], v16 offset:32768
 MM a[108:111], v[224:227], a[176:179], a[108:111]
 ds_read_b64_tr_b16 v[210:211], v16 offset:33280
 ds_read_b64_tr_b16 v[212:213], v16 offset:36864
 MM a[124:127], v[240:243], a[176:179], a[124:127]
 ds_read_b64_tr_b16 v[214:215], v16 offset:37376
 ds_read_b64_tr_b16 v[216:217], v16 offset:40960
 MM a[124:127], v[244:247], a[180:183], a[124:127]
 ds_read_b64_tr_b16 v[218:219], v16 offset:41472
 ds_read_b64_tr_b16 v[220:221], v16 offset:45056
 MM a[124:127], v[248:251], a[184:187], a[124:127]
 ds_read_b64_tr_b16 v[222:223], v16 offset:45568
 MM a[124:127], v[252:255], a[188:191], a[124:127]
 MM a[120:123], v[252:255], a[172:175], a[120:123]
 MM a[120:123], v[248:251], a[168:171], a[120:123]
 MM a[120:123], v[244:247], a[164:167], a[120:123]
 MM a[120:123], v[240:243], a[160:163], a[120:123]
 MM a[116:119], v[240:243], a[144:147], a[116:119]
 MM a[116:119], v[244:247], a[148:151], a[116:119]
 MM a[116:119], v[248:251], a[152:155], a[116:119]
 MM a[116:119], v[252:255], a[156:159], a[116:119]
 MM a[112:115], v[252:255], a[140:143], a[112:115]
 ds_read_b64_tr_b16 v[224:225], v17 offset:32768
 ds_read_b64_tr_b16 v[226:227], v17 offset:33280
 MM a[112:115], v[248:251], a[136:139], a[112:115]
 ds_read_b64_tr_b16 v[228:229], v17 offset:36864
 ds_read_b64_tr_b16 v[230:231], v17 offset:37376
 MM a[112:115], v[244:247], a[132:135], a[112:115]
 s_add_u32 m0, s47, 32768
 s_add_u32 s41, s45, 4194304
 ds_read_b64_tr_b16 v[232:233], v17 offset:40960
 MM a[112:115], v[240:243], a[128:131], a[112:115]
 s_waitcnt vmcnt(24) lgkmcnt(5)
 ds_read_b64_tr_b16 v[234:235], v17 offset:41472
 ds_read_b64_tr_b16 v[236:237], v17 offset:45056
 MM a[0:3], v[192:195], a[192:195], a[0:3]
 s_waitcnt vmcnt(22)
 s_waitcnt vmcnt(23)
 ds_read_b64_tr_b16 v[238:239], v17 offset:45568
 MM a[0:3], v[196:199], a[196:199], a[0:3]
 buffer_store_dwordx4 v[36:39], v1, s[16:19], s14 offen offset:1024 sc1
 MM a[0:3], v[200:203], a[200:203], a[0:3]
 buffer_load_dwordx4 v7, s[48:51], s41 offen offset:0 lds
 s_waitcnt vmcnt(22)
 MM a[0:3], v[204:207], a[204:207], a[0:3]
 s_waitcnt vmcnt(17)
 MM a[4:7], v[204:207], a[220:223], a[4:7]
 MM a[4:7], v[200:203], a[216:219], a[4:7]
 MM a[4:7], v[196:199], a[212:215], a[4:7]
 MM a[4:7], v[192:195], a[208:211], a[4:7]
 s_waitcnt vmcnt(16)
 MM a[8:11], v[192:195], a[224:227], a[8:11]
 s_waitcnt vmcnt(14)
 MM a[8:11], v[196:199], a[228:231], a[8:11]
 s_waitcnt vmcnt(13)
 MM a[8:11], v[200:203], a[232:235], a[8:11]
 s_waitcnt vmcnt(12)
 MM a[8:11], v[204:207], a[236:239], a[8:11]
 s_waitcnt vmcnt(5)
 s_add_u32 s42, s45, 4258816
 MM a[12:15], v[204:207], a[252:255], a[12:15]
 ds_read_b64_tr_b16 v[240:241], v18 offset:32768
 ds_read_b64_tr_b16 v[242:243], v18 offset:33280
 MM a[12:15], v[200:203], a[248:251], a[12:15]
 ds_read_b64_tr_b16 v[244:245], v18 offset:36864
 ds_read_b64_tr_b16 v[246:247], v18 offset:37376
 MM a[12:15], v[196:199], a[244:247], a[12:15]
 ds_read_b64_tr_b16 v[248:249], v18 offset:40960
 ds_read_b64_tr_b16 v[250:251], v18 offset:41472
 MM a[12:15], v[192:195], a[240:243], a[12:15]
 buffer_load_dwordx4 v8, s[48:51], s42 offen offset:1024 lds
 MM a[28:31], v[208:211], a[240:243], a[28:31]
 ds_read_b64_tr_b16 v[252:253], v18 offset:45056
 ds_read_b64_tr_b16 v[254:255], v18 offset:45568
 MM a[28:31], v[212:215], a[244:247], a[28:31]
 MM a[28:31], v[216:219], a[248:251], a[28:31]
 MM a[28:31], v[220:223], a[252:255], a[28:31]
 MM a[24:27], v[220:223], a[236:239], a[24:27]
 buffer_store_dwordx4 v[40:43], v1, s[16:19], s14 offen offset:2048 sc1
 MM a[24:27], v[216:219], a[232:235], a[24:27]
 MM a[24:27], v[212:215], a[228:231], a[24:27]
 MM a[24:27], v[208:211], a[224:227], a[24:27]
 MM a[20:23], v[208:211], a[208:211], a[20:23]
 s_add_u32 s43, s45, 4323328
 MM a[20:23], v[212:215], a[212:215], a[20:23]
 MM a[20:23], v[216:219], a[216:219], a[20:23]
 MM a[20:23], v[220:223], a[220:223], a[20:23]
 MM a[16:19], v[220:223], a[204:207], a[16:19]
 buffer_load_dwordx4 v7, s[48:51], s43 offen offset:2048 lds
 MM a[16:19], v[216:219], a[200:203], a[16:19]
 ds_read_b64_tr_b16 v[192:193], v15 offset:49152
 ds_read_b64_tr_b16 v[194:195], v15 offset:49664
 MM a[16:19], v[212:215], a[196:199], a[16:19]
 ds_read_b64_tr_b16 v[196:197], v15 offset:53248
 ds_read_b64_tr_b16 v[198:199], v15 offset:53760
 MM a[16:19], v[208:211], a[192:195], a[16:19]
 s_waitcnt lgkmcnt(4)
 ds_read_b64_tr_b16 v[200:201], v15 offset:57344
 ds_read_b64_tr_b16 v[202:203], v15 offset:57856
 MM a[32:35], v[224:227], a[192:195], a[32:35]
 ds_read_b64_tr_b16 v[204:205], v15 offset:61440
 ds_read_b64_tr_b16 v[206:207], v15 offset:61952
 MM a[32:35], v[228:231], a[196:199], a[32:35]
 MM a[32:35], v[232:235], a[200:203], a[32:35]
 MM a[32:35], v[236:239], a[204:207], a[32:35]
 MM a[36:39], v[236:239], a[220:223], a[36:39]
 MM a[36:39], v[232:235], a[216:219], a[36:39]
 s_add_u32 s40, s45, 4387840
 MM a[36:39], v[228:231], a[212:215], a[36:39]
 MM a[36:39], v[224:227], a[208:211], a[36:39]
 MM a[40:43], v[224:227], a[224:227], a[40:43]
 MM a[40:43], v[228:231], a[228:231], a[40:43]
 buffer_load_dwordx4 v8, s[48:51], s40 offen offset:3072 lds
 MM a[40:43], v[232:235], a[232:235], a[40:43]
 MM a[40:43], v[236:239], a[236:239], a[40:43]
 MM a[44:47], v[236:239], a[252:255], a[44:47]
 buffer_load_dword v24, v23, s[16:19], 0 offen sc1
 MM a[44:47], v[232:235], a[248:251], a[44:47]
 ds_read_b64_tr_b16 v[208:209], v16 offset:49152
 ds_read_b64_tr_b16 v[210:211], v16 offset:49664
 MM a[44:47], v[228:231], a[244:247], a[44:47]
 ds_read_b64_tr_b16 v[212:213], v16 offset:53248
 ds_read_b64_tr_b16 v[214:215], v16 offset:53760
 MM a[44:47], v[224:227], a[240:243], a[44:47]
 ds_read_b64_tr_b16 v[216:217], v16 offset:57344
 ds_read_b64_tr_b16 v[218:219], v16 offset:57856
 MM a[60:63], v[240:243], a[240:243], a[60:63]
 ds_read_b64_tr_b16 v[220:221], v16 offset:61440
 ds_read_b64_tr_b16 v[222:223], v16 offset:61952
 MM a[60:63], v[244:247], a[244:247], a[60:63]
 buffer_store_dwordx4 v[44:47], v1, s[16:19], s14 offen offset:3072 sc1
 MM a[60:63], v[248:251], a[248:251], a[60:63]
 s_add_u32 m0, s47, 49152
 s_add_u32 s41, s45, 4194432
 MM a[60:63], v[252:255], a[252:255], a[60:63]
 MM a[56:59], v[252:255], a[236:239], a[56:59]
 MM a[56:59], v[248:251], a[232:235], a[56:59]
 MM a[56:59], v[244:247], a[228:231], a[56:59]
 buffer_load_dwordx4 v7, s[48:51], s41 offen offset:0 lds
 MM a[56:59], v[240:243], a[224:227], a[56:59]
 MM a[52:55], v[240:243], a[208:211], a[52:55]
 MM a[52:55], v[244:247], a[212:215], a[52:55]
 MM a[52:55], v[248:251], a[216:219], a[52:55]
 MM a[52:55], v[252:255], a[220:223], a[52:55]
 MM a[48:51], v[252:255], a[204:207], a[48:51]
 ds_read_b64_tr_b16 v[224:225], v17 offset:49152
 ds_read_b64_tr_b16 v[226:227], v17 offset:49664
 MM a[48:51], v[248:251], a[200:203], a[48:51]
 ds_read_b64_tr_b16 v[228:229], v17 offset:53248
 ds_read_b64_tr_b16 v[230:231], v17 offset:53760
 MM a[48:51], v[244:247], a[196:199], a[48:51]
 s_waitcnt lgkmcnt(4)
 ds_read_b64_tr_b16 v[232:233], v17 offset:57344
 ds_read_b64_tr_b16 v[234:235], v17 offset:57856
 MM a[48:51], v[240:243], a[192:195], a[48:51]
 s_add_u32 s42, s45, 4258944
 ds_read_b64_tr_b16 v[236:237], v17 offset:61440
 ds_read_b64_tr_b16 v[238:239], v17 offset:61952
 MM a[64:67], v[192:195], a[192:195], a[64:67]
 MM a[64:67], v[196:199], a[196:199], a[64:67]
 MM a[64:67], v[200:203], a[200:203], a[64:67]
 MM a[64:67], v[204:207], a[204:207], a[64:67]
 buffer_load_dwordx4 v8, s[48:51], s42 offen offset:1024 lds
 MM a[68:71], v[204:207], a[220:223], a[68:71]
 buffer_store_dwordx4 v[48:51], v27, s[16:19], s14 offen offset:0 sc1
 MM a[68:71], v[200:203], a[216:219], a[68:71]
 MM a[68:71], v[196:199], a[212:215], a[68:71]
 MM a[68:71], v[192:195], a[208:211], a[68:71]
 MM a[72:75], v[192:195], a[224:227], a[72:75]
 MM a[72:75], v[196:199], a[228:231], a[72:75]
 MM a[72:75], v[200:203], a[232:235], a[72:75]
 MM a[72:75], v[204:207], a[236:239], a[72:75]
 MM a[76:79], v[204:207], a[252:255], a[76:79]
 s_add_u32 s43, s45, 4323456
 ds_read_b64_tr_b16 v[240:241], v18 offset:49152
 ds_read_b64_tr_b16 v[242:243], v18 offset:49664
 MM a[76:79], v[200:203], a[248:251], a[76:79]
 ds_read_b64_tr_b16 v[244:245], v18 offset:53248
 ds_read_b64_tr_b16 v[246:247], v18 offset:53760
 MM a[76:79], v[196:199], a[244:247], a[76:79]
 ds_read_b64_tr_b16 v[248:249], v18 offset:57344
 ds_read_b64_tr_b16 v[250:251], v18 offset:57856
 MM a[76:79], v[192:195], a[240:243], a[76:79]
 ds_read_b64_tr_b16 v[252:253], v18 offset:61440
 ds_read_b64_tr_b16 v[254:255], v18 offset:61952
 MM a[92:95], v[208:211], a[240:243], a[92:95]
 buffer_load_dwordx4 v7, s[48:51], s43 offen offset:2048 lds
 MM a[92:95], v[212:215], a[244:247], a[92:95]
 MM a[92:95], v[216:219], a[248:251], a[92:95]
 MM a[92:95], v[220:223], a[252:255], a[92:95]
 MM a[88:91], v[220:223], a[236:239], a[88:91]
 MM a[88:91], v[216:219], a[232:235], a[88:91]
 MM a[88:91], v[212:215], a[228:231], a[88:91]
 MM a[88:91], v[208:211], a[224:227], a[88:91]
 MM a[84:87], v[208:211], a[208:211], a[84:87]
 MM a[84:87], v[212:215], a[212:215], a[84:87]
 s_add_u32 s40, s45, 4387968
 MM a[84:87], v[216:219], a[216:219], a[84:87]
 MM a[84:87], v[220:223], a[220:223], a[84:87]
 MM a[80:83], v[220:223], a[204:207], a[80:83]
 MM a[80:83], v[216:219], a[200:203], a[80:83]
 buffer_load_dwordx4 v8, s[48:51], s40 offen offset:3072 lds
 MM a[80:83], v[212:215], a[196:199], a[80:83]
 MM a[80:83], v[208:211], a[192:195], a[80:83]
 s_waitcnt lgkmcnt(0)
 MM a[96:99], v[224:227], a[192:195], a[96:99]
 MM a[96:99], v[228:231], a[196:199], a[96:99]
 MM a[96:99], v[232:235], a[200:203], a[96:99]
 MM a[96:99], v[236:239], a[204:207], a[96:99]
 MM a[100:103], v[236:239], a[220:223], a[100:103]
 MM a[100:103], v[232:235], a[216:219], a[100:103]
 MM a[100:103], v[228:231], a[212:215], a[100:103]
 MM a[100:103], v[224:227], a[208:211], a[100:103]
 MM a[104:107], v[224:227], a[224:227], a[104:107]
 MM a[104:107], v[228:231], a[228:231], a[104:107]
 MM a[104:107], v[232:235], a[232:235], a[104:107]
 s_waitcnt vmcnt(14)
 s_barrier
 ds_read_b64_tr_b16 v[192:193], v11 offset:0
 MM a[104:107], v[236:239], a[236:239], a[104:107]
 ds_read_b64_tr_b16 v[194:195], v11 offset:512
 ds_read_b64_tr_b16 v[196:197], v11 offset:4096
 MM a[108:111], v[236:239], a[252:255], a[108:111]
 ds_read_b64_tr_b16 v[198:199], v11 offset:4608
 ds_read_b64_tr_b16 v[200:201], v11 offset:8192
 MM a[108:111], v[232:235], a[248:251], a[108:111]
 ds_read_b64_tr_b16 v[202:203], v11 offset:8704
 ds_read_b64_tr_b16 v[204:205], v11 offset:12288
 MM a[108:111], v[228:231], a[244:247], a[108:111]
 s_waitcnt vmcnt(6)
 v_cmp_ne_u32 vcc, s61, v24
 s_cbranch_vccnz spin2
spun2:
 MM a[108:111], v[224:227], a[240:243], a[108:111]
 ds_read_b64_tr_b16 v[206:207], v11 offset:12800
 ds_read_b64_tr_b16 v[208:209], v12 offset:0
 MM a[124:127], v[240:243], a[240:243], a[124:127]
 ds_read_b64_tr_b16 v[210:211], v12 offset:512
 ds_read_b64_tr_b16 v[212:213], v12 offset:4096
 MM a[124:127], v[244:247], a[244:247], a[124:127]
 ds_read_b64_tr_b16 v[214:215], v12 offset:4608
 ds_read_b64_tr_b16 v[216:217], v12 offset:8192
 MM a[124:127], v[248:251], a[248:251], a[124:127]
 s_add_u32 m0, s30, 0
 ds_read_b64_tr_b16 v[218:219], v12 offset:8704
 ds_read_b64_tr_b16 v[220:221], v12 offset:12288
 MM a[124:127], v[252:255], a[252:255], a[124:127]
 ds_read_b64_tr_b16 v[222:223], v12 offset:12800
 MM a[120:123], v[252:255], a[236:239], a[120:123]
 MM a[120:123], v[248:251], a[232:235], a[120:123]
 MM a[120:123], v[244:247], a[228:231], a[120:123]
 buffer_load_dwordx4 v1, s[4:7], s28 offen offset:0 sc1 lds
 MM a[120:123], v[240:243], a[224:227], a[120:123]
 MM a[116:119], v[240:243], a[208:211], a[116:119]
 MM a[116:119], v[244:247], a[212:215], a[116:119]
 MM a[116:119], v[248:251], a[216:219], a[116:119]
 MM a[116:119], v[252:255], a[220:223], a[116:119]
 MM a[112:115], v[252:255], a[204:207], a[112:115]
 ds_read_b64_tr_b16 v[224:225], v13 offset:0
 ds_read_b64_tr_b16 v[226:227], v13 offset:512
 MM a[112:115], v[248:251], a[200:203], a[112:115]
 ds_read_b64_tr_b16 v[228:229], v13 offset:4096
 ds_read_b64_tr_b16 v[230:231], v13 offset:4608
 MM a[112:115], v[244:247], a[196:199], a[112:115]
 s_waitcnt lgkmcnt(4)
 ds_read_b64_tr_b16 v[232:233], v13 offset:8192
 ds_read_b64_tr_b16 v[234:235], v13 offset:8704
 MM a[112:115], v[240:243], a[192:195], a[112:115]
 buffer_load_dwordx4 v1, s[4:7], s28 offen offset:1024 sc1 lds
 MM v[64:67], v[192:195], a[128:131], v[64:67]
 ds_read_b64_tr_b16 v[236:237], v13 offset:12288
 ds_read_b64_tr_b16 v[238:239], v13 offset:12800
 MM v[64:67], v[196:199], a[132:135], v[64:67]
 MM v[64:67], v[200:203], a[136:139], v[64:67]
 MM v[64:67], v[204:207], a[140:143], v[64:67]
 MM v[68:71], v[204:207], a[156:159], v[68:71]
 MM v[68:71], v[200:203], a[152:155], v[68:71]
 MM v[68:71], v[196:199], a[148:151], v[68:71]
 MM v[68:71], v[192:195], a[144:147], v[68:71]
 MM v[72:75], v[192:195], a[160:163], v[72:75]
 buffer_load_dwordx4 v1, s[4:7], s28 offen offset:2048 sc1 lds
 MM v[72:75], v[196:199], a[164:167], v[72:75]
 v_accvgpr_read_b32 v32, a0
 v_accvgpr_read_b32 v33, a1
 MM v[72:75], v[200:203], a[168:171], v[72:75]
 v_accvgpr_read_b32 v34, a2
 v_accvgpr_read_b32 v35, a3
 MM v[72:75], v[204:207], a[172:175], v[72:75]
 v_accvgpr_read_b32 v36, a16
 v_accvgpr_read_b32 v37, a17
 MM v[76:79], v[204:207], a[188:191], v[76:79]
 v_accvgpr_read_b32 v38, a18
 v_accvgpr_read_b32 v39, a19
 MM v[76:79], v[200:203], a[184:187], v[76:79]
 v_accvgpr_read_b32 v40, a64
 v_accvgpr_read_b32 v41, a65
 MM v[76:79], v[196:199], a[180:183], v[76:79]
 v_accvgpr_read_b32 v42, a66
 v_accvgpr_read_b32 v43, a67
 MM v[76:79], v[192:195], a[176:179], v[76:79]
 v_accvgpr_read_b32 v44, a80
 v_accvgpr_read_b32 v45, a81
 MM v[92:95], v[208:211], a[176:179], v[92:95]
 v_accvgpr_read_b32 v46, a82
 v_accvgpr_read_b32 v47, a83
 MM v[92:95], v[212:215], a[180:183], v[92:95]
 buffer_load_dwordx4 v1, s[4:7], s28 offen offset:3072 sc1 lds
 MM v[92:95], v[216:219], a[184:187], v[92:95]
 s_add_u32 s28, s28, 0x4000
 v_mul_f32 v32, v32, v40
 v_mul_f32 v33, v33, v41
 MM v[92:95], v[220:223], a[188:191], v[92:95]
 v_mul_f32 v34, v34, v42
 v_mul_f32 v35, v35, v43
 MM v[88:91], v[220:223], a[172:175], v[88:91]
 v_mul_f32 v36, v36, v44
 v_mul_f32 v37, v37, v45
 MM v[88:91], v[216:219], a[168:171], v[88:91]
 v_mul_f32 v38, v38, v46
 v_mul_f32 v39, v39, v47
 MM v[88:91], v[212:215], a[164:167], v[88:91]
 v_cvt_pk_bf16_f32 v32, v32, v33
 v_cvt_pk_bf16_f32 v33, v34, v35
 MM v[88:91], v[208:211], a[160:163], v[88:91]
 v_cvt_pk_bf16_f32 v34, v36, v37
 v_cvt_pk_bf16_f32 v35, v38, v39
 MM v[84:87], v[208:211], a[144:147], v[84:87]
 s_add_u32 s62, s32, s27
 ds_read_b64_tr_b16 v[240:241], v14 offset:0
 ds_read_b64_tr_b16 v[242:243], v14 offset:512
 MM v[84:87], v[212:215], a[148:151], v[84:87]
 ds_read_b64_tr_b16 v[244:245], v14 offset:4096
 ds_read_b64_tr_b16 v[246:247], v14 offset:4608
 MM v[84:87], v[216:219], a[152:155], v[84:87]
 s_add_u32 m0, s30, 16384
 ds_read_b64_tr_b16 v[248:249], v14 offset:8192
 ds_read_b64_tr_b16 v[250:251], v14 offset:8704
 MM v[84:87], v[220:223], a[156:159], v[84:87]
 ds_read_b64_tr_b16 v[252:253], v14 offset:12288
 ds_read_b64_tr_b16 v[254:255], v14 offset:12800
 MM v[80:83], v[220:223], a[140:143], v[80:83]
 buffer_store_dwordx4 v[32:35], v1, s[16:19], s62 offen sc1
 MM v[80:83], v[216:219], a[136:139], v[80:83]
 ds_read_b64_tr_b16 v[192:193], v11 offset:16384
 v_accvgpr_read_b32 v48, a4
 MM v[80:83], v[212:215], a[132:135], v[80:83]
 buffer_load_dwordx4 v1, s[4:7], s28 offen offset:0 sc1 lds
 MM v[80:83], v[208:211], a[128:131], v[80:83]
 s_waitcnt lgkmcnt(7)
 ds_read_b64_tr_b16 v[194:195], v11 offset:16896
 v_accvgpr_read_b32 v49, a5
 MM v[96:99], v[224:227], a[128:131], v[96:99]
 ds_read_b64_tr_b16 v[196:197], v11 offset:20480
 v_accvgpr_read_b32 v50, a6
 MM v[96:99], v[228:231], a[132:135], v[96:99]
 ds_read_b64_tr_b16 v[198:199], v11 offset:20992
 v_accvgpr_read_b32 v51, a7
 MM v[96:99], v[232:235], a[136:139], v[96:99]
 v_accvgpr_read_b32 v52, a20
 v_accvgpr_read_b32 v53, a21
 MM v[96:99], v[236:239], a[140:143], v[96:99]
 v_accvgpr_read_b32 v54, a22
 v_accvgpr_read_b32 v55, a23
 MM v[100:103], v[236:239], a[156:159], v[100:103]
 v_accvgpr_read_b32 v56, a68
 v_accvgpr_read_b32 v57, a69
 MM v[100:103], v[232:235], a[152:155], v[100:103]
 v_accvgpr_read_b32 v58, a70
 v_accvgpr_read_b32 v59, a71
 MM v[100:103], v[228:231], a[148:151], v[100:103]
 v_accvgpr_read_b32 v60, a84
 v_accvgpr_read_b32 v61, a85
 MM v[100:103], v[224:227], a[144:147], v[100:103]
 buffer_load_dwordx4 v1, s[4:7], s28 offen offset:1024 sc1 lds
 MM v[104:107], v[224:227], a[160:163], v[104:107]
 v_accvgpr_read_b32 v62, a86
 v_accvgpr_read_b32 v63, a87
 MM v[104:107], v[228:231], a[164:167], v[104:107]
 v_mul_f32 v48, v48, v56
 v_mul_f32 v49, v49, v57
 MM v[104:107], v[232:235], a[168:171], v[104:107]
 v_mul_f32 v50, v50, v58
 v_mul_f32 v51, v51, v59
 MM v[104:107], v[236:239], a[172:175], v[104:107]
 v_mul_f32 v52, v52, v60
 v_mul_f32 v53, v53, v61
 MM v[108:111], v[236:239], a[188:191], v[108:111]
 v_mul_f32 v54, v54, v62
 v_mul_f32 v55, v55, v63
 MM v[108:111], v[232:235], a[184:187], v[108:111]
 v_cvt_pk_bf16_f32 v48, v48, v49
 v_cvt_pk_bf16_f32 v49, v50, v51
 MM v[108:111], v[228:231], a[180:183], v[108:111]
 buffer_load_dword v25, v23, s[16:19], 0 offen offset:32 sc1
 MM v[108:111], v[224:227], a[176:179], v[108:111]
 s_waitcnt lgkmcnt(0)
 v_cvt_pk_bf16_f32 v50, v52, v53
 v_cvt_pk_bf16_f32 v51, v54, v55
 MM v[124:127], v[240:243], a[176:179], v[124:127]
 s_add_u32 s62, s33, s27
 ds_read_b64_tr_b16 v[200:201], v11 offset:24576
 v_accvgpr_read_b32 v32, a8
 MM v[124:127], v[244:247], a[180:183], v[124:127]
 ds_read_b64_tr_b16 v[202:203], v11 offset:25088
 v_accvgpr_read_b32 v33, a9
 MM v[124:127], v[248:251], a[184:187], v[124:127]
 ds_read_b64_tr_b16 v[204:205], v11 offset:28672
 v_accvgpr_read_b32 v34, a10
 MM v[124:127], v[252:255], a[188:191], v[124:127]
 ds_read_b64_tr_b16 v[206:207], v11 offset:29184
 v_accvgpr_read_b32 v35, a11
 MM v[120:123], v[252:255], a[172:175], v[120:123]
 buffer_load_dwordx4 v1, s[4:7], s28 offen offset:2048 sc1 lds
 MM v[120:123], v[248:251], a[168:171], v[120:123]
 buffer_store_dwordx4 v[48:51], v1, s[16:19], s62 offen sc1
 MM v[120:123], v[244:247], a[164:167], v[120:123]
 ds_read_b64_tr_b16 v[208:209], v12 offset:16384
 v_accvgpr_read_b32 v36, a24
 MM v[120:123], v[240:243], a[160:163], v[120:123]
 ds_read_b64_tr_b16 v[210:211], v12 offset:16896
 v_accvgpr_read_b32 v37, a25
 MM v[116:119], v[240:243], a[144:147], v[116:119]
 ds_read_b64_tr_b16 v[212:213], v12 offset:20480
 v_accvgpr_read_b32 v38, a26
 MM v[116:119], v[244:247], a[148:151], v[116:119]
 buffer_load_dwordx4 v1, s[4:7], s28 offen offset:3072 sc1 lds
 MM v[116:119], v[248:251], a[152:155], v[116:119]
 s_add_u32 s28, s28, 0x4000
 ds_read_b64_tr_b16 v[214:215], v12 offset:20992
 v_accvgpr_read_b32 v39, a27
 MM v[116:119], v[252:255], a[156:159], v[116:119]
 ds_read_b64_tr_b16 v[216:217], v12 offset:24576
 v_accvgpr_read_b32 v40, a72
 MM v[112:115], v[252:255], a[140:143], v[112:115]
 ds_read_b64_tr_b16 v[218:219], v12 offset:25088
 v_accvgpr_read_b32 v41, a73
 MM v[112:115], v[248:251], a[136:139], v[112:115]
 ds_read_b64_tr_b16 v[220:221], v12 offset:28672
 v_accvgpr_read_b32 v42, a74
 MM v[112:115], v[244:247], a[132:135], v[112:115]
 ds_read_b64_tr_b16 v[222:223], v12 offset:29184
 v_accvgpr_read_b32 v43, a75
 MM v[112:115], v[240:243], a[128:131], v[112:115]
 v_accvgpr_read_b32 v44, a88
 v_accvgpr_read_b32 v45, a89
 MM v[128:131], v[192:195], a[128:131], v[128:131]
 v_accvgpr_read_b32 v46, a90
 v_accvgpr_read_b32 v47, a91
 MM v[128:131], v[196:199], a[132:135], v[128:131]
 s_waitcnt lgkmcnt(4)
 v_mul_f32 v32, v32, v40
 v_mul_f32 v33, v33, v41
 MM v[128:131], v[200:203], a[136:139], v[128:131]
 v_mul_f32 v34, v34, v42
 v_mul_f32 v35, v35, v43
 MM v[128:131], v[204:207], a[140:143], v[128:131]
 v_mul_f32 v36, v36, v44
 v_mul_f32 v37, v37, v45
 MM v[132:135], v[204:207], a[156:159], v[132:135]
 v_mul_f32 v38, v38, v46
 v_mul_f32 v39, v39, v47
 MM v[132:135], v[200:203], a[152:155], v[132:135]
 v_cvt_pk_bf16_f32 v32, v32, v33
 v_cvt_pk_bf16_f32 v33, v34, v35
 MM v[132:135], v[196:199], a[148:151], v[132:135]
 v_cvt_pk_bf16_f32 v34, v36, v37
 v_cvt_pk_bf16_f32 v35, v38, v39
 MM v[132:135], v[192:195], a[144:147], v[132:135]
 s_add_u32 s62, s34, s27
 ds_read_b64_tr_b16 v[224:225], v13 offset:16384
 v_accvgpr_read_b32 v48, a12
 MM v[136:139], v[192:195], a[160:163], v[136:139]
 buffer_store_dwordx4 v[32:35], v1, s[16:19], s62 offen sc1
 MM v[136:139], v[196:199], a[164:167], v[136:139]
 ds_read_b64_tr_b16 v[226:227], v13 offset:16896
 v_accvgpr_read_b32 v49, a13
 MM v[136:139], v[200:203], a[168:171], v[136:139]
 ds_read_b64_tr_b16 v[228:229], v13 offset:20480
 v_accvgpr_read_b32 v50, a14
 MM v[136:139], v[204:207], a[172:175], v[136:139]
 ds_read_b64_tr_b16 v[230:231], v13 offset:20992
 v_accvgpr_read_b32 v51, a15
 MM v[140:143], v[204:207], a[188:191], v[140:143]
 ds_read_b64_tr_b16 v[232:233], v13 offset:24576
 v_accvgpr_read_b32 v52, a28
 MM v[140:143], v[200:203], a[184:187], v[140:143]
 ds_read_b64_tr_b16 v[234:235], v13 offset:25088
 v_accvgpr_read_b32 v53, a29
 MM v[140:143], v[196:199], a[180:183], v[140:143]
 ds_read_b64_tr_b16 v[236:237], v13 offset:28672
 v_accvgpr_read_b32 v54, a30
 MM v[140:143], v[192:195], a[176:179], v[140:143]
 ds_read_b64_tr_b16 v[238:239], v13 offset:29184
 v_accvgpr_read_b32 v55, a31
 MM v[156:159], v[208:211], a[176:179], v[156:159]
 v_accvgpr_read_b32 v56, a76
 v_accvgpr_read_b32 v57, a77
 MM v[156:159], v[212:215], a[180:183], v[156:159]
 s_waitcnt lgkmcnt(5)
 v_accvgpr_read_b32 v58, a78
 v_accvgpr_read_b32 v59, a79
 MM v[156:159], v[216:219], a[184:187], v[156:159]
 v_accvgpr_read_b32 v60, a92
 v_accvgpr_read_b32 v61, a93
 MM v[156:159], v[220:223], a[188:191], v[156:159]
 v_accvgpr_read_b32 v62, a94
 v_accvgpr_read_b32 v63, a95
 MM v[152:155], v[220:223], a[172:175], v[152:155]
 v_mul_f32 v48, v48, v56
 v_mul_f32 v49, v49, v57
 MM v[152:155], v[216:219], a[168:171], v[152:155]
 v_mul_f32 v50, v50, v58
 v_mul_f32 v51, v51, v59
 MM v[152:155], v[212:215], a[164:167], v[152:155]
 v_mul_f32 v52, v52, v60
 v_mul_f32 v53, v53, v61
 MM v[152:155], v[208:211], a[160:163], v[152:155]
 v_mul_f32 v54, v54, v62
 v_mul_f32 v55, v55, v63
 MM v[148:151], v[208:211], a[144:147], v[148:151]
 v_cvt_pk_bf16_f32 v48, v48, v49
 v_cvt_pk_bf16_f32 v49, v50, v51
 MM v[148:151], v[212:215], a[148:151], v[148:151]
 v_cvt_pk_bf16_f32 v50, v52, v53
 v_cvt_pk_bf16_f32 v51, v54, v55
 MM v[148:151], v[216:219], a[152:155], v[148:151]
 s_add_u32 s62, s35, s27
 ds_read_b64_tr_b16 v[240:241], v14 offset:16384
 v_accvgpr_read_b32 v32, a32
 MM v[148:151], v[220:223], a[156:159], v[148:151]
 buffer_store_dwordx4 v[48:51], v1, s[16:19], s62 offen sc1
 MM v[144:147], v[220:223], a[140:143], v[144:147]
 ds_read_b64_tr_b16 v[242:243], v14 offset:16896
 v_accvgpr_read_b32 v33, a33
 MM v[144:147], v[216:219], a[136:139], v[144:147]
 ds_read_b64_tr_b16 v[244:245], v14 offset:20480
 v_accvgpr_read_b32 v34, a34
 MM v[144:147], v[212:215], a[132:135], v[144:147]
 ds_read_b64_tr_b16 v[246:247], v14 offset:20992
 v_accvgpr_read_b32 v35, a35
 MM v[144:147], v[208:211], a[128:131], v[144:147]
 ds_read_b64_tr_b16 v[248:249], v14 offset:24576
 v_accvgpr_read_b32 v36, a48
 MM v[160:163], v[224:227], a[128:131], v[160:163]
 s_waitcnt lgkmcnt(5)
 ds_read_b64_tr_b16 v[250:251], v14 offset:25088
 v_accvgpr_read_b32 v37, a49
 MM v[160:163], v[228:231], a[132:135], v[160:163]
 ds_read_b64_tr_b16 v[252:253], v14 offset:28672
 v_accvgpr_read_b32 v38, a50
 MM v[160:163], v[232:235], a[136:139], v[160:163]
 ds_read_b64_tr_b16 v[254:255], v14 offset:29184
 v_accvgpr_read_b32 v39, a51
 MM v[160:163], v[236:239], a[140:143], v[160:163]
 v_accvgpr_read_b32 v40, a96
 v_accvgpr_read_b32 v41, a97
 MM v[164:167], v[236:239], a[156:159], v[164:167]
 v_accvgpr_read_b32 v42, a98
 v_accvgpr_read_b32 v43, a99
 MM v[164:167], v[232:235], a[152:155], v[164:167]
 v_accvgpr_read_b32 v44, a112
 v_accvgpr_read_b32 v45, a113
 MM v[164:167], v[228:231], a[148:151], v[164:167]
 v_accvgpr_read_b32 v46, a114
 v_accvgpr_read_b32 v47, a115
 MM v[164:167], v[224:227], a[144:147], v[164:167]
 v_mul_f32 v32, v32, v40
 v_mul_f32 v33, v33, v41
 MM v[168:171], v[224:227], a[160:163], v[168:171]
 v_mul_f32 v34, v34, v42
 v_mul_f32 v35, v35, v43
 MM v[168:171], v[228:231], a[164:167], v[168:171]
 v_mul_f32 v36, v36, v44
 v_mul_f32 v37, v37, v45
 MM v[168:171], v[232:235], a[168:171], v[168:171]
 s_waitcnt vmcnt(13)
 s_barrier
 v_mul_f32 v38, v38, v46
 MM v[168:171], v[236:239], a[172:175], v[168:171]
 s_waitcnt vmcnt(5)
 v_cmp_ne_u32 vcc, s61, v25
 s_cbranch_vccnz spin3
spun3:
 MM v[172:175], v[236:239], a[188:191], v[172:175]
 s_add_u32 m0, s30, 32768
 v_mul_f32 v39, v39, v47
 v_cvt_pk_bf16_f32 v32, v32, v33
 MM v[172:175], v[232:235], a[184:187], v[172:175]
 v_cvt_pk_bf16_f32 v33, v34, v35
 v_cvt_pk_bf16_f32 v34, v36, v37
 MM v[172:175], v[228:231], a[180:183], v[172:175]
 s_waitcnt lgkmcnt(0)
 ds_read_b64_tr_b16 v[192:193], v11 offset:32768
 v_cvt_pk_bf16_f32 v35, v38, v39
 MM v[172:175], v[224:227], a[176:179], v[172:175]
 s_add_u32 s62, s32, s27
 ds_read_b64_tr_b16 v[194:195], v11 offset:33280
 v_accvgpr_read_b32 v48, a36
 MM v[188:191], v[240:243], a[176:179], v[188:191]
 ds_read_b64_tr_b16 v[196:197], v11 offset:36864
 v_accvgpr_read_b32 v49, a37
 MM v[188:191], v[244:247], a[180:183], v[188:191]
 ds_read_b64_tr_b16 v[198:199], v11 offset:37376
 v_accvgpr_read_b32 v50, a38
 MM v[188:191], v[248:251], a[184:187], v[188:191]
 ds_read_b64_tr_b16 v[200:201], v11 offset:40960
 v_accvgpr_read_b32 v51, a39
 MM v[188:191], v[252:255], a[188:191], v[188:191]
 ds_read_b64_tr_b16 v[202:203], v11 offset:41472
 v_accvgpr_read_b32 v52, a52
 MM v[184:187], v[252:255], a[172:175], v[184:187]
 ds_read_b64_tr_b16 v[204:205], v11 offset:45056
 v_accvgpr_read_b32 v53, a53
 MM v[184:187], v[248:251], a[168:171], v[184:187]
 ds_read_b64_tr_b16 v[206:207], v11 offset:45568
 v_accvgpr_read_b32 v54, a54
 MM v[184:187], v[244:247], a[164:167], v[184:187]
 buffer_store_dwordx4 v[32:35], v27, s[16:19], s62 offen sc1
 MM v[184:187], v[240:243], a[160:163], v[184:187]
 buffer_load_dwordx4 v1, s[8:11], s29 offen offset:0 sc1 lds
 MM v[180:183], v[240:243], a[144:147], v[180:183]
 ds_read_b64_tr_b16 v[208:209], v12 offset:32768
 v_accvgpr_read_b32 v55, a55
 MM v[180:183], v[244:247], a[148:151], v[180:183]
 buffer_load_dwordx4 v1, s[8:11], s29 offen offset:1024 sc1 lds
 MM v[180:183], v[248:251], a[152:155], v[180:183]
 ds_read_b64_tr_b16 v[210:211], v12 offset:33280
 v_accvgpr_read_b32 v56, a100
 MM v[180:183], v[252:255], a[156:159], v[180:183]
 ds_read_b64_tr_b16 v[212:213], v12 offset:36864
 v_accvgpr_read_b32 v57, a101
 MM v[176:179], v[252:255], a[140:143], v[176:179]
 ds_read_b64_tr_b16 v[214:215], v12 offset:37376
 v_accvgpr_read_b32 v58, a102
 MM v[176:179], v[248:251], a[136:139], v[176:179]
 v_accvgpr_read_b32 v59, a103
 v_accvgpr_read_b32 v60, a116
 MM v[176:179], v[244:247], a[132:135], v[176:179]
 v_accvgpr_read_b32 v61, a117
 v_accvgpr_read_b32 v62, a118
 MM v[176:179], v[240:243], a[128:131], v[176:179]
 s_waitcnt lgkmcnt(3)
 v_accvgpr_read_b32 v63, a119
 v_mul_f32 v48, v48, v56
 MM v[64:67], v[192:195], a[192:195], v[64:67]
 v_mul_f32 v49, v49, v57
 v_mul_f32 v50, v50, v58
 MM v[64:67], v[196:199], a[196:199], v[64:67]
 v_mul_f32 v51, v51, v59
 v_mul_f32 v52, v52, v60
 MM v[64:67], v[200:203], a[200:203], v[64:67]
 v_mul_f32 v53, v53, v61
 v_mul_f32 v54, v54, v62
 MM v[64:67], v[204:207], a[204:207], v[64:67]
 v_mul_f32 v55, v55, v63
 v_cvt_pk_bf16_f32 v48, v48, v49
 MM v[68:71], v[204:207], a[220:223], v[68:71]
 v_cvt_pk_bf16_f32 v49, v50, v51
 v_cvt_pk_bf16_f32 v50, v52, v53
 MM v[68:71], v[200:203], a[216:219], v[68:71]
 ds_read_b64_tr_b16 v[216:217], v12 offset:40960
 v_cvt_pk_bf16_f32 v51, v54, v55
 MM v[68:71], v[196:199], a[212:215], v[68:71]
 s_add_u32 s62, s33, s27
 ds_read_b64_tr_b16 v[218:219], v12 offset:41472
 v_accvgpr_read_b32 v32, a40
 MM v[68:71], v[192:195], a[208:211], v[68:71]
 ds_read_b64_tr_b16 v[220:221], v12 offset:45056
 v_accvgpr_read_b32 v33, a41
 MM v[72:75], v[192:195], a[224:227], v[72:75]
 ds_read_b64_tr_b16 v[222:223], v12 offset:45568
 v_accvgpr_read_b32 v34, a42
 MM v[72:75], v[196:199], a[228:231], v[72:75]
 buffer_load_dwordx4 v1, s[8:11], s29 offen offset:2048 sc1 lds
 MM v[72:75], v[200:203], a[232:235], v[72:75]
 buffer_store_dwordx4 v[48:51], v27, s[16:19], s62 offen sc1
 MM v[72:75], v[204:207], a[236:239], v[72:75]
 buffer_load_dwordx4 v1, s[8:11], s29 offen offset:3072 sc1 lds
 MM v[76:79], v[204:207], a[252:255], v[76:79]
 s_add_u32 s29, s29, 0x4000
 ds_read_b64_tr_b16 v[224:225], v13 offset:32768
 v_accvgpr_read_b32 v35, a43
 MM v[76:79], v[200:203], a[248:251], v[76:79]
 ds_read_b64_tr_b16 v[226:227], v13 offset:33280
 v_accvgpr_read_b32 v36, a56
 MM v[76:79], v[196:199], a[244:247], v[76:79]
 ds_read_b64_tr_b16 v[228:229], v13 offset:36864
 v_accvgpr_read_b32 v37, a57
 MM v[76:79], v[192:195], a[240:243], v[76:79]
 s_waitcnt lgkmcnt(3)
 ds_read_b64_tr_b16 v[230:231], v13 offset:37376
 v_accvgpr_read_b32 v38, a58
 MM v[92:95], v[208:211], a[240:243], v[92:95]
 ds_read_b64_tr_b16 v[232:233], v13 offset:40960
 v_accvgpr_read_b32 v39, a59
 MM v[92:95], v[212:215], a[244:247], v[92:95]
 ds_read_b64_tr_b16 v[234:235], v13 offset:41472
 v_accvgpr_read_b32 v40, a104
 MM v[92:95], v[216:219], a[248:251], v[92:95]
 ds_read_b64_tr_b16 v[236:237], v13 offset:45056
 v_accvgpr_read_b32 v41, a105
 MM v[92:95], v[220:223], a[252:255], v[92:95]
 ds_read_b64_tr_b16 v[238:239], v13 offset:45568
 v_accvgpr_read_b32 v42, a106
 MM v[88:91], v[220:223], a[236:239], v[88:91]
 s_add_u32 m0, s30, 49152
 v_accvgpr_read_b32 v43, a107
 v_accvgpr_read_b32 v44, a120
 MM v[88:91], v[216:219], a[232:235], v[88:91]
 v_accvgpr_read_b32 v45, a121
 v_accvgpr_read_b32 v46, a122
 MM v[88:91], v[212:215], a[228:231], v[88:91]
 v_accvgpr_read_b32 v47, a123
 v_mul_f32 v32, v32, v40
 MM v[88:91], v[208:211], a[224:227], v[88:91]
 v_mul_f32 v33, v33, v41
 v_mul_f32 v34, v34, v42
 MM v[84:87], v[208:211], a[208:211], v[84:87]
 v_mul_f32 v35, v35, v43
 v_mul_f32 v36, v36, v44
 MM v[84:87], v[212:215], a[212:215], v[84:87]
 v_mul_f32 v37, v37, v45
 v_mul_f32 v38, v38, v46
 MM v[84:87], v[216:219], a[216:219], v[84:87]
 v_mul_f32 v39, v39, v47
 v_cvt_pk_bf16_f32 v32, v32, v33
 MM v[84:87], v[220:223], a[220:223], v[84:87]
 v_cvt_pk_bf16_f32 v33, v34, v35
 v_cvt_pk_bf16_f32 v34, v36, v37
 MM v[80:83], v[220:223], a[204:207], v[80:83]
 v_cvt_pk_bf16_f32 v35, v38, v39
 s_add_u32 s62, s34, s27
 MM v[80:83], v[216:219], a[200:203], v[80:83]
 buffer_store_dwordx4 v[32:35], v27, s[16:19], s62 offen sc1
 MM v[80:83], v[212:215], a[196:199], v[80:83]
 buffer_load_dwordx4 v1, s[8:11], s29 offen offset:0 sc1 lds
 MM v[80:83], v[208:211], a[192:195], v[80:83]
 s_waitcnt lgkmcnt(0)
 ds_read_b64_tr_b16 v[240:241], v14 offset:32768
 v_accvgpr_read_b32 v48, a44
 MM v[96:99], v[224:227], a[192:195], v[96:99]
 ds_read_b64_tr_b16 v[242:243], v14 offset:33280
 v_accvgpr_read_b32 v49, a45
 MM v[96:99], v[228:231], a[196:199], v[96:99]
 ds_read_b64_tr_b16 v[244:245], v14 offset:36864
 v_accvgpr_read_b32 v50, a46
 MM v[96:99], v[232:235], a[200:203], v[96:99]
 ds_read_b64_tr_b16 v[246:247], v14 offset:37376
 v_accvgpr_read_b32 v51, a47
 MM v[96:99], v[236:239], a[204:207], v[96:99]
 ds_read_b64_tr_b16 v[248:249], v14 offset:40960
 v_accvgpr_read_b32 v52, a60
 MM v[100:103], v[236:239], a[220:223], v[100:103]
 ds_read_b64_tr_b16 v[250:251], v14 offset:41472
 v_accvgpr_read_b32 v53, a61
 MM v[100:103], v[232:235], a[216:219], v[100:103]
 ds_read_b64_tr_b16 v[252:253], v14 offset:45056
 v_accvgpr_read_b32 v54, a62
 MM v[100:103], v[228:231], a[212:215], v[100:103]
 ds_read_b64_tr_b16 v[254:255], v14 offset:45568
 v_accvgpr_read_b32 v55, a63
 MM v[100:103], v[224:227], a[208:211], v[100:103]
 buffer_load_dwordx4 v1, s[8:11], s29 offen offset:1024 sc1 lds
 MM v[104:107], v[224:227], a[224:227], v[104:107]
 v_accvgpr_read_b32 v56, a108
 v_accvgpr_read_b32 v57, a109
 MM v[104:107], v[228:231], a[228:231], v[104:107]
 v_accvgpr_read_b32 v58, a110
 v_accvgpr_read_b32 v59, a111
 MM v[104:107], v[232:235], a[232:235], v[104:107]
 v_accvgpr_read_b32 v60, a124
 v_accvgpr_read_b32 v61, a125
 MM v[104:107], v[236:239], a[236:239], v[104:107]
 v_accvgpr_read_b32 v62, a126
 v_accvgpr_read_b32 v63, a127
 MM v[108:111], v[236:239], a[252:255], v[108:111]
 v_mul_f32 v48, v48, v56
 v_mul_f32 v49, v49, v57
 MM v[108:111], v[232:235], a[248:251], v[108:111]
 v_mul_f32 v50, v50, v58
 v_mul_f32 v51, v51, v59
 MM v[108:111], v[228:231], a[244:247], v[108:111]
 v_mul_f32 v52, v52, v60
 v_mul_f32 v53, v53, v61
 MM v[108:111], v[224:227], a[240:243], v[108:111]
 s_waitcnt lgkmcnt(0)
 v_mul_f32 v54, v54, v62
 v_mul_f32 v55, v55, v63
 MM v[124:127], v[240:243], a[240:243], v[124:127]
 v_cvt_pk_bf16_f32 v48, v48, v49
 v_cvt_pk_bf16_f32 v49, v50, v51
 MM v[124:127], v[244:247], a[244:247], v[124:127]
 v_cvt_pk_bf16_f32 v50, v52, v53
 v_cvt_pk_bf16_f32 v51, v54, v55
 MM v[124:127], v[248:251], a[248:251], v[124:127]
 buffer_load_dwordx4 v1, s[8:11], s29 offen offset:2048 sc1 lds
 MM v[124:127], v[252:255], a[252:255], v[124:127]
 s_add_u32 s62, s35, s27
 ds_read_b64_tr_b16 v[192:193], v11 offset:49152
 v_cmp_gt_i32 s[64:65], 0, v5
 MM v[120:123], v[252:255], a[236:239], v[120:123]
 buffer_store_dwordx4 v[48:51], v27, s[16:19], s62 offen sc1
 MM v[120:123], v[248:251], a[232:235], v[120:123]
 ds_read_b64_tr_b16 v[194:195], v11 offset:49664
 v_cmp_gt_i32 s[66:67], 1, v5
 MM v[120:123], v[244:247], a[228:231], v[120:123]
 ds_read_b64_tr_b16 v[196:197], v11 offset:53248
 ds_read_b64_tr_b16 v[198:199], v11 offset:53760
 MM v[120:123], v[240:243], a[224:227], v[120:123]
 ds_read_b64_tr_b16 v[200:201], v11 offset:57344
 ds_read_b64_tr_b16 v[202:203], v11 offset:57856
 MM v[116:119], v[240:243], a[208:211], v[116:119]
 ds_read_b64_tr_b16 v[204:205], v11 offset:61440
 ds_read_b64_tr_b16 v[206:207], v11 offset:61952
 MM v[116:119], v[244:247], a[212:215], v[116:119]
 buffer_load_dwordx4 v1, s[8:11], s29 offen offset:3072 sc1 lds
 MM v[116:119], v[248:251], a[216:219], v[116:119]
 s_add_u32 s29, s29, 0x4000
 ds_read_b64_tr_b16 v[208:209], v12 offset:49152
 v_cmp_gt_i32 s[68:69], 2, v5
 MM v[116:119], v[252:255], a[220:223], v[116:119]
 ds_read_b64_tr_b16 v[210:211], v12 offset:49664
 v_cmp_gt_i32 s[70:71], 3, v5
 MM v[112:115], v[252:255], a[204:207], v[112:115]
 ds_read_b64_tr_b16 v[212:213], v12 offset:53248
 v_cmp_gt_i32 s[72:73], 16, v5
 MM v[112:115], v[248:251], a[200:203], v[112:115]
 ds_read_b64_tr_b16 v[214:215], v12 offset:53760
 v_cmp_gt_i32 s[74:75], 17, v5
 MM v[112:115], v[244:247], a[196:199], v[112:115]
 ds_read_b64_tr_b16 v[216:217], v12 offset:57344
 v_cmp_gt_i32 s[76:77], 18, v5
 MM v[112:115], v[240:243], a[192:195], v[112:115]
 s_waitcnt lgkmcnt(5)
 ds_read_b64_tr_b16 v[218:219], v12 offset:57856
 v_cmp_gt_i32 s[78:79], 19, v5
 MM v[128:131], v[192:195], a[192:195], v[128:131]
 ds_read_b64_tr_b16 v[220:221], v12 offset:61440
 v_cmp_gt_i32 s[80:81], 32, v5
 MM v[128:131], v[196:199], a[196:199], v[128:131]
 ds_read_b64_tr_b16 v[222:223], v12 offset:61952
 v_cmp_gt_i32 s[82:83], 33, v5
 MM v[128:131], v[200:203], a[200:203], v[128:131]
 ds_read_b64_tr_b16 v[224:225], v13 offset:49152
 v_cmp_gt_i32 s[84:85], 34, v5
 MM v[128:131], v[204:207], a[204:207], v[128:131]
 ds_read_b64_tr_b16 v[226:227], v13 offset:49664
 v_cmp_gt_i32 s[86:87], 35, v5
 MM v[132:135], v[204:207], a[220:223], v[132:135]
 ds_read_b64_tr_b16 v[228:229], v13 offset:53248
 v_cmp_gt_i32 s[88:89], 48, v5
 MM v[132:135], v[200:203], a[216:219], v[132:135]
 ds_read_b64_tr_b16 v[230:231], v13 offset:53760
 v_cmp_gt_i32 s[90:91], 49, v5
 MM v[132:135], v[196:199], a[212:215], v[132:135]
 ds_read_b64_tr_b16 v[232:233], v13 offset:57344
 v_cmp_gt_i32 s[92:93], 50, v5
 MM v[132:135], v[192:195], a[208:211], v[132:135]
 ds_read_b64_tr_b16 v[234:235], v13 offset:57856
 v_cmp_gt_i32 s[94:95], 51, v5
 MM v[136:139], v[192:195], a[224:227], v[136:139]
 ds_read_b64_tr_b16 v[236:237], v13 offset:61440
 v_cvt_pk_bf16_f32 v64, v64, v65
 MM v[136:139], v[196:199], a[228:231], v[136:139]
 ds_read_b64_tr_b16 v[238:239], v13 offset:61952
 v_cvt_pk_bf16_f32 v65, v66, v67
 MM v[136:139], v[200:203], a[232:235], v[136:139]
 v_cvt_pk_bf16_f32 v66, v80, v81
 v_cvt_pk_bf16_f32 v67, v82, v83
 MM v[136:139], v[204:207], a[236:239], v[136:139]
 v_accvgpr_write_b32 a128, v64
 v_accvgpr_write_b32 a129, v65
 MM v[140:143], v[204:207], a[252:255], v[140:143]
 ds_read_b64_tr_b16 v[240:241], v14 offset:49152
 v_accvgpr_write_b32 a130, v66
 MM v[140:143], v[200:203], a[248:251], v[140:143]
 ds_read_b64_tr_b16 v[242:243], v14 offset:49664
 v_accvgpr_write_b32 a131, v67
 MM v[140:143], v[196:199], a[244:247], v[140:143]
 ds_read_b64_tr_b16 v[244:245], v14 offset:53248
 v_cvt_pk_bf16_f32 v68, v68, v69
 MM v[140:143], v[192:195], a[240:243], v[140:143]
 s_waitcnt lgkmcnt(4)
 ds_read_b64_tr_b16 v[246:247], v14 offset:53760
 v_cvt_pk_bf16_f32 v69, v70, v71
 MM v[156:159], v[208:211], a[240:243], v[156:159]
 ds_read_b64_tr_b16 v[248:249], v14 offset:57344
 v_cvt_pk_bf16_f32 v70, v84, v85
 MM v[156:159], v[212:215], a[244:247], v[156:159]
 ds_read_b64_tr_b16 v[250:251], v14 offset:57856
 v_cvt_pk_bf16_f32 v71, v86, v87
 MM v[156:159], v[216:219], a[248:251], v[156:159]
 ds_read_b64_tr_b16 v[252:253], v14 offset:61440
 v_accvgpr_write_b32 a144, v68
 MM v[156:159], v[220:223], a[252:255], v[156:159]
 ds_read_b64_tr_b16 v[254:255], v14 offset:61952
 v_accvgpr_write_b32 a145, v69
 MM v[152:155], v[220:223], a[236:239], v[152:155]
 s_waitcnt vmcnt(14)
 s_barrier
 s_add_u32 m0, s31, 0
 MM v[152:155], v[216:219], a[232:235], v[152:155]
 v_accvgpr_write_b32 a146, v70
 v_accvgpr_write_b32 a147, v71
 MM v[152:155], v[212:215], a[228:231], v[152:155]
 v_cvt_pk_bf16_f32 v72, v72, v73
 v_cvt_pk_bf16_f32 v73, v74, v75
 MM v[152:155], v[208:211], a[224:227], v[152:155]
 v_cvt_pk_bf16_f32 v74, v88, v89
 v_cvt_pk_bf16_f32 v75, v90, v91
 MM v[148:151], v[208:211], a[208:211], v[148:151]
 buffer_load_dwordx4 v1, s[4:7], s28 offen offset:0 sc1 lds
 MM v[148:151], v[212:215], a[212:215], v[148:151]
 v_accvgpr_write_b32 a160, v72
 v_accvgpr_write_b32 a161, v73
 MM v[148:151], v[216:219], a[216:219], v[148:151]
 v_accvgpr_write_b32 a162, v74
 v_accvgpr_write_b32 a163, v75
 MM v[148:151], v[220:223], a[220:223], v[148:151]
 buffer_load_dwordx4 v1, s[4:7], s28 offen offset:1024 sc1 lds
 MM v[144:147], v[220:223], a[204:207], v[144:147]
 v_cvt_pk_bf16_f32 v76, v76, v77
 v_cvt_pk_bf16_f32 v77, v78, v79
 MM v[144:147], v[216:219], a[200:203], v[144:147]
 v_cvt_pk_bf16_f32 v78, v92, v93
 v_cvt_pk_bf16_f32 v79, v94, v95
 MM v[144:147], v[212:215], a[196:199], v[144:147]
 buffer_load_dwordx4 v1, s[4:7], s28 offen offset:2048 sc1 lds
 MM v[144:147], v[208:211], a[192:195], v[144:147]
 v_accvgpr_write_b32 a176, v76
 v_accvgpr_write_b32 a177, v77
 MM v[160:163], v[224:227], a[192:195], v[160:163]
 s_waitcnt lgkmcnt(0)
 v_accvgpr_write_b32 a178, v78
 v_accvgpr_write_b32 a179, v79
 MM v[160:163], v[228:231], a[196:199], v[160:163]
 buffer_load_dwordx4 v1, s[4:7], s28 offen offset:3072 sc1 lds
 MM v[160:163], v[232:235], a[200:203], v[160:163]
 s_add_u32 s28, s28, 0x4000
 s_add_u32 m0, s31, 16384
 v_cvt_pk_bf16_f32 v96, v96, v97
 MM v[160:163], v[236:239], a[204:207], v[160:163]
 v_cvt_pk_bf16_f32 v97, v98, v99
 v_cvt_pk_bf16_f32 v98, v112, v113
 MM v[164:167], v[236:239], a[220:223], v[164:167]
 v_cvt_pk_bf16_f32 v99, v114, v115
 v_accvgpr_write_b32 a132, v96
 MM v[164:167], v[232:235], a[216:219], v[164:167]
 v_accvgpr_write_b32 a133, v97
 v_accvgpr_write_b32 a134, v98
 MM v[164:167], v[228:231], a[212:215], v[164:167]
 buffer_load_dwordx4 v1, s[4:7], s28 offen offset:0 sc1 lds
 MM v[164:167], v[224:227], a[208:211], v[164:167]
 v_accvgpr_write_b32 a135, v99
 v_cvt_pk_bf16_f32 v100, v100, v101
 MM v[168:171], v[224:227], a[224:227], v[168:171]
 v_cvt_pk_bf16_f32 v101, v102, v103
 v_cvt_pk_bf16_f32 v102, v116, v117
 MM v[168:171], v[228:231], a[228:231], v[168:171]
 buffer_load_dwordx4 v1, s[4:7], s28 offen offset:1024 sc1 lds
 MM v[168:171], v[232:235], a[232:235], v[168:171]
 v_cvt_pk_bf16_f32 v103, v118, v119
 v_accvgpr_write_b32 a148, v100
 MM v[168:171], v[236:239], a[236:239], v[168:171]
 v_accvgpr_write_b32 a149, v101
 v_accvgpr_write_b32 a150, v102
 MM v[172:175], v[236:239], a[252:255], v[172:175]
 buffer_load_dwordx4 v1, s[4:7], s28 offen offset:2048 sc1 lds
 MM v[172:175], v[232:235], a[248:251], v[172:175]
 v_accvgpr_write_b32 a151, v103
 v_cvt_pk_bf16_f32 v104, v104, v105
 MM v[172:175], v[228:231], a[244:247], v[172:175]
 v_cvt_pk_bf16_f32 v105, v106, v107
 v_cvt_pk_bf16_f32 v106, v120, v121
 MM v[172:175], v[224:227], a[240:243], v[172:175]
 buffer_load_dwordx4 v1, s[4:7], s28 offen offset:3072 sc1 lds
 MM v[188:191], v[240:243], a[240:243], v[188:191]
 s_add_u32 s28, s28, 0x4000
 v_cvt_pk_bf16_f32 v107, v122, v123
 v_accvgpr_write_b32 a164, v104
 MM v[188:191], v[244:247], a[244:247], v[188:191]
 v_accvgpr_write_b32 a165, v105
 v_accvgpr_write_b32 a166, v106
 MM v[188:191], v[248:251], a[248:251], v[188:191]
 v_accvgpr_write_b32 a167, v107
 v_cvt_pk_bf16_f32 v108, v108, v109
 MM v[188:191], v[252:255], a[252:255], v[188:191]
 v_cvt_pk_bf16_f32 v109, v110, v111
 v_cvt_pk_bf16_f32 v110, v124, v125
 MM v[184:187], v[252:255], a[236:239], v[184:187]
 v_cvt_pk_bf16_f32 v111, v126, v127
 v_accvgpr_write_b32 a180, v108
 MM v[184:187], v[248:251], a[232:235], v[184:187]
 v_accvgpr_write_b32 a181, v109
 v_accvgpr_write_b32 a182, v110
 MM v[184:187], v[244:247], a[228:231], v[184:187]
 v_accvgpr_write_b32 a183, v111
 v_cvt_pk_bf16_f32 v128, v128, v129
 MM v[184:187], v[240:243], a[224:227], v[184:187]
 v_cvt_pk_bf16_f32 v129, v130, v131
 v_cvt_pk_bf16_f32 v130, v144, v145
 MM v[180:183], v[240:243], a[208:211], v[180:183]
 v_cvt_pk_bf16_f32 v131, v146, v147
 v_accvgpr_write_b32 a136, v128
 MM v[180:183], v[244:247], a[212:215], v[180:183]
 v_accvgpr_write_b32 a137, v129
 v_accvgpr_write_b32 a138, v130
 MM v[180:183], v[248:251], a[216:219], v[180:183]
 v_accvgpr_write_b32 a139, v131
 v_cvt_pk_bf16_f32 v132, v132, v133
 MM v[180:183], v[252:255], a[220:223], v[180:183]
 v_cvt_pk_bf16_f32 v133, v134, v135
 v_cvt_pk_bf16_f32 v134, v148, v149
 MM v[176:179], v[252:255], a[204:207], v[176:179]
 v_cvt_pk_bf16_f32 v135, v150, v151
 v_accvgpr_write_b32 a152, v132
 MM v[176:179], v[248:251], a[200:203], v[176:179]
 v_accvgpr_write_b32 a153, v133
 v_accvgpr_write_b32 a154, v134
 MM v[176:179], v[244:247], a[196:199], v[176:179]
 v_accvgpr_write_b32 a155, v135
 v_cvt_pk_bf16_f32 v136, v136, v137
 MM v[176:179], v[240:243], a[192:195], v[176:179]
 ds_read_b128 v[192:195], v2 offset:0
 ds_read_b128 v[196:199], v2 offset:1024
 ds_read_b128 v[200:203], v2 offset:2048
 ds_read_b128 v[204:207], v2 offset:3072
 ds_read_b128 v[208:211], v2 offset:4096
 ds_read_b128 v[212:215], v2 offset:5120
 ds_read_b128 v[216:219], v2 offset:6144
 ds_read_b128 v[220:223], v2 offset:7168
 ds_read_b128 v[224:227], v2 offset:8192
 ds_read_b128 v[228:231], v2 offset:9216
 ds_read_b128 v[232:235], v2 offset:10240
 ds_read_b128 v[236:239], v2 offset:11264
 ds_read_b128 v[248:251], v2 offset:14336
 ds_read_b128 v[252:255], v2 offset:15360
 v_cvt_pk_bf16_f32 v137, v138, v139
 v_cvt_pk_bf16_f32 v138, v152, v153
 v_cvt_pk_bf16_f32 v139, v154, v155
 v_accvgpr_write_b32 a168, v136
 v_accvgpr_write_b32 a169, v137
 v_accvgpr_write_b32 a170, v138
 v_accvgpr_write_b32 a171, v139
 v_cvt_pk_bf16_f32 v140, v140, v141
 v_cvt_pk_bf16_f32 v141, v142, v143
 v_cvt_pk_bf16_f32 v142, v156, v157
 v_cvt_pk_bf16_f32 v143, v158, v159
 v_accvgpr_write_b32 a184, v140
 v_accvgpr_write_b32 a185, v141
 v_accvgpr_write_b32 a186, v142
 v_accvgpr_write_b32 a187, v143
 ds_read_b128 v[240:243], v2 offset:12288
 ds_read_b128 v[244:247], v2 offset:13312
 v_cvt_pk_bf16_f32 v160, v160, v161
 v_cvt_pk_bf16_f32 v161, v162, v163
 v_cvt_pk_bf16_f32 v162, v176, v177
 v_cvt_pk_bf16_f32 v163, v178, v179
 v_accvgpr_write_b32 a140, v160
 v_accvgpr_write_b32 a141, v161
 v_accvgpr_write_b32 a142, v162
 v_accvgpr_write_b32 a143, v163
 v_cvt_pk_bf16_f32 v164, v164, v165
 v_cvt_pk_bf16_f32 v165, v166, v167
 v_cvt_pk_bf16_f32 v166, v180, v181
 v_cvt_pk_bf16_f32 v167, v182, v183
 v_accvgpr_write_b32 a156, v164
 v_accvgpr_write_b32 a157, v165
 v_accvgpr_write_b32 a158, v166
 v_accvgpr_write_b32 a159, v167
 v_cvt_pk_bf16_f32 v168, v168, v169
 v_cvt_pk_bf16_f32 v169, v170, v171
 v_cvt_pk_bf16_f32 v170, v184, v185
 v_cvt_pk_bf16_f32 v171, v186, v187
 v_accvgpr_write_b32 a172, v168
 v_accvgpr_write_b32 a173, v169
 v_accvgpr_write_b32 a174, v170
 v_accvgpr_write_b32 a175, v171
 v_cvt_pk_bf16_f32 v172, v172, v173
 v_cvt_pk_bf16_f32 v173, v174, v175
 v_cvt_pk_bf16_f32 v174, v188, v189
 v_cvt_pk_bf16_f32 v175, v190, v191
 v_accvgpr_write_b32 a188, v172
 v_accvgpr_write_b32 a189, v173
 v_accvgpr_write_b32 a190, v174
 v_accvgpr_write_b32 a191, v175
 s_waitcnt lgkmcnt(0)
k_att:
 s_load_dwordx2 s[48:49], s[0:1], 0
 s_load_dwordx2 s[52:53], s[0:1], 80
 s_cmp_eq_u32 s26, 0
 s_cbranch_scc1 k_f_d1
 s_nop 1
 MM v[64:67], v[192:195], a[128:131], 0
 MM v[64:67], v[196:199], a[132:135], v[64:67]
 MM v[64:67], v[200:203], a[136:139], v[64:67]
 MM v[64:67], v[204:207], a[140:143], v[64:67]
 MM v[80:83], v[204:207], a[156:159], 0
 MM v[80:83], v[200:203], a[152:155], v[80:83]
 MM v[80:83], v[196:199], a[148:151], v[80:83]
 MM v[80:83], v[192:195], a[144:147], v[80:83]
 MM v[96:99], v[192:195], a[160:163], 0
 s_nop 2
 v_max3_f32 v8, v64, v65, v66
 v_max_f32 v8, v8, v67
 MM v[96:99], v[196:199], a[164:167], v[96:99]
 v_mov_b32 v9, v8
 MM v[96:99], v[200:203], a[168:171], v[96:99]
 MM v[96:99], v[204:207], a[172:175], v[96:99]
 v_permlane16_swap_b32 v8, v9
 v_max_f32 v8, v8, v9
 MM v[112:115], v[204:207], a[188:191], 0
 v_mov_b32 v9, v8
 v_max3_f32 v10, v80, v81, v82
 MM v[112:115], v[200:203], a[184:187], v[112:115]
 v_max_f32 v10, v10, v83
 v_mov_b32 v11, v10
 MM v[112:115], v[196:199], a[180:183], v[112:115]
 v_permlane32_swap_b32 v8, v9
 v_max_f32 v8, v8, v9
 MM v[112:115], v[192:195], a[176:179], v[112:115]
 v_sub_f32 v48, 0, v8
 v_sub_f32 v49, 0, v8
 MM v[116:119], v[208:211], a[176:179], 0
 v_sub_f32 v50, 0, v8
 v_sub_f32 v51, 0, v8
 MM v[116:119], v[212:215], a[180:183], v[116:119]
 v_permlane16_swap_b32 v10, v11
 v_max_f32 v10, v10, v11
 MM v[116:119], v[216:219], a[184:187], v[116:119]
 v_mov_b32 v11, v10
 v_max3_f32 v12, v96, v97, v98
 MM v[116:119], v[220:223], a[188:191], v[116:119]
 v_max_f32 v12, v12, v99
 v_mov_b32 v13, v12
 MM v[100:103], v[220:223], a[172:175], 0
 v_permlane32_swap_b32 v10, v11
 v_max_f32 v10, v10, v11
 MM v[100:103], v[216:219], a[168:171], v[100:103]
 v_sub_f32 v52, 0, v10
 v_sub_f32 v53, 0, v10
 MM v[100:103], v[212:215], a[164:167], v[100:103]
 v_sub_f32 v54, 0, v10
 v_sub_f32 v55, 0, v10
 MM v[100:103], v[208:211], a[160:163], v[100:103]
 v_permlane16_swap_b32 v12, v13
 v_max_f32 v12, v12, v13
 MM v[84:87], v[208:211], a[144:147], 0
 v_mov_b32 v13, v12
 v_max3_f32 v14, v112, v113, v114
 MM v[84:87], v[212:215], a[148:151], v[84:87]
 v_max_f32 v14, v14, v115
 v_mov_b32 v15, v14
 MM v[84:87], v[216:219], a[152:155], v[84:87]
 v_permlane32_swap_b32 v12, v13
 v_max_f32 v12, v12, v13
 MM v[84:87], v[220:223], a[156:159], v[84:87]
 v_sub_f32 v56, 0, v12
 v_sub_f32 v57, 0, v12
 MM v[68:71], v[220:223], a[140:143], 0
 v_sub_f32 v58, 0, v12
 v_sub_f32 v59, 0, v12
 MM v[68:71], v[216:219], a[136:139], v[68:71]
 v_permlane16_swap_b32 v14, v15
 v_max_f32 v14, v14, v15
 MM v[68:71], v[212:215], a[132:135], v[68:71]
 s_lshl_b32 s3, s2, 2
 s_add_u32 s3, s3, 70729728
 v_mov_b32 v15, v14
 MM v[68:71], v[208:211], a[128:131], v[68:71]
 s_add_u32 s3, s3, s100
 v_mov_b32 v16, s61
 v_sub_f32 v64, v64, v8
 MM v[72:75], v[224:227], a[128:131], v[48:51]
 v_permlane32_swap_b32 v14, v15
 v_max_f32 v14, v14, v15
 MM v[72:75], v[228:231], a[132:135], v[72:75]
 v_sub_f32 v60, 0, v14
 v_sub_f32 v61, 0, v14
 MM v[72:75], v[232:235], a[136:139], v[72:75]
 v_sub_f32 v62, 0, v14
 v_sub_f32 v63, 0, v14
 MM v[72:75], v[236:239], a[140:143], v[72:75]
 v_sub_f32 v65, v65, v8
 v_sub_f32 v66, v66, v8
 MM v[88:91], v[236:239], a[156:159], v[52:55]
 v_sub_f32 v67, v67, v8
 v_sub_f32 v80, v80, v10
 MM v[88:91], v[232:235], a[152:155], v[88:91]
 v_sub_f32 v68, v68, v8
 v_sub_f32 v69, v69, v8
 MM v[88:91], v[228:231], a[148:151], v[88:91]
 v_sub_f32 v70, v70, v8
 v_sub_f32 v71, v71, v8
 MM v[88:91], v[224:227], a[144:147], v[88:91]
 v_sub_f32 v81, v81, v10
 v_sub_f32 v82, v82, v10
 MM v[104:107], v[224:227], a[160:163], v[56:59]
 v_sub_f32 v83, v83, v10
 v_sub_f32 v84, v84, v10
 MM v[104:107], v[228:231], a[164:167], v[104:107]
 v_sub_f32 v85, v85, v10
 v_sub_f32 v86, v86, v10
 MM v[104:107], v[232:235], a[168:171], v[104:107]
 v_sub_f32 v87, v87, v10
 v_sub_f32 v96, v96, v12
 MM v[104:107], v[236:239], a[172:175], v[104:107]
 v_sub_f32 v97, v97, v12
 v_sub_f32 v98, v98, v12
 MM v[120:123], v[236:239], a[188:191], v[60:63]
 v_sub_f32 v99, v99, v12
 v_sub_f32 v100, v100, v12
 MM v[120:123], v[232:235], a[184:187], v[120:123]
 v_sub_f32 v101, v101, v12
 v_sub_f32 v102, v102, v12
 MM v[120:123], v[228:231], a[180:183], v[120:123]
 v_sub_f32 v103, v103, v12
 v_sub_f32 v112, v112, v14
 MM v[120:123], v[224:227], a[176:179], v[120:123]
 v_sub_f32 v113, v113, v14
 v_sub_f32 v114, v114, v14
 MM v[124:127], v[240:243], a[176:179], v[60:63]
 v_sub_f32 v115, v115, v14
 v_sub_f32 v116, v116, v14
 MM v[124:127], v[244:247], a[180:183], v[124:127]
 v_sub_f32 v117, v117, v14
 v_sub_f32 v118, v118, v14
 MM v[124:127], v[248:251], a[184:187], v[124:127]
 ds_read_b128 v[192:195], v2 offset:16384
 v_sub_f32 v119, v119, v14
 MM v[124:127], v[252:255], a[188:191], v[124:127]
 ds_read_b128 v[196:199], v2 offset:17408
 v_max3_f32 v5, v68, v69, v70
 MM v[108:111], v[252:255], a[172:175], v[56:59]
 ds_read_b128 v[200:203], v2 offset:18432
 v_max3_f32 v6, v71, v84, v85
 MM v[108:111], v[248:251], a[168:171], v[108:111]
 s_waitcnt vmcnt(4)
 ds_read_b128 v[204:207], v2 offset:19456
 v_max3_f32 v5, v86, v87, v5
 MM v[108:111], v[244:247], a[164:167], v[108:111]
 s_barrier
 ds_read_b128 v[208:211], v2 offset:20480
 v_max3_f32 v6, v100, v101, v6
 MM v[108:111], v[240:243], a[160:163], v[108:111]
 s_mov_b64 exec, 1
 buffer_store_dword v16, off, s[16:19], s3 sc1
 s_mov_b64 exec, -1
 MM v[92:95], v[240:243], a[144:147], v[52:55]
 ds_read_b128 v[212:215], v2 offset:21504
 v_max3_f32 v5, v102, v103, v5
 MM v[92:95], v[244:247], a[148:151], v[92:95]
 ds_read_b128 v[216:219], v2 offset:22528
 v_max3_f32 v6, v116, v117, v6
 MM v[92:95], v[248:251], a[152:155], v[92:95]
 ds_read_b128 v[220:223], v2 offset:23552
 v_max3_f32 v5, v118, v119, v5
 MM v[92:95], v[252:255], a[156:159], v[92:95]
 ds_read_b128 v[224:227], v2 offset:24576
 ds_read_b128 v[228:231], v2 offset:25600
 MM v[76:79], v[252:255], a[140:143], v[48:51]
 ds_read_b128 v[232:235], v2 offset:26624
 ds_read_b128 v[236:239], v2 offset:27648
 MM v[76:79], v[248:251], a[136:139], v[76:79]
 ds_read_b128 v[248:251], v2 offset:30720
 ds_read_b128 v[252:255], v2 offset:31744
 MM v[76:79], v[244:247], a[132:135], v[76:79]
 ds_read_b128 v[244:247], v2 offset:29696
 v_max3_f32 v6, v72, v73, v6
 MM v[76:79], v[240:243], a[128:131], v[76:79]
 ds_read_b128 v[240:243], v2 offset:28672
 v_max3_f32 v5, v74, v75, v5
 v_max3_f32 v6, v88, v89, v6
 v_max3_f32 v5, v90, v91, v5
 v_max3_f32 v6, v104, v105, v6
 v_max3_f32 v5, v106, v107, v5
 v_max3_f32 v6, v120, v121, v6
 v_max3_f32 v5, v122, v123, v5
 v_max3_f32 v6, v124, v125, v6
 v_max3_f32 v5, v126, v127, v5
 v_max3_f32 v6, v108, v109, v6
 v_max3_f32 v5, v110, v111, v5
 v_max3_f32 v6, v92, v93, v6
 v_max3_f32 v5, v94, v95, v5
 v_max3_f32 v6, v76, v77, v6
 v_max3_f32 v5, v78, v79, v5
 v_max_f32 v5, v5, v6
 v_cmp_lt_f32 vcc, 0x42400000, v5
 s_waitcnt lgkmcnt(0)
 s_cbranch_vccnz ftS_r
ftS_ok:
 s_mov_b32 s44, s26
 MM v[128:131], v[192:195], a[128:131], v[48:51]
 s_add_u32 m0, s30, 0
 v_exp_f32 v64, v64
 MM v[128:131], v[196:199], a[132:135], v[128:131]
 buffer_load_dwordx4 v1, s[4:7], s28 offen offset:0 sc1 lds
 MM v[128:131], v[200:203], a[136:139], v[128:131]
 v_exp_f32 v65, v65
 MM v[128:131], v[204:207], a[140:143], v[128:131]
 v_exp_f32 v66, v66
 MM v[144:147], v[204:207], a[156:159], v[52:55]
 ds_read_b128 a[220:223], v2 offset:39936
 v_cvt_pk_bf16_f32 v64, v64, v65
 MM v[144:147], v[200:203], a[152:155], v[144:147]
 v_exp_f32 v67, v67
 MM v[144:147], v[196:199], a[148:151], v[144:147]
 v_exp_f32 v68, v68
 MM v[144:147], v[192:195], a[144:147], v[144:147]
 ds_read_b128 a[252:255], v2 offset:48128
 v_cvt_pk_bf16_f32 v65, v66, v67
 MM v[160:163], v[192:195], a[160:163], v[56:59]
 v_exp_f32 v69, v69
 MM v[160:163], v[196:199], a[164:167], v[160:163]
 v_exp_f32 v70, v70
 MM v[160:163], v[200:203], a[168:171], v[160:163]
 ds_read_b128 a[248:251], v2 offset:47104
 v_cvt_pk_bf16_f32 v66, v68, v69
 MM v[160:163], v[204:207], a[172:175], v[160:163]
 v_exp_f32 v71, v71
 MM v[176:179], v[204:207], a[188:191], v[60:63]
 v_exp_f32 v72, v72
 MM v[176:179], v[200:203], a[184:187], v[176:179]
 ds_read_b128 a[216:219], v2 offset:38912
 v_cvt_pk_bf16_f32 v67, v70, v71
 MM v[176:179], v[196:199], a[180:183], v[176:179]
 buffer_load_dwordx4 v1, s[4:7], s28 offen offset:1024 sc1 lds
 MM v[176:179], v[192:195], a[176:179], v[176:179]
 v_exp_f32 v73, v73
 MM v[180:183], v[208:211], a[176:179], v[60:63]
 ds_read_b128 a[212:215], v2 offset:37888
 v_cvt_pk_bf16_f32 v72, v72, v73
 MM v[180:183], v[212:215], a[180:183], v[180:183]
 v_exp_f32 v74, v74
 MM v[180:183], v[216:219], a[184:187], v[180:183]
 v_exp_f32 v75, v75
 MM v[180:183], v[220:223], a[188:191], v[180:183]
 ds_read_b128 a[244:247], v2 offset:46080
 v_cvt_pk_bf16_f32 v73, v74, v75
 MM v[164:167], v[220:223], a[172:175], v[56:59]
 v_exp_f32 v76, v76
 MM v[164:167], v[216:219], a[168:171], v[164:167]
 v_exp_f32 v77, v77
 MM v[164:167], v[212:215], a[164:167], v[164:167]
 ds_read_b128 a[240:243], v2 offset:45056
 v_cvt_pk_bf16_f32 v74, v76, v77
 MM v[164:167], v[208:211], a[160:163], v[164:167]
 v_exp_f32 v78, v78
 MM v[148:151], v[208:211], a[144:147], v[52:55]
 v_exp_f32 v79, v79
 MM v[148:151], v[212:215], a[148:151], v[148:151]
 ds_read_b128 a[208:211], v2 offset:36864
 v_cvt_pk_bf16_f32 v75, v78, v79
 MM v[148:151], v[216:219], a[152:155], v[148:151]
 v_exp_f32 v80, v80
 MM v[148:151], v[220:223], a[156:159], v[148:151]
 v_exp_f32 v81, v81
 MM v[132:135], v[220:223], a[140:143], v[48:51]
 buffer_load_dwordx4 v1, s[4:7], s28 offen offset:2048 sc1 lds
 MM v[132:135], v[216:219], a[136:139], v[132:135]
 ds_read_b128 a[204:207], v2 offset:35840
 v_cvt_pk_bf16_f32 v80, v80, v81
 MM v[132:135], v[212:215], a[132:135], v[132:135]
 v_exp_f32 v82, v82
 MM v[132:135], v[208:211], a[128:131], v[132:135]
 v_exp_f32 v83, v83
 MM v[136:139], v[224:227], a[128:131], v[48:51]
 ds_read_b128 a[236:239], v2 offset:44032
 v_cvt_pk_bf16_f32 v81, v82, v83
 MM v[136:139], v[228:231], a[132:135], v[136:139]
 v_exp_f32 v84, v84
 MM v[136:139], v[232:235], a[136:139], v[136:139]
 v_exp_f32 v85, v85
 MM v[136:139], v[236:239], a[140:143], v[136:139]
 ds_read_b128 a[232:235], v2 offset:43008
 v_cvt_pk_bf16_f32 v82, v84, v85
 MM v[152:155], v[236:239], a[156:159], v[52:55]
 v_exp_f32 v86, v86
 MM v[152:155], v[232:235], a[152:155], v[152:155]
 v_exp_f32 v87, v87
 MM v[152:155], v[228:231], a[148:151], v[152:155]
 ds_read_b128 a[200:203], v2 offset:34816
 v_cvt_pk_bf16_f32 v83, v86, v87
 MM v[152:155], v[224:227], a[144:147], v[152:155]
 v_exp_f32 v88, v88
 MM v[168:171], v[224:227], a[160:163], v[56:59]
 v_exp_f32 v89, v89
 MM v[168:171], v[228:231], a[164:167], v[168:171]
 ds_read_b128 a[196:199], v2 offset:33792
 v_cvt_pk_bf16_f32 v88, v88, v89
 MM v[168:171], v[232:235], a[168:171], v[168:171]
 buffer_load_dwordx4 v1, s[4:7], s28 offen offset:3072 sc1 lds
 MM v[168:171], v[236:239], a[172:175], v[168:171]
 s_add_u32 s28, s28, 0x4000
 v_exp_f32 v90, v90
 MM v[184:187], v[236:239], a[188:191], v[60:63]
 ds_read_b128 a[228:231], v2 offset:41984
 v_accvgpr_write_b32 a96, 0
 MM v[184:187], v[232:235], a[184:187], v[184:187]
 v_exp_f32 v91, v91
 MM v[184:187], v[228:231], a[180:183], v[184:187]
 v_exp_f32 v92, v92
 MM v[184:187], v[224:227], a[176:179], v[184:187]
 ds_read_b128 a[224:227], v2 offset:40960
 v_cvt_pk_bf16_f32 v89, v90, v91
 MM v[188:191], v[240:243], a[176:179], v[60:63]
 v_exp_f32 v93, v93
 MM v[188:191], v[244:247], a[180:183], v[188:191]
 v_exp_f32 v94, v94
 MM v[188:191], v[248:251], a[184:187], v[188:191]
 ds_read_b128 a[192:195], v2 offset:32768
 v_cvt_pk_bf16_f32 v90, v92, v93
 MM v[188:191], v[252:255], a[188:191], v[188:191]
 v_exp_f32 v95, v95
 MM v[172:175], v[252:255], a[172:175], v[56:59]
 s_add_u32 m0, s31, 32768
 v_cvt_pk_bf16_f32 v91, v94, v95
 v_accvgpr_write_b32 a97, 0
 MM v[172:175], v[248:251], a[168:171], v[172:175]
 v_exp_f32 v96, v96
 MM v[172:175], v[244:247], a[164:167], v[172:175]
 v_exp_f32 v97, v97
 MM v[172:175], v[240:243], a[160:163], v[172:175]
 v_exp_f32 v98, v98
 MM v[156:159], v[240:243], a[144:147], v[52:55]
 buffer_load_dwordx4 v1, s[8:11], s29 offen offset:0 sc1 lds
 MM v[156:159], v[244:247], a[148:151], v[156:159]
 v_exp_f32 v99, v99
 MM v[156:159], v[248:251], a[152:155], v[156:159]
 v_exp_f32 v100, v100
 MM v[156:159], v[252:255], a[156:159], v[156:159]
 v_exp_f32 v101, v101
 MM v[140:143], v[252:255], a[140:143], v[48:51]
 v_exp_f32 v102, v102
 MM v[140:143], v[248:251], a[136:139], v[140:143]
 v_exp_f32 v103, v103
 MM v[140:143], v[244:247], a[132:135], v[140:143]
 v_exp_f32 v104, v104
 MM v[140:143], v[240:243], a[128:131], v[140:143]
 s_waitcnt lgkmcnt(0)
 v_exp_f32 v105, v105
 MM a[28:31], a[220:223], v[64:67], 0
 v_exp_f32 v106, v106
 MM a[28:31], a[252:255], v[72:75], a[28:31]
 v_exp_f32 v107, v107
 MM a[24:27], a[248:251], v[72:75], 0
 v_exp_f32 v108, v108
 MM a[24:27], a[216:219], v[64:67], a[24:27]
 v_exp_f32 v109, v109
 MM a[20:23], a[212:215], v[64:67], 0
 v_exp_f32 v110, v110
 MM a[20:23], a[244:247], v[72:75], a[20:23]
 buffer_load_dwordx4 v1, s[8:11], s29 offen offset:1024 sc1 lds
 MM a[16:19], a[240:243], v[72:75], 0
 v_exp_f32 v111, v111
 MM a[16:19], a[208:211], v[64:67], a[16:19]
 v_cvt_pk_bf16_f32 v96, v96, v97
 v_cvt_pk_bf16_f32 v97, v98, v99
 MM a[12:15], a[204:207], v[64:67], 0
 v_cvt_pk_bf16_f32 v98, v100, v101
 v_cvt_pk_bf16_f32 v99, v102, v103
 MM a[12:15], a[236:239], v[72:75], a[12:15]
 v_cvt_pk_bf16_f32 v104, v104, v105
 v_cvt_pk_bf16_f32 v105, v106, v107
 MM a[8:11], a[232:235], v[72:75], 0
 v_cvt_pk_bf16_f32 v106, v108, v109
 v_cvt_pk_bf16_f32 v107, v110, v111
 MM a[8:11], a[200:203], v[64:67], a[8:11]
 ds_read_b128 v[192:195], v3 offset:0
 v_accvgpr_write_b32 a98, 0
 MM a[4:7], a[196:199], v[64:67], 0
 ds_read_b128 v[196:199], v3 offset:1024
 v_accvgpr_write_b32 a99, 0
 MM a[4:7], a[228:231], v[72:75], a[4:7]
 ds_read_b128 v[200:203], v3 offset:2048
 v_accvgpr_write_b32 a100, 0
 MM a[0:3], a[224:227], v[72:75], 0
 ds_read_b128 v[204:207], v3 offset:3072
 v_accvgpr_write_b32 a101, 0
 MM a[0:3], a[192:195], v[64:67], a[0:3]
 ds_read_b128 v[208:211], v3 offset:4096
 v_accvgpr_write_b32 a102, 0
 MM v[32:35], v[28:31], v[64:67], 0
 ds_read_b128 v[212:215], v3 offset:5120
 v_accvgpr_write_b32 a103, 0
 MM v[32:35], v[28:31], v[72:75], v[32:35]
 ds_read_b128 v[216:219], v3 offset:6144
 v_accvgpr_write_b32 a104, 0
 MM a[32:35], a[224:227], v[88:91], 0
 ds_read_b128 v[220:223], v3 offset:7168
 v_accvgpr_write_b32 a105, 0
 MM a[32:35], a[192:195], v[80:83], a[32:35]
 buffer_load_dwordx4 v1, s[8:11], s29 offen offset:2048 sc1 lds
 MM a[36:39], a[196:199], v[80:83], 0
 ds_read_b128 v[224:227], v3 offset:8192
 v_accvgpr_write_b32 a106, 0
 MM a[36:39], a[228:231], v[88:91], a[36:39]
 ds_read_b128 v[228:231], v3 offset:9216
 v_accvgpr_write_b32 a107, 0
 MM a[40:43], a[232:235], v[88:91], 0
 ds_read_b128 v[232:235], v3 offset:10240
 v_accvgpr_write_b32 a108, 0
 MM a[40:43], a[200:203], v[80:83], a[40:43]
 v_accvgpr_write_b32 a109, 0
 v_accvgpr_write_b32 a110, 0
 MM a[44:47], a[204:207], v[80:83], 0
 ds_read_b128 v[236:239], v3 offset:11264
 v_accvgpr_write_b32 a111, 0
 MM a[44:47], a[236:239], v[88:91], a[44:47]
 v_accvgpr_write_b32 a112, 0
 v_accvgpr_write_b32 a113, 0
 MM a[48:51], a[240:243], v[88:91], 0
 ds_read_b128 v[240:243], v3 offset:12288
 v_accvgpr_write_b32 a114, 0
 MM a[48:51], a[208:211], v[80:83], a[48:51]
 v_accvgpr_write_b32 a115, 0
 v_accvgpr_write_b32 a116, 0
 MM a[52:55], a[212:215], v[80:83], 0
 ds_read_b128 v[244:247], v3 offset:13312
 v_accvgpr_write_b32 a117, 0
 MM a[52:55], a[244:247], v[88:91], a[52:55]
 v_accvgpr_write_b32 a118, 0
 v_accvgpr_write_b32 a119, 0
 MM a[56:59], a[248:251], v[88:91], 0
 ds_read_b128 v[248:251], v3 offset:14336
 v_accvgpr_write_b32 a120, 0
 MM a[56:59], a[216:219], v[80:83], a[56:59]
 v_accvgpr_write_b32 a121, 0
 v_accvgpr_write_b32 a122, 0
 MM a[60:63], a[220:223], v[80:83], 0
 ds_read_b128 v[252:255], v3 offset:15360
 v_accvgpr_write_b32 a123, 0
 MM a[60:63], a[252:255], v[88:91], a[60:63]
 buffer_load_dwordx4 v1, s[8:11], s29 offen offset:3072 sc1 lds
 MM v[36:39], v[28:31], v[88:91], 0
 s_add_u32 s29, s29, 0x4000
 v_accvgpr_write_b32 a124, 0
 v_accvgpr_write_b32 a125, 0
 MM v[36:39], v[28:31], v[80:83], v[36:39]
 v_accvgpr_write_b32 a126, 0
 v_accvgpr_write_b32 a127, 0
 MM a[92:95], a[220:223], v[96:99], 0
 v_mov_b32 v44, 0
 v_mov_b32 v45, 0
 MM a[92:95], a[252:255], v[104:107], a[92:95]
 v_mov_b32 v46, 0
 v_mov_b32 v47, 0
 MM a[88:91], a[248:251], v[104:107], 0
 v_exp_f32 v112, v112
 MM a[88:91], a[216:219], v[96:99], a[88:91]
 v_exp_f32 v113, v113
 MM a[84:87], a[212:215], v[96:99], 0
 v_exp_f32 v114, v114
 MM a[84:87], a[244:247], v[104:107], a[84:87]
 v_exp_f32 v115, v115
 MM a[80:83], a[240:243], v[104:107], 0
 v_exp_f32 v116, v116
 MM a[80:83], a[208:211], v[96:99], a[80:83]
 v_exp_f32 v117, v117
 MM a[76:79], a[204:207], v[96:99], 0
 v_exp_f32 v118, v118
 MM a[76:79], a[236:239], v[104:107], a[76:79]
 v_exp_f32 v119, v119
 MM a[72:75], a[232:235], v[104:107], 0
 v_exp_f32 v120, v120
 MM a[72:75], a[200:203], v[96:99], a[72:75]
 v_exp_f32 v121, v121
 MM a[68:71], a[196:199], v[96:99], 0
 v_exp_f32 v122, v122
 MM a[68:71], a[228:231], v[104:107], a[68:71]
 s_waitcnt vmcnt(8) lgkmcnt(0)
 v_exp_f32 v123, v123
 MM a[64:67], a[224:227], v[104:107], 0
 s_barrier
 v_exp_f32 v124, v124
 MM a[64:67], a[192:195], v[96:99], a[64:67]
 s_sub_u32 s44, s44, 1
 v_exp_f32 v125, v125
 v_exp_f32 v126, v126
 v_exp_f32 v127, v127
 v_max3_f32 v5, v128, v129, v130
 v_max3_f32 v6, v131, v144, v145
 v_max3_f32 v5, v146, v147, v5
 v_max3_f32 v6, v160, v161, v6
 v_max3_f32 v5, v162, v163, v5
 v_max3_f32 v6, v176, v177, v6
 v_max3_f32 v5, v178, v179, v5
 v_max3_f32 v6, v180, v181, v6
 v_max3_f32 v5, v182, v183, v5
 v_max3_f32 v6, v164, v165, v6
 v_max3_f32 v5, v166, v167, v5
 v_max3_f32 v6, v148, v149, v6
 v_max3_f32 v5, v150, v151, v5
 v_max3_f32 v6, v132, v133, v6
 v_max3_f32 v5, v134, v135, v5
 v_max3_f32 v6, v136, v137, v6
 v_max3_f32 v5, v138, v139, v5
 v_max3_f32 v6, v152, v153, v6
 v_max3_f32 v5, v154, v155, v5
 v_max3_f32 v6, v168, v169, v6
 v_max3_f32 v5, v170, v171, v5
 v_max3_f32 v6, v184, v185, v6
 v_max3_f32 v5, v186, v187, v5
 v_max3_f32 v6, v188, v189, v6
 v_max3_f32 v5, v190, v191, v5
 v_max3_f32 v6, v172, v173, v6
 v_max3_f32 v5, v174, v175, v5
 v_max3_f32 v6, v156, v157, v6
 v_max3_f32 v5, v158, v159, v5
 v_max3_f32 v6, v140, v141, v6
 v_max3_f32 v5, v142, v143, v5
 MM v[40:43], v[28:31], v[96:99], 0
 s_cmp_eq_u32 s44, 0
 v_cvt_pk_bf16_f32 v112, v112, v113
 v_cvt_pk_bf16_f32 v113, v114, v115
 v_cvt_pk_bf16_f32 v114, v116, v117
 v_cvt_pk_bf16_f32 v115, v118, v119
 v_cvt_pk_bf16_f32 v120, v120, v121
 v_cvt_pk_bf16_f32 v121, v122, v123
 v_cvt_pk_bf16_f32 v122, v124, v125
 v_cvt_pk_bf16_f32 v123, v126, v127
 v_max_f32 v5, v5, v6
 v_cmp_lt_f32 vcc, 0x42400000, v5
 MM v[40:43], v[28:31], v[104:107], v[40:43]
 s_cbranch_vccnz f0ss_r
f0ss_ok:
 s_cbranch_scc1 k_sexit
 s_branch k_smid
k_sloop:
 MM a[96:99], a[192:195], v[176:179], a[96:99]
 s_add_u32 m0, s30, 0
 v_exp_f32 v64, v64
 MM a[96:99], a[224:227], v[184:187], a[96:99]
 buffer_load_dwordx4 v1, s[4:7], s28 offen offset:0 sc1 lds
 MM a[100:103], a[228:231], v[184:187], a[100:103]
 v_exp_f32 v65, v65
 MM a[100:103], a[196:199], v[176:179], a[100:103]
 v_exp_f32 v66, v66
 MM a[104:107], a[200:203], v[176:179], a[104:107]
 v_exp_f32 v67, v67
 MM a[104:107], a[232:235], v[184:187], a[104:107]
 v_exp_f32 v68, v68
 MM a[108:111], a[236:239], v[184:187], a[108:111]
 v_exp_f32 v69, v69
 MM a[108:111], a[204:207], v[176:179], a[108:111]
 v_exp_f32 v70, v70
 MM a[112:115], a[208:211], v[176:179], a[112:115]
 v_exp_f32 v71, v71
 MM a[112:115], a[240:243], v[184:187], a[112:115]
 v_exp_f32 v72, v72
 MM a[116:119], a[244:247], v[184:187], a[116:119]
 v_exp_f32 v73, v73
 MM a[116:119], a[212:215], v[176:179], a[116:119]
 v_exp_f32 v74, v74
 MM a[120:123], a[216:219], v[176:179], a[120:123]
 v_exp_f32 v75, v75
 MM a[120:123], a[248:251], v[184:187], a[120:123]
 v_exp_f32 v76, v76
 MM a[124:127], a[252:255], v[184:187], a[124:127]
 v_exp_f32 v77, v77
 MM a[124:127], a[220:223], v[176:179], a[124:127]
 v_exp_f32 v78, v78
 MM v[44:47], v[28:31], v[176:179], v[44:47]
 v_exp_f32 v79, v79
 MM v[44:47], v[28:31], v[184:187], v[44:47]
 buffer_load_dwordx4 v1, s[4:7], s28 offen offset:1024 sc1 lds
 MM v[128:131], v[192:195], a[128:131], v[48:51]
 v_cvt_pk_bf16_f32 v64, v64, v65
 v_cvt_pk_bf16_f32 v65, v66, v67
 MM v[128:131], v[196:199], a[132:135], v[128:131]
 v_cvt_pk_bf16_f32 v66, v68, v69
 v_cvt_pk_bf16_f32 v67, v70, v71
 MM v[128:131], v[200:203], a[136:139], v[128:131]
 v_cvt_pk_bf16_f32 v72, v72, v73
 v_cvt_pk_bf16_f32 v73, v74, v75
 MM v[128:131], v[204:207], a[140:143], v[128:131]
 v_cvt_pk_bf16_f32 v74, v76, v77
 v_cvt_pk_bf16_f32 v75, v78, v79
 MM v[144:147], v[204:207], a[156:159], v[52:55]
 v_exp_f32 v80, v80
 MM v[144:147], v[200:203], a[152:155], v[144:147]
 v_exp_f32 v81, v81
 MM v[144:147], v[196:199], a[148:151], v[144:147]
 ds_read_b128 a[252:255], v2 offset:48128
 v_cvt_pk_bf16_f32 v80, v80, v81
 MM v[144:147], v[192:195], a[144:147], v[144:147]
 v_exp_f32 v82, v82
 MM v[160:163], v[192:195], a[160:163], v[56:59]
 v_exp_f32 v83, v83
 MM v[160:163], v[196:199], a[164:167], v[160:163]
 ds_read_b128 a[220:223], v2 offset:39936
 v_cvt_pk_bf16_f32 v81, v82, v83
 MM v[160:163], v[200:203], a[168:171], v[160:163]
 v_exp_f32 v84, v84
 MM v[160:163], v[204:207], a[172:175], v[160:163]
 ds_read_b128 a[216:219], v2 offset:38912
 v_max3_f32 v5, v128, v129, v130
 MM v[176:179], v[204:207], a[188:191], v[60:63]
 v_exp_f32 v85, v85
 MM v[176:179], v[200:203], a[184:187], v[176:179]
 ds_read_b128 a[248:251], v2 offset:47104
 v_cvt_pk_bf16_f32 v82, v84, v85
 MM v[176:179], v[196:199], a[180:183], v[176:179]
 v_exp_f32 v86, v86
 MM v[176:179], v[192:195], a[176:179], v[176:179]
 buffer_load_dwordx4 v1, s[4:7], s28 offen offset:2048 sc1 lds
 MM v[180:183], v[208:211], a[176:179], v[60:63]
 ds_read_b128 a[244:247], v2 offset:46080
 v_max3_f32 v6, v131, v144, v145
 MM v[180:183], v[212:215], a[180:183], v[180:183]
 v_exp_f32 v87, v87
 MM v[180:183], v[216:219], a[184:187], v[180:183]
 v_exp_f32 v88, v88
 MM v[180:183], v[220:223], a[188:191], v[180:183]
 ds_read_b128 a[212:215], v2 offset:37888
 v_cvt_pk_bf16_f32 v83, v86, v87
 MM v[164:167], v[220:223], a[172:175], v[56:59]
 v_exp_f32 v89, v89
 MM v[164:167], v[216:219], a[168:171], v[164:167]
 v_exp_f32 v90, v90
 MM v[164:167], v[212:215], a[164:167], v[164:167]
 ds_read_b128 a[208:211], v2 offset:36864
 v_cvt_pk_bf16_f32 v88, v88, v89
 MM v[164:167], v[208:211], a[160:163], v[164:167]
 v_exp_f32 v91, v91
 MM v[148:151], v[208:211], a[144:147], v[52:55]
 v_exp_f32 v92, v92
 MM v[148:151], v[212:215], a[148:151], v[148:151]
 ds_read_b128 a[240:243], v2 offset:45056
 v_cvt_pk_bf16_f32 v89, v90, v91
 MM v[148:151], v[216:219], a[152:155], v[148:151]
 v_exp_f32 v93, v93
 MM v[148:151], v[220:223], a[156:159], v[148:151]
 v_exp_f32 v94, v94
 MM v[132:135], v[220:223], a[140:143], v[48:51]
 v_exp_f32 v95, v95
 MM v[132:135], v[216:219], a[136:139], v[132:135]
 ds_read_b128 a[236:239], v2 offset:44032
 v_cvt_pk_bf16_f32 v90, v92, v93
 MM v[132:135], v[212:215], a[132:135], v[132:135]
 v_cvt_pk_bf16_f32 v91, v94, v95
 v_max3_f32 v5, v146, v147, v5
 MM v[132:135], v[208:211], a[128:131], v[132:135]
 buffer_load_dwordx4 v1, s[4:7], s28 offen offset:3072 sc1 lds
 MM v[136:139], v[224:227], a[128:131], v[48:51]
 s_add_u32 s28, s28, 0x4000
 ds_read_b128 a[204:207], v2 offset:35840
 v_max3_f32 v6, v160, v161, v6
 MM v[136:139], v[228:231], a[132:135], v[136:139]
 v_exp_f32 v96, v96
 MM v[136:139], v[232:235], a[136:139], v[136:139]
 v_exp_f32 v97, v97
 MM v[136:139], v[236:239], a[140:143], v[136:139]
 ds_read_b128 a[200:203], v2 offset:34816
 v_cvt_pk_bf16_f32 v96, v96, v97
 MM v[152:155], v[236:239], a[156:159], v[52:55]
 v_exp_f32 v98, v98
 MM v[152:155], v[232:235], a[152:155], v[152:155]
 v_exp_f32 v99, v99
 MM v[152:155], v[228:231], a[148:151], v[152:155]
 ds_read_b128 a[232:235], v2 offset:43008
 v_cvt_pk_bf16_f32 v97, v98, v99
 MM v[152:155], v[224:227], a[144:147], v[152:155]
 v_exp_f32 v100, v100
 MM v[168:171], v[224:227], a[160:163], v[56:59]
 v_exp_f32 v101, v101
 MM v[168:171], v[228:231], a[164:167], v[168:171]
 ds_read_b128 a[228:231], v2 offset:41984
 v_cvt_pk_bf16_f32 v98, v100, v101
 MM v[168:171], v[232:235], a[168:171], v[168:171]
 v_exp_f32 v102, v102
 MM v[168:171], v[236:239], a[172:175], v[168:171]
 s_add_u32 m0, s31, 32768
 v_exp_f32 v103, v103
 MM v[184:187], v[236:239], a[188:191], v[60:63]
 ds_read_b128 a[196:199], v2 offset:33792
 v_cvt_pk_bf16_f32 v99, v102, v103
 MM v[184:187], v[232:235], a[184:187], v[184:187]
 v_exp_f32 v104, v104
 MM v[184:187], v[228:231], a[180:183], v[184:187]
 v_exp_f32 v105, v105
 MM v[184:187], v[224:227], a[176:179], v[184:187]
 buffer_load_dwordx4 v1, s[8:11], s29 offen offset:0 sc1 lds
 MM v[188:191], v[240:243], a[176:179], v[60:63]
 ds_read_b128 a[192:195], v2 offset:32768
 v_cvt_pk_bf16_f32 v104, v104, v105
 MM v[188:191], v[244:247], a[180:183], v[188:191]
 v_exp_f32 v106, v106
 MM v[188:191], v[248:251], a[184:187], v[188:191]
 ds_read_b128 a[224:227], v2 offset:40960
 v_max3_f32 v5, v162, v163, v5
 MM v[188:191], v[252:255], a[188:191], v[188:191]
 v_exp_f32 v107, v107
 MM v[172:175], v[252:255], a[172:175], v[56:59]
 v_exp_f32 v108, v108
 MM v[172:175], v[248:251], a[168:171], v[172:175]
 v_exp_f32 v109, v109
 MM v[172:175], v[244:247], a[164:167], v[172:175]
 v_exp_f32 v110, v110
 MM v[172:175], v[240:243], a[160:163], v[172:175]
 v_exp_f32 v111, v111
 MM v[156:159], v[240:243], a[144:147], v[52:55]
 v_cvt_pk_bf16_f32 v105, v106, v107
 v_cvt_pk_bf16_f32 v106, v108, v109
 MM v[156:159], v[244:247], a[148:151], v[156:159]
 v_cvt_pk_bf16_f32 v107, v110, v111
 v_max3_f32 v6, v176, v177, v6
 MM v[156:159], v[248:251], a[152:155], v[156:159]
 v_exp_f32 v112, v112
 MM v[156:159], v[252:255], a[156:159], v[156:159]
 v_exp_f32 v113, v113
 MM v[140:143], v[252:255], a[140:143], v[48:51]
 v_exp_f32 v114, v114
 MM v[140:143], v[248:251], a[136:139], v[140:143]
 v_exp_f32 v115, v115
 MM v[140:143], v[244:247], a[132:135], v[140:143]
 s_waitcnt lgkmcnt(0)
 v_exp_f32 v116, v116
 MM v[140:143], v[240:243], a[128:131], v[140:143]
 buffer_load_dwordx4 v1, s[8:11], s29 offen offset:1024 sc1 lds
 MM a[28:31], a[252:255], v[72:75], a[28:31]
 v_exp_f32 v117, v117
 MM a[28:31], a[220:223], v[64:67], a[28:31]
 v_exp_f32 v118, v118
 MM a[24:27], a[216:219], v[64:67], a[24:27]
 ds_read_b128 v[192:195], v3 offset:0
 v_max3_f32 v5, v178, v179, v5
 MM a[24:27], a[248:251], v[72:75], a[24:27]
 v_exp_f32 v119, v119
 MM a[20:23], a[244:247], v[72:75], a[20:23]
 ds_read_b128 v[196:199], v3 offset:1024
 v_max3_f32 v6, v180, v181, v6
 MM a[20:23], a[212:215], v[64:67], a[20:23]
 v_exp_f32 v120, v120
 MM a[16:19], a[208:211], v[64:67], a[16:19]
 ds_read_b128 v[200:203], v3 offset:2048
 v_max3_f32 v5, v182, v183, v5
 MM a[16:19], a[240:243], v[72:75], a[16:19]
 v_exp_f32 v121, v121
 MM a[12:15], a[236:239], v[72:75], a[12:15]
 ds_read_b128 v[204:207], v3 offset:3072
 v_max3_f32 v6, v164, v165, v6
 MM a[12:15], a[204:207], v[64:67], a[12:15]
 v_exp_f32 v122, v122
 MM a[8:11], a[200:203], v[64:67], a[8:11]
 ds_read_b128 v[208:211], v3 offset:4096
 v_max3_f32 v5, v166, v167, v5
 MM a[8:11], a[232:235], v[72:75], a[8:11]
 v_exp_f32 v123, v123
 MM a[4:7], a[228:231], v[72:75], a[4:7]
 ds_read_b128 v[212:215], v3 offset:5120
 v_max3_f32 v6, v148, v149, v6
 MM a[4:7], a[196:199], v[64:67], a[4:7]
 v_exp_f32 v124, v124
 MM a[0:3], a[192:195], v[64:67], a[0:3]
 ds_read_b128 v[216:219], v3 offset:6144
 v_max3_f32 v5, v150, v151, v5
 MM a[0:3], a[224:227], v[72:75], a[0:3]
 buffer_load_dwordx4 v1, s[8:11], s29 offen offset:2048 sc1 lds
 MM v[32:35], v[28:31], v[72:75], v[32:35]
 ds_read_b128 v[220:223], v3 offset:7168
 v_max3_f32 v6, v132, v133, v6
 MM v[32:35], v[28:31], v[64:67], v[32:35]
 v_exp_f32 v125, v125
 MM a[32:35], a[192:195], v[80:83], a[32:35]
 ds_read_b128 v[224:227], v3 offset:8192
 v_max3_f32 v5, v134, v135, v5
 MM a[32:35], a[224:227], v[88:91], a[32:35]
 v_exp_f32 v126, v126
 MM a[36:39], a[228:231], v[88:91], a[36:39]
 ds_read_b128 v[228:231], v3 offset:9216
 v_max3_f32 v6, v136, v137, v6
 MM a[36:39], a[196:199], v[80:83], a[36:39]
 v_exp_f32 v127, v127
 MM a[40:43], a[200:203], v[80:83], a[40:43]
 ds_read_b128 v[232:235], v3 offset:10240
 v_max3_f32 v5, v138, v139, v5
 MM a[40:43], a[232:235], v[88:91], a[40:43]
 v_max3_f32 v6, v152, v153, v6
 v_max3_f32 v5, v154, v155, v5
 MM a[44:47], a[236:239], v[88:91], a[44:47]
 ds_read_b128 v[236:239], v3 offset:11264
 v_max3_f32 v6, v168, v169, v6
 MM a[44:47], a[204:207], v[80:83], a[44:47]
 v_max3_f32 v5, v170, v171, v5
 v_max3_f32 v6, v184, v185, v6
 MM a[48:51], a[208:211], v[80:83], a[48:51]
 ds_read_b128 v[240:243], v3 offset:12288
 v_max3_f32 v5, v186, v187, v5
 MM a[48:51], a[240:243], v[88:91], a[48:51]
 v_max3_f32 v6, v188, v189, v6
 v_max3_f32 v5, v190, v191, v5
 MM a[52:55], a[244:247], v[88:91], a[52:55]
 ds_read_b128 v[244:247], v3 offset:13312
 v_max3_f32 v6, v172, v173, v6
 MM a[52:55], a[212:215], v[80:83], a[52:55]
 v_max3_f32 v5, v174, v175, v5
 v_max3_f32 v6, v156, v157, v6
 MM a[56:59], a[216:219], v[80:83], a[56:59]
 ds_read_b128 v[248:251], v3 offset:14336
 v_max3_f32 v5, v158, v159, v5
 MM a[56:59], a[248:251], v[88:91], a[56:59]
 buffer_load_dwordx4 v1, s[8:11], s29 offen offset:3072 sc1 lds
 MM a[60:63], a[252:255], v[88:91], a[60:63]
 s_add_u32 s29, s29, 0x4000
 ds_read_b128 v[252:255], v3 offset:15360
 v_max3_f32 v6, v140, v141, v6
 MM a[60:63], a[220:223], v[80:83], a[60:63]
 v_max3_f32 v5, v142, v143, v5
 v_cvt_pk_bf16_f32 v112, v112, v113
 MM v[36:39], v[28:31], v[80:83], v[36:39]
 v_cvt_pk_bf16_f32 v113, v114, v115
 v_cvt_pk_bf16_f32 v114, v116, v117
 MM v[36:39], v[28:31], v[88:91], v[36:39]
 v_cvt_pk_bf16_f32 v115, v118, v119
 v_cvt_pk_bf16_f32 v120, v120, v121
 MM a[92:95], a[252:255], v[104:107], a[92:95]
 v_cvt_pk_bf16_f32 v121, v122, v123
 v_cvt_pk_bf16_f32 v122, v124, v125
 MM a[92:95], a[220:223], v[96:99], a[92:95]
 v_cvt_pk_bf16_f32 v123, v126, v127
 v_max_f32 v5, v5, v6
 MM a[88:91], a[216:219], v[96:99], a[88:91]
 v_cmp_lt_f32 vcc, 0x42400000, v5
 MM a[88:91], a[248:251], v[104:107], a[88:91]
 MM a[84:87], a[244:247], v[104:107], a[84:87]
 MM a[84:87], a[212:215], v[96:99], a[84:87]
 MM a[80:83], a[208:211], v[96:99], a[80:83]
 MM a[80:83], a[240:243], v[104:107], a[80:83]
 MM a[76:79], a[236:239], v[104:107], a[76:79]
 MM a[76:79], a[204:207], v[96:99], a[76:79]
 MM a[72:75], a[200:203], v[96:99], a[72:75]
 MM a[72:75], a[232:235], v[104:107], a[72:75]
 MM a[68:71], a[228:231], v[104:107], a[68:71]
 MM a[68:71], a[196:199], v[96:99], a[68:71]
 s_waitcnt vmcnt(8) lgkmcnt(0)
 MM a[64:67], a[192:195], v[96:99], a[64:67]
 s_barrier
 MM a[64:67], a[224:227], v[104:107], a[64:67]
 s_sub_u32 s44, s44, 1
 MM v[40:43], v[28:31], v[104:107], v[40:43]
 s_cmp_eq_u32 s44, 0
 MM v[40:43], v[28:31], v[96:99], v[40:43]
 s_cbranch_vccnz b0ss_r
b0ss_ok:
 s_cbranch_scc1 k_sexit
k_smid:
 MM a[96:99], a[192:195], v[112:115], a[96:99]
 s_add_u32 m0, s30, 16384
 v_exp_f32 v128, v128
 MM a[96:99], a[224:227], v[120:123], a[96:99]
 buffer_load_dwordx4 v1, s[4:7], s28 offen offset:0 sc1 lds
 MM a[100:103], a[228:231], v[120:123], a[100:103]
 v_exp_f32 v129, v129
 MM a[100:103], a[196:199], v[112:115], a[100:103]
 v_exp_f32 v130, v130
 MM a[104:107], a[200:203], v[112:115], a[104:107]
 v_exp_f32 v131, v131
 MM a[104:107], a[232:235], v[120:123], a[104:107]
 v_exp_f32 v132, v132
 MM a[108:111], a[236:239], v[120:123], a[108:111]
 v_exp_f32 v133, v133
 MM a[108:111], a[204:207], v[112:115], a[108:111]
 v_exp_f32 v134, v134
 MM a[112:115], a[208:211], v[112:115], a[112:115]
 v_exp_f32 v135, v135
 MM a[112:115], a[240:243], v[120:123], a[112:115]
 v_exp_f32 v136, v136
 MM a[116:119], a[244:247], v[120:123], a[116:119]
 v_exp_f32 v137, v137
 MM a[116:119], a[212:215], v[112:115], a[116:119]
 v_exp_f32 v138, v138
 MM a[120:123], a[216:219], v[112:115], a[120:123]
 v_exp_f32 v139, v139
 MM a[120:123], a[248:251], v[120:123], a[120:123]
 v_exp_f32 v140, v140
 MM a[124:127], a[252:255], v[120:123], a[124:127]
 v_exp_f32 v141, v141
 MM a[124:127], a[220:223], v[112:115], a[124:127]
 v_exp_f32 v142, v142
 MM v[44:47], v[28:31], v[112:115], v[44:47]
 v_exp_f32 v143, v143
 MM v[44:47], v[28:31], v[120:123], v[44:47]
 buffer_load_dwordx4 v1, s[4:7], s28 offen offset:1024 sc1 lds
 MM v[64:67], v[192:195], a[128:131], v[48:51]
 v_cvt_pk_bf16_f32 v128, v128, v129
 v_cvt_pk_bf16_f32 v129, v130, v131
 MM v[64:67], v[196:199], a[132:135], v[64:67]
 v_cvt_pk_bf16_f32 v130, v132, v133
 v_cvt_pk_bf16_f32 v131, v134, v135
 MM v[64:67], v[200:203], a[136:139], v[64:67]
 v_cvt_pk_bf16_f32 v136, v136, v137
 v_cvt_pk_bf16_f32 v137, v138, v139
 MM v[64:67], v[204:207], a[140:143], v[64:67]
 v_cvt_pk_bf16_f32 v138, v140, v141
 v_cvt_pk_bf16_f32 v139, v142, v143
 MM v[80:83], v[204:207], a[156:159], v[52:55]
 v_exp_f32 v144, v144
 MM v[80:83], v[200:203], a[152:155], v[80:83]
 v_exp_f32 v145, v145
 MM v[80:83], v[196:199], a[148:151], v[80:83]
 ds_read_b128 a[252:255], v2 offset:64512
 v_cvt_pk_bf16_f32 v144, v144, v145
 MM v[80:83], v[192:195], a[144:147], v[80:83]
 v_exp_f32 v146, v146
 MM v[96:99], v[192:195], a[160:163], v[56:59]
 v_exp_f32 v147, v147
 MM v[96:99], v[196:199], a[164:167], v[96:99]
 ds_read_b128 a[220:223], v2 offset:56320
 v_cvt_pk_bf16_f32 v145, v146, v147
 MM v[96:99], v[200:203], a[168:171], v[96:99]
 v_exp_f32 v148, v148
 MM v[96:99], v[204:207], a[172:175], v[96:99]
 ds_read_b128 a[216:219], v2 offset:55296
 v_max3_f32 v5, v64, v65, v66
 MM v[112:115], v[204:207], a[188:191], v[60:63]
 v_exp_f32 v149, v149
 MM v[112:115], v[200:203], a[184:187], v[112:115]
 ds_read_b128 a[248:251], v2 offset:63488
 v_cvt_pk_bf16_f32 v146, v148, v149
 MM v[112:115], v[196:199], a[180:183], v[112:115]
 v_exp_f32 v150, v150
 MM v[112:115], v[192:195], a[176:179], v[112:115]
 buffer_load_dwordx4 v1, s[4:7], s28 offen offset:2048 sc1 lds
 MM v[116:119], v[208:211], a[176:179], v[60:63]
 ds_read_b128 a[244:247], v2 offset:62464
 v_max3_f32 v6, v67, v80, v81
 MM v[116:119], v[212:215], a[180:183], v[116:119]
 v_exp_f32 v151, v151
 MM v[116:119], v[216:219], a[184:187], v[116:119]
 v_exp_f32 v152, v152
 MM v[116:119], v[220:223], a[188:191], v[116:119]
 ds_read_b128 a[212:215], v2 offset:54272
 v_cvt_pk_bf16_f32 v147, v150, v151
 MM v[100:103], v[220:223], a[172:175], v[56:59]
 v_exp_f32 v153, v153
 MM v[100:103], v[216:219], a[168:171], v[100:103]
 v_exp_f32 v154, v154
 MM v[100:103], v[212:215], a[164:167], v[100:103]
 ds_read_b128 a[208:211], v2 offset:53248
 v_cvt_pk_bf16_f32 v152, v152, v153
 MM v[100:103], v[208:211], a[160:163], v[100:103]
 v_exp_f32 v155, v155
 MM v[84:87], v[208:211], a[144:147], v[52:55]
 v_exp_f32 v156, v156
 MM v[84:87], v[212:215], a[148:151], v[84:87]
 ds_read_b128 a[240:243], v2 offset:61440
 v_cvt_pk_bf16_f32 v153, v154, v155
 MM v[84:87], v[216:219], a[152:155], v[84:87]
 v_exp_f32 v157, v157
 MM v[84:87], v[220:223], a[156:159], v[84:87]
 v_exp_f32 v158, v158
 MM v[68:71], v[220:223], a[140:143], v[48:51]
 v_exp_f32 v159, v159
 MM v[68:71], v[216:219], a[136:139], v[68:71]
 ds_read_b128 a[236:239], v2 offset:60416
 v_cvt_pk_bf16_f32 v154, v156, v157
 MM v[68:71], v[212:215], a[132:135], v[68:71]
 v_cvt_pk_bf16_f32 v155, v158, v159
 v_max3_f32 v5, v82, v83, v5
 MM v[68:71], v[208:211], a[128:131], v[68:71]
 buffer_load_dwordx4 v1, s[4:7], s28 offen offset:3072 sc1 lds
 MM v[72:75], v[224:227], a[128:131], v[48:51]
 s_add_u32 s28, s28, 0x4000
 ds_read_b128 a[204:207], v2 offset:52224
 v_max3_f32 v6, v96, v97, v6
 MM v[72:75], v[228:231], a[132:135], v[72:75]
 v_exp_f32 v160, v160
 MM v[72:75], v[232:235], a[136:139], v[72:75]
 v_exp_f32 v161, v161
 MM v[72:75], v[236:239], a[140:143], v[72:75]
 ds_read_b128 a[200:203], v2 offset:51200
 v_cvt_pk_bf16_f32 v160, v160, v161
 MM v[88:91], v[236:239], a[156:159], v[52:55]
 v_exp_f32 v162, v162
 MM v[88:91], v[232:235], a[152:155], v[88:91]
 v_exp_f32 v163, v163
 MM v[88:91], v[228:231], a[148:151], v[88:91]
 ds_read_b128 a[232:235], v2 offset:59392
 v_cvt_pk_bf16_f32 v161, v162, v163
 MM v[88:91], v[224:227], a[144:147], v[88:91]
 v_exp_f32 v164, v164
 MM v[104:107], v[224:227], a[160:163], v[56:59]
 v_exp_f32 v165, v165
 MM v[104:107], v[228:231], a[164:167], v[104:107]
 ds_read_b128 a[228:231], v2 offset:58368
 v_cvt_pk_bf16_f32 v162, v164, v165
 MM v[104:107], v[232:235], a[168:171], v[104:107]
 v_exp_f32 v166, v166
 MM v[104:107], v[236:239], a[172:175], v[104:107]
 s_add_u32 m0, s31, 49152
 v_exp_f32 v167, v167
 MM v[120:123], v[236:239], a[188:191], v[60:63]
 ds_read_b128 a[196:199], v2 offset:50176
 v_cvt_pk_bf16_f32 v163, v166, v167
 MM v[120:123], v[232:235], a[184:187], v[120:123]
 v_exp_f32 v168, v168
 MM v[120:123], v[228:231], a[180:183], v[120:123]
 v_exp_f32 v169, v169
 MM v[120:123], v[224:227], a[176:179], v[120:123]
 buffer_load_dwordx4 v1, s[8:11], s29 offen offset:0 sc1 lds
 MM v[124:127], v[240:243], a[176:179], v[60:63]
 ds_read_b128 a[192:195], v2 offset:49152
 v_cvt_pk_bf16_f32 v168, v168, v169
 MM v[124:127], v[244:247], a[180:183], v[124:127]
 v_exp_f32 v170, v170
 MM v[124:127], v[248:251], a[184:187], v[124:127]
 ds_read_b128 a[224:227], v2 offset:57344
 v_max3_f32 v5, v98, v99, v5
 MM v[124:127], v[252:255], a[188:191], v[124:127]
 v_exp_f32 v171, v171
 MM v[108:111], v[252:255], a[172:175], v[56:59]
 v_exp_f32 v172, v172
 MM v[108:111], v[248:251], a[168:171], v[108:111]
 v_exp_f32 v173, v173
 MM v[108:111], v[244:247], a[164:167], v[108:111]
 v_exp_f32 v174, v174
 MM v[108:111], v[240:243], a[160:163], v[108:111]
 v_exp_f32 v175, v175
 MM v[92:95], v[240:243], a[144:147], v[52:55]
 v_cvt_pk_bf16_f32 v169, v170, v171
 v_cvt_pk_bf16_f32 v170, v172, v173
 MM v[92:95], v[244:247], a[148:151], v[92:95]
 v_cvt_pk_bf16_f32 v171, v174, v175
 v_max3_f32 v6, v112, v113, v6
 MM v[92:95], v[248:251], a[152:155], v[92:95]
 v_exp_f32 v176, v176
 MM v[92:95], v[252:255], a[156:159], v[92:95]
 v_exp_f32 v177, v177
 MM v[76:79], v[252:255], a[140:143], v[48:51]
 v_exp_f32 v178, v178
 MM v[76:79], v[248:251], a[136:139], v[76:79]
 v_exp_f32 v179, v179
 MM v[76:79], v[244:247], a[132:135], v[76:79]
 s_waitcnt lgkmcnt(0)
 v_exp_f32 v180, v180
 MM v[76:79], v[240:243], a[128:131], v[76:79]
 buffer_load_dwordx4 v1, s[8:11], s29 offen offset:1024 sc1 lds
 MM a[28:31], a[252:255], v[136:139], a[28:31]
 v_exp_f32 v181, v181
 MM a[28:31], a[220:223], v[128:131], a[28:31]
 v_exp_f32 v182, v182
 MM a[24:27], a[216:219], v[128:131], a[24:27]
 ds_read_b128 v[192:195], v3 offset:16384
 v_max3_f32 v5, v114, v115, v5
 MM a[24:27], a[248:251], v[136:139], a[24:27]
 v_exp_f32 v183, v183
 MM a[20:23], a[244:247], v[136:139], a[20:23]
 ds_read_b128 v[196:199], v3 offset:17408
 v_max3_f32 v6, v116, v117, v6
 MM a[20:23], a[212:215], v[128:131], a[20:23]
 v_exp_f32 v184, v184
 MM a[16:19], a[208:211], v[128:131], a[16:19]
 ds_read_b128 v[200:203], v3 offset:18432
 v_max3_f32 v5, v118, v119, v5
 MM a[16:19], a[240:243], v[136:139], a[16:19]
 v_exp_f32 v185, v185
 MM a[12:15], a[236:239], v[136:139], a[12:15]
 ds_read_b128 v[204:207], v3 offset:19456
 v_max3_f32 v6, v100, v101, v6
 MM a[12:15], a[204:207], v[128:131], a[12:15]
 v_exp_f32 v186, v186
 MM a[8:11], a[200:203], v[128:131], a[8:11]
 ds_read_b128 v[208:211], v3 offset:20480
 v_max3_f32 v5, v102, v103, v5
 MM a[8:11], a[232:235], v[136:139], a[8:11]
 v_exp_f32 v187, v187
 MM a[4:7], a[228:231], v[136:139], a[4:7]
 ds_read_b128 v[212:215], v3 offset:21504
 v_max3_f32 v6, v84, v85, v6
 MM a[4:7], a[196:199], v[128:131], a[4:7]
 v_exp_f32 v188, v188
 MM a[0:3], a[192:195], v[128:131], a[0:3]
 ds_read_b128 v[216:219], v3 offset:22528
 v_max3_f32 v5, v86, v87, v5
 MM a[0:3], a[224:227], v[136:139], a[0:3]
 buffer_load_dwordx4 v1, s[8:11], s29 offen offset:2048 sc1 lds
 MM v[32:35], v[28:31], v[136:139], v[32:35]
 ds_read_b128 v[220:223], v3 offset:23552
 v_max3_f32 v6, v68, v69, v6
 MM v[32:35], v[28:31], v[128:131], v[32:35]
 v_exp_f32 v189, v189
 MM a[32:35], a[192:195], v[144:147], a[32:35]
 ds_read_b128 v[224:227], v3 offset:24576
 v_max3_f32 v5, v70, v71, v5
 MM a[32:35], a[224:227], v[152:155], a[32:35]
 v_exp_f32 v190, v190
 MM a[36:39], a[228:231], v[152:155], a[36:39]
 ds_read_b128 v[228:231], v3 offset:25600
 v_max3_f32 v6, v72, v73, v6
 MM a[36:39], a[196:199], v[144:147], a[36:39]
 v_exp_f32 v191, v191
 MM a[40:43], a[200:203], v[144:147], a[40:43]
 ds_read_b128 v[232:235], v3 offset:26624
 v_max3_f32 v5, v74, v75, v5
 MM a[40:43], a[232:235], v[152:155], a[40:43]
 v_max3_f32 v6, v88, v89, v6
 v_max3_f32 v5, v90, v91, v5
 MM a[44:47], a[236:239], v[152:155], a[44:47]
 ds_read_b128 v[236:239], v3 offset:27648
 v_max3_f32 v6, v104, v105, v6
 MM a[44:47], a[204:207], v[144:147], a[44:47]
 v_max3_f32 v5, v106, v107, v5
 v_max3_f32 v6, v120, v121, v6
 MM a[48:51], a[208:211], v[144:147], a[48:51]
 ds_read_b128 v[240:243], v3 offset:28672
 v_max3_f32 v5, v122, v123, v5
 MM a[48:51], a[240:243], v[152:155], a[48:51]
 v_max3_f32 v6, v124, v125, v6
 v_max3_f32 v5, v126, v127, v5
 MM a[52:55], a[244:247], v[152:155], a[52:55]
 ds_read_b128 v[244:247], v3 offset:29696
 v_max3_f32 v6, v108, v109, v6
 MM a[52:55], a[212:215], v[144:147], a[52:55]
 v_max3_f32 v5, v110, v111, v5
 v_max3_f32 v6, v92, v93, v6
 MM a[56:59], a[216:219], v[144:147], a[56:59]
 ds_read_b128 v[248:251], v3 offset:30720
 v_max3_f32 v5, v94, v95, v5
 MM a[56:59], a[248:251], v[152:155], a[56:59]
 buffer_load_dwordx4 v1, s[8:11], s29 offen offset:3072 sc1 lds
 MM a[60:63], a[252:255], v[152:155], a[60:63]
 s_add_u32 s29, s29, 0x4000
 ds_read_b128 v[252:255], v3 offset:31744
 v_max3_f32 v6, v76, v77, v6
 MM a[60:63], a[220:223], v[144:147], a[60:63]
 v_max3_f32 v5, v78, v79, v5
 v_cvt_pk_bf16_f32 v176, v176, v177
 MM v[36:39], v[28:31], v[144:147], v[36:39]
 v_cvt_pk_bf16_f32 v177, v178, v179
 v_cvt_pk_bf16_f32 v178, v180, v181
 MM v[36:39], v[28:31], v[152:155], v[36:39]
 v_cvt_pk_bf16_f32 v179, v182, v183
 v_cvt_pk_bf16_f32 v184, v184, v185
 MM a[92:95], a[252:255], v[168:171], a[92:95]
 v_cvt_pk_bf16_f32 v185, v186, v187
 v_cvt_pk_bf16_f32 v186, v188, v189
 MM a[92:95], a[220:223], v[160:163], a[92:95]
 v_cvt_pk_bf16_f32 v187, v190, v191
 v_max_f32 v5, v5, v6
 MM a[88:91], a[216:219], v[160:163], a[88:91]
 v_cmp_lt_f32 vcc, 0x42400000, v5
 MM a[88:91], a[248:251], v[168:171], a[88:91]
 MM a[84:87], a[244:247], v[168:171], a[84:87]
 MM a[84:87], a[212:215], v[160:163], a[84:87]
 MM a[80:83], a[208:211], v[160:163], a[80:83]
 MM a[80:83], a[240:243], v[168:171], a[80:83]
 s_xor_b32 s30, s30, 0x10000
 v_xor_b32 v2, 0x10000, v2
 v_xor_b32 v3, 0x10000, v3
 MM a[76:79], a[236:239], v[168:171], a[76:79]
 s_xor_b32 s31, s31, 0x10000
 MM a[76:79], a[204:207], v[160:163], a[76:79]
 MM a[72:75], a[200:203], v[160:163], a[72:75]
 MM a[72:75], a[232:235], v[168:171], a[72:75]
 MM a[68:71], a[228:231], v[168:171], a[68:71]
 MM a[68:71], a[196:199], v[160:163], a[68:71]
 s_waitcnt vmcnt(8) lgkmcnt(0)
 MM a[64:67], a[192:195], v[160:163], a[64:67]
 s_barrier
 MM a[64:67], a[224:227], v[168:171], a[64:67]
 MM v[40:43], v[28:31], v[168:171], v[40:43]
 MM v[40:43], v[28:31], v[160:163], v[40:43]
 s_cbranch_vccnz b1ss_r
b1ss_ok:
 s_branch k_sloop
k_sexit:
 MM a[96:99], a[192:195], v[112:115], a[96:99]
 s_add_u32 m0, s30, 16384
 v_cndmask_b32 v64, v48, v4, s[64:65]
 v_cndmask_b32 v65, v48, v4, s[66:67]
 MM a[96:99], a[224:227], v[120:123], a[96:99]
 buffer_load_dwordx4 v1, s[4:7], s28 offen offset:0 sc1 lds
 MM a[100:103], a[228:231], v[120:123], a[100:103]
 v_cndmask_b32 v66, v48, v4, s[68:69]
 v_cndmask_b32 v67, v48, v4, s[70:71]
 MM a[100:103], a[196:199], v[112:115], a[100:103]
 v_cndmask_b32 v68, v48, v4, s[72:73]
 v_cndmask_b32 v69, v48, v4, s[74:75]
 MM a[104:107], a[200:203], v[112:115], a[104:107]
 v_cndmask_b32 v70, v48, v4, s[76:77]
 v_cndmask_b32 v71, v48, v4, s[78:79]
 MM a[104:107], a[232:235], v[120:123], a[104:107]
 v_cndmask_b32 v72, v48, v4, s[80:81]
 v_cndmask_b32 v73, v48, v4, s[82:83]
 MM a[108:111], a[236:239], v[120:123], a[108:111]
 v_cndmask_b32 v74, v48, v4, s[84:85]
 v_cndmask_b32 v75, v48, v4, s[86:87]
 MM a[108:111], a[204:207], v[112:115], a[108:111]
 v_cndmask_b32 v76, v48, v4, s[88:89]
 v_cndmask_b32 v77, v48, v4, s[90:91]
 MM a[112:115], a[208:211], v[112:115], a[112:115]
 v_cndmask_b32 v78, v48, v4, s[92:93]
 v_cndmask_b32 v79, v48, v4, s[94:95]
 MM a[112:115], a[240:243], v[120:123], a[112:115]
 v_exp_f32 v128, v128
 MM a[116:119], a[244:247], v[120:123], a[116:119]
 v_exp_f32 v129, v129
 MM a[116:119], a[212:215], v[112:115], a[116:119]
 v_exp_f32 v130, v130
 MM a[120:123], a[216:219], v[112:115], a[120:123]
 v_exp_f32 v131, v131
 MM a[120:123], a[248:251], v[120:123], a[120:123]
 v_exp_f32 v132, v132
 MM a[124:127], a[252:255], v[120:123], a[124:127]
 v_exp_f32 v133, v133
 MM a[124:127], a[220:223], v[112:115], a[124:127]
 v_exp_f32 v134, v134
 MM v[44:47], v[28:31], v[112:115], v[44:47]
 v_exp_f32 v135, v135
 MM v[44:47], v[28:31], v[120:123], v[44:47]
 buffer_load_dwordx4 v1, s[4:7], s28 offen offset:1024 sc1 lds
 MM v[64:67], v[192:195], a[128:131], v[64:67]
 v_exp_f32 v136, v136
 MM v[64:67], v[196:199], a[132:135], v[64:67]
 v_exp_f32 v137, v137
 MM v[64:67], v[200:203], a[136:139], v[64:67]
 v_exp_f32 v138, v138
 MM v[64:67], v[204:207], a[140:143], v[64:67]
 v_exp_f32 v139, v139
 MM v[80:83], v[204:207], a[156:159], v[52:55]
 ds_read_b128 a[252:255], v2 offset:64512
 v_cvt_pk_bf16_f32 v128, v128, v129
 MM v[80:83], v[200:203], a[152:155], v[80:83]
 v_exp_f32 v140, v140
 MM v[80:83], v[196:199], a[148:151], v[80:83]
 v_exp_f32 v141, v141
 MM v[80:83], v[192:195], a[144:147], v[80:83]
 ds_read_b128 a[220:223], v2 offset:56320
 v_cvt_pk_bf16_f32 v129, v130, v131
 MM v[96:99], v[192:195], a[160:163], v[56:59]
 v_exp_f32 v142, v142
 MM v[96:99], v[196:199], a[164:167], v[96:99]
 v_exp_f32 v143, v143
 MM v[96:99], v[200:203], a[168:171], v[96:99]
 ds_read_b128 a[216:219], v2 offset:55296
 v_cvt_pk_bf16_f32 v130, v132, v133
 MM v[96:99], v[204:207], a[172:175], v[96:99]
 v_cvt_pk_bf16_f32 v131, v134, v135
 v_cvt_pk_bf16_f32 v136, v136, v137
 MM v[112:115], v[204:207], a[188:191], v[60:63]
 v_cvt_pk_bf16_f32 v137, v138, v139
 v_cvt_pk_bf16_f32 v138, v140, v141
 MM v[112:115], v[200:203], a[184:187], v[112:115]
 ds_read_b128 a[248:251], v2 offset:63488
 v_cvt_pk_bf16_f32 v139, v142, v143
 MM v[112:115], v[196:199], a[180:183], v[112:115]
 v_exp_f32 v144, v144
 MM v[112:115], v[192:195], a[176:179], v[112:115]
 buffer_load_dwordx4 v1, s[4:7], s28 offen offset:2048 sc1 lds
 MM v[116:119], v[208:211], a[176:179], v[60:63]
 ds_read_b128 a[244:247], v2 offset:62464
 v_max3_f32 v5, v64, v65, v66
 MM v[116:119], v[212:215], a[180:183], v[116:119]
 v_exp_f32 v145, v145
 MM v[116:119], v[216:219], a[184:187], v[116:119]
 v_exp_f32 v146, v146
 MM v[116:119], v[220:223], a[188:191], v[116:119]
 ds_read_b128 a[212:215], v2 offset:54272
 v_cvt_pk_bf16_f32 v144, v144, v145
 MM v[100:103], v[220:223], a[172:175], v[56:59]
 v_exp_f32 v147, v147
 MM v[100:103], v[216:219], a[168:171], v[100:103]
 v_exp_f32 v148, v148
 MM v[100:103], v[212:215], a[164:167], v[100:103]
 ds_read_b128 a[208:211], v2 offset:53248
 v_cvt_pk_bf16_f32 v145, v146, v147
 MM v[100:103], v[208:211], a[160:163], v[100:103]
 v_exp_f32 v149, v149
 MM v[84:87], v[208:211], a[144:147], v[52:55]
 v_exp_f32 v150, v150
 MM v[84:87], v[212:215], a[148:151], v[84:87]
 ds_read_b128 a[240:243], v2 offset:61440
 v_cvt_pk_bf16_f32 v146, v148, v149
 MM v[84:87], v[216:219], a[152:155], v[84:87]
 v_exp_f32 v151, v151
 MM v[84:87], v[220:223], a[156:159], v[84:87]
 v_exp_f32 v152, v152
 MM v[68:71], v[220:223], a[140:143], v[68:71]
 v_exp_f32 v153, v153
 MM v[68:71], v[216:219], a[136:139], v[68:71]
 ds_read_b128 a[236:239], v2 offset:60416
 v_cvt_pk_bf16_f32 v147, v150, v151
 MM v[68:71], v[212:215], a[132:135], v[68:71]
 v_exp_f32 v154, v154
 MM v[68:71], v[208:211], a[128:131], v[68:71]
 buffer_load_dwordx4 v1, s[4:7], s28 offen offset:3072 sc1 lds
 MM v[72:75], v[224:227], a[128:131], v[72:75]
 s_add_u32 s28, s28, 0x4000
 ds_read_b128 a[204:207], v2 offset:52224
 v_cvt_pk_bf16_f32 v152, v152, v153
 MM v[72:75], v[228:231], a[132:135], v[72:75]
 v_exp_f32 v155, v155
 MM v[72:75], v[232:235], a[136:139], v[72:75]
 v_exp_f32 v156, v156
 MM v[72:75], v[236:239], a[140:143], v[72:75]
 ds_read_b128 a[200:203], v2 offset:51200
 v_cvt_pk_bf16_f32 v153, v154, v155
 MM v[88:91], v[236:239], a[156:159], v[52:55]
 v_exp_f32 v157, v157
 MM v[88:91], v[232:235], a[152:155], v[88:91]
 v_exp_f32 v158, v158
 MM v[88:91], v[228:231], a[148:151], v[88:91]
 ds_read_b128 a[232:235], v2 offset:59392
 v_cvt_pk_bf16_f32 v154, v156, v157
 MM v[88:91], v[224:227], a[144:147], v[88:91]
 v_exp_f32 v159, v159
 MM v[104:107], v[224:227], a[160:163], v[56:59]
 v_cvt_pk_bf16_f32 v155, v158, v159
 v_max3_f32 v6, v67, v80, v81
 MM v[104:107], v[228:231], a[164:167], v[104:107]
 ds_read_b128 a[228:231], v2 offset:58368
 v_max3_f32 v5, v82, v83, v5
 MM v[104:107], v[232:235], a[168:171], v[104:107]
 v_exp_f32 v160, v160
 MM v[104:107], v[236:239], a[172:175], v[104:107]
 s_add_u32 m0, s31, 49152
 v_exp_f32 v161, v161
 MM v[120:123], v[236:239], a[188:191], v[60:63]
 ds_read_b128 a[196:199], v2 offset:50176
 v_cvt_pk_bf16_f32 v160, v160, v161
 MM v[120:123], v[232:235], a[184:187], v[120:123]
 v_exp_f32 v162, v162
 MM v[120:123], v[228:231], a[180:183], v[120:123]
 v_exp_f32 v163, v163
 MM v[120:123], v[224:227], a[176:179], v[120:123]
 buffer_load_dwordx4 v1, s[8:11], s29 offen offset:0 sc1 lds
 MM v[124:127], v[240:243], a[176:179], v[60:63]
 ds_read_b128 a[192:195], v2 offset:49152
 v_cvt_pk_bf16_f32 v161, v162, v163
 MM v[124:127], v[244:247], a[180:183], v[124:127]
 v_exp_f32 v164, v164
 MM v[124:127], v[248:251], a[184:187], v[124:127]
 ds_read_b128 a[224:227], v2 offset:57344
 v_max3_f32 v6, v96, v97, v6
 MM v[124:127], v[252:255], a[188:191], v[124:127]
 v_exp_f32 v165, v165
 MM v[108:111], v[252:255], a[172:175], v[56:59]
 v_exp_f32 v166, v166
 MM v[108:111], v[248:251], a[168:171], v[108:111]
 v_exp_f32 v167, v167
 MM v[108:111], v[244:247], a[164:167], v[108:111]
 v_exp_f32 v168, v168
 MM v[108:111], v[240:243], a[160:163], v[108:111]
 v_exp_f32 v169, v169
 MM v[92:95], v[240:243], a[144:147], v[52:55]
 v_exp_f32 v170, v170
 MM v[92:95], v[244:247], a[148:151], v[92:95]
 v_exp_f32 v171, v171
 MM v[92:95], v[248:251], a[152:155], v[92:95]
 v_exp_f32 v172, v172
 MM v[92:95], v[252:255], a[156:159], v[92:95]
 v_exp_f32 v173, v173
 MM v[76:79], v[252:255], a[140:143], v[76:79]
 v_exp_f32 v174, v174
 MM v[76:79], v[248:251], a[136:139], v[76:79]
 v_exp_f32 v175, v175
 MM v[76:79], v[244:247], a[132:135], v[76:79]
 s_waitcnt lgkmcnt(0)
 v_cvt_pk_bf16_f32 v162, v164, v165
 v_cvt_pk_bf16_f32 v163, v166, v167
 MM v[76:79], v[240:243], a[128:131], v[76:79]
 buffer_load_dwordx4 v1, s[8:11], s29 offen offset:1024 sc1 lds
 MM a[28:31], a[252:255], v[136:139], a[28:31]
 v_cvt_pk_bf16_f32 v168, v168, v169
 v_cvt_pk_bf16_f32 v169, v170, v171
 MM a[28:31], a[220:223], v[128:131], a[28:31]
 v_cvt_pk_bf16_f32 v170, v172, v173
 v_cvt_pk_bf16_f32 v171, v174, v175
 MM a[24:27], a[216:219], v[128:131], a[24:27]
 ds_read_b128 v[192:195], v3 offset:16384
 v_max3_f32 v5, v98, v99, v5
 MM a[24:27], a[248:251], v[136:139], a[24:27]
 v_exp_f32 v176, v176
 MM a[20:23], a[244:247], v[136:139], a[20:23]
 ds_read_b128 v[196:199], v3 offset:17408
 v_max3_f32 v6, v112, v113, v6
 MM a[20:23], a[212:215], v[128:131], a[20:23]
 v_exp_f32 v177, v177
 MM a[16:19], a[208:211], v[128:131], a[16:19]
 ds_read_b128 v[200:203], v3 offset:18432
 v_max3_f32 v5, v114, v115, v5
 MM a[16:19], a[240:243], v[136:139], a[16:19]
 v_exp_f32 v178, v178
 MM a[12:15], a[236:239], v[136:139], a[12:15]
 ds_read_b128 v[204:207], v3 offset:19456
 v_max3_f32 v6, v116, v117, v6
 MM a[12:15], a[204:207], v[128:131], a[12:15]
 v_exp_f32 v179, v179
 MM a[8:11], a[200:203], v[128:131], a[8:11]
 ds_read_b128 v[208:211], v3 offset:20480
 v_max3_f32 v5, v118, v119, v5
 MM a[8:11], a[232:235], v[136:139], a[8:11]
 v_exp_f32 v180, v180
 MM a[4:7], a[228:231], v[136:139], a[4:7]
 ds_read_b128 v[212:215], v3 offset:21504
 v_max3_f32 v6, v100, v101, v6
 MM a[4:7], a[196:199], v[128:131], a[4:7]
 v_exp_f32 v181, v181
 MM a[0:3], a[192:195], v[128:131], a[0:3]
 ds_read_b128 v[216:219], v3 offset:22528
 v_max3_f32 v5, v102, v103, v5
 MM a[0:3], a[224:227], v[136:139], a[0:3]
 buffer_load_dwordx4 v1, s[8:11], s29 offen offset:2048 sc1 lds
 MM v[32:35], v[28:31], v[136:139], v[32:35]
 ds_read_b128 v[220:223], v3 offset:23552
 v_max3_f32 v6, v84, v85, v6
 MM v[32:35], v[28:31], v[128:131], v[32:35]
 v_exp_f32 v182, v182
 MM a[32:35], a[192:195], v[144:147], a[32:35]
 ds_read_b128 v[224:227], v3 offset:24576
 v_max3_f32 v5, v86, v87, v5
 MM a[32:35], a[224:227], v[152:155], a[32:35]
 v_exp_f32 v183, v183
 MM a[36:39], a[228:231], v[152:155], a[36:39]
 ds_read_b128 v[228:231], v3 offset:25600
 v_max3_f32 v6, v68, v69, v6
 MM a[36:39], a[196:199], v[144:147], a[36:39]
 v_exp_f32 v184, v184
 MM a[40:43], a[200:203], v[144:147], a[40:43]
 ds_read_b128 v[232:235], v3 offset:26624
 v_max3_f32 v5, v70, v71, v5
 MM a[40:43], a[232:235], v[152:155], a[40:43]
 v_exp_f32 v185, v185
 MM a[44:47], a[236:239], v[152:155], a[44:47]
 ds_read_b128 v[236:239], v3 offset:27648
 v_max3_f32 v6, v72, v73, v6
 MM a[44:47], a[204:207], v[144:147], a[44:47]
 v_exp_f32 v186, v186
 MM a[48:51], a[208:211], v[144:147], a[48:51]
 ds_read_b128 v[240:243], v3 offset:28672
 v_max3_f32 v5, v74, v75, v5
 MM a[48:51], a[240:243], v[152:155], a[48:51]
 v_exp_f32 v187, v187
 MM a[52:55], a[244:247], v[152:155], a[52:55]
 ds_read_b128 v[244:247], v3 offset:29696
 v_max3_f32 v6, v88, v89, v6
 MM a[52:55], a[212:215], v[144:147], a[52:55]
 v_exp_f32 v188, v188
 MM a[56:59], a[216:219], v[144:147], a[56:59]
 ds_read_b128 v[248:251], v3 offset:30720
 v_max3_f32 v5, v90, v91, v5
 MM a[56:59], a[248:251], v[152:155], a[56:59]
 buffer_load_dwordx4 v1, s[8:11], s29 offen offset:3072 sc1 lds
 MM a[60:63], a[252:255], v[152:155], a[60:63]
 s_add_u32 s29, s29, 0x4000
 ds_read_b128 v[252:255], v3 offset:31744
 v_max3_f32 v6, v104, v105, v6
 MM a[60:63], a[220:223], v[144:147], a[60:63]
 v_exp_f32 v189, v189
 MM v[36:39], v[28:31], v[144:147], v[36:39]
 v_exp_f32 v190, v190
 MM v[36:39], v[28:31], v[152:155], v[36:39]
 v_exp_f32 v191, v191
 MM a[92:95], a[252:255], v[168:171], a[92:95]
 v_max3_f32 v5, v106, v107, v5
 v_max3_f32 v6, v120, v121, v6
 MM a[92:95], a[220:223], v[160:163], a[92:95]
 v_max3_f32 v5, v122, v123, v5
 v_max3_f32 v6, v124, v125, v6
 MM a[88:91], a[216:219], v[160:163], a[88:91]
 v_max3_f32 v5, v126, v127, v5
 v_max3_f32 v6, v108, v109, v6
 MM a[88:91], a[248:251], v[168:171], a[88:91]
 v_max3_f32 v5, v110, v111, v5
 v_max3_f32 v6, v92, v93, v6
 MM a[84:87], a[244:247], v[168:171], a[84:87]
 v_max3_f32 v5, v94, v95, v5
 v_max3_f32 v6, v76, v77, v6
 MM a[84:87], a[212:215], v[160:163], a[84:87]
 v_max3_f32 v5, v78, v79, v5
 v_cvt_pk_bf16_f32 v176, v176, v177
 MM a[80:83], a[208:211], v[160:163], a[80:83]
 v_cvt_pk_bf16_f32 v177, v178, v179
 v_cvt_pk_bf16_f32 v178, v180, v181
 MM a[80:83], a[240:243], v[168:171], a[80:83]
 s_xor_b32 s30, s30, 0x10000
 v_xor_b32 v2, 0x10000, v2
 v_xor_b32 v3, 0x10000, v3
 MM a[76:79], a[236:239], v[168:171], a[76:79]
 s_xor_b32 s31, s31, 0x10000
 v_cvt_pk_bf16_f32 v179, v182, v183
 v_cvt_pk_bf16_f32 v184, v184, v185
 MM a[76:79], a[204:207], v[160:163], a[76:79]
 v_cvt_pk_bf16_f32 v185, v186, v187
 v_cvt_pk_bf16_f32 v186, v188, v189
 MM a[72:75], a[200:203], v[160:163], a[72:75]
 v_cvt_pk_bf16_f32 v187, v190, v191
 v_max_f32 v5, v5, v6
 MM a[72:75], a[232:235], v[168:171], a[72:75]
 v_cmp_lt_f32 vcc, 0x42400000, v5
 MM a[68:71], a[228:231], v[168:171], a[68:71]
 MM a[68:71], a[196:199], v[160:163], a[68:71]
 s_waitcnt vmcnt(8) lgkmcnt(0)
 MM a[64:67], a[192:195], v[160:163], a[64:67]
 s_barrier
 MM a[64:67], a[224:227], v[168:171], a[64:67]
 MM v[40:43], v[28:31], v[168:171], v[40:43]
 MM v[40:43], v[28:31], v[160:163], v[40:43]
 s_cbranch_vccnz b1sd1_r
b1sd1_ok:
 MM a[96:99], a[192:195], v[176:179], a[96:99]
 s_add_u32 m0, s30, 0
 v_cndmask_b32 v144, v52, v4, s[64:65]
 v_cndmask_b32 v145, v52, v4, s[66:67]
 MM a[96:99], a[224:227], v[184:187], a[96:99]
 buffer_load_dwordx4 v1, s[4:7], s28 offen offset:0 sc1 lds
 MM a[100:103], a[228:231], v[184:187], a[100:103]
 v_cndmask_b32 v146, v52, v4, s[68:69]
 v_cndmask_b32 v147, v52, v4, s[70:71]
 MM a[100:103], a[196:199], v[176:179], a[100:103]
 v_cndmask_b32 v148, v52, v4, s[72:73]
 v_cndmask_b32 v149, v52, v4, s[74:75]
 MM a[104:107], a[200:203], v[176:179], a[104:107]
 v_cndmask_b32 v150, v52, v4, s[76:77]
 v_cndmask_b32 v151, v52, v4, s[78:79]
 MM a[104:107], a[232:235], v[184:187], a[104:107]
 v_cndmask_b32 v152, v52, v4, s[80:81]
 v_cndmask_b32 v153, v52, v4, s[82:83]
 MM a[108:111], a[236:239], v[184:187], a[108:111]
 v_cndmask_b32 v154, v52, v4, s[84:85]
 v_cndmask_b32 v155, v52, v4, s[86:87]
 MM a[108:111], a[204:207], v[176:179], a[108:111]
 v_cndmask_b32 v156, v52, v4, s[88:89]
 v_cndmask_b32 v157, v52, v4, s[90:91]
 MM a[112:115], a[208:211], v[176:179], a[112:115]
 v_cndmask_b32 v158, v52, v4, s[92:93]
 v_cndmask_b32 v159, v52, v4, s[94:95]
 MM a[112:115], a[240:243], v[184:187], a[112:115]
 v_exp_f32 v64, v64
 MM a[116:119], a[244:247], v[184:187], a[116:119]
 buffer_load_dwordx4 v1, s[4:7], s28 offen offset:1024 sc1 lds
 MM a[116:119], a[212:215], v[176:179], a[116:119]
 v_exp_f32 v65, v65
 MM a[120:123], a[216:219], v[176:179], a[120:123]
 v_exp_f32 v66, v66
 MM a[120:123], a[248:251], v[184:187], a[120:123]
 v_exp_f32 v67, v67
 MM a[124:127], a[252:255], v[184:187], a[124:127]
 v_exp_f32 v68, v68
 MM a[124:127], a[220:223], v[176:179], a[124:127]
 v_exp_f32 v69, v69
 MM v[44:47], v[28:31], v[176:179], v[44:47]
 v_exp_f32 v70, v70
 MM v[44:47], v[28:31], v[184:187], v[44:47]
 v_exp_f32 v71, v71
 MM v[144:147], v[192:195], a[144:147], v[144:147]
 ds_read_b128 a[252:255], v2 offset:48128
 v_cvt_pk_bf16_f32 v64, v64, v65
 MM v[144:147], v[196:199], a[148:151], v[144:147]
 buffer_load_dwordx4 v1, s[4:7], s28 offen offset:2048 sc1 lds
 MM v[144:147], v[200:203], a[152:155], v[144:147]
 ds_read_b128 a[220:223], v2 offset:39936
 v_cvt_pk_bf16_f32 v65, v66, v67
 MM v[144:147], v[204:207], a[156:159], v[144:147]
 v_exp_f32 v72, v72
 MM v[160:163], v[204:207], a[172:175], v[56:59]
 ds_read_b128 a[216:219], v2 offset:38912
 v_cvt_pk_bf16_f32 v66, v68, v69
 MM v[160:163], v[200:203], a[168:171], v[160:163]
 v_exp_f32 v73, v73
 MM v[160:163], v[196:199], a[164:167], v[160:163]
 v_exp_f32 v74, v74
 MM v[160:163], v[192:195], a[160:163], v[160:163]
 ds_read_b128 a[248:251], v2 offset:47104
 v_cvt_pk_bf16_f32 v67, v70, v71
 MM v[176:179], v[192:195], a[176:179], v[60:63]
 v_exp_f32 v75, v75
 MM v[176:179], v[196:199], a[180:183], v[176:179]
 ds_read_b128 a[244:247], v2 offset:46080
 v_cvt_pk_bf16_f32 v72, v72, v73
 MM v[176:179], v[200:203], a[184:187], v[176:179]
 buffer_load_dwordx4 v1, s[4:7], s28 offen offset:3072 sc1 lds
 MM v[176:179], v[204:207], a[188:191], v[176:179]
 s_add_u32 s28, s28, 0x4000
 ds_read_b128 a[212:215], v2 offset:37888
 v_cvt_pk_bf16_f32 v73, v74, v75
 MM v[180:183], v[220:223], a[188:191], v[60:63]
 v_exp_f32 v76, v76
 MM v[180:183], v[216:219], a[184:187], v[180:183]
 v_exp_f32 v77, v77
 MM v[180:183], v[212:215], a[180:183], v[180:183]
 ds_read_b128 a[208:211], v2 offset:36864
 v_cvt_pk_bf16_f32 v74, v76, v77
 MM v[180:183], v[208:211], a[176:179], v[180:183]
 s_add_u32 m0, s31, 32768
 v_exp_f32 v78, v78
 MM v[164:167], v[208:211], a[160:163], v[56:59]
 ds_read_b128 a[240:243], v2 offset:45056
 v_max3_f32 v5, v144, v145, v146
 MM v[164:167], v[212:215], a[164:167], v[164:167]
 v_exp_f32 v79, v79
 MM v[164:167], v[216:219], a[168:171], v[164:167]
 v_cvt_pk_bf16_f32 v75, v78, v79
 v_max3_f32 v6, v147, v160, v161
 MM v[164:167], v[220:223], a[172:175], v[164:167]
 buffer_load_dwordx4 v1, s[8:11], s29 offen offset:0 sc1 lds
 MM v[148:151], v[220:223], a[156:159], v[148:151]
 ds_read_b128 a[236:239], v2 offset:44032
 v_max3_f32 v5, v162, v163, v5
 MM v[148:151], v[216:219], a[152:155], v[148:151]
 ds_read_b128 a[204:207], v2 offset:35840
 v_max3_f32 v6, v176, v177, v6
 MM v[148:151], v[212:215], a[148:151], v[148:151]
 v_exp_f32 v80, v80
 MM v[148:151], v[208:211], a[144:147], v[148:151]
 ds_read_b128 a[200:203], v2 offset:34816
 v_max3_f32 v5, v178, v179, v5
 MM v[152:155], v[224:227], a[144:147], v[152:155]
 v_exp_f32 v81, v81
 MM v[152:155], v[228:231], a[148:151], v[152:155]
 v_exp_f32 v82, v82
 MM v[152:155], v[232:235], a[152:155], v[152:155]
 ds_read_b128 a[232:235], v2 offset:43008
 v_cvt_pk_bf16_f32 v80, v80, v81
 MM v[152:155], v[236:239], a[156:159], v[152:155]
 v_exp_f32 v83, v83
 MM v[168:171], v[236:239], a[172:175], v[56:59]
 buffer_load_dwordx4 v1, s[8:11], s29 offen offset:1024 sc1 lds
 MM v[168:171], v[232:235], a[168:171], v[168:171]
 ds_read_b128 a[228:231], v2 offset:41984
 v_cvt_pk_bf16_f32 v81, v82, v83
 MM v[168:171], v[228:231], a[164:167], v[168:171]
 ds_read_b128 a[196:199], v2 offset:33792
 v_max3_f32 v6, v180, v181, v6
 MM v[168:171], v[224:227], a[160:163], v[168:171]
 v_exp_f32 v84, v84
 MM v[184:187], v[224:227], a[176:179], v[60:63]
 v_exp_f32 v85, v85
 MM v[184:187], v[228:231], a[180:183], v[184:187]
 ds_read_b128 a[192:195], v2 offset:32768
 v_cvt_pk_bf16_f32 v82, v84, v85
 MM v[184:187], v[232:235], a[184:187], v[184:187]
 v_exp_f32 v86, v86
 MM v[184:187], v[236:239], a[188:191], v[184:187]
 ds_read_b128 a[224:227], v2 offset:40960
 v_max3_f32 v5, v182, v183, v5
 MM v[188:191], v[252:255], a[188:191], v[60:63]
 v_exp_f32 v87, v87
 MM v[188:191], v[248:251], a[184:187], v[188:191]
 buffer_load_dwordx4 v1, s[8:11], s29 offen offset:2048 sc1 lds
 MM v[188:191], v[244:247], a[180:183], v[188:191]
 v_exp_f32 v88, v88
 MM v[188:191], v[240:243], a[176:179], v[188:191]
 v_exp_f32 v89, v89
 MM v[172:175], v[240:243], a[160:163], v[56:59]
 v_exp_f32 v90, v90
 MM v[172:175], v[244:247], a[164:167], v[172:175]
 v_exp_f32 v91, v91
 MM v[172:175], v[248:251], a[168:171], v[172:175]
 v_exp_f32 v92, v92
 MM v[172:175], v[252:255], a[172:175], v[172:175]
 v_exp_f32 v93, v93
 MM v[156:159], v[252:255], a[156:159], v[156:159]
 v_exp_f32 v94, v94
 MM v[156:159], v[248:251], a[152:155], v[156:159]
 s_waitcnt lgkmcnt(0)
 v_exp_f32 v95, v95
 MM v[156:159], v[244:247], a[148:151], v[156:159]
 buffer_load_dwordx4 v1, s[8:11], s29 offen offset:3072 sc1 lds
 MM v[156:159], v[240:243], a[144:147], v[156:159]
 s_add_u32 s29, s29, 0x4000
 v_cvt_pk_bf16_f32 v83, v86, v87
 v_cvt_pk_bf16_f32 v88, v88, v89
 MM a[28:31], a[252:255], v[72:75], a[28:31]
 v_cvt_pk_bf16_f32 v89, v90, v91
 v_cvt_pk_bf16_f32 v90, v92, v93
 MM a[28:31], a[220:223], v[64:67], a[28:31]
 v_cvt_pk_bf16_f32 v91, v94, v95
 v_max3_f32 v6, v164, v165, v6
 MM a[24:27], a[216:219], v[64:67], a[24:27]
 v_exp_f32 v96, v96
 MM a[24:27], a[248:251], v[72:75], a[24:27]
 v_exp_f32 v97, v97
 MM a[20:23], a[244:247], v[72:75], a[20:23]
 v_exp_f32 v98, v98
 MM a[20:23], a[212:215], v[64:67], a[20:23]
 v_exp_f32 v99, v99
 MM a[16:19], a[208:211], v[64:67], a[16:19]
 v_exp_f32 v100, v100
 MM a[16:19], a[240:243], v[72:75], a[16:19]
 v_exp_f32 v101, v101
 MM a[12:15], a[236:239], v[72:75], a[12:15]
 v_exp_f32 v102, v102
 MM a[12:15], a[204:207], v[64:67], a[12:15]
 v_exp_f32 v103, v103
 MM a[8:11], a[200:203], v[64:67], a[8:11]
 v_exp_f32 v104, v104
 MM a[8:11], a[232:235], v[72:75], a[8:11]
 v_exp_f32 v105, v105
 MM a[4:7], a[228:231], v[72:75], a[4:7]
 v_exp_f32 v106, v106
 MM a[4:7], a[196:199], v[64:67], a[4:7]
 v_exp_f32 v107, v107
 MM a[0:3], a[192:195], v[64:67], a[0:3]
 v_exp_f32 v108, v108
 MM a[0:3], a[224:227], v[72:75], a[0:3]
 v_exp_f32 v109, v109
 MM v[32:35], v[28:31], v[72:75], v[32:35]
 v_exp_f32 v110, v110
 MM v[32:35], v[28:31], v[64:67], v[32:35]
 v_exp_f32 v111, v111
 MM a[32:35], a[192:195], v[80:83], a[32:35]
 v_cvt_pk_bf16_f32 v96, v96, v97
 v_cvt_pk_bf16_f32 v97, v98, v99
 MM a[32:35], a[224:227], v[88:91], a[32:35]
 v_cvt_pk_bf16_f32 v98, v100, v101
 v_cvt_pk_bf16_f32 v99, v102, v103
 MM a[36:39], a[228:231], v[88:91], a[36:39]
 v_cvt_pk_bf16_f32 v104, v104, v105
 v_cvt_pk_bf16_f32 v105, v106, v107
 MM a[36:39], a[196:199], v[80:83], a[36:39]
 v_cvt_pk_bf16_f32 v106, v108, v109
 v_cvt_pk_bf16_f32 v107, v110, v111
 MM a[40:43], a[200:203], v[80:83], a[40:43]
 ds_read_b128 v[192:195], v3 offset:0
 v_max3_f32 v5, v166, v167, v5
 MM a[40:43], a[232:235], v[88:91], a[40:43]
 ds_read_b128 v[196:199], v3 offset:1024
 v_max3_f32 v6, v148, v149, v6
 MM a[44:47], a[236:239], v[88:91], a[44:47]
 ds_read_b128 v[200:203], v3 offset:2048
 v_max3_f32 v5, v150, v151, v5
 MM a[44:47], a[204:207], v[80:83], a[44:47]
 ds_read_b128 v[204:207], v3 offset:3072
 v_max3_f32 v6, v152, v153, v6
 MM a[48:51], a[208:211], v[80:83], a[48:51]
 ds_read_b128 v[208:211], v3 offset:4096
 v_max3_f32 v5, v154, v155, v5
 MM a[48:51], a[240:243], v[88:91], a[48:51]
 ds_read_b128 v[212:215], v3 offset:5120
 v_max3_f32 v6, v168, v169, v6
 MM a[52:55], a[244:247], v[88:91], a[52:55]
 ds_read_b128 v[216:219], v3 offset:6144
 v_max3_f32 v5, v170, v171, v5
 MM a[52:55], a[212:215], v[80:83], a[52:55]
 ds_read_b128 v[220:223], v3 offset:7168
 v_max3_f32 v6, v184, v185, v6
 MM a[56:59], a[216:219], v[80:83], a[56:59]
 ds_read_b128 v[224:227], v3 offset:8192
 v_max3_f32 v5, v186, v187, v5
 MM a[56:59], a[248:251], v[88:91], a[56:59]
 ds_read_b128 v[228:231], v3 offset:9216
 v_max3_f32 v6, v188, v189, v6
 MM a[60:63], a[252:255], v[88:91], a[60:63]
 ds_read_b128 v[232:235], v3 offset:10240
 v_max3_f32 v5, v190, v191, v5
 MM a[60:63], a[220:223], v[80:83], a[60:63]
 ds_read_b128 v[236:239], v3 offset:11264
 v_max3_f32 v6, v172, v173, v6
 MM v[36:39], v[28:31], v[80:83], v[36:39]
 ds_read_b128 v[240:243], v3 offset:12288
 v_max3_f32 v5, v174, v175, v5
 MM v[36:39], v[28:31], v[88:91], v[36:39]
 ds_read_b128 v[244:247], v3 offset:13312
 v_max3_f32 v6, v156, v157, v6
 MM a[92:95], a[252:255], v[104:107], a[92:95]
 ds_read_b128 v[248:251], v3 offset:14336
 v_max3_f32 v5, v158, v159, v5
 MM a[92:95], a[220:223], v[96:99], a[92:95]
 ds_read_b128 v[252:255], v3 offset:15360
 v_mov_b32 v128, v4
 MM a[88:91], a[216:219], v[96:99], a[88:91]
 v_exp_f32 v112, v112
 MM a[88:91], a[248:251], v[104:107], a[88:91]
 v_exp_f32 v113, v113
 MM a[84:87], a[244:247], v[104:107], a[84:87]
 v_exp_f32 v114, v114
 MM a[84:87], a[212:215], v[96:99], a[84:87]
 v_exp_f32 v115, v115
 MM a[80:83], a[208:211], v[96:99], a[80:83]
 v_exp_f32 v116, v116
 MM a[80:83], a[240:243], v[104:107], a[80:83]
 v_exp_f32 v117, v117
 MM a[76:79], a[236:239], v[104:107], a[76:79]
 v_exp_f32 v118, v118
 MM a[76:79], a[204:207], v[96:99], a[76:79]
 v_exp_f32 v119, v119
 MM a[72:75], a[200:203], v[96:99], a[72:75]
 v_exp_f32 v120, v120
 MM a[72:75], a[232:235], v[104:107], a[72:75]
 v_exp_f32 v121, v121
 MM a[68:71], a[228:231], v[104:107], a[68:71]
 v_exp_f32 v122, v122
 MM a[68:71], a[196:199], v[96:99], a[68:71]
 s_waitcnt vmcnt(4) lgkmcnt(0)
 v_exp_f32 v123, v123
 MM a[64:67], a[192:195], v[96:99], a[64:67]
 s_barrier
 v_exp_f32 v124, v124
 MM a[64:67], a[224:227], v[104:107], a[64:67]
 v_exp_f32 v125, v125
 v_exp_f32 v126, v126
 v_exp_f32 v127, v127
 MM v[40:43], v[28:31], v[104:107], v[40:43]
 s_cmp_eq_u32 s26, 7
 v_cvt_pk_bf16_f32 v112, v112, v113
 v_cvt_pk_bf16_f32 v113, v114, v115
 v_cvt_pk_bf16_f32 v114, v116, v117
 v_cvt_pk_bf16_f32 v115, v118, v119
 v_cvt_pk_bf16_f32 v120, v120, v121
 v_cvt_pk_bf16_f32 v121, v122, v123
 v_cvt_pk_bf16_f32 v122, v124, v125
 v_cvt_pk_bf16_f32 v123, v126, v127
 v_mov_b32 v129, v4
 v_mov_b32 v130, v4
 v_mov_b32 v131, v4
 v_mov_b32 v132, v4
 v_mov_b32 v133, v4
 v_mov_b32 v134, v4
 v_mov_b32 v135, v4
 v_mov_b32 v136, v4
 v_mov_b32 v137, v4
 v_mov_b32 v138, v4
 v_mov_b32 v139, v4
 v_mov_b32 v140, v4
 v_mov_b32 v141, v4
 v_mov_b32 v142, v4
 v_mov_b32 v143, v4
 v_max_f32 v5, v5, v6
 v_cmp_lt_f32 vcc, 0x42400000, v5
 MM v[40:43], v[28:31], v[96:99], v[40:43]
 s_cbranch_vccnz b0d1d2_r
b0d1d2_ok:
 s_cbranch_scc1 k_d2rd
k_d2r:
 MM a[96:99], a[192:195], v[112:115], a[96:99]
 s_add_u32 m0, s30, 16384
 v_exp_f32 v144, v144
 MM a[96:99], a[224:227], v[120:123], a[96:99]
 buffer_load_dwordx4 v1, s[4:7], s28 offen offset:0 sc1 lds
 MM a[100:103], a[228:231], v[120:123], a[100:103]
 v_exp_f32 v145, v145
 MM a[100:103], a[196:199], v[112:115], a[100:103]
 v_exp_f32 v146, v146
 MM a[104:107], a[200:203], v[112:115], a[104:107]
 v_exp_f32 v147, v147
 MM a[104:107], a[232:235], v[120:123], a[104:107]
 v_exp_f32 v148, v148
 MM a[108:111], a[236:239], v[120:123], a[108:111]
 buffer_load_dwordx4 v1, s[4:7], s28 offen offset:1024 sc1 lds
 MM a[108:111], a[204:207], v[112:115], a[108:111]
 v_exp_f32 v149, v149
 MM a[112:115], a[208:211], v[112:115], a[112:115]
 v_exp_f32 v150, v150
 MM a[112:115], a[240:243], v[120:123], a[112:115]
 v_exp_f32 v151, v151
 MM a[116:119], a[244:247], v[120:123], a[116:119]
 v_exp_f32 v152, v152
 MM a[116:119], a[212:215], v[112:115], a[116:119]
 v_exp_f32 v153, v153
 MM a[120:123], a[216:219], v[112:115], a[120:123]
 buffer_load_dwordx4 v1, s[4:7], s28 offen offset:2048 sc1 lds
 MM a[120:123], a[248:251], v[120:123], a[120:123]
 v_exp_f32 v154, v154
 MM a[124:127], a[252:255], v[120:123], a[124:127]
 v_exp_f32 v155, v155
 MM a[124:127], a[220:223], v[112:115], a[124:127]
 v_exp_f32 v156, v156
 MM v[44:47], v[28:31], v[112:115], v[44:47]
 v_exp_f32 v157, v157
 MM v[44:47], v[28:31], v[120:123], v[44:47]
 v_exp_f32 v158, v158
 MM v[64:67], v[192:195], a[160:163], v[56:59]
 buffer_load_dwordx4 v1, s[4:7], s28 offen offset:3072 sc1 lds
 MM v[64:67], v[196:199], a[164:167], v[64:67]
 s_add_u32 s28, s28, 0x4000
 v_exp_f32 v159, v159
 MM v[64:67], v[200:203], a[168:171], v[64:67]
 s_add_u32 m0, s31, 49152
 v_cvt_pk_bf16_f32 v144, v144, v145
 v_cvt_pk_bf16_f32 v145, v146, v147
 MM v[64:67], v[204:207], a[172:175], v[64:67]
 v_cvt_pk_bf16_f32 v146, v148, v149
 v_cvt_pk_bf16_f32 v147, v150, v151
 MM v[80:83], v[204:207], a[188:191], v[60:63]
 ds_read_b128 a[224:227], v2 offset:57344
 v_cvt_pk_bf16_f32 v152, v152, v153
 MM v[80:83], v[200:203], a[184:187], v[80:83]
 ds_read_b128 v[200:203], v3 offset:18432
 v_cvt_pk_bf16_f32 v153, v154, v155
 MM v[80:83], v[196:199], a[180:183], v[80:83]
 buffer_load_dwordx4 v1, s[8:11], s29 offen offset:0 sc1 lds
 MM v[80:83], v[192:195], a[176:179], v[80:83]
 ds_read_b128 a[192:195], v2 offset:49152
 v_cvt_pk_bf16_f32 v154, v156, v157
 MM v[84:87], v[208:211], a[176:179], v[60:63]
 ds_read_b128 v[192:195], v3 offset:16384
 v_cvt_pk_bf16_f32 v155, v158, v159
 MM v[84:87], v[212:215], a[180:183], v[84:87]
 ds_read_b128 v[196:199], v3 offset:17408
 ds_read_b128 v[204:207], v3 offset:19456
 MM v[84:87], v[216:219], a[184:187], v[84:87]
 v_exp_f32 v160, v160
 MM v[84:87], v[220:223], a[188:191], v[84:87]
 ds_read_b128 a[196:199], v2 offset:50176
 v_max3_f32 v5, v64, v65, v66
 MM v[68:71], v[220:223], a[172:175], v[56:59]
 buffer_load_dwordx4 v1, s[8:11], s29 offen offset:1024 sc1 lds
 MM v[68:71], v[216:219], a[168:171], v[68:71]
 ds_read_b128 a[228:231], v2 offset:58368
 ds_read_b128 v[216:219], v3 offset:22528
 MM v[68:71], v[212:215], a[164:167], v[68:71]
 ds_read_b128 v[212:215], v3 offset:21504
 ds_read_b128 v[220:223], v3 offset:23552
 MM v[68:71], v[208:211], a[160:163], v[68:71]
 ds_read_b128 v[208:211], v3 offset:20480
 v_max3_f32 v6, v67, v80, v81
 MM v[72:75], v[224:227], a[160:163], v[56:59]
 ds_read_b128 a[232:235], v2 offset:59392
 v_max3_f32 v5, v82, v83, v5
 MM v[72:75], v[228:231], a[164:167], v[72:75]
 v_exp_f32 v161, v161
 MM v[72:75], v[232:235], a[168:171], v[72:75]
 buffer_load_dwordx4 v1, s[8:11], s29 offen offset:2048 sc1 lds
 MM v[72:75], v[236:239], a[172:175], v[72:75]
 ds_read_b128 a[200:203], v2 offset:51200
 v_cvt_pk_bf16_f32 v160, v160, v161
 MM v[88:91], v[236:239], a[188:191], v[60:63]
 ds_read_b128 v[236:239], v3 offset:27648
 v_max3_f32 v6, v84, v85, v6
 MM v[88:91], v[232:235], a[184:187], v[88:91]
 ds_read_b128 v[232:235], v3 offset:26624
 v_max3_f32 v5, v86, v87, v5
 MM v[88:91], v[228:231], a[180:183], v[88:91]
 ds_read_b128 a[204:207], v2 offset:52224
 ds_read_b128 v[228:231], v3 offset:25600
 MM v[88:91], v[224:227], a[176:179], v[88:91]
 buffer_load_dwordx4 v1, s[8:11], s29 offen offset:3072 sc1 lds
 MM v[92:95], v[240:243], a[176:179], v[60:63]
 s_add_u32 s29, s29, 0x4000
 ds_read_b128 v[224:227], v3 offset:24576
 v_max3_f32 v6, v68, v69, v6
 MM v[92:95], v[244:247], a[180:183], v[92:95]
 s_add_u32 m0, s31, 0
 ds_read_b128 a[236:239], v2 offset:60416
 v_max3_f32 v5, v70, v71, v5
 MM v[92:95], v[248:251], a[184:187], v[92:95]
 v_exp_f32 v162, v162
 MM v[92:95], v[252:255], a[188:191], v[92:95]
 v_exp_f32 v163, v163
 MM v[76:79], v[252:255], a[172:175], v[56:59]
 ds_read_b128 v[252:255], v3 offset:31744
 v_cvt_pk_bf16_f32 v161, v162, v163
 MM v[76:79], v[248:251], a[168:171], v[76:79]
 buffer_load_dwordx4 v1, s[4:7], s28 offen offset:0 sc1 lds
 MM v[76:79], v[244:247], a[164:167], v[76:79]
 ds_read_b128 a[240:243], v2 offset:61440
 v_max3_f32 v6, v72, v73, v6
 MM v[76:79], v[240:243], a[160:163], v[76:79]
 s_waitcnt lgkmcnt(3)
 ds_read_b128 v[240:243], v3 offset:28672
 v_max3_f32 v5, v74, v75, v5
 MM v[96:99], v[192:195], a[160:163], v[56:59]
 ds_read_b128 a[208:211], v2 offset:53248
 v_max3_f32 v6, v88, v89, v6
 MM v[96:99], v[196:199], a[164:167], v[96:99]
 ds_read_b128 v[244:247], v3 offset:29696
 v_max3_f32 v5, v90, v91, v5
 MM v[96:99], v[200:203], a[168:171], v[96:99]
 v_exp_f32 v164, v164
 MM v[96:99], v[204:207], a[172:175], v[96:99]
 buffer_load_dwordx4 v1, s[4:7], s28 offen offset:1024 sc1 lds
 MM v[112:115], v[204:207], a[188:191], v[60:63]
 ds_read_b128 a[212:215], v2 offset:54272
 v_max3_f32 v6, v92, v93, v6
 MM v[112:115], v[200:203], a[184:187], v[112:115]
 ds_read_b128 v[248:251], v3 offset:30720
 v_max3_f32 v5, v94, v95, v5
 MM v[112:115], v[196:199], a[180:183], v[112:115]
 v_exp_f32 v165, v165
 MM v[112:115], v[192:195], a[176:179], v[112:115]
 ds_read_b128 a[244:247], v2 offset:62464
 v_cvt_pk_bf16_f32 v162, v164, v165
 MM v[116:119], v[208:211], a[176:179], v[60:63]
 v_exp_f32 v166, v166
 MM v[116:119], v[212:215], a[180:183], v[116:119]
 buffer_load_dwordx4 v1, s[4:7], s28 offen offset:2048 sc1 lds
 MM v[116:119], v[216:219], a[184:187], v[116:119]
 ds_read_b128 a[248:251], v2 offset:63488
 v_max3_f32 v6, v76, v77, v6
 MM v[116:119], v[220:223], a[188:191], v[116:119]
 v_exp_f32 v167, v167
 MM v[100:103], v[220:223], a[172:175], v[56:59]
 ds_read_b128 a[216:219], v2 offset:55296
 v_cvt_pk_bf16_f32 v163, v166, v167
 MM v[100:103], v[216:219], a[168:171], v[100:103]
 v_exp_f32 v168, v168
 MM v[100:103], v[212:215], a[164:167], v[100:103]
 v_exp_f32 v169, v169
 MM v[100:103], v[208:211], a[160:163], v[100:103]
 buffer_load_dwordx4 v1, s[4:7], s28 offen offset:3072 sc1 lds
 MM v[104:107], v[224:227], a[160:163], v[56:59]
 s_add_u32 s28, s28, 0x4000
 ds_read_b128 a[220:223], v2 offset:56320
 v_cvt_pk_bf16_f32 v168, v168, v169
 MM v[104:107], v[228:231], a[164:167], v[104:107]
 v_exp_f32 v170, v170
 MM v[104:107], v[232:235], a[168:171], v[104:107]
 ds_read_b128 a[252:255], v2 offset:64512
 v_max3_f32 v5, v78, v79, v5
 MM v[104:107], v[236:239], a[172:175], v[104:107]
 v_exp_f32 v171, v171
 MM v[120:123], v[236:239], a[188:191], v[60:63]
 v_exp_f32 v172, v172
 MM v[120:123], v[232:235], a[184:187], v[120:123]
 v_exp_f32 v173, v173
 MM v[120:123], v[228:231], a[180:183], v[120:123]
 v_exp_f32 v174, v174
 MM v[120:123], v[224:227], a[176:179], v[120:123]
 s_waitcnt lgkmcnt(1)
 v_exp_f32 v175, v175
 MM v[124:127], v[240:243], a[176:179], v[60:63]
 v_cvt_pk_bf16_f32 v169, v170, v171
 v_cvt_pk_bf16_f32 v170, v172, v173
 MM v[124:127], v[244:247], a[180:183], v[124:127]
 v_cvt_pk_bf16_f32 v171, v174, v175
 v_max3_f32 v6, v96, v97, v6
 MM v[124:127], v[248:251], a[184:187], v[124:127]
 v_exp_f32 v176, v176
 MM v[124:127], v[252:255], a[188:191], v[124:127]
 v_exp_f32 v177, v177
 MM v[108:111], v[252:255], a[172:175], v[56:59]
 v_exp_f32 v178, v178
 MM v[108:111], v[248:251], a[168:171], v[108:111]
 v_exp_f32 v179, v179
 MM v[108:111], v[244:247], a[164:167], v[108:111]
 v_exp_f32 v180, v180
 MM v[108:111], v[240:243], a[160:163], v[108:111]
 v_exp_f32 v181, v181
 MM a[32:35], a[224:227], v[152:155], a[32:35]
 v_exp_f32 v182, v182
 MM a[32:35], a[192:195], v[144:147], a[32:35]
 v_exp_f32 v183, v183
 MM a[36:39], a[196:199], v[144:147], a[36:39]
 ds_read_b128 v[192:195], v2 offset:0
 v_max3_f32 v5, v98, v99, v5
 MM a[36:39], a[228:231], v[152:155], a[36:39]
 ds_read_b128 v[196:199], v2 offset:1024
 v_max3_f32 v6, v112, v113, v6
 MM a[40:43], a[232:235], v[152:155], a[40:43]
 ds_read_b128 v[200:203], v2 offset:2048
 v_max3_f32 v5, v114, v115, v5
 MM a[40:43], a[200:203], v[144:147], a[40:43]
 ds_read_b128 v[204:207], v2 offset:3072
 v_max3_f32 v6, v116, v117, v6
 MM a[44:47], a[204:207], v[144:147], a[44:47]
 ds_read_b128 v[208:211], v2 offset:4096
 v_max3_f32 v5, v118, v119, v5
 MM a[44:47], a[236:239], v[152:155], a[44:47]
 ds_read_b128 v[212:215], v2 offset:5120
 v_max3_f32 v6, v100, v101, v6
 MM a[48:51], a[240:243], v[152:155], a[48:51]
 ds_read_b128 v[216:219], v2 offset:6144
 v_max3_f32 v5, v102, v103, v5
 MM a[48:51], a[208:211], v[144:147], a[48:51]
 ds_read_b128 v[220:223], v2 offset:7168
 v_max3_f32 v6, v104, v105, v6
 MM a[52:55], a[212:215], v[144:147], a[52:55]
 ds_read_b128 v[224:227], v2 offset:8192
 v_max3_f32 v5, v106, v107, v5
 MM a[52:55], a[244:247], v[152:155], a[52:55]
 ds_read_b128 v[228:231], v2 offset:9216
 v_max3_f32 v6, v120, v121, v6
 MM a[56:59], a[248:251], v[152:155], a[56:59]
 ds_read_b128 v[232:235], v2 offset:10240
 v_max3_f32 v5, v122, v123, v5
 MM a[56:59], a[216:219], v[144:147], a[56:59]
 ds_read_b128 v[236:239], v2 offset:11264
 v_max3_f32 v6, v124, v125, v6
 MM a[60:63], a[220:223], v[144:147], a[60:63]
 s_waitcnt lgkmcnt(6)
 ds_read_b128 v[240:243], v2 offset:12288
 v_max3_f32 v5, v126, v127, v5
 MM a[60:63], a[252:255], v[152:155], a[60:63]
 ds_read_b128 v[244:247], v2 offset:13312
 v_max3_f32 v6, v108, v109, v6
 MM v[36:39], v[28:31], v[152:155], v[36:39]
 ds_read_b128 v[248:251], v2 offset:14336
 v_max3_f32 v5, v110, v111, v5
 MM v[36:39], v[28:31], v[144:147], v[36:39]
 ds_read_b128 v[252:255], v2 offset:15360
 v_cvt_pk_bf16_f32 v176, v176, v177
 MM a[92:95], a[220:223], v[160:163], a[92:95]
 v_exp_f32 v184, v184
 MM a[92:95], a[252:255], v[168:171], a[92:95]
 v_exp_f32 v185, v185
 MM a[88:91], a[248:251], v[168:171], a[88:91]
 v_exp_f32 v186, v186
 MM a[88:91], a[216:219], v[160:163], a[88:91]
 v_exp_f32 v187, v187
 MM a[84:87], a[212:215], v[160:163], a[84:87]
 v_exp_f32 v188, v188
 MM a[84:87], a[244:247], v[168:171], a[84:87]
 v_exp_f32 v189, v189
 MM a[80:83], a[240:243], v[168:171], a[80:83]
 v_exp_f32 v190, v190
 MM a[80:83], a[208:211], v[160:163], a[80:83]
 s_xor_b32 s30, s30, 0x10000
 v_xor_b32 v2, 0x10000, v2
 v_xor_b32 v3, 0x10000, v3
 MM a[76:79], a[204:207], v[160:163], a[76:79]
 s_xor_b32 s31, s31, 0x10000
 v_exp_f32 v191, v191
 MM a[76:79], a[236:239], v[168:171], a[76:79]
 v_cvt_pk_bf16_f32 v177, v178, v179
 v_cvt_pk_bf16_f32 v178, v180, v181
 MM a[72:75], a[232:235], v[168:171], a[72:75]
 v_cvt_pk_bf16_f32 v179, v182, v183
 v_cvt_pk_bf16_f32 v184, v184, v185
 MM a[72:75], a[200:203], v[160:163], a[72:75]
 v_cvt_pk_bf16_f32 v185, v186, v187
 v_cvt_pk_bf16_f32 v186, v188, v189
 MM a[68:71], a[196:199], v[160:163], a[68:71]
 v_cvt_pk_bf16_f32 v187, v190, v191
 v_max_f32 v5, v5, v6
 MM a[68:71], a[228:231], v[168:171], a[68:71]
 s_waitcnt vmcnt(0) lgkmcnt(0)
 v_cmp_lt_f32 vcc, 0x42400000, v5
 MM a[64:67], a[224:227], v[168:171], a[64:67]
 s_barrier
 MM a[64:67], a[192:195], v[160:163], a[64:67]
 MM v[40:43], v[28:31], v[160:163], v[40:43]
 MM v[40:43], v[28:31], v[168:171], v[40:43]
 s_cbranch_vccnz b1d2r_r
b1d2r_ok:
 s_nop 7
 v_rcp_f32 v34, v32
 v_rcp_f32 v35, v32
 v_rcp_f32 v38, v36
 v_rcp_f32 v39, v36
 v_accvgpr_read_b32 v128, a0
 v_accvgpr_read_b32 v129, a1
 v_accvgpr_read_b32 v130, a2
 v_accvgpr_read_b32 v131, a3
 v_accvgpr_read_b32 v132, a4
 v_accvgpr_read_b32 v133, a5
 v_accvgpr_read_b32 v134, a6
 v_accvgpr_read_b32 v135, a7
 v_pk_mul_f32 v[128:129], v[128:129], v[34:35]
 v_pk_mul_f32 v[130:131], v[130:131], v[34:35]
 v_pk_mul_f32 v[132:133], v[132:133], v[34:35]
 v_pk_mul_f32 v[134:135], v[134:135], v[34:35]
 v_cvt_pk_bf16_f32 v128, v128, v129
 v_cvt_pk_bf16_f32 v129, v130, v131
 v_cvt_pk_bf16_f32 v130, v132, v133
 v_cvt_pk_bf16_f32 v131, v134, v135
 s_add_u32 s41, s32, 0
 buffer_store_dwordx4 v[128:131], v1, s[16:19], s41 offen sc1
 v_accvgpr_read_b32 v136, a8
 v_accvgpr_read_b32 v137, a9
 v_accvgpr_read_b32 v138, a10
 v_accvgpr_read_b32 v139, a11
 v_accvgpr_read_b32 v140, a12
 v_accvgpr_read_b32 v141, a13
 v_accvgpr_read_b32 v142, a14
 v_accvgpr_read_b32 v143, a15
 v_pk_mul_f32 v[136:137], v[136:137], v[34:35]
 v_pk_mul_f32 v[138:139], v[138:139], v[34:35]
 v_pk_mul_f32 v[140:141], v[140:141], v[34:35]
 v_pk_mul_f32 v[142:143], v[142:143], v[34:35]
 v_cvt_pk_bf16_f32 v136, v136, v137
 v_cvt_pk_bf16_f32 v137, v138, v139
 v_cvt_pk_bf16_f32 v138, v140, v141
 v_cvt_pk_bf16_f32 v139, v142, v143
 s_add_u32 s42, s32, 4096
 buffer_store_dwordx4 v[136:139], v1, s[16:19], s42 offen sc1
 v_accvgpr_read_b32 v144, a16
 v_accvgpr_read_b32 v145, a17
 v_accvgpr_read_b32 v146, a18
 v_accvgpr_read_b32 v147, a19
 v_accvgpr_read_b32 v148, a20
 v_accvgpr_read_b32 v149, a21
 v_accvgpr_read_b32 v150, a22
 v_accvgpr_read_b32 v151, a23
 v_pk_mul_f32 v[144:145], v[144:145], v[34:35]
 v_pk_mul_f32 v[146:147], v[146:147], v[34:35]
 v_pk_mul_f32 v[148:149], v[148:149], v[34:35]
 v_pk_mul_f32 v[150:151], v[150:151], v[34:35]
 v_cvt_pk_bf16_f32 v144, v144, v145
 v_cvt_pk_bf16_f32 v145, v146, v147
 v_cvt_pk_bf16_f32 v146, v148, v149
 v_cvt_pk_bf16_f32 v147, v150, v151
 s_add_u32 s43, s32, 8192
 buffer_store_dwordx4 v[144:147], v1, s[16:19], s43 offen sc1
 v_accvgpr_read_b32 v152, a24
 v_accvgpr_read_b32 v153, a25
 v_accvgpr_read_b32 v154, a26
 v_accvgpr_read_b32 v155, a27
 v_accvgpr_read_b32 v156, a28
 v_accvgpr_read_b32 v157, a29
 v_accvgpr_read_b32 v158, a30
 v_accvgpr_read_b32 v159, a31
 v_pk_mul_f32 v[152:153], v[152:153], v[34:35]
 v_pk_mul_f32 v[154:155], v[154:155], v[34:35]
 v_pk_mul_f32 v[156:157], v[156:157], v[34:35]
 v_pk_mul_f32 v[158:159], v[158:159], v[34:35]
 v_cvt_pk_bf16_f32 v152, v152, v153
 v_cvt_pk_bf16_f32 v153, v154, v155
 v_cvt_pk_bf16_f32 v154, v156, v157
 v_cvt_pk_bf16_f32 v155, v158, v159
 s_add_u32 s40, s32, 12288
 buffer_store_dwordx4 v[152:155], v1, s[16:19], s40 offen sc1
 v_accvgpr_read_b32 v160, a32
 v_accvgpr_read_b32 v161, a33
 v_accvgpr_read_b32 v162, a34
 v_accvgpr_read_b32 v163, a35
 v_accvgpr_read_b32 v164, a36
 v_accvgpr_read_b32 v165, a37
 v_accvgpr_read_b32 v166, a38
 v_accvgpr_read_b32 v167, a39
 v_pk_mul_f32 v[160:161], v[160:161], v[38:39]
 v_pk_mul_f32 v[162:163], v[162:163], v[38:39]
 v_pk_mul_f32 v[164:165], v[164:165], v[38:39]
 v_pk_mul_f32 v[166:167], v[166:167], v[38:39]
 v_cvt_pk_bf16_f32 v160, v160, v161
 v_cvt_pk_bf16_f32 v161, v162, v163
 v_cvt_pk_bf16_f32 v162, v164, v165
 v_cvt_pk_bf16_f32 v163, v166, v167
 s_add_u32 s41, s33, 0
 buffer_store_dwordx4 v[160:163], v1, s[16:19], s41 offen sc1
 v_accvgpr_read_b32 v168, a40
 v_accvgpr_read_b32 v169, a41
 v_accvgpr_read_b32 v170, a42
 v_accvgpr_read_b32 v171, a43
 v_accvgpr_read_b32 v172, a44
 v_accvgpr_read_b32 v173, a45
 v_accvgpr_read_b32 v174, a46
 v_accvgpr_read_b32 v175, a47
 v_pk_mul_f32 v[168:169], v[168:169], v[38:39]
 v_pk_mul_f32 v[170:171], v[170:171], v[38:39]
 v_pk_mul_f32 v[172:173], v[172:173], v[38:39]
 v_pk_mul_f32 v[174:175], v[174:175], v[38:39]
 v_cvt_pk_bf16_f32 v168, v168, v169
 v_cvt_pk_bf16_f32 v169, v170, v171
 v_cvt_pk_bf16_f32 v170, v172, v173
 v_cvt_pk_bf16_f32 v171, v174, v175
 s_add_u32 s42, s33, 4096
 buffer_store_dwordx4 v[168:171], v1, s[16:19], s42 offen sc1
 v_accvgpr_read_b32 v128, a48
 v_accvgpr_read_b32 v129, a49
 v_accvgpr_read_b32 v130, a50
 v_accvgpr_read_b32 v131, a51
 v_accvgpr_read_b32 v132, a52
 v_accvgpr_read_b32 v133, a53
 v_accvgpr_read_b32 v134, a54
 v_accvgpr_read_b32 v135, a55
 v_pk_mul_f32 v[128:129], v[128:129], v[38:39]
 v_pk_mul_f32 v[130:131], v[130:131], v[38:39]
 v_pk_mul_f32 v[132:133], v[132:133], v[38:39]
 v_pk_mul_f32 v[134:135], v[134:135], v[38:39]
 v_cvt_pk_bf16_f32 v128, v128, v129
 v_cvt_pk_bf16_f32 v129, v130, v131
 v_cvt_pk_bf16_f32 v130, v132, v133
 v_cvt_pk_bf16_f32 v131, v134, v135
 s_add_u32 s43, s33, 8192
 buffer_store_dwordx4 v[128:131], v1, s[16:19], s43 offen sc1
 v_accvgpr_read_b32 v136, a56
 v_accvgpr_read_b32 v137, a57
 v_accvgpr_read_b32 v138, a58
 v_accvgpr_read_b32 v139, a59
 v_accvgpr_read_b32 v140, a60
 v_accvgpr_read_b32 v141, a61
 v_accvgpr_read_b32 v142, a62
 v_accvgpr_read_b32 v143, a63
 v_pk_mul_f32 v[136:137], v[136:137], v[38:39]
 v_pk_mul_f32 v[138:139], v[138:139], v[38:39]
 v_pk_mul_f32 v[140:141], v[140:141], v[38:39]
 v_pk_mul_f32 v[142:143], v[142:143], v[38:39]
 v_cvt_pk_bf16_f32 v136, v136, v137
 v_cvt_pk_bf16_f32 v137, v138, v139
 v_cvt_pk_bf16_f32 v138, v140, v141
 v_cvt_pk_bf16_f32 v139, v142, v143
 s_add_u32 s40, s33, 12288
 buffer_store_dwordx4 v[136:139], v1, s[16:19], s40 offen sc1
 s_sub_u32 s44, 7, s26
k_rloop:
 MM a[96:99], a[192:195], v[176:179], a[96:99]
 s_add_u32 m0, s30, 16384
 v_exp_f32 v64, v64
 MM a[96:99], a[224:227], v[184:187], a[96:99]
 buffer_load_dwordx4 v1, s[4:7], s28 offen offset:0 sc1 lds
 MM a[100:103], a[228:231], v[184:187], a[100:103]
 ds_read_b128 a[60:63], v2 offset:48128
 ds_read_b128 a[28:31], v2 offset:39936
 MM a[100:103], a[196:199], v[176:179], a[100:103]
 ds_read_b128 a[24:27], v2 offset:38912
 ds_read_b128 a[56:59], v2 offset:47104
 MM a[104:107], a[200:203], v[176:179], a[104:107]
 v_exp_f32 v65, v65
 MM a[104:107], a[232:235], v[184:187], a[104:107]
 ds_read_b128 a[52:55], v2 offset:46080
 v_cvt_pk_bf16_f32 v64, v64, v65
 MM a[108:111], a[236:239], v[184:187], a[108:111]
 v_exp_f32 v66, v66
 MM a[108:111], a[204:207], v[176:179], a[108:111]
 buffer_load_dwordx4 v1, s[4:7], s28 offen offset:1024 sc1 lds
 MM a[112:115], a[208:211], v[176:179], a[112:115]
 ds_read_b128 a[20:23], v2 offset:37888
 ds_read_b128 a[16:19], v2 offset:36864
 MM a[112:115], a[240:243], v[184:187], a[112:115]
 v_exp_f32 v67, v67
 MM a[116:119], a[244:247], v[184:187], a[116:119]
 ds_read_b128 a[48:51], v2 offset:45056
 v_cvt_pk_bf16_f32 v65, v66, v67
 MM a[116:119], a[212:215], v[176:179], a[116:119]
 ds_read_b128 a[44:47], v2 offset:44032
 ds_read_b128 a[12:15], v2 offset:35840
 MM a[120:123], a[216:219], v[176:179], a[120:123]
 v_exp_f32 v68, v68
 MM a[120:123], a[248:251], v[184:187], a[120:123]
 buffer_load_dwordx4 v1, s[4:7], s28 offen offset:2048 sc1 lds
 MM a[124:127], a[252:255], v[184:187], a[124:127]
 ds_read_b128 a[8:11], v2 offset:34816
 ds_read_b128 a[40:43], v2 offset:43008
 MM a[124:127], a[220:223], v[176:179], a[124:127]
 v_exp_f32 v69, v69
 MM v[44:47], v[28:31], v[176:179], v[44:47]
 ds_read_b128 a[36:39], v2 offset:41984
 v_cvt_pk_bf16_f32 v66, v68, v69
 MM v[44:47], v[28:31], v[184:187], v[44:47]
 ds_read_b128 a[4:7], v2 offset:33792
 ds_read_b128 a[0:3], v2 offset:32768
 MM v[128:131], v[192:195], a[160:163], v[56:59]
 v_exp_f32 v70, v70
 MM v[128:131], v[196:199], a[164:167], v[128:131]
 v_exp_f32 v71, v71
 MM v[128:131], v[200:203], a[168:171], v[128:131]
 buffer_load_dwordx4 v1, s[4:7], s28 offen offset:3072 sc1 lds
 MM v[128:131], v[204:207], a[172:175], v[128:131]
 s_add_u32 s28, s28, 0x4000
 ds_read_b128 a[32:35], v2 offset:40960
 v_cvt_pk_bf16_f32 v67, v70, v71
 MM v[144:147], v[204:207], a[188:191], v[60:63]
 s_add_u32 m0, s31, 32768
 v_exp_f32 v72, v72
 MM v[144:147], v[200:203], a[184:187], v[144:147]
 ds_read_b128 v[200:203], v3 offset:18432
 ds_read_b128 v[204:207], v3 offset:19456
 MM v[144:147], v[196:199], a[180:183], v[144:147]
 v_exp_f32 v73, v73
 MM v[144:147], v[192:195], a[176:179], v[144:147]
 ds_read_b128 v[192:195], v3 offset:16384
 v_cvt_pk_bf16_f32 v72, v72, v73
 MM v[148:151], v[208:211], a[176:179], v[60:63]
 buffer_load_dwordx4 v1, s[8:11], s29 offen offset:0 sc1 lds
 MM v[148:151], v[212:215], a[180:183], v[148:151]
 v_exp_f32 v74, v74
 MM v[148:151], v[216:219], a[184:187], v[148:151]
 v_exp_f32 v75, v75
 MM v[148:151], v[220:223], a[188:191], v[148:151]
 ds_read_b128 v[196:199], v3 offset:17408
 v_cvt_pk_bf16_f32 v73, v74, v75
 MM v[132:135], v[220:223], a[172:175], v[56:59]
 ds_read_b128 v[220:223], v3 offset:23552
 v_max3_f32 v5, v128, v129, v130
 MM v[132:135], v[216:219], a[168:171], v[132:135]
 v_exp_f32 v76, v76
 MM v[132:135], v[212:215], a[164:167], v[132:135]
 buffer_load_dwordx4 v1, s[8:11], s29 offen offset:1024 sc1 lds
 MM v[132:135], v[208:211], a[160:163], v[132:135]
 ds_read_b128 v[208:211], v3 offset:20480
 v_max3_f32 v6, v131, v144, v145
 MM v[136:139], v[224:227], a[160:163], v[56:59]
 ds_read_b128 v[212:215], v3 offset:21504
 v_max3_f32 v5, v146, v147, v5
 MM v[136:139], v[228:231], a[164:167], v[136:139]
 v_exp_f32 v77, v77
 MM v[136:139], v[232:235], a[168:171], v[136:139]
 ds_read_b128 v[216:219], v3 offset:22528
 v_cvt_pk_bf16_f32 v74, v76, v77
 MM v[136:139], v[236:239], a[172:175], v[136:139]
 v_exp_f32 v78, v78
 MM v[152:155], v[236:239], a[188:191], v[60:63]
 ds_read_b128 v[236:239], v3 offset:27648
 v_max3_f32 v6, v148, v149, v6
 MM v[152:155], v[232:235], a[184:187], v[152:155]
 buffer_load_dwordx4 v1, s[8:11], s29 offen offset:2048 sc1 lds
 MM v[152:155], v[228:231], a[180:183], v[152:155]
 ds_read_b128 v[228:231], v3 offset:25600
 v_max3_f32 v5, v150, v151, v5
 MM v[152:155], v[224:227], a[176:179], v[152:155]
 ds_read_b128 v[224:227], v3 offset:24576
 v_max3_f32 v6, v132, v133, v6
 MM v[156:159], v[240:243], a[176:179], v[60:63]
 ds_read_b128 v[232:235], v3 offset:26624
 v_max3_f32 v5, v134, v135, v5
 MM v[156:159], v[244:247], a[180:183], v[156:159]
 v_exp_f32 v79, v79
 MM v[156:159], v[248:251], a[184:187], v[156:159]
 v_exp_f32 v80, v80
 MM v[156:159], v[252:255], a[188:191], v[156:159]
 buffer_load_dwordx4 v1, s[8:11], s29 offen offset:3072 sc1 lds
 MM v[140:143], v[252:255], a[172:175], v[56:59]
 s_add_u32 s29, s29, 0x4000
 ds_read_b128 v[252:255], v3 offset:31744
 v_cvt_pk_bf16_f32 v75, v78, v79
 MM v[140:143], v[248:251], a[168:171], v[140:143]
 ds_read_b128 v[248:251], v3 offset:30720
 v_max3_f32 v6, v136, v137, v6
 MM v[140:143], v[244:247], a[164:167], v[140:143]
 s_add_u32 m0, s31, 49152
 ds_read_b128 v[244:247], v3 offset:29696
 v_max3_f32 v5, v138, v139, v5
 MM v[140:143], v[240:243], a[160:163], v[140:143]
 s_waitcnt lgkmcnt(3)
 ds_read_b128 v[240:243], v3 offset:28672
 v_max3_f32 v6, v152, v153, v6
 MM v[160:163], v[192:195], a[160:163], v[56:59]
 v_exp_f32 v81, v81
 MM v[160:163], v[196:199], a[164:167], v[160:163]
 v_exp_f32 v82, v82
 MM v[160:163], v[200:203], a[168:171], v[160:163]
 buffer_load_dwordx4 v1, s[8:11], s29 offen offset:0 sc1 lds
 MM v[160:163], v[204:207], a[172:175], v[160:163]
 v_exp_f32 v83, v83
 MM v[176:179], v[204:207], a[188:191], v[60:63]
 v_exp_f32 v84, v84
 MM v[176:179], v[200:203], a[184:187], v[176:179]
 v_exp_f32 v85, v85
 MM v[176:179], v[196:199], a[180:183], v[176:179]
 v_exp_f32 v86, v86
 MM v[176:179], v[192:195], a[176:179], v[176:179]
 v_exp_f32 v87, v87
 MM v[180:183], v[208:211], a[176:179], v[60:63]
 buffer_load_dwordx4 v1, s[8:11], s29 offen offset:1024 sc1 lds
 MM v[180:183], v[212:215], a[180:183], v[180:183]
 v_exp_f32 v88, v88
 MM v[180:183], v[216:219], a[184:187], v[180:183]
 v_exp_f32 v89, v89
 MM v[180:183], v[220:223], a[188:191], v[180:183]
 v_exp_f32 v90, v90
 MM v[164:167], v[220:223], a[172:175], v[56:59]
 ds_read_b128 a[252:255], v2 offset:64512
 v_cvt_pk_bf16_f32 v80, v80, v81
 MM v[164:167], v[216:219], a[168:171], v[164:167]
 v_exp_f32 v91, v91
 MM v[164:167], v[212:215], a[164:167], v[164:167]
 buffer_load_dwordx4 v1, s[8:11], s29 offen offset:2048 sc1 lds
 MM v[164:167], v[208:211], a[160:163], v[164:167]
 ds_read_b128 a[220:223], v2 offset:56320
 v_cvt_pk_bf16_f32 v81, v82, v83
 MM v[168:171], v[224:227], a[160:163], v[56:59]
 v_exp_f32 v92, v92
 MM v[168:171], v[228:231], a[164:167], v[168:171]
 ds_read_b128 a[216:219], v2 offset:55296
 v_cvt_pk_bf16_f32 v82, v84, v85
 MM v[168:171], v[232:235], a[168:171], v[168:171]
 v_exp_f32 v93, v93
 MM v[168:171], v[236:239], a[172:175], v[168:171]
 v_exp_f32 v94, v94
 MM v[184:187], v[236:239], a[188:191], v[60:63]
 ds_read_b128 a[248:251], v2 offset:63488
 v_cvt_pk_bf16_f32 v83, v86, v87
 MM v[184:187], v[232:235], a[184:187], v[184:187]
 buffer_load_dwordx4 v1, s[8:11], s29 offen offset:3072 sc1 lds
 MM v[184:187], v[228:231], a[180:183], v[184:187]
 s_add_u32 s29, s29, 0x4000
 v_exp_f32 v95, v95
 MM v[184:187], v[224:227], a[176:179], v[184:187]
 s_add_u32 m0, s31, 0
 ds_read_b128 a[244:247], v2 offset:62464
 v_cvt_pk_bf16_f32 v88, v88, v89
 s_waitcnt lgkmcnt(3)
 MM v[188:191], v[240:243], a[176:179], v[60:63]
 v_cvt_pk_bf16_f32 v89, v90, v91
 v_cvt_pk_bf16_f32 v90, v92, v93
 MM v[188:191], v[244:247], a[180:183], v[188:191]
 v_cvt_pk_bf16_f32 v91, v94, v95
 v_max3_f32 v5, v154, v155, v5
 MM v[188:191], v[248:251], a[184:187], v[188:191]
 ds_read_b128 a[212:215], v2 offset:54272
 v_max3_f32 v6, v156, v157, v6
 MM v[188:191], v[252:255], a[188:191], v[188:191]
 buffer_load_dwordx4 v1, s[4:7], s28 offen offset:0 sc1 lds
 MM v[172:175], v[252:255], a[172:175], v[56:59]
 v_exp_f32 v96, v96
 MM v[172:175], v[248:251], a[168:171], v[172:175]
 ds_read_b128 a[208:211], v2 offset:53248
 v_max3_f32 v5, v158, v159, v5
 MM v[172:175], v[244:247], a[164:167], v[172:175]
 v_exp_f32 v97, v97
 MM v[172:175], v[240:243], a[160:163], v[172:175]
 v_exp_f32 v98, v98
 MM a[92:95], a[60:63], v[72:75], a[92:95]
 ds_read_b128 a[240:243], v2 offset:61440
 v_cvt_pk_bf16_f32 v96, v96, v97
 MM a[92:95], a[28:31], v[64:67], a[92:95]
 buffer_load_dwordx4 v1, s[4:7], s28 offen offset:1024 sc1 lds
 MM a[88:91], a[24:27], v[64:67], a[88:91]
 v_exp_f32 v99, v99
 MM a[88:91], a[56:59], v[72:75], a[88:91]
 ds_read_b128 a[236:239], v2 offset:60416
 v_cvt_pk_bf16_f32 v97, v98, v99
 MM a[84:87], a[52:55], v[72:75], a[84:87]
 v_exp_f32 v100, v100
 MM a[84:87], a[20:23], v[64:67], a[84:87]
 ds_read_b128 a[204:207], v2 offset:52224
 v_max3_f32 v6, v140, v141, v6
 MM a[80:83], a[16:19], v[64:67], a[80:83]
 v_exp_f32 v101, v101
 MM a[80:83], a[48:51], v[72:75], a[80:83]
 v_exp_f32 v102, v102
 MM a[76:79], a[44:47], v[72:75], a[76:79]
 buffer_load_dwordx4 v1, s[4:7], s28 offen offset:2048 sc1 lds
 MM a[76:79], a[12:15], v[64:67], a[76:79]
 ds_read_b128 a[200:203], v2 offset:51200
 v_cvt_pk_bf16_f32 v98, v100, v101
 MM a[72:75], a[8:11], v[64:67], a[72:75]
 v_exp_f32 v103, v103
 MM a[72:75], a[40:43], v[72:75], a[72:75]
 ds_read_b128 a[232:235], v2 offset:59392
 v_cvt_pk_bf16_f32 v99, v102, v103
 MM a[68:71], a[36:39], v[72:75], a[68:71]
 v_exp_f32 v104, v104
 MM a[68:71], a[4:7], v[64:67], a[68:71]
 v_exp_f32 v105, v105
 MM a[64:67], a[0:3], v[64:67], a[64:67]
 buffer_load_dwordx4 v1, s[4:7], s28 offen offset:3072 sc1 lds
 MM a[64:67], a[32:35], v[72:75], a[64:67]
 s_add_u32 s28, s28, 0x4000
 ds_read_b128 a[228:231], v2 offset:58368
 v_cvt_pk_bf16_f32 v104, v104, v105
 MM v[40:43], v[28:31], v[72:75], v[40:43]
 v_exp_f32 v106, v106
 MM v[40:43], v[28:31], v[64:67], v[40:43]
 ds_read_b128 a[196:199], v2 offset:50176
 v_max3_f32 v5, v142, v143, v5
 MM a[96:99], a[0:3], v[80:83], a[96:99]
 v_exp_f32 v107, v107
 MM a[96:99], a[32:35], v[88:91], a[96:99]
 v_exp_f32 v108, v108
 MM a[100:103], a[36:39], v[88:91], a[100:103]
 v_exp_f32 v109, v109
 MM a[100:103], a[4:7], v[80:83], a[100:103]
 v_exp_f32 v110, v110
 MM a[104:107], a[8:11], v[80:83], a[104:107]
 v_exp_f32 v111, v111
 MM a[104:107], a[40:43], v[88:91], a[104:107]
 ds_read_b128 a[192:195], v2 offset:49152
 v_cvt_pk_bf16_f32 v105, v106, v107
 MM a[108:111], a[44:47], v[88:91], a[108:111]
 v_cvt_pk_bf16_f32 v106, v108, v109
 v_cvt_pk_bf16_f32 v107, v110, v111
 MM a[108:111], a[12:15], v[80:83], a[108:111]
 ds_read_b128 a[224:227], v2 offset:57344
 v_max3_f32 v6, v160, v161, v6
 MM a[112:115], a[16:19], v[80:83], a[112:115]
 ds_read_b128 v[192:195], v2 offset:0
 v_max3_f32 v5, v162, v163, v5
 MM a[112:115], a[48:51], v[88:91], a[112:115]
 ds_read_b128 v[196:199], v2 offset:1024
 v_max3_f32 v6, v176, v177, v6
 MM a[116:119], a[52:55], v[88:91], a[116:119]
 ds_read_b128 v[200:203], v2 offset:2048
 v_max3_f32 v5, v178, v179, v5
 MM a[116:119], a[20:23], v[80:83], a[116:119]
 ds_read_b128 v[204:207], v2 offset:3072
 v_max3_f32 v6, v180, v181, v6
 MM a[120:123], a[24:27], v[80:83], a[120:123]
 ds_read_b128 v[208:211], v2 offset:4096
 v_max3_f32 v5, v182, v183, v5
 MM a[120:123], a[56:59], v[88:91], a[120:123]
 ds_read_b128 v[212:215], v2 offset:5120
 v_max3_f32 v6, v164, v165, v6
 MM a[124:127], a[60:63], v[88:91], a[124:127]
 ds_read_b128 v[216:219], v2 offset:6144
 v_max3_f32 v5, v166, v167, v5
 MM a[124:127], a[28:31], v[80:83], a[124:127]
 ds_read_b128 v[220:223], v2 offset:7168
 v_max3_f32 v6, v168, v169, v6
 MM v[44:47], v[28:31], v[80:83], v[44:47]
 ds_read_b128 v[224:227], v2 offset:8192
 v_max3_f32 v5, v170, v171, v5
 MM v[44:47], v[28:31], v[88:91], v[44:47]
 ds_read_b128 v[228:231], v2 offset:9216
 v_max3_f32 v6, v184, v185, v6
 MM a[92:95], a[252:255], v[104:107], a[92:95]
 ds_read_b128 v[232:235], v2 offset:10240
 v_max3_f32 v5, v186, v187, v5
 MM a[92:95], a[220:223], v[96:99], a[92:95]
 s_waitcnt lgkmcnt(6)
 ds_read_b128 v[236:239], v2 offset:11264
 ds_read_b128 v[240:243], v2 offset:12288
 MM a[88:91], a[216:219], v[96:99], a[88:91]
 ds_read_b128 v[244:247], v2 offset:13312
 ds_read_b128 v[248:251], v2 offset:14336
 MM a[88:91], a[248:251], v[104:107], a[88:91]
 ds_read_b128 v[252:255], v2 offset:15360
 v_max3_f32 v6, v188, v189, v6
 MM a[84:87], a[244:247], v[104:107], a[84:87]
 v_exp_f32 v112, v112
 MM a[84:87], a[212:215], v[96:99], a[84:87]
 v_exp_f32 v113, v113
 MM a[80:83], a[208:211], v[96:99], a[80:83]
 v_exp_f32 v114, v114
 MM a[80:83], a[240:243], v[104:107], a[80:83]
 v_exp_f32 v115, v115
 MM a[76:79], a[236:239], v[104:107], a[76:79]
 v_exp_f32 v116, v116
 MM a[76:79], a[204:207], v[96:99], a[76:79]
 v_exp_f32 v117, v117
 MM a[72:75], a[200:203], v[96:99], a[72:75]
 v_exp_f32 v118, v118
 MM a[72:75], a[232:235], v[104:107], a[72:75]
 v_exp_f32 v119, v119
 MM a[68:71], a[228:231], v[104:107], a[68:71]
 v_exp_f32 v120, v120
 MM a[68:71], a[196:199], v[96:99], a[68:71]
 s_waitcnt vmcnt(0) lgkmcnt(0)
 v_exp_f32 v121, v121
 MM a[64:67], a[192:195], v[96:99], a[64:67]
 s_barrier
 v_exp_f32 v122, v122
 MM a[64:67], a[224:227], v[104:107], a[64:67]
 s_sub_u32 s44, s44, 1
 v_exp_f32 v123, v123
 v_exp_f32 v124, v124
 v_exp_f32 v125, v125
 v_exp_f32 v126, v126
 v_exp_f32 v127, v127
 v_max3_f32 v5, v190, v191, v5
 v_max3_f32 v6, v172, v173, v6
 v_max3_f32 v5, v174, v175, v5
 MM v[40:43], v[28:31], v[104:107], v[40:43]
 s_cmp_eq_u32 s44, 0
 v_cvt_pk_bf16_f32 v112, v112, v113
 v_cvt_pk_bf16_f32 v113, v114, v115
 v_cvt_pk_bf16_f32 v114, v116, v117
 v_cvt_pk_bf16_f32 v115, v118, v119
 v_cvt_pk_bf16_f32 v120, v120, v121
 v_cvt_pk_bf16_f32 v121, v122, v123
 v_cvt_pk_bf16_f32 v122, v124, v125
 v_cvt_pk_bf16_f32 v123, v126, v127
 v_max_f32 v5, v5, v6
 v_cmp_lt_f32 vcc, 0x42400000, v5
 MM v[40:43], v[28:31], v[96:99], v[40:43]
 s_cbranch_vccnz b0rr_r
b0rr_ok:
 s_cbranch_scc1 k_rexit
 MM a[96:99], a[192:195], v[112:115], a[96:99]
 s_add_u32 m0, s31, 16384
 v_exp_f32 v128, v128
 MM a[96:99], a[224:227], v[120:123], a[96:99]
 buffer_load_dwordx4 v1, s[4:7], s28 offen offset:0 sc1 lds
 MM a[100:103], a[228:231], v[120:123], a[100:103]
 ds_read_b128 a[60:63], v3 offset:48128
 ds_read_b128 a[28:31], v3 offset:39936
 MM a[100:103], a[196:199], v[112:115], a[100:103]
 ds_read_b128 a[24:27], v3 offset:38912
 ds_read_b128 a[56:59], v3 offset:47104
 MM a[104:107], a[200:203], v[112:115], a[104:107]
 v_exp_f32 v129, v129
 MM a[104:107], a[232:235], v[120:123], a[104:107]
 ds_read_b128 a[52:55], v3 offset:46080
 v_cvt_pk_bf16_f32 v128, v128, v129
 MM a[108:111], a[236:239], v[120:123], a[108:111]
 v_exp_f32 v130, v130
 MM a[108:111], a[204:207], v[112:115], a[108:111]
 buffer_load_dwordx4 v1, s[4:7], s28 offen offset:1024 sc1 lds
 MM a[112:115], a[208:211], v[112:115], a[112:115]
 ds_read_b128 a[20:23], v3 offset:37888
 ds_read_b128 a[16:19], v3 offset:36864
 MM a[112:115], a[240:243], v[120:123], a[112:115]
 v_exp_f32 v131, v131
 MM a[116:119], a[244:247], v[120:123], a[116:119]
 ds_read_b128 a[48:51], v3 offset:45056
 v_cvt_pk_bf16_f32 v129, v130, v131
 MM a[116:119], a[212:215], v[112:115], a[116:119]
 ds_read_b128 a[44:47], v3 offset:44032
 ds_read_b128 a[12:15], v3 offset:35840
 MM a[120:123], a[216:219], v[112:115], a[120:123]
 v_exp_f32 v132, v132
 MM a[120:123], a[248:251], v[120:123], a[120:123]
 buffer_load_dwordx4 v1, s[4:7], s28 offen offset:2048 sc1 lds
 MM a[124:127], a[252:255], v[120:123], a[124:127]
 ds_read_b128 a[8:11], v3 offset:34816
 ds_read_b128 a[40:43], v3 offset:43008
 MM a[124:127], a[220:223], v[112:115], a[124:127]
 v_exp_f32 v133, v133
 MM v[44:47], v[28:31], v[112:115], v[44:47]
 ds_read_b128 a[36:39], v3 offset:41984
 v_cvt_pk_bf16_f32 v130, v132, v133
 MM v[44:47], v[28:31], v[120:123], v[44:47]
 ds_read_b128 a[4:7], v3 offset:33792
 ds_read_b128 a[0:3], v3 offset:32768
 MM v[64:67], v[192:195], a[160:163], v[56:59]
 v_exp_f32 v134, v134
 MM v[64:67], v[196:199], a[164:167], v[64:67]
 v_exp_f32 v135, v135
 MM v[64:67], v[200:203], a[168:171], v[64:67]
 buffer_load_dwordx4 v1, s[4:7], s28 offen offset:3072 sc1 lds
 MM v[64:67], v[204:207], a[172:175], v[64:67]
 s_add_u32 s28, s28, 0x4000
 ds_read_b128 a[32:35], v3 offset:40960
 v_cvt_pk_bf16_f32 v131, v134, v135
 MM v[80:83], v[204:207], a[188:191], v[60:63]
 s_add_u32 m0, s30, 32768
 v_exp_f32 v136, v136
 MM v[80:83], v[200:203], a[184:187], v[80:83]
 ds_read_b128 v[200:203], v2 offset:18432
 ds_read_b128 v[204:207], v2 offset:19456
 MM v[80:83], v[196:199], a[180:183], v[80:83]
 v_exp_f32 v137, v137
 MM v[80:83], v[192:195], a[176:179], v[80:83]
 ds_read_b128 v[192:195], v2 offset:16384
 v_cvt_pk_bf16_f32 v136, v136, v137
 MM v[84:87], v[208:211], a[176:179], v[60:63]
 buffer_load_dwordx4 v1, s[8:11], s29 offen offset:0 sc1 lds
 MM v[84:87], v[212:215], a[180:183], v[84:87]
 v_exp_f32 v138, v138
 MM v[84:87], v[216:219], a[184:187], v[84:87]
 v_exp_f32 v139, v139
 MM v[84:87], v[220:223], a[188:191], v[84:87]
 ds_read_b128 v[196:199], v2 offset:17408
 v_cvt_pk_bf16_f32 v137, v138, v139
 MM v[68:71], v[220:223], a[172:175], v[56:59]
 ds_read_b128 v[220:223], v2 offset:23552
 v_max3_f32 v5, v64, v65, v66
 MM v[68:71], v[216:219], a[168:171], v[68:71]
 v_exp_f32 v140, v140
 MM v[68:71], v[212:215], a[164:167], v[68:71]
 buffer_load_dwordx4 v1, s[8:11], s29 offen offset:1024 sc1 lds
 MM v[68:71], v[208:211], a[160:163], v[68:71]
 ds_read_b128 v[208:211], v2 offset:20480
 v_max3_f32 v6, v67, v80, v81
 MM v[72:75], v[224:227], a[160:163], v[56:59]
 ds_read_b128 v[212:215], v2 offset:21504
 v_max3_f32 v5, v82, v83, v5
 MM v[72:75], v[228:231], a[164:167], v[72:75]
 v_exp_f32 v141, v141
 MM v[72:75], v[232:235], a[168:171], v[72:75]
 ds_read_b128 v[216:219], v2 offset:22528
 v_cvt_pk_bf16_f32 v138, v140, v141
 MM v[72:75], v[236:239], a[172:175], v[72:75]
 v_exp_f32 v142, v142
 MM v[88:91], v[236:239], a[188:191], v[60:63]
 ds_read_b128 v[236:239], v2 offset:27648
 v_max3_f32 v6, v84, v85, v6
 MM v[88:91], v[232:235], a[184:187], v[88:91]
 buffer_load_dwordx4 v1, s[8:11], s29 offen offset:2048 sc1 lds
 MM v[88:91], v[228:231], a[180:183], v[88:91]
 ds_read_b128 v[228:231], v2 offset:25600
 v_max3_f32 v5, v86, v87, v5
 MM v[88:91], v[224:227], a[176:179], v[88:91]
 ds_read_b128 v[224:227], v2 offset:24576
 v_max3_f32 v6, v68, v69, v6
 MM v[92:95], v[240:243], a[176:179], v[60:63]
 ds_read_b128 v[232:235], v2 offset:26624
 v_max3_f32 v5, v70, v71, v5
 MM v[92:95], v[244:247], a[180:183], v[92:95]
 v_exp_f32 v143, v143
 MM v[92:95], v[248:251], a[184:187], v[92:95]
 v_exp_f32 v144, v144
 MM v[92:95], v[252:255], a[188:191], v[92:95]
 buffer_load_dwordx4 v1, s[8:11], s29 offen offset:3072 sc1 lds
 MM v[76:79], v[252:255], a[172:175], v[56:59]
 s_add_u32 s29, s29, 0x4000
 ds_read_b128 v[252:255], v2 offset:31744
 v_cvt_pk_bf16_f32 v139, v142, v143
 MM v[76:79], v[248:251], a[168:171], v[76:79]
 ds_read_b128 v[248:251], v2 offset:30720
 v_max3_f32 v6, v72, v73, v6
 MM v[76:79], v[244:247], a[164:167], v[76:79]
 s_add_u32 m0, s30, 49152
 ds_read_b128 v[244:247], v2 offset:29696
 v_max3_f32 v5, v74, v75, v5
 MM v[76:79], v[240:243], a[160:163], v[76:79]
 s_waitcnt lgkmcnt(3)
 ds_read_b128 v[240:243], v2 offset:28672
 v_max3_f32 v6, v88, v89, v6
 MM v[96:99], v[192:195], a[160:163], v[56:59]
 v_exp_f32 v145, v145
 MM v[96:99], v[196:199], a[164:167], v[96:99]
 v_exp_f32 v146, v146
 MM v[96:99], v[200:203], a[168:171], v[96:99]
 buffer_load_dwordx4 v1, s[8:11], s29 offen offset:0 sc1 lds
 MM v[96:99], v[204:207], a[172:175], v[96:99]
 v_exp_f32 v147, v147
 MM v[112:115], v[204:207], a[188:191], v[60:63]
 v_exp_f32 v148, v148
 MM v[112:115], v[200:203], a[184:187], v[112:115]
 v_exp_f32 v149, v149
 MM v[112:115], v[196:199], a[180:183], v[112:115]
 v_exp_f32 v150, v150
 MM v[112:115], v[192:195], a[176:179], v[112:115]
 v_exp_f32 v151, v151
 MM v[116:119], v[208:211], a[176:179], v[60:63]
 buffer_load_dwordx4 v1, s[8:11], s29 offen offset:1024 sc1 lds
 MM v[116:119], v[212:215], a[180:183], v[116:119]
 v_exp_f32 v152, v152
 MM v[116:119], v[216:219], a[184:187], v[116:119]
 v_exp_f32 v153, v153
 MM v[116:119], v[220:223], a[188:191], v[116:119]
 v_exp_f32 v154, v154
 MM v[100:103], v[220:223], a[172:175], v[56:59]
 ds_read_b128 a[252:255], v3 offset:64512
 v_cvt_pk_bf16_f32 v144, v144, v145
 MM v[100:103], v[216:219], a[168:171], v[100:103]
 v_exp_f32 v155, v155
 MM v[100:103], v[212:215], a[164:167], v[100:103]
 buffer_load_dwordx4 v1, s[8:11], s29 offen offset:2048 sc1 lds
 MM v[100:103], v[208:211], a[160:163], v[100:103]
 ds_read_b128 a[220:223], v3 offset:56320
 v_cvt_pk_bf16_f32 v145, v146, v147
 MM v[104:107], v[224:227], a[160:163], v[56:59]
 v_exp_f32 v156, v156
 MM v[104:107], v[228:231], a[164:167], v[104:107]
 ds_read_b128 a[216:219], v3 offset:55296
 v_cvt_pk_bf16_f32 v146, v148, v149
 MM v[104:107], v[232:235], a[168:171], v[104:107]
 v_exp_f32 v157, v157
 MM v[104:107], v[236:239], a[172:175], v[104:107]
 v_exp_f32 v158, v158
 MM v[120:123], v[236:239], a[188:191], v[60:63]
 ds_read_b128 a[248:251], v3 offset:63488
 v_cvt_pk_bf16_f32 v147, v150, v151
 MM v[120:123], v[232:235], a[184:187], v[120:123]
 buffer_load_dwordx4 v1, s[8:11], s29 offen offset:3072 sc1 lds
 MM v[120:123], v[228:231], a[180:183], v[120:123]
 s_add_u32 s29, s29, 0x4000
 v_exp_f32 v159, v159
 MM v[120:123], v[224:227], a[176:179], v[120:123]
 s_add_u32 m0, s30, 0
 ds_read_b128 a[244:247], v3 offset:62464
 v_cvt_pk_bf16_f32 v152, v152, v153
 s_waitcnt lgkmcnt(3)
 MM v[124:127], v[240:243], a[176:179], v[60:63]
 v_cvt_pk_bf16_f32 v153, v154, v155
 v_cvt_pk_bf16_f32 v154, v156, v157
 MM v[124:127], v[244:247], a[180:183], v[124:127]
 v_cvt_pk_bf16_f32 v155, v158, v159
 v_max3_f32 v5, v90, v91, v5
 MM v[124:127], v[248:251], a[184:187], v[124:127]
 ds_read_b128 a[212:215], v3 offset:54272
 v_max3_f32 v6, v92, v93, v6
 MM v[124:127], v[252:255], a[188:191], v[124:127]
 buffer_load_dwordx4 v1, s[4:7], s28 offen offset:0 sc1 lds
 MM v[108:111], v[252:255], a[172:175], v[56:59]
 v_exp_f32 v160, v160
 MM v[108:111], v[248:251], a[168:171], v[108:111]
 ds_read_b128 a[208:211], v3 offset:53248
 v_max3_f32 v5, v94, v95, v5
 MM v[108:111], v[244:247], a[164:167], v[108:111]
 v_exp_f32 v161, v161
 MM v[108:111], v[240:243], a[160:163], v[108:111]
 v_exp_f32 v162, v162
 MM a[92:95], a[60:63], v[136:139], a[92:95]
 ds_read_b128 a[240:243], v3 offset:61440
 v_cvt_pk_bf16_f32 v160, v160, v161
 MM a[92:95], a[28:31], v[128:131], a[92:95]
 buffer_load_dwordx4 v1, s[4:7], s28 offen offset:1024 sc1 lds
 MM a[88:91], a[24:27], v[128:131], a[88:91]
 v_exp_f32 v163, v163
 MM a[88:91], a[56:59], v[136:139], a[88:91]
 ds_read_b128 a[236:239], v3 offset:60416
 v_cvt_pk_bf16_f32 v161, v162, v163
 MM a[84:87], a[52:55], v[136:139], a[84:87]
 v_exp_f32 v164, v164
 MM a[84:87], a[20:23], v[128:131], a[84:87]
 ds_read_b128 a[204:207], v3 offset:52224
 v_max3_f32 v6, v76, v77, v6
 MM a[80:83], a[16:19], v[128:131], a[80:83]
 v_exp_f32 v165, v165
 MM a[80:83], a[48:51], v[136:139], a[80:83]
 v_exp_f32 v166, v166
 MM a[76:79], a[44:47], v[136:139], a[76:79]
 buffer_load_dwordx4 v1, s[4:7], s28 offen offset:2048 sc1 lds
 MM a[76:79], a[12:15], v[128:131], a[76:79]
 ds_read_b128 a[200:203], v3 offset:51200
 v_cvt_pk_bf16_f32 v162, v164, v165
 MM a[72:75], a[8:11], v[128:131], a[72:75]
 v_exp_f32 v167, v167
 MM a[72:75], a[40:43], v[136:139], a[72:75]
 ds_read_b128 a[232:235], v3 offset:59392
 v_cvt_pk_bf16_f32 v163, v166, v167
 MM a[68:71], a[36:39], v[136:139], a[68:71]
 v_exp_f32 v168, v168
 MM a[68:71], a[4:7], v[128:131], a[68:71]
 v_exp_f32 v169, v169
 MM a[64:67], a[0:3], v[128:131], a[64:67]
 buffer_load_dwordx4 v1, s[4:7], s28 offen offset:3072 sc1 lds
 MM a[64:67], a[32:35], v[136:139], a[64:67]
 s_add_u32 s28, s28, 0x4000
 ds_read_b128 a[228:231], v3 offset:58368
 v_cvt_pk_bf16_f32 v168, v168, v169
 MM v[40:43], v[28:31], v[136:139], v[40:43]
 v_exp_f32 v170, v170
 MM v[40:43], v[28:31], v[128:131], v[40:43]
 ds_read_b128 a[196:199], v3 offset:50176
 v_max3_f32 v5, v78, v79, v5
 MM a[96:99], a[0:3], v[144:147], a[96:99]
 v_exp_f32 v171, v171
 MM a[96:99], a[32:35], v[152:155], a[96:99]
 v_exp_f32 v172, v172
 MM a[100:103], a[36:39], v[152:155], a[100:103]
 v_exp_f32 v173, v173
 MM a[100:103], a[4:7], v[144:147], a[100:103]
 v_exp_f32 v174, v174
 MM a[104:107], a[8:11], v[144:147], a[104:107]
 v_exp_f32 v175, v175
 MM a[104:107], a[40:43], v[152:155], a[104:107]
 ds_read_b128 a[192:195], v3 offset:49152
 v_cvt_pk_bf16_f32 v169, v170, v171
 MM a[108:111], a[44:47], v[152:155], a[108:111]
 v_cvt_pk_bf16_f32 v170, v172, v173
 v_cvt_pk_bf16_f32 v171, v174, v175
 MM a[108:111], a[12:15], v[144:147], a[108:111]
 ds_read_b128 a[224:227], v3 offset:57344
 v_max3_f32 v6, v96, v97, v6
 MM a[112:115], a[16:19], v[144:147], a[112:115]
 ds_read_b128 v[192:195], v3 offset:0
 v_max3_f32 v5, v98, v99, v5
 MM a[112:115], a[48:51], v[152:155], a[112:115]
 ds_read_b128 v[196:199], v3 offset:1024
 v_max3_f32 v6, v112, v113, v6
 MM a[116:119], a[52:55], v[152:155], a[116:119]
 ds_read_b128 v[200:203], v3 offset:2048
 v_max3_f32 v5, v114, v115, v5
 MM a[116:119], a[20:23], v[144:147], a[116:119]
 ds_read_b128 v[204:207], v3 offset:3072
 v_max3_f32 v6, v116, v117, v6
 MM a[120:123], a[24:27], v[144:147], a[120:123]
 ds_read_b128 v[208:211], v3 offset:4096
 v_max3_f32 v5, v118, v119, v5
 MM a[120:123], a[56:59], v[152:155], a[120:123]
 ds_read_b128 v[212:215], v3 offset:5120
 v_max3_f32 v6, v100, v101, v6
 MM a[124:127], a[60:63], v[152:155], a[124:127]
 ds_read_b128 v[216:219], v3 offset:6144
 v_max3_f32 v5, v102, v103, v5
 MM a[124:127], a[28:31], v[144:147], a[124:127]
 ds_read_b128 v[220:223], v3 offset:7168
 v_max3_f32 v6, v104, v105, v6
 MM v[44:47], v[28:31], v[144:147], v[44:47]
 ds_read_b128 v[224:227], v3 offset:8192
 v_max3_f32 v5, v106, v107, v5
 MM v[44:47], v[28:31], v[152:155], v[44:47]
 ds_read_b128 v[228:231], v3 offset:9216
 v_max3_f32 v6, v120, v121, v6
 MM a[92:95], a[252:255], v[168:171], a[92:95]
 ds_read_b128 v[232:235], v3 offset:10240
 v_max3_f32 v5, v122, v123, v5
 MM a[92:95], a[220:223], v[160:163], a[92:95]
 s_waitcnt lgkmcnt(6)
 ds_read_b128 v[236:239], v3 offset:11264
 ds_read_b128 v[240:243], v3 offset:12288
 MM a[88:91], a[216:219], v[160:163], a[88:91]
 ds_read_b128 v[244:247], v3 offset:13312
 ds_read_b128 v[248:251], v3 offset:14336
 MM a[88:91], a[248:251], v[168:171], a[88:91]
 ds_read_b128 v[252:255], v3 offset:15360
 v_max3_f32 v6, v124, v125, v6
 MM a[84:87], a[244:247], v[168:171], a[84:87]
 v_exp_f32 v176, v176
 MM a[84:87], a[212:215], v[160:163], a[84:87]
 v_exp_f32 v177, v177
 MM a[80:83], a[208:211], v[160:163], a[80:83]
 v_exp_f32 v178, v178
 MM a[80:83], a[240:243], v[168:171], a[80:83]
 v_exp_f32 v179, v179
 MM a[76:79], a[236:239], v[168:171], a[76:79]
 v_exp_f32 v180, v180
 MM a[76:79], a[204:207], v[160:163], a[76:79]
 v_exp_f32 v181, v181
 MM a[72:75], a[200:203], v[160:163], a[72:75]
 v_exp_f32 v182, v182
 MM a[72:75], a[232:235], v[168:171], a[72:75]
 v_exp_f32 v183, v183
 MM a[68:71], a[228:231], v[168:171], a[68:71]
 v_exp_f32 v184, v184
 MM a[68:71], a[196:199], v[160:163], a[68:71]
 s_waitcnt vmcnt(0) lgkmcnt(0)
 v_exp_f32 v185, v185
 MM a[64:67], a[192:195], v[160:163], a[64:67]
 s_barrier
 v_exp_f32 v186, v186
 MM a[64:67], a[224:227], v[168:171], a[64:67]
 v_exp_f32 v187, v187
 v_exp_f32 v188, v188
 v_exp_f32 v189, v189
 v_exp_f32 v190, v190
 v_exp_f32 v191, v191
 v_max3_f32 v5, v126, v127, v5
 v_max3_f32 v6, v108, v109, v6
 v_max3_f32 v5, v110, v111, v5
 MM v[40:43], v[28:31], v[168:171], v[40:43]
 v_cvt_pk_bf16_f32 v176, v176, v177
 v_cvt_pk_bf16_f32 v177, v178, v179
 v_cvt_pk_bf16_f32 v178, v180, v181
 v_cvt_pk_bf16_f32 v179, v182, v183
 v_cvt_pk_bf16_f32 v184, v184, v185
 v_cvt_pk_bf16_f32 v185, v186, v187
 v_cvt_pk_bf16_f32 v186, v188, v189
 v_cvt_pk_bf16_f32 v187, v190, v191
 v_max_f32 v5, v5, v6
 v_cmp_lt_f32 vcc, 0x42400000, v5
 MM v[40:43], v[28:31], v[160:163], v[40:43]
 s_cbranch_vccnz b1rr_r
b1rr_ok:
 s_branch k_rloop
k_rexit:
 MM a[96:99], a[192:195], v[112:115], a[96:99]
 s_add_u32 m0, s30, 32768
 ds_read_b128 a[60:63], v3 offset:48128
 v_cndmask_b32 v64, v56, v4, s[64:65]
 MM a[96:99], a[224:227], v[120:123], a[96:99]
 buffer_load_dwordx4 v1, s[8:11], s29 offen offset:0 sc1 lds
 MM a[100:103], a[228:231], v[120:123], a[100:103]
 s_and_b32 s12, s2, 3
 ds_read_b128 a[28:31], v3 offset:39936
 v_cndmask_b32 v65, v56, v4, s[66:67]
 MM a[100:103], a[196:199], v[112:115], a[100:103]
 s_lshl_b32 s12, s12, 2
 ds_read_b128 a[24:27], v3 offset:38912
 v_cndmask_b32 v66, v56, v4, s[68:69]
 MM a[104:107], a[200:203], v[112:115], a[104:107]
 s_lshr_b32 s37, s2, 6
 ds_read_b128 a[56:59], v3 offset:47104
 v_cndmask_b32 v67, v56, v4, s[70:71]
 MM a[104:107], a[232:235], v[120:123], a[104:107]
 s_add_u32 s12, s12, s37
 ds_read_b128 a[52:55], v3 offset:46080
 v_cndmask_b32 v68, v56, v4, s[72:73]
 MM a[108:111], a[236:239], v[120:123], a[108:111]
 s_lshl_b32 s12, s12, 1
 ds_read_b128 a[20:23], v3 offset:37888
 v_cndmask_b32 v69, v56, v4, s[74:75]
 MM a[108:111], a[204:207], v[112:115], a[108:111]
 s_bfe_u32 s36, s2, 0x10002
 ds_read_b128 a[16:19], v3 offset:36864
 v_cndmask_b32 v70, v56, v4, s[76:77]
 MM a[112:115], a[208:211], v[112:115], a[112:115]
 s_add_u32 s12, s12, s36
 ds_read_b128 a[48:51], v3 offset:45056
 v_cndmask_b32 v71, v56, v4, s[78:79]
 MM a[112:115], a[240:243], v[120:123], a[112:115]
 s_bfe_u32 s13, s2, 0x30003
 v_cndmask_b32 v72, v56, v4, s[80:81]
 v_cndmask_b32 v73, v56, v4, s[82:83]
 MM a[116:119], a[244:247], v[120:123], a[116:119]
 s_mov_b32 s50, 2621440
 ds_read_b128 a[44:47], v3 offset:44032
 v_cndmask_b32 v74, v56, v4, s[84:85]
 MM a[116:119], a[212:215], v[112:115], a[116:119]
 s_mov_b32 s51, 0x20000
 ds_read_b128 a[12:15], v3 offset:35840
 v_cndmask_b32 v75, v56, v4, s[86:87]
 MM a[120:123], a[216:219], v[112:115], a[120:123]
 buffer_load_dwordx4 v1, s[8:11], s29 offen offset:1024 sc1 lds
 MM a[120:123], a[248:251], v[120:123], a[120:123]
 s_lshl_b32 s39, s12, 6
 ds_read_b128 a[8:11], v3 offset:34816
 v_cndmask_b32 v76, v56, v4, s[88:89]
 MM a[124:127], a[252:255], v[120:123], a[124:127]
 s_lshl_b32 s37, s24, 4
 ds_read_b128 a[40:43], v3 offset:43008
 v_cndmask_b32 v77, v56, v4, s[90:91]
 MM a[124:127], a[220:223], v[112:115], a[124:127]
 s_add_u32 s39, s39, s37
 ds_read_b128 a[36:39], v3 offset:41984
 v_cndmask_b32 v78, v56, v4, s[92:93]
 MM v[44:47], v[28:31], v[112:115], v[44:47]
 s_mul_i32 s56, s39, 1280
 ds_read_b128 a[4:7], v3 offset:33792
 v_cndmask_b32 v79, v56, v4, s[94:95]
 MM v[44:47], v[28:31], v[120:123], v[44:47]
 s_mul_i32 s39, s13, 160
 s_add_u32 s56, s56, s39
 ds_read_b128 a[0:3], v3 offset:32768
 MM v[64:67], v[192:195], a[160:163], v[64:67]
 s_lshl_b32 s57, s24, 12
 ds_read_b128 a[32:35], v3 offset:40960
 v_cndmask_b32 v112, v60, v4, s[64:65]
 MM v[64:67], v[196:199], a[164:167], v[64:67]
 s_add_u32 s57, s57, 0x24000
 v_cndmask_b32 v113, v60, v4, s[66:67]
 v_cndmask_b32 v114, v60, v4, s[68:69]
 MM v[64:67], v[200:203], a[168:171], v[64:67]
 v_cndmask_b32 v115, v60, v4, s[70:71]
 v_cndmask_b32 v116, v60, v4, s[72:73]
 MM v[64:67], v[204:207], a[172:175], v[64:67]
 v_cndmask_b32 v117, v60, v4, s[74:75]
 v_cndmask_b32 v118, v60, v4, s[76:77]
 MM v[80:83], v[204:207], a[188:191], v[60:63]
 ds_read_b128 v[204:207], v2 offset:19456
 v_cndmask_b32 v119, v60, v4, s[78:79]
 MM v[80:83], v[200:203], a[184:187], v[80:83]
 buffer_load_dwordx4 v1, s[8:11], s29 offen offset:2048 sc1 lds
 MM v[80:83], v[196:199], a[180:183], v[80:83]
 ds_read_b128 v[196:199], v2 offset:17408
 v_cndmask_b32 v120, v60, v4, s[80:81]
 MM v[80:83], v[192:195], a[176:179], v[80:83]
 ds_read_b128 v[192:195], v2 offset:16384
 v_cndmask_b32 v121, v60, v4, s[82:83]
 MM v[84:87], v[208:211], a[176:179], v[60:63]
 ds_read_b128 v[200:203], v2 offset:18432
 v_cndmask_b32 v122, v60, v4, s[84:85]
 MM v[84:87], v[212:215], a[180:183], v[84:87]
 v_cndmask_b32 v123, v60, v4, s[86:87]
 v_cndmask_b32 v124, v60, v4, s[88:89]
 MM v[84:87], v[216:219], a[184:187], v[84:87]
 v_cndmask_b32 v125, v60, v4, s[90:91]
 v_cndmask_b32 v126, v60, v4, s[92:93]
 MM v[84:87], v[220:223], a[188:191], v[84:87]
 v_cndmask_b32 v127, v60, v4, s[94:95]
 v_add_u32 v20, 0, v1
 MM v[68:71], v[220:223], a[172:175], v[68:71]
 ds_read_b128 v[220:223], v2 offset:23552
 v_add_u32 v18, 70729728, v1
 MM v[68:71], v[216:219], a[168:171], v[68:71]
 ds_read_b128 v[216:219], v2 offset:22528
 v_mul_u32_u24 v16, 205, v20
 MM v[68:71], v[212:215], a[164:167], v[68:71]
 ds_read_b128 v[212:215], v2 offset:21504
 v_lshrrev_b32 v16, 15, v16
 MM v[68:71], v[208:211], a[160:163], v[68:71]
 ds_read_b128 v[208:211], v2 offset:20480
 v_mul_u32_u24 v16, 1120, v16
 MM v[72:75], v[224:227], a[160:163], v[72:75]
 buffer_load_dwordx4 v1, s[8:11], s29 offen offset:3072 sc1 lds
 MM v[72:75], v[228:231], a[164:167], v[72:75]
 s_add_u32 s29, s29, 0x4000
 v_exp_f32 v128, v128
 MM v[72:75], v[232:235], a[168:171], v[72:75]
 v_exp_f32 v129, v129
 MM v[72:75], v[236:239], a[172:175], v[72:75]
 v_exp_f32 v130, v130
 MM v[88:91], v[236:239], a[188:191], v[60:63]
 ds_read_b128 v[236:239], v2 offset:27648
 v_cvt_pk_bf16_f32 v128, v128, v129
 MM v[88:91], v[232:235], a[184:187], v[88:91]
 ds_read_b128 v[232:235], v2 offset:26624
 v_add_u32 v20, v20, v16
 MM v[88:91], v[228:231], a[180:183], v[88:91]
 ds_read_b128 v[228:231], v2 offset:25600
 v_add_u32 v21, 1024, v1
 MM v[88:91], v[224:227], a[176:179], v[88:91]
 ds_read_b128 v[224:227], v2 offset:24576
 v_mul_u32_u24 v16, 205, v21
 MM v[92:95], v[240:243], a[176:179], v[60:63]
 s_add_u32 m0, s30, 49152
 v_exp_f32 v131, v131
 MM v[92:95], v[244:247], a[180:183], v[92:95]
 v_exp_f32 v132, v132
 MM v[92:95], v[248:251], a[184:187], v[92:95]
 v_exp_f32 v133, v133
 MM v[92:95], v[252:255], a[188:191], v[92:95]
 v_exp_f32 v134, v134
 MM v[76:79], v[252:255], a[172:175], v[76:79]
 buffer_load_dwordx4 v1, s[8:11], s29 offen offset:0 sc1 lds
 MM v[76:79], v[248:251], a[168:171], v[76:79]
 ds_read_b128 v[252:255], v2 offset:31744
 v_cvt_pk_bf16_f32 v129, v130, v131
 MM v[76:79], v[244:247], a[164:167], v[76:79]
 ds_read_b128 v[248:251], v2 offset:30720
 v_cvt_pk_bf16_f32 v130, v132, v133
 MM v[76:79], v[240:243], a[160:163], v[76:79]
 s_waitcnt lgkmcnt(2)
 ds_read_b128 v[244:247], v2 offset:29696
 v_lshrrev_b32 v16, 15, v16
 MM v[112:115], v[192:195], a[176:179], v[112:115]
 ds_read_b128 v[240:243], v2 offset:28672
 v_mul_u32_u24 v16, 1120, v16
 MM v[112:115], v[196:199], a[180:183], v[112:115]
 ds_read_b128 a[252:255], v3 offset:64512
 v_add_u32 v21, v21, v16
 MM v[112:115], v[200:203], a[184:187], v[112:115]
 ds_read_b128 a[220:223], v3 offset:56320
 v_add_u32 v17, 2048, v1
 MM v[112:115], v[204:207], a[188:191], v[112:115]
 v_exp_f32 v135, v135
 MM v[116:119], v[220:223], a[188:191], v[116:119]
 v_exp_f32 v136, v136
 MM v[116:119], v[216:219], a[184:187], v[116:119]
 v_exp_f32 v137, v137
 MM v[116:119], v[212:215], a[180:183], v[116:119]
 v_exp_f32 v138, v138
 MM v[116:119], v[208:211], a[176:179], v[116:119]
 buffer_load_dwordx4 v1, s[8:11], s29 offen offset:1024 sc1 lds
 MM v[120:123], v[224:227], a[176:179], v[120:123]
 v_exp_f32 v139, v139
 MM v[120:123], v[228:231], a[180:183], v[120:123]
 v_exp_f32 v140, v140
 MM v[120:123], v[232:235], a[184:187], v[120:123]
 v_exp_f32 v141, v141
 MM v[120:123], v[236:239], a[188:191], v[120:123]
 s_waitcnt lgkmcnt(0)
 v_exp_f32 v142, v142
 MM v[124:127], v[252:255], a[188:191], v[124:127]
 v_exp_f32 v143, v143
 MM v[124:127], v[248:251], a[184:187], v[124:127]
 ds_read_b128 a[216:219], v3 offset:55296
 v_cvt_pk_bf16_f32 v131, v134, v135
 v_cvt_pk_bf16_f32 v136, v136, v137
 v_cvt_pk_bf16_f32 v137, v138, v139
 v_cvt_pk_bf16_f32 v138, v140, v141
 v_cvt_pk_bf16_f32 v139, v142, v143
 MM v[124:127], v[244:247], a[180:183], v[124:127]
 ds_read_b128 a[248:251], v3 offset:63488
 v_mul_u32_u24 v16, 205, v17
 MM v[124:127], v[240:243], a[176:179], v[124:127]
 ds_read_b128 a[244:247], v3 offset:62464
 v_lshrrev_b32 v16, 15, v16
 MM a[92:95], a[60:63], v[136:139], a[92:95]
 buffer_load_dwordx4 v[8:11], v18, s[16:19], 0 offen sc1
 MM a[92:95], a[28:31], v[128:131], a[92:95]
 ds_read_b128 a[212:215], v3 offset:54272
 v_mul_u32_u24 v16, 1120, v16
 MM a[88:91], a[24:27], v[128:131], a[88:91]
 buffer_load_dwordx4 v1, s[8:11], s29 offen offset:2048 sc1 lds
 MM a[88:91], a[56:59], v[136:139], a[88:91]
 ds_read_b128 a[208:211], v3 offset:53248
 v_add_u32 v17, v17, v16
 MM a[84:87], a[52:55], v[136:139], a[84:87]
 ds_read_b128 a[240:243], v3 offset:61440
 v_lshrrev_b32 v16, 9, v1
 MM a[84:87], a[20:23], v[128:131], a[84:87]
 v_exp_f32 v144, v144
 MM a[80:83], a[16:19], v[128:131], a[80:83]
 v_exp_f32 v145, v145
 MM a[80:83], a[48:51], v[136:139], a[80:83]
 v_exp_f32 v146, v146
 MM a[76:79], a[44:47], v[136:139], a[76:79]
 v_exp_f32 v147, v147
 MM a[76:79], a[12:15], v[128:131], a[76:79]
 v_exp_f32 v148, v148
 MM a[72:75], a[8:11], v[128:131], a[72:75]
 v_exp_f32 v149, v149
 MM a[72:75], a[40:43], v[136:139], a[72:75]
 v_exp_f32 v150, v150
 MM a[68:71], a[36:39], v[136:139], a[68:71]
 v_exp_f32 v151, v151
 MM a[68:71], a[4:7], v[128:131], a[68:71]
 v_exp_f32 v152, v152
 MM a[64:67], a[0:3], v[128:131], a[64:67]
 v_exp_f32 v153, v153
 v_exp_f32 v154, v154
 v_exp_f32 v155, v155
 v_exp_f32 v156, v156
 v_exp_f32 v157, v157
 v_exp_f32 v158, v158
 v_exp_f32 v159, v159
 MM a[64:67], a[32:35], v[136:139], a[64:67]
 ds_read_b128 a[236:239], v3 offset:60416
 v_cvt_pk_bf16_f32 v144, v144, v145
 v_cvt_pk_bf16_f32 v145, v146, v147
 v_cvt_pk_bf16_f32 v146, v148, v149
 v_cvt_pk_bf16_f32 v147, v150, v151
 v_cvt_pk_bf16_f32 v152, v152, v153
 v_cvt_pk_bf16_f32 v153, v154, v155
 v_cvt_pk_bf16_f32 v154, v156, v157
 v_cvt_pk_bf16_f32 v155, v158, v159
 MM v[40:43], v[28:31], v[136:139], v[40:43]
 ds_read_b128 a[204:207], v3 offset:52224
 ds_read_b128 a[200:203], v3 offset:51200
 MM v[40:43], v[28:31], v[128:131], v[40:43]
 buffer_load_dwordx4 v1, s[8:11], s29 offen offset:3072 sc1 lds
 MM a[96:99], a[0:3], v[144:147], a[96:99]
 s_add_u32 s29, s29, 0x4000
 ds_read_b128 a[232:235], v3 offset:59392
 v_mul_u32_u24 v16, 0x700000, v16
 MM a[96:99], a[32:35], v[152:155], a[96:99]
 ds_read_b128 a[228:231], v3 offset:58368
 v_lshl_add_u32 v17, v16, 8, v17
 MM a[100:103], a[36:39], v[152:155], a[100:103]
 s_mul_i32 s14, s12, 745472
 s_add_u32 s14, s14, 37748736
 ds_read_b128 a[196:199], v3 offset:50176
 MM a[100:103], a[4:7], v[144:147], a[100:103]
 s_mul_i32 s15, s13, 931840
 v_exp_f32 v160, v160
 MM a[104:107], a[8:11], v[144:147], a[104:107]
 s_add_u32 s15, s15, 62914560
 v_exp_f32 v161, v161
 MM a[104:107], a[40:43], v[152:155], a[104:107]
 s_mul_i32 s38, s24, 7
 v_exp_f32 v162, v162
 MM a[108:111], a[44:47], v[152:155], a[108:111]
 s_mul_i32 s36, s36, 27
 v_exp_f32 v163, v163
 MM a[108:111], a[12:15], v[144:147], a[108:111]
 s_add_u32 s38, s38, s36
 v_exp_f32 v164, v164
 MM a[112:115], a[16:19], v[144:147], a[112:115]
 s_add_u32 s38, s38, 128
 v_exp_f32 v165, v165
 MM a[112:115], a[48:51], v[152:155], a[112:115]
 s_lshl_b32 s20, s38, 12
 v_exp_f32 v166, v166
 MM a[116:119], a[52:55], v[152:155], a[116:119]
 s_xor_b32 s36, s12, 1
 v_exp_f32 v167, v167
 MM a[116:119], a[20:23], v[144:147], a[116:119]
 s_mul_i32 s22, s36, 745472
 v_exp_f32 v168, v168
 MM a[120:123], a[24:27], v[144:147], a[120:123]
 s_add_u32 s22, s22, 37748736
 v_exp_f32 v169, v169
 MM a[120:123], a[56:59], v[152:155], a[120:123]
 s_add_u32 s23, s20, s22
 v_exp_f32 v170, v170
 MM a[124:127], a[60:63], v[152:155], a[124:127]
 ds_read_b128 a[192:195], v3 offset:49152
 v_exp_f32 v171, v171
 v_exp_f32 v172, v172
 v_exp_f32 v173, v173
 v_exp_f32 v174, v174
 v_exp_f32 v175, v175
 MM a[124:127], a[28:31], v[144:147], a[124:127]
 v_cvt_pk_bf16_f32 v160, v160, v161
 v_cvt_pk_bf16_f32 v161, v162, v163
 v_cvt_pk_bf16_f32 v162, v164, v165
 v_cvt_pk_bf16_f32 v163, v166, v167
 v_cvt_pk_bf16_f32 v168, v168, v169
 v_cvt_pk_bf16_f32 v169, v170, v171
 v_cvt_pk_bf16_f32 v170, v172, v173
 v_cvt_pk_bf16_f32 v171, v174, v175
 MM v[44:47], v[28:31], v[144:147], v[44:47]
 s_add_u32 s20, s20, s14
 s_mul_i32 s21, s38, 5120
 s_add_u32 s21, s21, s15
 s_add_u32 s37, s24, 1
 s_and_b32 s37, s37, 3
 s_lshl_b32 s37, s37, 10
 v_add_u32 v12, s37, v1
 s_add_u32 s37, s24, 2
 s_and_b32 s37, s37, 3
 s_lshl_b32 s37, s37, 10
 v_add_u32 v13, s37, v1
 s_add_u32 s37, s24, 3
 s_and_b32 s37, s37, 3
 s_lshl_b32 s37, s37, 10
 v_add_u32 v14, s37, v1
 s_add_u32 s37, s24, 4
 s_and_b32 s37, s37, 3
 s_lshl_b32 s37, s37, 10
 v_add_u32 v15, s37, v1
 MM v[44:47], v[28:31], v[152:155], v[44:47]
 s_add_u32 m0, s57, 0
 ds_read_b128 a[224:227], v3 offset:57344
 v_max3_f32 v5, v64, v65, v66
 MM a[92:95], a[252:255], v[168:171], a[92:95]
 buffer_load_dwordx4 v20, s[48:51], s56 offen lds
 MM a[92:95], a[220:223], v[160:163], a[92:95]
 s_add_u32 m0, s57, 1024
 v_exp_f32 v176, v176
 s_waitcnt lgkmcnt(2)
 MM a[88:91], a[216:219], v[160:163], a[88:91]
 buffer_load_dwordx4 v21, s[48:51], s56 offen lds
 MM a[88:91], a[248:251], v[168:171], a[88:91]
 s_add_u32 m0, s57, 2048
 v_exp_f32 v177, v177
 MM a[84:87], a[244:247], v[168:171], a[84:87]
 buffer_load_dwordx4 v17, s[48:51], s56 offen lds
 MM a[84:87], a[212:215], v[160:163], a[84:87]
 v_exp_f32 v178, v178
 MM a[80:83], a[208:211], v[160:163], a[80:83]
 v_exp_f32 v179, v179
 MM a[80:83], a[240:243], v[168:171], a[80:83]
 v_exp_f32 v180, v180
 MM a[76:79], a[236:239], v[168:171], a[76:79]
 v_exp_f32 v181, v181
 MM a[76:79], a[204:207], v[160:163], a[76:79]
 v_exp_f32 v182, v182
 MM a[72:75], a[200:203], v[160:163], a[72:75]
 v_exp_f32 v183, v183
 MM a[72:75], a[232:235], v[168:171], a[72:75]
 v_exp_f32 v184, v184
 MM a[68:71], a[228:231], v[168:171], a[68:71]
 v_exp_f32 v185, v185
 MM a[68:71], a[196:199], v[160:163], a[68:71]
 s_waitcnt vmcnt(3) lgkmcnt(0)
 v_exp_f32 v186, v186
 MM a[64:67], a[192:195], v[160:163], a[64:67]
 s_barrier
 v_exp_f32 v187, v187
 MM a[64:67], a[224:227], v[168:171], a[64:67]
 v_exp_f32 v188, v188
 v_exp_f32 v189, v189
 v_exp_f32 v190, v190
 v_exp_f32 v191, v191
 v_max3_f32 v6, v67, v80, v81
 v_max3_f32 v5, v82, v83, v5
 v_max3_f32 v6, v84, v85, v6
 v_max3_f32 v5, v86, v87, v5
 v_max3_f32 v6, v68, v69, v6
 v_max3_f32 v5, v70, v71, v5
 v_max3_f32 v6, v72, v73, v6
 v_max3_f32 v5, v74, v75, v5
 v_max3_f32 v6, v88, v89, v6
 v_max3_f32 v5, v90, v91, v5
 v_max3_f32 v6, v92, v93, v6
 v_max3_f32 v5, v94, v95, v5
 v_max3_f32 v6, v76, v77, v6
 v_max3_f32 v5, v78, v79, v5
 v_max3_f32 v6, v112, v113, v6
 v_max3_f32 v5, v114, v115, v5
 v_max3_f32 v6, v116, v117, v6
 v_max3_f32 v5, v118, v119, v5
 v_max3_f32 v6, v120, v121, v6
 v_max3_f32 v5, v122, v123, v5
 v_max3_f32 v6, v124, v125, v6
 v_max3_f32 v5, v126, v127, v5
 MM v[40:43], v[28:31], v[168:171], v[40:43]
 v_cvt_pk_bf16_f32 v176, v176, v177
 v_cvt_pk_bf16_f32 v177, v178, v179
 v_cvt_pk_bf16_f32 v178, v180, v181
 v_cvt_pk_bf16_f32 v179, v182, v183
 v_cvt_pk_bf16_f32 v184, v184, v185
 v_cvt_pk_bf16_f32 v185, v186, v187
 v_cvt_pk_bf16_f32 v186, v188, v189
 v_cvt_pk_bf16_f32 v187, v190, v191
 v_mov_b32 v96, v4
 v_mov_b32 v97, v4
 v_mov_b32 v98, v4
 v_mov_b32 v99, v4
 v_mov_b32 v100, v4
 v_mov_b32 v101, v4
 v_mov_b32 v102, v4
 v_mov_b32 v103, v4
 v_mov_b32 v104, v4
 v_mov_b32 v105, v4
 v_mov_b32 v106, v4
 v_mov_b32 v107, v4
 v_mov_b32 v108, v4
 v_mov_b32 v109, v4
 v_mov_b32 v110, v4
 v_mov_b32 v111, v4
 v_max_f32 v5, v5, v6
 v_cmp_lt_f32 vcc, 0x42400000, v5
 MM v[40:43], v[28:31], v[160:163], v[40:43]
 s_cbranch_vccnz b1rrd_r
b1rrd_ok:
k_last:
 MM v[44:47], v[28:31], v[176:179], v[44:47]
 v_xor_b32 v8, s61, v8
 v_xor_b32 v9, s61, v9
 v_xor_b32 v10, s61, v10
 v_xor_b32 v11, s61, v11
 v_or3_b32 v8, v8, v9, v10
 v_or_b32 v8, v8, v11
 v_cmp_ne_u32 vcc, 0, v8
 s_cbranch_vccnz spin4
spun4:
 MM v[44:47], v[28:31], v[184:187], v[44:47]
 s_add_u32 s42, s23, 0
 s_add_u32 s41, s21, 0
 s_add_u32 s40, s20, 0
 MM a[96:99], a[224:227], v[184:187], a[96:99]
 ds_read_b128 a[0:3], v2 offset:32768
 ds_read_b128 a[32:35], v2 offset:40960
 MM a[96:99], a[192:195], v[176:179], a[96:99]
 ds_read_b128 a[36:39], v2 offset:41984
 ds_read_b128 a[4:7], v2 offset:33792
 MM a[100:103], a[196:199], v[176:179], a[100:103]
 buffer_load_dwordx4 a[128:131], v12, s[16:19], s42 offen sc1
 MM a[100:103], a[228:231], v[184:187], a[100:103]
 buffer_load_dwordx4 a[132:135], v1, s[16:19], s41 offen offset:0 sc1
 MM a[104:107], a[232:235], v[184:187], a[104:107]
 v_exp_f32 v64, v64
 MM a[104:107], a[200:203], v[176:179], a[104:107]
 buffer_load_dwordx4 a[136:139], v1, s[16:19], s41 offen offset:1024 sc1
 MM a[108:111], a[204:207], v[176:179], a[108:111]
 buffer_load_dwordx4 a[140:143], v1, s[16:19], s41 offen offset:2048 sc1
 MM a[108:111], a[236:239], v[184:187], a[108:111]
 v_exp_f32 v65, v65
 MM a[112:115], a[240:243], v[184:187], a[112:115]
 buffer_load_dwordx4 a[144:147], v1, s[16:19], s41 offen offset:3072 sc1
 MM a[112:115], a[208:211], v[176:179], a[112:115]
 buffer_load_dwordx4 a[148:151], v27, s[16:19], s41 offen offset:0 sc1
 MM a[116:119], a[212:215], v[176:179], a[116:119]
 v_exp_f32 v66, v66
 MM a[116:119], a[244:247], v[184:187], a[116:119]
 v_exp_f32 v67, v67
 MM a[120:123], a[248:251], v[184:187], a[120:123]
 ds_read_b128 a[8:11], v2 offset:34816
 v_exp_f32 v68, v68
 v_exp_f32 v69, v69
 v_exp_f32 v70, v70
 v_exp_f32 v71, v71
 v_exp_f32 v72, v72
 v_exp_f32 v73, v73
 v_exp_f32 v74, v74
 v_exp_f32 v75, v75
 v_exp_f32 v76, v76
 v_exp_f32 v77, v77
 v_exp_f32 v78, v78
 v_exp_f32 v79, v79
 MM a[120:123], a[216:219], v[176:179], a[120:123]
 buffer_load_dwordx4 a[152:155], v13, s[16:19], s42 offen sc1
 ds_read_b128 a[40:43], v2 offset:43008
 ds_read_b128 a[44:47], v2 offset:44032
 v_cvt_pk_bf16_f32 v64, v64, v65
 v_cvt_pk_bf16_f32 v65, v66, v67
 v_cvt_pk_bf16_f32 v66, v68, v69
 v_cvt_pk_bf16_f32 v67, v70, v71
 v_cvt_pk_bf16_f32 v72, v72, v73
 v_cvt_pk_bf16_f32 v73, v74, v75
 v_cvt_pk_bf16_f32 v74, v76, v77
 v_cvt_pk_bf16_f32 v75, v78, v79
 MM a[124:127], a[220:223], v[176:179], a[124:127]
 buffer_load_dwordx4 a[156:159], v14, s[16:19], s42 offen sc1
 ds_read_b128 a[12:15], v2 offset:35840
 MM a[124:127], a[252:255], v[184:187], a[124:127]
 s_waitcnt lgkmcnt(4)
 ds_read_b128 a[16:19], v2 offset:36864
 ds_read_b128 a[48:51], v2 offset:45056
 MM v[40:43], v[28:31], v[72:75], v[40:43]
 buffer_load_dwordx4 a[160:163], v15, s[16:19], s42 offen sc1
 ds_read_b128 a[52:55], v2 offset:46080
 ds_read_b128 a[20:23], v2 offset:37888
 MM v[40:43], v[28:31], v[64:67], v[40:43]
 buffer_load_dwordx4 a[164:167], v12, s[16:19], s40 offen sc1
 ds_read_b128 a[24:27], v2 offset:38912
 MM a[64:67], a[0:3], v[64:67], a[64:67]
 ds_read_b128 a[56:59], v2 offset:47104
 ds_read_b128 a[60:63], v2 offset:48128
 MM a[64:67], a[32:35], v[72:75], a[64:67]
 buffer_load_dwordx4 a[168:171], v13, s[16:19], s40 offen sc1
 ds_read_b128 a[28:31], v2 offset:39936
 MM a[68:71], a[36:39], v[72:75], a[68:71]
 buffer_load_dwordx4 a[172:175], v14, s[16:19], s40 offen sc1
 MM a[68:71], a[4:7], v[64:67], a[68:71]
 buffer_load_dwordx4 a[176:179], v15, s[16:19], s40 offen sc1
 s_waitcnt lgkmcnt(8)
 MM a[72:75], a[8:11], v[64:67], a[72:75]
 s_add_u32 s88, s23, 4096
 s_add_u32 s87, s21, 5120
 s_add_u32 s43, s20, 4096
 MM a[72:75], a[40:43], v[72:75], a[72:75]
 buffer_load_dwordx4 a[180:183], v12, s[16:19], s88 offen sc1
 MM a[76:79], a[44:47], v[72:75], a[76:79]
 buffer_load_dwordx4 a[184:187], v1, s[16:19], s87 offen offset:0 sc1
 MM a[76:79], a[12:15], v[64:67], a[76:79]
 buffer_load_dwordx4 a[188:191], v1, s[16:19], s87 offen offset:1024 sc1
 s_waitcnt lgkmcnt(1)
 MM a[80:83], a[16:19], v[64:67], a[80:83]
 ds_read_b128 a[192:195], v2 offset:49152
 ds_read_b128 a[224:227], v2 offset:57344
 MM a[80:83], a[48:51], v[72:75], a[80:83]
 buffer_load_dwordx4 v[192:195], v1, s[16:19], s87 offen offset:2048 sc1
 MM a[84:87], a[52:55], v[72:75], a[84:87]
 buffer_load_dwordx4 v[196:199], v1, s[16:19], s87 offen offset:3072 sc1
 MM a[84:87], a[20:23], v[64:67], a[84:87]
 v_exp_f32 v80, v80
 MM a[88:91], a[24:27], v[64:67], a[88:91]
 s_waitcnt lgkmcnt(2)
 v_exp_f32 v81, v81
 v_exp_f32 v82, v82
 v_exp_f32 v83, v83
 v_exp_f32 v84, v84
 v_exp_f32 v85, v85
 v_exp_f32 v86, v86
 v_exp_f32 v87, v87
 v_exp_f32 v88, v88
 v_exp_f32 v89, v89
 v_exp_f32 v90, v90
 v_exp_f32 v91, v91
 v_exp_f32 v92, v92
 v_exp_f32 v93, v93
 v_exp_f32 v94, v94
 v_exp_f32 v95, v95
 MM a[88:91], a[56:59], v[72:75], a[88:91]
 buffer_load_dwordx4 v[200:203], v27, s[16:19], s87 offen offset:0 sc1
 ds_read_b128 a[228:231], v2 offset:58368
 v_cvt_pk_bf16_f32 v80, v80, v81
 v_cvt_pk_bf16_f32 v81, v82, v83
 v_cvt_pk_bf16_f32 v82, v84, v85
 v_cvt_pk_bf16_f32 v83, v86, v87
 v_cvt_pk_bf16_f32 v88, v88, v89
 v_cvt_pk_bf16_f32 v89, v90, v91
 v_cvt_pk_bf16_f32 v90, v92, v93
 v_cvt_pk_bf16_f32 v91, v94, v95
 MM a[92:95], a[60:63], v[72:75], a[92:95]
 buffer_load_dwordx4 v[204:207], v13, s[16:19], s88 offen sc1
 MM a[92:95], a[28:31], v[64:67], a[92:95]
 ds_read_b128 a[196:199], v2 offset:50176
 ds_read_b128 a[200:203], v2 offset:51200
 MM v[44:47], v[28:31], v[80:83], v[44:47]
 buffer_load_dwordx4 v[208:211], v14, s[16:19], s88 offen sc1
 MM v[44:47], v[28:31], v[88:91], v[44:47]
 buffer_load_dwordx4 v[212:215], v15, s[16:19], s88 offen sc1
 MM a[124:127], a[60:63], v[88:91], a[124:127]
 ds_read_b128 a[232:235], v2 offset:59392
 ds_read_b128 a[236:239], v2 offset:60416
 MM a[124:127], a[28:31], v[80:83], a[124:127]
 buffer_load_dwordx4 v[216:219], v12, s[16:19], s43 offen sc1
 MM a[120:123], a[24:27], v[80:83], a[120:123]
 buffer_load_dwordx4 v[220:223], v13, s[16:19], s43 offen sc1
 MM a[120:123], a[56:59], v[88:91], a[120:123]
 ds_read_b128 a[204:207], v2 offset:52224
 ds_read_b128 a[208:211], v2 offset:53248
 MM a[116:119], a[52:55], v[88:91], a[116:119]
 buffer_load_dwordx4 v[224:227], v14, s[16:19], s43 offen sc1
 MM a[116:119], a[20:23], v[80:83], a[116:119]
 buffer_load_dwordx4 v[228:231], v15, s[16:19], s43 offen sc1
 MM a[112:115], a[16:19], v[80:83], a[112:115]
 s_add_u32 s42, s23, 8192
 s_add_u32 s41, s21, 10240
 s_add_u32 s40, s20, 8192
 MM a[112:115], a[48:51], v[88:91], a[112:115]
 buffer_load_dwordx4 v[232:235], v12, s[16:19], s42 offen sc1
 ds_read_b128 a[240:243], v2 offset:61440
 MM a[108:111], a[44:47], v[88:91], a[108:111]
 buffer_load_dwordx4 v[236:239], v1, s[16:19], s41 offen offset:0 sc1
 MM a[108:111], a[12:15], v[80:83], a[108:111]
 ds_read_b128 a[244:247], v2 offset:62464
 ds_read_b128 a[212:215], v2 offset:54272
 MM a[104:107], a[8:11], v[80:83], a[104:107]
 buffer_load_dwordx4 v[240:243], v1, s[16:19], s41 offen offset:1024 sc1
 MM a[104:107], a[40:43], v[88:91], a[104:107]
 buffer_load_dwordx4 v[244:247], v1, s[16:19], s41 offen offset:2048 sc1
 MM a[100:103], a[36:39], v[88:91], a[100:103]
 v_exp_f32 v112, v112
 v_exp_f32 v113, v113
 v_exp_f32 v114, v114
 v_exp_f32 v115, v115
 v_exp_f32 v116, v116
 v_exp_f32 v117, v117
 v_exp_f32 v118, v118
 v_exp_f32 v119, v119
 v_exp_f32 v120, v120
 v_exp_f32 v121, v121
 v_exp_f32 v122, v122
 v_exp_f32 v123, v123
 v_exp_f32 v124, v124
 v_exp_f32 v125, v125
 v_exp_f32 v126, v126
 v_exp_f32 v127, v127
 MM a[100:103], a[4:7], v[80:83], a[100:103]
 buffer_load_dwordx4 v[248:251], v1, s[16:19], s41 offen offset:3072 sc1
 ds_read_b128 a[216:219], v2 offset:55296
 v_cvt_pk_bf16_f32 v112, v112, v113
 v_cvt_pk_bf16_f32 v113, v114, v115
 v_cvt_pk_bf16_f32 v114, v116, v117
 v_cvt_pk_bf16_f32 v115, v118, v119
 v_cvt_pk_bf16_f32 v120, v120, v121
 v_cvt_pk_bf16_f32 v121, v122, v123
 v_cvt_pk_bf16_f32 v122, v124, v125
 v_cvt_pk_bf16_f32 v123, v126, v127
 MM a[96:99], a[0:3], v[80:83], a[96:99]
 buffer_load_dwordx4 v[252:255], v27, s[16:19], s41 offen offset:0 sc1
 ds_read_b128 a[248:251], v2 offset:63488
 MM a[96:99], a[32:35], v[88:91], a[96:99]
 ds_read_b128 a[252:255], v2 offset:64512
 ds_read_b128 a[220:223], v2 offset:56320
 MM v[44:47], v[28:31], v[120:123], v[44:47]
 v_rcp_f32 v42, v40
 MM v[44:47], v[28:31], v[112:115], v[44:47]
 s_waitcnt lgkmcnt(4)
 v_rcp_f32 v43, v40
 MM a[96:99], a[192:195], v[112:115], a[96:99]
 v_accvgpr_read_b32 v128, a64
 v_accvgpr_read_b32 v129, a65
 MM a[96:99], a[224:227], v[120:123], a[96:99]
 v_accvgpr_read_b32 v130, a66
 v_accvgpr_read_b32 v131, a67
 MM a[100:103], a[228:231], v[120:123], a[100:103]
 v_accvgpr_read_b32 v132, a68
 v_accvgpr_read_b32 v133, a69
 MM a[100:103], a[196:199], v[112:115], a[100:103]
 v_accvgpr_read_b32 v134, a70
 v_accvgpr_read_b32 v135, a71
 MM a[104:107], a[200:203], v[112:115], a[104:107]
 v_pk_mul_f32 v[128:129], v[128:129], v[42:43]
 v_pk_mul_f32 v[130:131], v[130:131], v[42:43]
 MM a[104:107], a[232:235], v[120:123], a[104:107]
 v_pk_mul_f32 v[132:133], v[132:133], v[42:43]
 v_pk_mul_f32 v[134:135], v[134:135], v[42:43]
 MM a[108:111], a[236:239], v[120:123], a[108:111]
 v_cvt_pk_bf16_f32 v128, v128, v129
 v_cvt_pk_bf16_f32 v129, v130, v131
 MM a[108:111], a[204:207], v[112:115], a[108:111]
 v_cvt_pk_bf16_f32 v130, v132, v133
 v_cvt_pk_bf16_f32 v131, v134, v135
 MM a[112:115], a[208:211], v[112:115], a[112:115]
 s_add_u32 s62, s34, 0
 v_accvgpr_read_b32 v136, a72
 v_accvgpr_read_b32 v137, a73
 MM a[112:115], a[240:243], v[120:123], a[112:115]
 s_waitcnt lgkmcnt(0)
 v_accvgpr_read_b32 v138, a74
 v_accvgpr_read_b32 v139, a75
 v_accvgpr_read_b32 v140, a76
 v_accvgpr_read_b32 v141, a77
 v_accvgpr_read_b32 v142, a78
 v_accvgpr_read_b32 v143, a79
 v_pk_mul_f32 v[136:137], v[136:137], v[42:43]
 v_pk_mul_f32 v[138:139], v[138:139], v[42:43]
 v_pk_mul_f32 v[140:141], v[140:141], v[42:43]
 v_pk_mul_f32 v[142:143], v[142:143], v[42:43]
 v_cvt_pk_bf16_f32 v136, v136, v137
 v_cvt_pk_bf16_f32 v137, v138, v139
 v_cvt_pk_bf16_f32 v138, v140, v141
 v_cvt_pk_bf16_f32 v139, v142, v143
 MM a[116:119], a[244:247], v[120:123], a[116:119]
 buffer_store_dwordx4 v[128:131], v1, s[16:19], s62 offen sc1
 s_add_u32 s62, s34, 4096
 v_accvgpr_read_b32 v144, a80
 v_accvgpr_read_b32 v145, a81
 v_accvgpr_read_b32 v146, a82
 v_accvgpr_read_b32 v147, a83
 v_accvgpr_read_b32 v148, a84
 v_accvgpr_read_b32 v149, a85
 v_accvgpr_read_b32 v150, a86
 v_accvgpr_read_b32 v151, a87
 v_pk_mul_f32 v[144:145], v[144:145], v[42:43]
 v_pk_mul_f32 v[146:147], v[146:147], v[42:43]
 v_pk_mul_f32 v[148:149], v[148:149], v[42:43]
 v_pk_mul_f32 v[150:151], v[150:151], v[42:43]
 v_cvt_pk_bf16_f32 v144, v144, v145
 v_cvt_pk_bf16_f32 v145, v146, v147
 v_cvt_pk_bf16_f32 v146, v148, v149
 v_cvt_pk_bf16_f32 v147, v150, v151
 MM a[116:119], a[212:215], v[112:115], a[116:119]
 buffer_store_dwordx4 v[136:139], v1, s[16:19], s62 offen sc1
 s_add_u32 s62, s34, 8192
 v_accvgpr_read_b32 v152, a88
 v_accvgpr_read_b32 v153, a89
 v_accvgpr_read_b32 v154, a90
 v_accvgpr_read_b32 v155, a91
 v_accvgpr_read_b32 v156, a92
 v_accvgpr_read_b32 v157, a93
 v_accvgpr_read_b32 v158, a94
 v_accvgpr_read_b32 v159, a95
 v_pk_mul_f32 v[152:153], v[152:153], v[42:43]
 v_pk_mul_f32 v[154:155], v[154:155], v[42:43]
 v_pk_mul_f32 v[156:157], v[156:157], v[42:43]
 v_pk_mul_f32 v[158:159], v[158:159], v[42:43]
 v_cvt_pk_bf16_f32 v152, v152, v153
 v_cvt_pk_bf16_f32 v153, v154, v155
 v_cvt_pk_bf16_f32 v154, v156, v157
 v_cvt_pk_bf16_f32 v155, v158, v159
 v_rcp_f32 v46, v44
 v_rcp_f32 v47, v44
 MM a[120:123], a[216:219], v[112:115], a[120:123]
 buffer_store_dwordx4 v[144:147], v1, s[16:19], s62 offen sc1
 s_add_u32 s62, s34, 12288
 v_accvgpr_read_b32 v160, a96
 v_accvgpr_read_b32 v161, a97
 v_accvgpr_read_b32 v162, a98
 v_accvgpr_read_b32 v163, a99
 v_accvgpr_read_b32 v164, a100
 v_accvgpr_read_b32 v165, a101
 v_accvgpr_read_b32 v166, a102
 v_accvgpr_read_b32 v167, a103
 v_pk_mul_f32 v[160:161], v[160:161], v[46:47]
 v_pk_mul_f32 v[162:163], v[162:163], v[46:47]
 v_pk_mul_f32 v[164:165], v[164:165], v[46:47]
 v_pk_mul_f32 v[166:167], v[166:167], v[46:47]
 v_cvt_pk_bf16_f32 v160, v160, v161
 v_cvt_pk_bf16_f32 v161, v162, v163
 v_cvt_pk_bf16_f32 v162, v164, v165
 v_cvt_pk_bf16_f32 v163, v166, v167
 MM a[120:123], a[248:251], v[120:123], a[120:123]
 buffer_store_dwordx4 v[152:155], v1, s[16:19], s62 offen sc1
 s_add_u32 s62, s35, 0
 v_accvgpr_read_b32 v168, a104
 v_accvgpr_read_b32 v169, a105
 v_accvgpr_read_b32 v170, a106
 v_accvgpr_read_b32 v171, a107
 v_accvgpr_read_b32 v172, a108
 v_accvgpr_read_b32 v173, a109
 v_accvgpr_read_b32 v174, a110
 v_accvgpr_read_b32 v175, a111
 v_pk_mul_f32 v[168:169], v[168:169], v[46:47]
 v_pk_mul_f32 v[170:171], v[170:171], v[46:47]
 v_pk_mul_f32 v[172:173], v[172:173], v[46:47]
 v_pk_mul_f32 v[174:175], v[174:175], v[46:47]
 v_cvt_pk_bf16_f32 v168, v168, v169
 v_cvt_pk_bf16_f32 v169, v170, v171
 v_cvt_pk_bf16_f32 v170, v172, v173
 v_cvt_pk_bf16_f32 v171, v174, v175
 MM a[124:127], a[252:255], v[120:123], a[124:127]
 buffer_store_dwordx4 v[160:163], v1, s[16:19], s62 offen sc1
 s_add_u32 s62, s35, 4096
 MM a[124:127], a[220:223], v[112:115], a[124:127]
 buffer_store_dwordx4 v[168:171], v1, s[16:19], s62 offen sc1
 v_accvgpr_read_b32 v128, a112
 v_accvgpr_read_b32 v129, a113
 v_accvgpr_read_b32 v130, a114
 v_accvgpr_read_b32 v131, a115
 v_accvgpr_read_b32 v132, a116
 v_accvgpr_read_b32 v133, a117
 v_accvgpr_read_b32 v134, a118
 v_accvgpr_read_b32 v135, a119
 v_pk_mul_f32 v[128:129], v[128:129], v[46:47]
 v_pk_mul_f32 v[130:131], v[130:131], v[46:47]
 v_pk_mul_f32 v[132:133], v[132:133], v[46:47]
 v_pk_mul_f32 v[134:135], v[134:135], v[46:47]
 v_cvt_pk_bf16_f32 v128, v128, v129
 v_cvt_pk_bf16_f32 v129, v130, v131
 v_cvt_pk_bf16_f32 v130, v132, v133
 v_cvt_pk_bf16_f32 v131, v134, v135
 s_add_u32 s62, s35, 8192
 buffer_store_dwordx4 v[128:131], v1, s[16:19], s62 offen sc1
 v_accvgpr_read_b32 v136, a120
 v_accvgpr_read_b32 v137, a121
 v_accvgpr_read_b32 v138, a122
 v_accvgpr_read_b32 v139, a123
 v_accvgpr_read_b32 v140, a124
 v_accvgpr_read_b32 v141, a125
 v_accvgpr_read_b32 v142, a126
 v_accvgpr_read_b32 v143, a127
 v_pk_mul_f32 v[136:137], v[136:137], v[46:47]
 v_pk_mul_f32 v[138:139], v[138:139], v[46:47]
 v_pk_mul_f32 v[140:141], v[140:141], v[46:47]
 v_pk_mul_f32 v[142:143], v[142:143], v[46:47]
 v_cvt_pk_bf16_f32 v136, v136, v137
 v_cvt_pk_bf16_f32 v137, v138, v139
 v_cvt_pk_bf16_f32 v138, v140, v141
 v_cvt_pk_bf16_f32 v139, v142, v143
 s_add_u32 s62, s35, 12288
 buffer_store_dwordx4 v[136:139], v1, s[16:19], s62 offen sc1
 s_waitcnt vmcnt(38)
 MM a[48:51], a[132:135], a[128:131], 0
 buffer_load_dwordx4 a[0:3], v13, s[16:19], s42 offen sc1
 s_waitcnt vmcnt(38)
 MM a[52:55], a[136:139], a[128:131], 0
 buffer_load_dwordx4 a[4:7], v14, s[16:19], s42 offen sc1
 s_waitcnt vmcnt(38)
 MM a[56:59], a[140:143], a[128:131], 0
 s_and_b32 s3, s2, 31
 s_lshl_b32 s3, s3, 2
 s_lshl_b32 s39, s26, 8
 s_waitcnt vmcnt(37)
 MM a[60:63], a[144:147], a[128:131], 0
 s_add_u32 s3, s3, s39
 s_add_u32 s3, s3, 70647808
 s_add_u32 s3, s3, s100
 s_waitcnt vmcnt(36)
 MM a[64:67], a[148:151], a[128:131], 0
 s_waitcnt vmcnt(35)
 v_mov_b32 v6, s61
 v_lshlrev_b32 v11, 7, v1
 MM a[84:87], a[148:151], a[152:155], 0
 buffer_load_dwordx4 a[8:11], v15, s[16:19], s42 offen sc1
 MM a[80:83], a[144:147], a[152:155], 0
 buffer_load_dwordx4 a[12:15], v12, s[16:19], s40 offen sc1
 MM a[76:79], a[140:143], a[152:155], 0
 buffer_load_dwordx4 a[16:19], v13, s[16:19], s40 offen sc1
 MM a[72:75], a[136:139], a[152:155], 0
 buffer_load_dwordx4 a[20:23], v14, s[16:19], s40 offen sc1
 MM a[68:71], a[132:135], a[152:155], 0
 buffer_load_dwordx4 a[24:27], v15, s[16:19], s40 offen sc1
 s_waitcnt vmcnt(39)
 MM a[88:91], a[132:135], a[156:159], 0
 s_waitcnt vmcnt(7)
 s_barrier
 v_mov_b32 v2, v27
 MM a[92:95], a[136:139], a[156:159], 0
 s_mov_b64 exec, 0xffff
 buffer_store_dword v6, v11, s[16:19], s3 offen sc1
 s_mov_b64 exec, -1
 MM a[96:99], a[140:143], a[156:159], 0
 s_add_u32 s88, s23, 12288
 s_add_u32 s87, s21, 15360
 s_add_u32 s43, s20, 12288
 MM a[100:103], a[144:147], a[156:159], 0
 buffer_load_dwordx4 a[28:31], v12, s[16:19], s88 offen sc1
 MM a[104:107], a[148:151], a[156:159], 0
 buffer_load_dwordx4 a[32:35], v1, s[16:19], s87 offen offset:0 sc1
 MM a[124:127], a[148:151], a[160:163], 0
 buffer_load_dwordx4 a[36:39], v1, s[16:19], s87 offen offset:1024 sc1
 MM a[120:123], a[144:147], a[160:163], 0
 buffer_load_dwordx4 a[40:43], v1, s[16:19], s87 offen offset:2048 sc1
 MM a[116:119], a[140:143], a[160:163], 0
 s_add_u32 s70, s20, 24576
 s_add_u32 s71, s21, 30720
 s_add_u32 s93, s23, 24576
 MM a[112:115], a[136:139], a[160:163], 0
 buffer_load_dwordx4 a[44:47], v1, s[16:19], s87 offen offset:3072 sc1
 MM a[108:111], a[132:135], a[160:163], 0
 s_cmp_ge_u32 s24, 3
 s_cselect_b32 s70, 2130706432, s70
 s_cselect_b32 s71, 2130706432, s71
 s_cselect_b32 s93, 2130706432, s93
 MM v[104:107], a[132:135], a[164:167], 0
 buffer_load_dwordx4 a[192:195], v2, s[16:19], s87 offen offset:0 sc1
 MM v[108:111], a[136:139], a[164:167], 0
 s_bfe_u32 s36, s2, 0x10002
 s_lshl_b32 s36, s36, 2
 s_add_u32 s36, s36, s24
 MM v[112:115], a[140:143], a[164:167], 0
 buffer_load_dwordx4 a[196:199], v13, s[16:19], s88 offen sc1
 MM v[116:119], a[144:147], a[164:167], 0
 s_mul_i32 s36, s36, 14
 s_lshl_b32 s37, s36, 12
 s_add_u32 s84, s14, s37
 MM v[120:123], a[148:151], a[164:167], 0
 s_add_u32 s22, s22, s37
 s_mul_i32 s37, s36, 5120
 s_add_u32 s86, s15, s37
 MM v[140:143], a[148:151], a[168:171], 0
 s_mul_i32 s36, s24, 4
 s_add_u32 s36, s36, 112
 s_lshl_b32 s37, s36, 12
 MM v[136:139], a[144:147], a[168:171], 0
 s_add_u32 s14, s14, s37
 s_mul_i32 s37, s36, 5120
 s_add_u32 s15, s15, s37
 MM v[132:135], a[140:143], a[168:171], 0
 s_mov_b32 s54, 2621440
 s_mov_b32 s55, 0x20000
 s_mul_i32 s36, s24, 15360
 MM v[128:131], a[136:139], a[168:171], 0
 v_add_u32 v7, s36, v1
 v_bfe_u32 v8, v1, 4, 4
 MM v[124:127], a[132:135], a[168:171], 0
 v_mul_u32_u24 v5, 160, v8
 v_lshrrev_b32 v8, 8, v1
 MM v[144:147], a[132:135], a[172:175], 0
 buffer_load_dwordx4 a[200:203], v14, s[16:19], s88 offen sc1
 MM v[148:151], a[136:139], a[172:175], 0
 v_lshl_add_u32 v5, v8, 3, v5
 v_add_u32 v5, s57, v5
 MM v[152:155], a[140:143], a[172:175], 0
 s_mul_i32 s36, s24, 20480
 s_add_u32 s36, s36, 61440
 MM v[156:159], a[144:147], a[172:175], 0
 v_add_u32 v22, s36, v1
 MM v[160:163], a[148:151], a[172:175], 0
 v_add_u32 v9, 61440, v1
 MM v[180:183], a[148:151], a[176:179], 0
 v_lshrrev_b32 v8, 10, v12
 MM v[176:179], a[144:147], a[176:179], 0
 v_mul_u32_u24 v19, 20480, v8
 MM v[172:175], a[140:143], a[176:179], 0
 v_add_u32 v19, v19, v9
 MM v[168:171], a[136:139], a[176:179], 0
 v_mul_u32_u24 v8, 15360, v8
 MM v[164:167], a[132:135], a[176:179], 0
 v_add_u32 v16, v8, v1
 MM a[48:51], a[184:187], a[180:183], a[48:51]
 v_lshrrev_b32 v8, 10, v13
 MM a[48:51], v[236:239], v[232:235], a[48:51]
 buffer_load_dwordx4 a[204:207], v15, s[16:19], s88 offen sc1
 MM a[52:55], v[240:243], v[232:235], a[52:55]
 v_mul_u32_u24 v10, 20480, v8
 v_add_u32 v10, v10, v9
 MM a[52:55], a[188:191], a[180:183], a[52:55]
 v_mul_u32_u24 v8, 15360, v8
 MM a[56:59], v[192:195], a[180:183], a[56:59]
 v_add_u32 v3, v8, v1
 MM a[56:59], v[244:247], v[232:235], a[56:59]
 v_lshrrev_b32 v8, 10, v14
 MM a[60:63], v[248:251], v[232:235], a[60:63]
 v_mul_u32_u24 v23, 20480, v8
 MM a[60:63], v[196:199], a[180:183], a[60:63]
 v_add_u32 v23, v23, v9
 MM a[64:67], v[200:203], a[180:183], a[64:67]
 v_mul_u32_u24 v8, 15360, v8
 MM a[64:67], v[252:255], v[232:235], a[64:67]
 s_waitcnt vmcnt(16)
 v_add_u32 v18, v8, v1
 MM a[84:87], v[252:255], a[0:3], a[84:87]
 buffer_load_dwordx4 a[208:211], v12, s[16:19], s43 offen sc1
 MM a[84:87], v[200:203], v[204:207], a[84:87]
 v_lshrrev_b32 v8, 10, v15
 v_mul_u32_u24 v0, 20480, v8
 MM a[80:83], v[196:199], v[204:207], a[80:83]
 v_add_u32 v0, v0, v9
 MM a[80:83], v[248:251], a[0:3], a[80:83]
 s_lshr_b32 s36, s12, 1
 MM a[76:79], v[244:247], a[0:3], a[76:79]
 s_sub_u32 s37, 15, s36
 MM a[76:79], v[192:195], v[204:207], a[76:79]
 s_min_u32 s36, s36, s37
 MM a[72:75], a[188:191], v[204:207], a[72:75]
 s_lshl_b32 s36, s36, 8
 MM a[72:75], v[240:243], a[0:3], a[72:75]
 s_add_u32 s36, s36, 70647808
 MM a[68:71], v[236:239], a[0:3], a[68:71]
 s_and_b32 s37, s13, 3
 MM a[68:71], a[184:187], v[204:207], a[68:71]
 s_lshl_b32 s37, s37, 2
 MM a[88:91], a[184:187], v[208:211], a[88:91]
 s_waitcnt vmcnt(16)
 s_add_u32 s37, s37, s24
 MM a[88:91], v[236:239], a[4:7], a[88:91]
 buffer_load_dwordx4 a[212:215], v13, s[16:19], s43 offen sc1
 MM a[92:95], v[240:243], a[4:7], a[92:95]
 s_lshl_b32 s37, s37, 11
 s_add_u32 s36, s36, s37
 MM a[92:95], a[188:191], v[208:211], a[92:95]
 v_bfe_u32 v8, v1, 2, 7
 MM a[96:99], v[192:195], v[208:211], a[96:99]
 v_add_u32 v4, s36, v8
 MM a[96:99], v[244:247], a[4:7], a[96:99]
 s_lshl_b32 s89, s2, 2
 MM a[100:103], v[248:251], a[4:7], a[100:103]
 s_add_u32 s89, s89, s24
 MM a[100:103], v[196:199], v[208:211], a[100:103]
 s_mul_i32 s89, s89, 5120
 MM a[104:107], v[200:203], v[208:211], a[104:107]
 s_add_u32 s89, s89, 71303168
 MM a[104:107], v[252:255], a[4:7], a[104:107]
 s_waitcnt vmcnt(16)
 s_xor_b32 s90, s2, 4
 MM a[124:127], v[252:255], a[8:11], a[124:127]
 buffer_load_dwordx4 a[216:219], v14, s[16:19], s43 offen sc1
 MM a[124:127], v[200:203], v[212:215], a[124:127]
 s_lshl_b32 s91, s90, 4
 s_add_u32 s91, s91, s24
 MM a[120:123], v[196:199], v[212:215], a[120:123]
 s_lshl_b32 s91, s91, 3
 MM a[120:123], v[248:251], a[8:11], a[120:123]
 s_add_u32 s91, s91, 70746112
 MM a[116:119], v[244:247], a[8:11], a[116:119]
 s_lshl_b32 s90, s90, 2
 MM a[116:119], v[192:195], v[212:215], a[116:119]
 s_add_u32 s90, s90, s24
 MM a[112:115], a[188:191], v[212:215], a[112:115]
 s_mul_i32 s90, s90, 5120
 MM a[112:115], v[240:243], a[8:11], a[112:115]
 s_add_u32 s90, s90, 71303168
 MM a[108:111], v[236:239], a[8:11], a[108:111]
 s_add_u32 s94, s89, 5242880
 MM a[108:111], a[184:187], v[212:215], a[108:111]
 s_add_u32 s95, s90, 5242880
 MM v[104:107], a[184:187], v[216:219], v[104:107]
 s_waitcnt vmcnt(16)
 MM v[104:107], v[236:239], a[12:15], v[104:107]
 buffer_load_dwordx4 a[220:223], v15, s[16:19], s43 offen sc1
 MM v[108:111], v[240:243], a[12:15], v[108:111]
 s_add_u32 s42, s23, 16384
 s_add_u32 s41, s21, 20480
 s_add_u32 s40, s20, 16384
 MM v[108:111], a[188:191], v[216:219], v[108:111]
 buffer_load_dwordx4 a[224:227], v12, s[16:19], s42 offen sc1
 MM v[112:115], v[192:195], v[216:219], v[112:115]
 MM v[112:115], v[244:247], a[12:15], v[112:115]
 buffer_load_dwordx4 a[228:231], v1, s[16:19], s41 offen offset:0 sc1
 MM v[116:119], v[248:251], a[12:15], v[116:119]
 MM v[116:119], v[196:199], v[216:219], v[116:119]
 buffer_load_dwordx4 a[232:235], v1, s[16:19], s41 offen offset:1024 sc1
 MM v[120:123], v[200:203], v[216:219], v[120:123]
 s_waitcnt vmcnt(19)
 MM v[120:123], v[252:255], a[12:15], v[120:123]
 buffer_load_dwordx4 a[236:239], v1, s[16:19], s41 offen offset:2048 sc1
 MM v[140:143], v[252:255], a[16:19], v[140:143]
 MM v[140:143], v[200:203], v[220:223], v[140:143]
 buffer_load_dwordx4 a[240:243], v1, s[16:19], s41 offen offset:3072 sc1
 MM v[136:139], v[196:199], v[220:223], v[136:139]
 MM v[136:139], v[248:251], a[16:19], v[136:139]
 buffer_load_dwordx4 a[244:247], v2, s[16:19], s41 offen offset:0 sc1
 MM v[132:135], v[244:247], a[16:19], v[132:135]
 MM v[132:135], v[192:195], v[220:223], v[132:135]
 buffer_load_dwordx4 a[248:251], v13, s[16:19], s42 offen sc1
 MM v[128:131], a[188:191], v[220:223], v[128:131]
 MM v[128:131], v[240:243], a[16:19], v[128:131]
 buffer_load_dwordx4 a[252:255], v14, s[16:19], s42 offen sc1
 MM v[124:127], v[236:239], a[16:19], v[124:127]
 MM v[124:127], a[184:187], v[220:223], v[124:127]
 buffer_load_dwordx4 v[184:187], v15, s[16:19], s42 offen sc1
 MM v[144:147], a[184:187], v[224:227], v[144:147]
 s_waitcnt vmcnt(24)
 MM v[144:147], v[236:239], a[20:23], v[144:147]
 buffer_load_dwordx4 v[188:191], v12, s[16:19], s40 offen sc1
 MM v[148:151], v[240:243], a[20:23], v[148:151]
 MM v[148:151], a[188:191], v[224:227], v[148:151]
 buffer_load_dwordx4 a[128:131], v13, s[16:19], s40 offen sc1
 MM v[152:155], v[192:195], v[224:227], v[152:155]
 MM v[152:155], v[244:247], a[20:23], v[152:155]
 buffer_load_dwordx4 a[132:135], v14, s[16:19], s40 offen sc1
 MM v[156:159], v[248:251], a[20:23], v[156:159]
 MM v[156:159], v[196:199], v[224:227], v[156:159]
 buffer_load_dwordx4 a[136:139], v15, s[16:19], s40 offen sc1
 MM v[160:163], v[200:203], v[224:227], v[160:163]
 s_add_u32 s88, s23, 20480
 s_add_u32 s87, s21, 25600
 s_add_u32 s43, s20, 20480
 MM v[160:163], v[252:255], a[20:23], v[160:163]
 buffer_load_dwordx4 a[140:143], v12, s[16:19], s88 offen sc1
 s_waitcnt vmcnt(28)
 MM v[180:183], v[252:255], a[24:27], v[180:183]
 MM v[180:183], v[200:203], v[228:231], v[180:183]
 buffer_load_dwordx4 a[144:147], v1, s[16:19], s87 offen offset:0 sc1
 MM v[176:179], v[196:199], v[228:231], v[176:179]
 MM v[176:179], v[248:251], a[24:27], v[176:179]
 buffer_load_dwordx4 a[148:151], v1, s[16:19], s87 offen offset:1024 sc1
 MM v[172:175], v[244:247], a[24:27], v[172:175]
 MM v[172:175], v[192:195], v[228:231], v[172:175]
 buffer_load_dwordx4 a[152:155], v1, s[16:19], s87 offen offset:2048 sc1
 MM v[168:171], a[188:191], v[228:231], v[168:171]
 MM v[168:171], v[240:243], a[24:27], v[168:171]
 buffer_load_dwordx4 a[156:159], v1, s[16:19], s87 offen offset:3072 sc1
 MM v[164:167], v[236:239], a[24:27], v[164:167]
 s_waitcnt vmcnt(29)
 MM v[164:167], a[184:187], v[228:231], v[164:167]
 buffer_load_dwordx4 a[160:163], v2, s[16:19], s87 offen offset:0 sc1
 MM a[48:51], a[32:35], a[28:31], a[48:51]
 s_waitcnt vmcnt(16)
 s_waitcnt vmcnt(17)
 MM a[48:51], a[228:231], a[224:227], a[48:51]
 buffer_load_dwordx4 a[164:167], v13, s[16:19], s88 offen sc1
 MM a[52:55], a[232:235], a[224:227], a[52:55]
 MM a[52:55], a[36:39], a[28:31], a[52:55]
 buffer_load_dwordx4 a[168:171], v14, s[16:19], s88 offen sc1
 MM a[56:59], a[40:43], a[28:31], a[56:59]
 s_waitcnt vmcnt(16)
 s_waitcnt vmcnt(17)
 MM a[56:59], a[236:239], a[224:227], a[56:59]
 buffer_load_dwordx4 a[172:175], v15, s[16:19], s88 offen sc1
 MM a[60:63], a[240:243], a[224:227], a[60:63]
 MM a[60:63], a[44:47], a[28:31], a[60:63]
 MM a[64:67], a[192:195], a[28:31], a[64:67]
 s_waitcnt vmcnt(16)
 MM a[64:67], a[244:247], a[224:227], a[64:67]
 s_waitcnt vmcnt(15)
 MM a[84:87], a[244:247], a[248:251], a[84:87]
 buffer_load_dwordx4 a[176:179], v12, s[16:19], s43 offen sc1
 MM a[84:87], a[192:195], a[196:199], a[84:87]
 MM a[80:83], a[44:47], a[196:199], a[80:83]
 MM a[80:83], a[240:243], a[248:251], a[80:83]
 MM a[76:79], a[236:239], a[248:251], a[76:79]
 MM a[76:79], a[40:43], a[196:199], a[76:79]
 MM a[72:75], a[36:39], a[196:199], a[72:75]
 MM a[72:75], a[232:235], a[248:251], a[72:75]
 MM a[68:71], a[228:231], a[248:251], a[68:71]
 MM a[68:71], a[32:35], a[196:199], a[68:71]
 MM a[88:91], a[32:35], a[200:203], a[88:91]
 s_waitcnt vmcnt(15)
 MM a[88:91], a[228:231], a[252:255], a[88:91]
 buffer_load_dwordx4 a[180:183], v13, s[16:19], s43 offen sc1
 MM a[92:95], a[232:235], a[252:255], a[92:95]
 MM a[92:95], a[36:39], a[200:203], a[92:95]
 MM a[96:99], a[40:43], a[200:203], a[96:99]
 MM a[96:99], a[236:239], a[252:255], a[96:99]
 MM a[100:103], a[240:243], a[252:255], a[100:103]
 MM a[100:103], a[44:47], a[200:203], a[100:103]
 MM a[104:107], a[192:195], a[200:203], a[104:107]
 MM a[104:107], a[244:247], a[252:255], a[104:107]
 s_waitcnt vmcnt(15)
 MM a[124:127], a[244:247], v[184:187], a[124:127]
 buffer_load_dwordx4 a[184:187], v14, s[16:19], s43 offen sc1
 MM a[124:127], a[192:195], a[204:207], a[124:127]
 MM a[120:123], a[44:47], a[204:207], a[120:123]
 MM a[120:123], a[240:243], v[184:187], a[120:123]
 MM a[116:119], a[236:239], v[184:187], a[116:119]
 MM a[116:119], a[40:43], a[204:207], a[116:119]
 MM a[112:115], a[36:39], a[204:207], a[112:115]
 MM a[112:115], a[232:235], v[184:187], a[112:115]
 MM a[108:111], a[228:231], v[184:187], a[108:111]
 MM a[108:111], a[32:35], a[204:207], a[108:111]
 MM v[104:107], a[32:35], a[208:211], v[104:107]
 s_waitcnt vmcnt(15)
 MM v[104:107], a[228:231], v[188:191], v[104:107]
 buffer_load_dwordx4 a[188:191], v15, s[16:19], s43 offen sc1
 MM v[108:111], a[232:235], v[188:191], v[108:111]
 MM v[108:111], a[36:39], a[208:211], v[108:111]
 buffer_load_dwordx4 v[192:195], v12, s[16:19], s93 offen sc1
 MM v[112:115], a[40:43], a[208:211], v[112:115]
 MM v[112:115], a[236:239], v[188:191], v[112:115]
 buffer_load_dwordx4 v[196:199], v1, s[16:19], s71 offen offset:0 sc1
 MM v[116:119], a[240:243], v[188:191], v[116:119]
 MM v[116:119], a[44:47], a[208:211], v[116:119]
 buffer_load_dwordx4 v[200:203], v1, s[16:19], s71 offen offset:1024 sc1
 MM v[120:123], a[192:195], a[208:211], v[120:123]
 s_waitcnt vmcnt(18)
 MM v[120:123], a[244:247], v[188:191], v[120:123]
 buffer_load_dwordx4 v[204:207], v1, s[16:19], s71 offen offset:2048 sc1
 MM v[140:143], a[244:247], a[128:131], v[140:143]
 MM v[140:143], a[192:195], a[212:215], v[140:143]
 buffer_load_dwordx4 v[208:211], v1, s[16:19], s71 offen offset:3072 sc1
 MM v[136:139], a[44:47], a[212:215], v[136:139]
 MM v[136:139], a[240:243], a[128:131], v[136:139]
 buffer_load_dwordx4 v[212:215], v2, s[16:19], s71 offen offset:0 sc1
 MM v[132:135], a[236:239], a[128:131], v[132:135]
 buffer_load_dword v6, v4, s[16:19], 0 offen sc1
 MM v[132:135], a[40:43], a[212:215], v[132:135]
 buffer_load_dwordx4 v[216:219], v13, s[16:19], s93 offen sc1
 MM v[128:131], a[36:39], a[212:215], v[128:131]
 MM v[128:131], a[232:235], a[128:131], v[128:131]
 buffer_load_dwordx4 v[220:223], v14, s[16:19], s93 offen sc1
 MM v[124:127], a[228:231], a[128:131], v[124:127]
 MM v[124:127], a[32:35], a[212:215], v[124:127]
 buffer_load_dwordx4 v[224:227], v15, s[16:19], s93 offen sc1
 MM v[144:147], a[32:35], a[216:219], v[144:147]
 s_waitcnt vmcnt(24)
 MM v[144:147], a[228:231], a[132:135], v[144:147]
 buffer_load_dwordx4 v[228:231], v12, s[16:19], s70 offen sc1
 MM v[148:151], a[232:235], a[132:135], v[148:151]
 MM v[148:151], a[36:39], a[216:219], v[148:151]
 buffer_load_dwordx4 v[232:235], v13, s[16:19], s70 offen sc1
 MM v[152:155], a[40:43], a[216:219], v[152:155]
 MM v[152:155], a[236:239], a[132:135], v[152:155]
 buffer_load_dwordx4 v[236:239], v14, s[16:19], s70 offen sc1
 MM v[156:159], a[240:243], a[132:135], v[156:159]
 MM v[156:159], a[44:47], a[216:219], v[156:159]
 buffer_load_dwordx4 v[240:243], v15, s[16:19], s70 offen sc1
 MM v[160:163], a[192:195], a[216:219], v[160:163]
 MM v[160:163], a[244:247], a[132:135], v[160:163]
 s_waitcnt vmcnt(27)
 MM v[180:183], a[244:247], a[136:139], v[180:183]
 MM v[180:183], a[192:195], a[220:223], v[180:183]
 MM v[176:179], a[44:47], a[220:223], v[176:179]
 MM v[176:179], a[240:243], a[136:139], v[176:179]
 MM v[172:175], a[236:239], a[136:139], v[172:175]
 MM v[172:175], a[40:43], a[220:223], v[172:175]
 MM v[168:171], a[36:39], a[220:223], v[168:171]
 MM v[168:171], a[232:235], a[136:139], v[168:171]
 MM v[164:167], a[228:231], a[136:139], v[164:167]
 MM v[164:167], a[32:35], a[220:223], v[164:167]
 s_waitcnt vmcnt(25)
 MM a[48:51], a[144:147], a[140:143], a[48:51]
 s_waitcnt vmcnt(7)
 v_cmp_ne_u32 vcc, s61, v6
 s_cbranch_vccnz spin5
spun5:
 MM a[48:51], v[196:199], v[192:195], a[48:51]
 s_add_u32 s88, s22, 0
 s_add_u32 s87, s86, 0
 s_add_u32 s43, s84, 0
 MM a[52:55], v[200:203], v[192:195], a[52:55]
 MM a[52:55], a[148:151], a[140:143], a[52:55]
 MM a[56:59], a[152:155], a[140:143], a[56:59]
 MM a[56:59], v[204:207], v[192:195], a[56:59]
 MM a[60:63], v[208:211], v[192:195], a[60:63]
 buffer_load_dwordx4 v[244:247], v12, s[16:19], s43 offen sc1
 MM a[60:63], a[156:159], a[140:143], a[60:63]
 MM a[64:67], a[160:163], a[140:143], a[64:67]
 buffer_load_dwordx4 v[248:251], v1, s[16:19], s87 offen offset:0 sc1
 MM a[64:67], v[212:215], v[192:195], a[64:67]
 s_waitcnt vmcnt(8)
 MM a[84:87], v[212:215], v[216:219], a[84:87]
 buffer_load_dwordx4 v[252:255], v1, s[16:19], s87 offen offset:1024 sc1
 MM a[84:87], a[160:163], a[164:167], a[84:87]
 ds_write_b128 v19, a[48:51] offset:0
 MM a[80:83], a[156:159], a[164:167], a[80:83]
 buffer_load_dwordx4 a[0:3], v1, s[16:19], s87 offen offset:2048 sc1
 MM a[80:83], v[208:211], v[216:219], a[80:83]
 ds_write_b128 v19, a[52:55] offset:1024
 MM a[76:79], v[204:207], v[216:219], a[76:79]
 buffer_load_dwordx4 a[4:7], v1, s[16:19], s87 offen offset:3072 sc1
 MM a[76:79], a[152:155], a[164:167], a[76:79]
 ds_write_b128 v19, a[56:59] offset:2048
 MM a[72:75], a[148:151], a[164:167], a[72:75]
 buffer_load_dwordx4 a[8:11], v2, s[16:19], s87 offen offset:0 sc1
 MM a[72:75], v[200:203], v[216:219], a[72:75]
 ds_write_b128 v19, a[60:63] offset:3072
 MM a[68:71], v[196:199], v[216:219], a[68:71]
 buffer_load_dwordx4 a[12:15], v13, s[16:19], s43 offen sc1
 MM a[68:71], a[144:147], a[164:167], a[68:71]
 ds_write_b128 v19, a[64:67] offset:4096
 MM a[88:91], a[144:147], a[168:171], a[88:91]
 buffer_load_dwordx4 a[16:19], v14, s[16:19], s43 offen sc1
 s_waitcnt vmcnt(13)
 MM a[88:91], v[196:199], v[220:223], a[88:91]
 ds_write_b128 v10, a[84:87] offset:9216
 MM a[92:95], v[200:203], v[220:223], a[92:95]
 buffer_load_dwordx4 a[20:23], v15, s[16:19], s43 offen sc1
 MM a[92:95], a[148:151], a[168:171], a[92:95]
 ds_write_b128 v10, a[80:83] offset:8192
 MM a[96:99], a[152:155], a[168:171], a[96:99]
 buffer_load_dwordx4 a[24:27], v12, s[16:19], s88 offen sc1
 MM a[96:99], v[204:207], v[220:223], a[96:99]
 ds_write_b128 v10, a[76:79] offset:7168
 MM a[100:103], v[208:211], v[220:223], a[100:103]
 buffer_load_dwordx4 a[28:31], v13, s[16:19], s88 offen sc1
 MM a[100:103], a[156:159], a[168:171], a[100:103]
 ds_write_b128 v10, a[72:75] offset:6144
 MM a[104:107], a[160:163], a[168:171], a[104:107]
 ds_write_b128 v10, a[68:71] offset:5120
 MM a[104:107], v[212:215], v[220:223], a[104:107]
 s_waitcnt vmcnt(15)
 MM a[124:127], v[212:215], v[224:227], a[124:127]
 buffer_load_dwordx4 a[32:35], v14, s[16:19], s88 offen sc1
 MM a[124:127], a[160:163], a[172:175], a[124:127]
 ds_write_b128 v23, a[88:91] offset:10240
 MM a[120:123], a[156:159], a[172:175], a[120:123]
 ds_write_b128 v23, a[92:95] offset:11264
 MM a[120:123], v[208:211], v[224:227], a[120:123]
 MM a[116:119], v[204:207], v[224:227], a[116:119]
 ds_write_b128 v23, a[96:99] offset:12288
 MM a[116:119], a[152:155], a[172:175], a[116:119]
 MM a[112:115], a[148:151], a[172:175], a[112:115]
 ds_write_b128 v23, a[100:103] offset:13312
 MM a[112:115], v[200:203], v[224:227], a[112:115]
 MM a[108:111], v[196:199], v[224:227], a[108:111]
 ds_write_b128 v23, a[104:107] offset:14336
 MM a[108:111], a[144:147], a[172:175], a[108:111]
 s_waitcnt vmcnt(15)
 MM v[104:107], a[144:147], a[176:179], v[104:107]
 ds_write_b128 v0, a[124:127] offset:19456
 MM v[104:107], v[196:199], v[228:231], v[104:107]
 buffer_load_dwordx4 a[36:39], v15, s[16:19], s88 offen sc1
 MM v[108:111], v[200:203], v[228:231], v[108:111]
 s_add_u32 s42, s22, 4096
 s_add_u32 s41, s86, 5120
 s_add_u32 s40, s84, 4096
 MM v[108:111], a[148:151], a[176:179], v[108:111]
 buffer_load_dwordx4 a[40:43], v12, s[16:19], s40 offen sc1
 MM v[112:115], a[152:155], a[176:179], v[112:115]
 ds_write_b128 v0, a[120:123] offset:18432
 MM v[112:115], v[204:207], v[228:231], v[112:115]
 buffer_load_dwordx4 a[44:47], v1, s[16:19], s41 offen offset:0 sc1
 MM v[116:119], v[208:211], v[228:231], v[116:119]
 ds_write_b128 v0, a[116:119] offset:17408
 MM v[116:119], a[156:159], a[176:179], v[116:119]
 buffer_load_dwordx4 a[192:195], v1, s[16:19], s41 offen offset:1024 sc1
 MM v[120:123], a[160:163], a[176:179], v[120:123]
 ds_write_b128 v0, a[112:115] offset:16384
 MM v[120:123], v[212:215], v[228:231], v[120:123]
 buffer_load_dwordx4 a[196:199], v1, s[16:19], s41 offen offset:2048 sc1
 s_waitcnt vmcnt(19)
 MM v[140:143], v[212:215], v[232:235], v[140:143]
 ds_write_b128 v0, a[108:111] offset:15360
 MM v[140:143], a[160:163], a[180:183], v[140:143]
 buffer_load_dwordx4 a[200:203], v1, s[16:19], s41 offen offset:3072 sc1
 MM v[136:139], a[156:159], a[180:183], v[136:139]
 MM v[136:139], v[208:211], v[232:235], v[136:139]
 buffer_load_dwordx4 a[204:207], v2, s[16:19], s41 offen offset:0 sc1
 MM v[132:135], v[204:207], v[232:235], v[132:135]
 MM v[132:135], a[152:155], a[180:183], v[132:135]
 buffer_load_dwordx4 a[208:211], v13, s[16:19], s40 offen sc1
 MM v[128:131], a[148:151], a[180:183], v[128:131]
 MM v[128:131], v[200:203], v[232:235], v[128:131]
 buffer_load_dwordx4 a[212:215], v14, s[16:19], s40 offen sc1
 MM v[124:127], v[196:199], v[232:235], v[124:127]
 MM v[124:127], a[144:147], a[180:183], v[124:127]
 buffer_load_dwordx4 a[216:219], v15, s[16:19], s40 offen sc1
 MM v[144:147], a[144:147], a[184:187], v[144:147]
 s_waitcnt vmcnt(23)
 MM v[144:147], v[196:199], v[236:239], v[144:147]
 buffer_load_dwordx4 a[220:223], v12, s[16:19], s42 offen sc1
 MM v[148:151], v[200:203], v[236:239], v[148:151]
 MM v[148:151], a[148:151], a[184:187], v[148:151]
 buffer_load_dwordx4 a[224:227], v13, s[16:19], s42 offen sc1
 MM v[152:155], a[152:155], a[184:187], v[152:155]
 MM v[152:155], v[204:207], v[236:239], v[152:155]
 buffer_load_dwordx4 a[228:231], v14, s[16:19], s42 offen sc1
 MM v[156:159], v[208:211], v[236:239], v[156:159]
 MM v[156:159], a[156:159], a[184:187], v[156:159]
 buffer_load_dwordx4 a[232:235], v15, s[16:19], s42 offen sc1
 MM v[160:163], a[160:163], a[184:187], v[160:163]
 s_add_u32 s88, s22, 8192
 s_add_u32 s87, s86, 10240
 s_add_u32 s43, s84, 8192
 MM v[160:163], v[212:215], v[236:239], v[160:163]
 buffer_load_dwordx4 a[236:239], v12, s[16:19], s88 offen sc1
 s_waitcnt vmcnt(27)
 MM v[180:183], v[212:215], v[240:243], v[180:183]
 MM v[180:183], a[160:163], a[188:191], v[180:183]
 buffer_load_dwordx4 a[240:243], v1, s[16:19], s87 offen offset:0 sc1
 MM v[176:179], a[156:159], a[188:191], v[176:179]
 MM v[176:179], v[208:211], v[240:243], v[176:179]
 buffer_load_dwordx4 a[244:247], v1, s[16:19], s87 offen offset:1024 sc1
 MM v[172:175], v[204:207], v[240:243], v[172:175]
 MM v[172:175], a[152:155], a[188:191], v[172:175]
 buffer_load_dwordx4 a[248:251], v1, s[16:19], s87 offen offset:2048 sc1
 MM v[168:171], a[148:151], a[188:191], v[168:171]
 MM v[168:171], v[200:203], v[240:243], v[168:171]
 buffer_load_dwordx4 a[252:255], v1, s[16:19], s87 offen offset:3072 sc1
 MM v[164:167], v[196:199], v[240:243], v[164:167]
 s_waitcnt vmcnt(29)
 MM v[164:167], a[144:147], a[188:191], v[164:167]
 buffer_load_dwordx4 v[184:187], v2, s[16:19], s87 offen offset:0 sc1
 MM v[24:27], v[248:251], v[244:247], 0
 s_waitcnt vmcnt(16)
 s_waitcnt vmcnt(17)
 MM v[24:27], a[44:47], a[40:43], v[24:27]
 buffer_load_dwordx4 v[188:191], v13, s[16:19], s88 offen sc1
 MM v[28:31], a[192:195], a[40:43], 0
 MM v[28:31], v[252:255], v[244:247], v[28:31]
 buffer_load_dwordx4 a[128:131], v14, s[16:19], s88 offen sc1
 MM v[32:35], a[0:3], v[244:247], 0
 s_waitcnt vmcnt(16)
 s_waitcnt vmcnt(17)
 MM v[32:35], a[196:199], a[40:43], v[32:35]
 buffer_load_dwordx4 a[132:135], v15, s[16:19], s88 offen sc1
 MM v[36:39], a[200:203], a[40:43], 0
 MM v[36:39], a[4:7], v[244:247], v[36:39]
 MM v[40:43], a[8:11], v[244:247], 0
 s_waitcnt vmcnt(16)
 MM v[40:43], a[204:207], a[40:43], v[40:43]
 s_waitcnt vmcnt(15)
 MM v[60:63], a[204:207], a[208:211], 0
 buffer_load_dwordx4 a[136:139], v12, s[16:19], s43 offen sc1
 MM v[60:63], a[8:11], a[12:15], v[60:63]
 ds_write_b128 v16, v[104:107] offset:0
 MM v[56:59], a[4:7], a[12:15], 0
 MM v[56:59], a[200:203], a[208:211], v[56:59]
 ds_write_b128 v16, v[108:111] offset:1024
 MM v[52:55], a[196:199], a[208:211], 0
 MM v[52:55], a[0:3], a[12:15], v[52:55]
 MM v[48:51], v[252:255], a[12:15], 0
 ds_write_b128 v16, v[112:115] offset:2048
 MM v[48:51], a[192:195], a[208:211], v[48:51]
 MM v[44:47], a[44:47], a[208:211], 0
 MM v[44:47], v[248:251], a[12:15], v[44:47]
 ds_write_b128 v16, v[116:119] offset:3072
 MM v[64:67], v[248:251], a[16:19], 0
 s_waitcnt vmcnt(15)
 MM v[64:67], a[44:47], a[212:215], v[64:67]
 buffer_load_dwordx4 a[140:143], v13, s[16:19], s43 offen sc1
 MM v[68:71], a[192:195], a[212:215], 0
 ds_write_b128 v16, v[120:123] offset:4096
 MM v[68:71], v[252:255], a[16:19], v[68:71]
 MM v[72:75], a[0:3], a[16:19], 0
 MM v[72:75], a[196:199], a[212:215], v[72:75]
 ds_write_b128 v3, v[124:127] offset:5120
 MM v[76:79], a[200:203], a[212:215], 0
 MM v[76:79], a[4:7], a[16:19], v[76:79]
 MM v[80:83], a[8:11], a[16:19], 0
 ds_write_b128 v3, v[128:131] offset:6144
 MM v[80:83], a[204:207], a[212:215], v[80:83]
 s_waitcnt vmcnt(15)
 MM v[100:103], a[204:207], a[216:219], 0
 buffer_load_dwordx4 a[144:147], v14, s[16:19], s43 offen sc1
 MM v[100:103], a[8:11], a[20:23], v[100:103]
 ds_write_b128 v3, v[132:135] offset:7168
 MM v[96:99], a[4:7], a[20:23], 0
 MM v[96:99], a[200:203], a[216:219], v[96:99]
 MM v[92:95], a[196:199], a[216:219], 0
 ds_write_b128 v3, v[136:139] offset:8192
 MM v[92:95], a[0:3], a[20:23], v[92:95]
 MM v[88:91], v[252:255], a[20:23], 0
 MM v[88:91], a[192:195], a[216:219], v[88:91]
 ds_write_b128 v3, v[140:143] offset:9216
 MM v[84:87], a[44:47], a[216:219], 0
 MM v[84:87], v[248:251], a[20:23], v[84:87]
 s_waitcnt vmcnt(15)
 MM a[48:51], v[248:251], a[24:27], 0
 ds_write_b128 v18, v[144:147] offset:10240
 MM a[48:51], a[44:47], a[220:223], a[48:51]
 buffer_load_dwordx4 a[148:151], v15, s[16:19], s43 offen sc1
 MM a[52:55], a[192:195], a[220:223], 0
 s_add_u32 s42, s22, 12288
 s_add_u32 s41, s86, 15360
 s_add_u32 s40, s84, 12288
 MM a[52:55], v[252:255], a[24:27], a[52:55]
 buffer_load_dwordx4 a[152:155], v12, s[16:19], s42 offen sc1
 MM a[56:59], a[0:3], a[24:27], 0
 ds_write_b128 v18, v[148:151] offset:11264
 MM a[56:59], a[196:199], a[220:223], a[56:59]
 buffer_load_dwordx4 a[156:159], v1, s[16:19], s41 offen offset:0 sc1
 MM a[60:63], a[200:203], a[220:223], 0
 ds_write_b128 v18, v[152:155] offset:12288
 MM a[60:63], a[4:7], a[24:27], a[60:63]
 buffer_load_dwordx4 a[160:163], v1, s[16:19], s41 offen offset:1024 sc1
 MM a[64:67], a[8:11], a[24:27], 0
 s_waitcnt vmcnt(18)
 MM a[64:67], a[204:207], a[220:223], a[64:67]
 buffer_load_dwordx4 a[164:167], v1, s[16:19], s41 offen offset:2048 sc1
 MM a[84:87], a[204:207], a[224:227], 0
 ds_write_b128 v18, v[156:159] offset:13312
 MM a[84:87], a[8:11], a[28:31], a[84:87]
 buffer_load_dwordx4 a[168:171], v1, s[16:19], s41 offen offset:3072 sc1
 MM a[80:83], a[4:7], a[28:31], 0
 ds_write_b128 v18, v[160:163] offset:14336
 MM a[80:83], a[200:203], a[224:227], a[80:83]
 buffer_load_dwordx4 a[172:175], v2, s[16:19], s41 offen offset:0 sc1
 MM a[76:79], a[196:199], a[224:227], 0
 MM a[76:79], a[0:3], a[28:31], a[76:79]
 buffer_load_dwordx4 a[176:179], v13, s[16:19], s42 offen sc1
 MM a[72:75], v[252:255], a[28:31], 0
 MM a[72:75], a[192:195], a[224:227], a[72:75]
 buffer_load_dwordx4 a[180:183], v14, s[16:19], s42 offen sc1
 MM a[68:71], a[44:47], a[224:227], 0
 MM a[68:71], v[248:251], a[28:31], a[68:71]
 buffer_load_dwordx4 a[184:187], v15, s[16:19], s42 offen sc1
 MM a[88:91], v[248:251], a[32:35], 0
 s_waitcnt vmcnt(23)
 MM a[88:91], a[44:47], a[228:231], a[88:91]
 buffer_load_dwordx4 a[188:191], v12, s[16:19], s40 offen sc1
 MM a[92:95], a[192:195], a[228:231], 0
 MM a[92:95], v[252:255], a[32:35], a[92:95]
 buffer_load_dwordx4 v[192:195], v13, s[16:19], s40 offen sc1
 MM a[96:99], a[0:3], a[32:35], 0
 MM a[96:99], a[196:199], a[228:231], a[96:99]
 buffer_load_dwordx4 v[196:199], v14, s[16:19], s40 offen sc1
 MM a[100:103], a[200:203], a[228:231], 0
 MM a[100:103], a[4:7], a[32:35], a[100:103]
 buffer_load_dwordx4 v[200:203], v15, s[16:19], s40 offen sc1
 MM a[104:107], a[8:11], a[32:35], 0
 s_add_u32 s88, s22, 16384
 s_add_u32 s87, s86, 20480
 s_add_u32 s43, s84, 16384
 MM a[104:107], a[204:207], a[228:231], a[104:107]
 buffer_load_dwordx4 v[204:207], v12, s[16:19], s88 offen sc1
 s_waitcnt vmcnt(27)
 MM a[124:127], a[204:207], a[232:235], 0
 s_waitcnt lgkmcnt(0)
 s_barrier
 MM a[124:127], a[8:11], a[36:39], a[124:127]
 buffer_load_dwordx4 v[208:211], v1, s[16:19], s87 offen offset:0 sc1
 MM a[120:123], a[4:7], a[36:39], 0
 ds_read_b128 v[104:107], v22 offset:0
 ds_read_b128 v[108:111], v22 offset:5120
 MM a[120:123], a[200:203], a[232:235], a[120:123]
 buffer_load_dwordx4 v[212:215], v1, s[16:19], s87 offen offset:1024 sc1
 MM a[116:119], a[196:199], a[232:235], 0
 ds_read_b128 v[112:115], v22 offset:10240
 ds_read_b128 v[116:119], v22 offset:15360
 MM a[116:119], a[0:3], a[36:39], a[116:119]
 buffer_load_dwordx4 v[216:219], v1, s[16:19], s87 offen offset:2048 sc1
 MM a[112:115], v[252:255], a[36:39], 0
 ds_read_b128 v[120:123], v22 offset:1024
 ds_read_b128 v[124:127], v22 offset:6144
 MM a[112:115], a[192:195], a[232:235], a[112:115]
 buffer_load_dwordx4 v[220:223], v1, s[16:19], s87 offen offset:3072 sc1
 MM a[108:111], a[44:47], a[232:235], 0
 s_waitcnt vmcnt(29)
 ds_read_b128 v[128:131], v22 offset:11264
 ds_read_b128 v[132:135], v22 offset:16384
 MM a[108:111], v[248:251], a[36:39], a[108:111]
 buffer_load_dwordx4 v[224:227], v2, s[16:19], s87 offen offset:0 sc1
 MM a[48:51], a[240:243], a[236:239], a[48:51]
 s_waitcnt lgkmcnt(6)
 v_add_f32 v104, v104, v108
 v_add_f32 v105, v105, v109
 s_waitcnt vmcnt(17)
 MM a[48:51], a[156:159], a[152:155], a[48:51]
 buffer_load_dwordx4 v[228:231], v13, s[16:19], s88 offen sc1
 s_waitcnt vmcnt(17)
 MM a[52:55], a[160:163], a[152:155], a[52:55]
 s_waitcnt vmcnt(16)
 v_add_f32 v106, v106, v110
 v_add_f32 v107, v107, v111
 MM a[52:55], a[244:247], a[236:239], a[52:55]
 buffer_load_dwordx4 v[232:235], v14, s[16:19], s88 offen sc1
 MM a[56:59], a[248:251], a[236:239], a[56:59]
 s_waitcnt lgkmcnt(2)
 v_add_f32 v112, v112, v116
 v_add_f32 v113, v113, v117
 MM a[56:59], a[164:167], a[152:155], a[56:59]
 buffer_load_dwordx4 v[236:239], v15, s[16:19], s88 offen sc1
 s_waitcnt vmcnt(17)
 MM a[60:63], a[168:171], a[152:155], a[60:63]
 v_add_f32 v114, v114, v118
 v_add_f32 v115, v115, v119
 MM a[60:63], a[252:255], a[236:239], a[60:63]
 s_waitcnt vmcnt(15)
 v_add_f32 v104, v104, v112
 v_add_f32 v105, v105, v113
 MM a[64:67], v[184:187], a[236:239], a[64:67]
 s_waitcnt vmcnt(16)
 v_add_f32 v106, v106, v114
 v_add_f32 v107, v107, v115
 MM a[64:67], a[172:175], a[152:155], a[64:67]
 buffer_store_dwordx4 v[104:107], v1, s[16:19], s94 offen offset:0 sc1
 MM a[84:87], a[172:175], a[176:179], a[84:87]
 buffer_load_dwordx4 v[240:243], v12, s[16:19], s43 offen sc1
 MM a[84:87], v[184:187], v[188:191], a[84:87]
 ds_read_b128 v[104:107], v22 offset:2048
 v_add_f32 v120, v120, v124
 MM a[80:83], a[252:255], v[188:191], a[80:83]
 ds_read_b128 v[108:111], v22 offset:7168
 v_add_f32 v121, v121, v125
 MM a[80:83], a[168:171], a[176:179], a[80:83]
 ds_read_b128 v[112:115], v22 offset:12288
 v_add_f32 v122, v122, v126
 MM a[76:79], a[164:167], a[176:179], a[76:79]
 ds_read_b128 v[116:119], v22 offset:17408
 v_add_f32 v123, v123, v127
 MM a[76:79], a[248:251], v[188:191], a[76:79]
 s_waitcnt lgkmcnt(4)
 v_add_f32 v128, v128, v132
 v_add_f32 v129, v129, v133
 MM a[72:75], a[244:247], v[188:191], a[72:75]
 v_add_f32 v130, v130, v134
 v_add_f32 v131, v131, v135
 MM a[72:75], a[160:163], a[176:179], a[72:75]
 v_add_f32 v120, v120, v128
 v_add_f32 v121, v121, v129
 MM a[68:71], a[156:159], a[176:179], a[68:71]
 v_add_f32 v122, v122, v130
 v_add_f32 v123, v123, v131
 MM a[68:71], a[240:243], v[188:191], a[68:71]
 buffer_store_dwordx4 v[120:123], v1, s[16:19], s94 offen offset:1024 sc1
 MM a[88:91], a[240:243], a[128:131], a[88:91]
 s_waitcnt vmcnt(17)
 ds_read_b128 v[120:123], v22 offset:3072
 s_waitcnt lgkmcnt(2)
 v_add_f32 v104, v104, v108
 MM a[88:91], a[156:159], a[180:183], a[88:91]
 buffer_load_dwordx4 v[244:247], v13, s[16:19], s43 offen sc1
 MM a[92:95], a[160:163], a[180:183], a[92:95]
 ds_read_b128 v[124:127], v22 offset:8192
 v_add_f32 v105, v105, v109
 MM a[92:95], a[244:247], a[128:131], a[92:95]
 ds_read_b128 v[128:131], v22 offset:13312
 v_add_f32 v106, v106, v110
 MM a[96:99], a[248:251], a[128:131], a[96:99]
 ds_read_b128 v[132:135], v22 offset:18432
 v_add_f32 v107, v107, v111
 MM a[96:99], a[164:167], a[180:183], a[96:99]
 s_waitcnt lgkmcnt(4)
 v_add_f32 v112, v112, v116
 v_add_f32 v113, v113, v117
 MM a[100:103], a[168:171], a[180:183], a[100:103]
 v_add_f32 v114, v114, v118
 v_add_f32 v115, v115, v119
 MM a[100:103], a[252:255], a[128:131], a[100:103]
 v_add_f32 v104, v104, v112
 v_add_f32 v105, v105, v113
 MM a[104:107], v[184:187], a[128:131], a[104:107]
 s_waitcnt vmcnt(17)
 v_add_f32 v106, v106, v114
 v_add_f32 v107, v107, v115
 MM a[104:107], a[172:175], a[180:183], a[104:107]
 buffer_store_dwordx4 v[104:107], v1, s[16:19], s94 offen offset:2048 sc1
 MM a[124:127], a[172:175], a[184:187], a[124:127]
 buffer_load_dwordx4 v[248:251], v14, s[16:19], s43 offen sc1
 MM a[124:127], v[184:187], a[132:135], a[124:127]
 ds_read_b128 v[104:107], v22 offset:4096
 s_waitcnt lgkmcnt(1)
 v_add_f32 v120, v120, v124
 MM a[120:123], a[252:255], a[132:135], a[120:123]
 ds_read_b128 v[108:111], v22 offset:9216
 v_add_f32 v121, v121, v125
 MM a[120:123], a[168:171], a[184:187], a[120:123]
 ds_read_b128 v[112:115], v22 offset:14336
 v_add_f32 v122, v122, v126
 MM a[116:119], a[164:167], a[184:187], a[116:119]
 ds_read_b128 v[116:119], v22 offset:19456
 v_add_f32 v123, v123, v127
 MM a[116:119], a[248:251], a[132:135], a[116:119]
 v_add_f32 v128, v128, v132
 v_add_f32 v129, v129, v133
 MM a[112:115], a[244:247], a[132:135], a[112:115]
 v_add_f32 v130, v130, v134
 v_add_f32 v131, v131, v135
 MM a[112:115], a[160:163], a[184:187], a[112:115]
 v_add_f32 v120, v120, v128
 v_add_f32 v121, v121, v129
 MM a[108:111], a[156:159], a[184:187], a[108:111]
 s_waitcnt vmcnt(18)
 v_add_f32 v122, v122, v130
 v_add_f32 v123, v123, v131
 MM a[108:111], a[240:243], a[132:135], a[108:111]
 buffer_store_dwordx4 v[120:123], v1, s[16:19], s94 offen offset:3072 sc1
 MM v[24:27], a[240:243], a[136:139], v[24:27]
 s_waitcnt lgkmcnt(1)
 v_add_f32 v104, v104, v108
 v_add_f32 v105, v105, v109
 MM v[24:27], a[156:159], a[188:191], v[24:27]
 buffer_load_dwordx4 v[252:255], v15, s[16:19], s43 offen sc1
 MM v[28:31], a[160:163], a[188:191], v[28:31]
 s_add_u32 s42, s22, 20480
 s_add_u32 s41, s86, 25600
 s_add_u32 s40, s84, 20480
 MM v[28:31], a[244:247], a[136:139], v[28:31]
 buffer_load_dwordx4 a[0:3], v12, s[16:19], s42 offen sc1
 MM v[32:35], a[248:251], a[136:139], v[32:35]
 v_add_f32 v106, v106, v110
 v_add_f32 v107, v107, v111
 MM v[32:35], a[164:167], a[188:191], v[32:35]
 buffer_load_dwordx4 a[4:7], v1, s[16:19], s41 offen offset:0 sc1
 MM v[36:39], a[168:171], a[188:191], v[36:39]
 s_waitcnt lgkmcnt(0)
 v_add_f32 v112, v112, v116
 v_add_f32 v113, v113, v117
 MM v[36:39], a[252:255], a[136:139], v[36:39]
 buffer_load_dwordx4 a[8:11], v1, s[16:19], s41 offen offset:1024 sc1
 MM v[40:43], v[184:187], a[136:139], v[40:43]
 s_waitcnt vmcnt(22)
 v_add_f32 v114, v114, v118
 v_add_f32 v115, v115, v119
 MM v[40:43], a[172:175], a[188:191], v[40:43]
 buffer_load_dwordx4 a[12:15], v1, s[16:19], s41 offen offset:2048 sc1
 MM v[60:63], a[172:175], v[192:195], v[60:63]
 v_add_f32 v104, v104, v112
 v_add_f32 v105, v105, v113
 MM v[60:63], v[184:187], a[140:143], v[60:63]
 buffer_load_dwordx4 a[16:19], v1, s[16:19], s41 offen offset:3072 sc1
 MM v[56:59], a[252:255], a[140:143], v[56:59]
 v_add_f32 v106, v106, v114
 v_add_f32 v107, v107, v115
 MM v[56:59], a[168:171], v[192:195], v[56:59]
 buffer_load_dwordx4 a[20:23], v2, s[16:19], s41 offen offset:0 sc1
 MM v[52:55], a[164:167], v[192:195], v[52:55]
 buffer_store_dwordx4 v[104:107], v2, s[16:19], s94 offen offset:0 sc1
 MM v[52:55], a[248:251], a[140:143], v[52:55]
 buffer_load_dwordx4 a[24:27], v13, s[16:19], s42 offen sc1
 MM v[48:51], a[244:247], a[140:143], v[48:51]
 MM v[48:51], a[160:163], v[192:195], v[48:51]
 buffer_load_dwordx4 a[28:31], v14, s[16:19], s42 offen sc1
 MM v[44:47], a[156:159], v[192:195], v[44:47]
 MM v[44:47], a[240:243], a[140:143], v[44:47]
 buffer_load_dwordx4 a[32:35], v15, s[16:19], s42 offen sc1
 MM v[64:67], a[240:243], a[144:147], v[64:67]
 s_waitcnt vmcnt(28)
 MM v[64:67], a[156:159], v[196:199], v[64:67]
 buffer_load_dwordx4 a[36:39], v12, s[16:19], s40 offen sc1
 MM v[68:71], a[160:163], v[196:199], v[68:71]
 MM v[68:71], a[244:247], a[144:147], v[68:71]
 buffer_load_dwordx4 a[40:43], v13, s[16:19], s40 offen sc1
 MM v[72:75], a[248:251], a[144:147], v[72:75]
 MM v[72:75], a[164:167], v[196:199], v[72:75]
 buffer_load_dwordx4 a[44:47], v14, s[16:19], s40 offen sc1
 MM v[76:79], a[168:171], v[196:199], v[76:79]
 MM v[76:79], a[252:255], a[144:147], v[76:79]
 buffer_load_dwordx4 a[192:195], v15, s[16:19], s40 offen sc1
 MM v[80:83], v[184:187], a[144:147], v[80:83]
 s_add_u32 s88, s22, 24576
 s_add_u32 s87, s86, 30720
 s_add_u32 s43, s84, 24576
 MM v[80:83], a[172:175], v[196:199], v[80:83]
 buffer_load_dwordx4 a[196:199], v12, s[16:19], s88 offen sc1
 s_waitcnt vmcnt(32)
 MM v[100:103], a[172:175], v[200:203], v[100:103]
 MM v[100:103], v[184:187], a[148:151], v[100:103]
 buffer_load_dwordx4 a[200:203], v1, s[16:19], s87 offen offset:0 sc1
 MM v[96:99], a[252:255], a[148:151], v[96:99]
 MM v[96:99], a[168:171], v[200:203], v[96:99]
 buffer_load_dwordx4 a[204:207], v1, s[16:19], s87 offen offset:1024 sc1
 MM v[92:95], a[164:167], v[200:203], v[92:95]
 MM v[92:95], a[248:251], a[148:151], v[92:95]
 buffer_load_dwordx4 a[208:211], v1, s[16:19], s87 offen offset:2048 sc1
 MM v[88:91], a[244:247], a[148:151], v[88:91]
 MM v[88:91], a[160:163], v[200:203], v[88:91]
 buffer_load_dwordx4 a[212:215], v1, s[16:19], s87 offen offset:3072 sc1
 MM v[84:87], a[156:159], v[200:203], v[84:87]
 s_waitcnt vmcnt(34)
 MM v[84:87], a[240:243], a[148:151], v[84:87]
 buffer_load_dwordx4 a[216:219], v2, s[16:19], s87 offen offset:0 sc1
 MM a[48:51], v[208:211], v[204:207], a[48:51]
 s_waitcnt vmcnt(17)
 s_waitcnt vmcnt(18)
 MM a[48:51], a[4:7], a[0:3], a[48:51]
 buffer_load_dwordx4 a[220:223], v13, s[16:19], s88 offen sc1
 MM a[52:55], a[8:11], a[0:3], a[52:55]
 MM a[52:55], v[212:215], v[204:207], a[52:55]
 buffer_load_dwordx4 a[224:227], v14, s[16:19], s88 offen sc1
 MM a[56:59], v[216:219], v[204:207], a[56:59]
 s_waitcnt vmcnt(17)
 s_waitcnt vmcnt(18)
 MM a[56:59], a[12:15], a[0:3], a[56:59]
 buffer_load_dwordx4 a[228:231], v15, s[16:19], s88 offen sc1
 MM a[60:63], a[16:19], a[0:3], a[60:63]
 MM a[60:63], v[220:223], v[204:207], a[60:63]
 MM a[64:67], v[224:227], v[204:207], a[64:67]
 s_waitcnt vmcnt(17)
 MM a[64:67], a[20:23], a[0:3], a[64:67]
 s_waitcnt vmcnt(15)
 MM a[84:87], a[20:23], a[24:27], a[84:87]
 buffer_load_dwordx4 a[232:235], v12, s[16:19], s43 offen sc1
 MM a[84:87], v[224:227], v[228:231], a[84:87]
 ds_read_b128 v[104:107], v7 offset:0
 ds_read_b128 v[108:111], v7 offset:1024
 MM a[80:83], v[220:223], v[228:231], a[80:83]
 ds_read_b128 v[112:115], v7 offset:2048
 ds_read_b128 v[116:119], v7 offset:3072
 MM a[80:83], a[16:19], a[24:27], a[80:83]
 ds_read_b128 v[120:123], v7 offset:4096
 ds_read_b128 v[124:127], v7 offset:5120
 MM a[76:79], a[12:15], a[24:27], a[76:79]
 ds_read_b128 v[128:131], v7 offset:6144
 ds_read_b128 v[132:135], v7 offset:7168
 MM a[76:79], v[216:219], v[228:231], a[76:79]
 ds_read_b128 v[136:139], v7 offset:8192
 ds_read_b128 v[140:143], v7 offset:9216
 MM a[72:75], v[212:215], v[228:231], a[72:75]
 ds_read_b128 v[144:147], v7 offset:10240
 ds_read_b128 v[148:151], v7 offset:11264
 MM a[72:75], a[8:11], a[24:27], a[72:75]
 ds_read_b128 v[152:155], v7 offset:12288
 ds_read_b128 v[156:159], v7 offset:13312
 MM a[68:71], a[4:7], a[24:27], a[68:71]
 ds_read_b128 v[160:163], v7 offset:14336
 MM a[68:71], v[208:211], v[228:231], a[68:71]
 MM a[88:91], v[208:211], v[232:235], a[88:91]
 s_waitcnt vmcnt(15)
 MM a[88:91], a[4:7], a[28:31], a[88:91]
 buffer_load_dwordx4 a[236:239], v13, s[16:19], s43 offen sc1
 MM a[92:95], a[8:11], a[28:31], a[92:95]
 MM a[92:95], v[212:215], v[232:235], a[92:95]
 MM a[96:99], v[216:219], v[232:235], a[96:99]
 MM a[96:99], a[12:15], a[28:31], a[96:99]
 MM a[100:103], a[16:19], a[28:31], a[100:103]
 MM a[100:103], v[220:223], v[232:235], a[100:103]
 MM a[104:107], v[224:227], v[232:235], a[104:107]
 MM a[104:107], a[20:23], a[28:31], a[104:107]
 s_waitcnt vmcnt(15)
 MM a[124:127], a[20:23], a[32:35], a[124:127]
 buffer_load_dwordx4 a[240:243], v14, s[16:19], s43 offen sc1
 MM a[124:127], v[224:227], v[236:239], a[124:127]
 MM a[120:123], v[220:223], v[236:239], a[120:123]
 MM a[120:123], a[16:19], a[32:35], a[120:123]
 MM a[116:119], a[12:15], a[32:35], a[116:119]
 MM a[116:119], v[216:219], v[236:239], a[116:119]
 MM a[112:115], v[212:215], v[236:239], a[112:115]
 MM a[112:115], a[8:11], a[32:35], a[112:115]
 MM a[108:111], a[4:7], a[32:35], a[108:111]
 MM a[108:111], v[208:211], v[236:239], a[108:111]
 s_waitcnt vmcnt(15)
 MM v[24:27], v[208:211], v[240:243], v[24:27]
 s_lshl_b32 s3, s2, 4
 s_add_u32 s3, s3, s24
 s_lshl_b32 s3, s3, 3
 MM v[24:27], a[4:7], a[36:39], v[24:27]
 s_add_u32 s3, s3, 70746112
 v_mov_b32 v6, s61
 s_waitcnt lgkmcnt(0)
 v_add_f32 v104, v104, v124
 MM v[28:31], a[8:11], a[36:39], v[28:31]
 buffer_load_dwordx4 a[244:247], v15, s[16:19], s43 offen sc1
 MM v[28:31], v[212:215], v[240:243], v[28:31]
 s_add_u32 s42, s22, 28672
 s_add_u32 s41, s86, 35840
 s_add_u32 s40, s84, 28672
 MM v[32:35], v[216:219], v[240:243], v[32:35]
 buffer_load_dwordx4 a[248:251], v12, s[16:19], s42 offen sc1
 MM v[32:35], a[12:15], a[36:39], v[32:35]
 buffer_load_dwordx4 a[252:255], v1, s[16:19], s41 offen offset:0 sc1
 MM v[36:39], a[16:19], a[36:39], v[36:39]
 v_add_f32 v144, v144, v164
 v_add_f32 v105, v105, v125
 MM v[36:39], v[220:223], v[240:243], v[36:39]
 buffer_load_dwordx4 v[184:187], v1, s[16:19], s41 offen offset:1024 sc1
 MM v[40:43], v[224:227], v[240:243], v[40:43]
 s_waitcnt vmcnt(18)
 v_add_f32 v145, v145, v165
 v_add_f32 v106, v106, v126
 MM v[40:43], a[20:23], a[36:39], v[40:43]
 buffer_load_dwordx4 v[188:191], v1, s[16:19], s41 offen offset:2048 sc1
 MM v[60:63], a[20:23], a[40:43], v[60:63]
 v_add_f32 v146, v146, v166
 v_add_f32 v107, v107, v127
 MM v[60:63], v[224:227], v[244:247], v[60:63]
 buffer_load_dwordx4 a[128:131], v1, s[16:19], s41 offen offset:3072 sc1
 MM v[56:59], v[220:223], v[244:247], v[56:59]
 s_mov_b64 exec, 1
 buffer_store_dword v6, off, s[16:19], s3 offset:4 sc1
 s_mov_b64 exec, -1
 MM v[56:59], a[16:19], a[40:43], v[56:59]
 buffer_load_dwordx4 a[132:135], v2, s[16:19], s41 offen offset:0 sc1
 MM v[52:55], a[12:15], a[40:43], v[52:55]
 v_add_f32 v147, v147, v167
 v_add_f32 v108, v108, v128
 MM v[52:55], v[216:219], v[244:247], v[52:55]
 buffer_load_dwordx4 a[136:139], v13, s[16:19], s42 offen sc1
 MM v[48:51], v[212:215], v[244:247], v[48:51]
 v_add_f32 v148, v148, v168
 v_add_f32 v109, v109, v129
 MM v[48:51], a[8:11], a[40:43], v[48:51]
 buffer_load_dwordx4 a[140:143], v14, s[16:19], s42 offen sc1
 MM v[44:47], a[4:7], a[40:43], v[44:47]
 v_add_f32 v149, v149, v169
 v_add_f32 v110, v110, v130
 MM v[44:47], v[208:211], v[244:247], v[44:47]
 buffer_load_dwordx4 a[144:147], v15, s[16:19], s42 offen sc1
 MM v[64:67], v[208:211], v[248:251], v[64:67]
 s_waitcnt vmcnt(24)
 v_add_f32 v150, v150, v170
 v_add_f32 v111, v111, v131
 MM v[64:67], a[4:7], a[44:47], v[64:67]
 buffer_load_dwordx4 a[148:151], v12, s[16:19], s40 offen sc1
 MM v[68:71], a[8:11], a[44:47], v[68:71]
 v_add_f32 v151, v151, v171
 v_add_f32 v112, v112, v132
 MM v[68:71], v[212:215], v[248:251], v[68:71]
 buffer_load_dwordx4 a[152:155], v13, s[16:19], s40 offen sc1
 MM v[72:75], v[216:219], v[248:251], v[72:75]
 v_add_f32 v152, v152, v172
 v_add_f32 v113, v113, v133
 MM v[72:75], a[12:15], a[44:47], v[72:75]
 buffer_load_dwordx4 a[156:159], v14, s[16:19], s40 offen sc1
 MM v[76:79], a[16:19], a[44:47], v[76:79]
 v_add_f32 v153, v153, v173
 v_add_f32 v114, v114, v134
 MM v[76:79], v[220:223], v[248:251], v[76:79]
 buffer_load_dwordx4 a[160:163], v15, s[16:19], s40 offen sc1
 MM v[80:83], v[224:227], v[248:251], v[80:83]
 s_add_u32 s88, s22, 32768
 s_add_u32 s87, s86, 40960
 s_add_u32 s43, s84, 32768
 MM v[80:83], a[20:23], a[44:47], v[80:83]
 buffer_load_dwordx4 a[164:167], v12, s[16:19], s88 offen sc1
 s_waitcnt vmcnt(28)
 MM v[100:103], a[20:23], a[192:195], v[100:103]
 v_add_f32 v154, v154, v174
 v_add_f32 v115, v115, v135
 MM v[100:103], v[224:227], v[252:255], v[100:103]
 buffer_load_dwordx4 a[168:171], v1, s[16:19], s87 offen offset:0 sc1
 MM v[96:99], v[220:223], v[252:255], v[96:99]
 v_add_f32 v155, v155, v175
 v_add_f32 v116, v116, v136
 MM v[96:99], a[16:19], a[192:195], v[96:99]
 buffer_load_dwordx4 a[172:175], v1, s[16:19], s87 offen offset:1024 sc1
 MM v[92:95], a[12:15], a[192:195], v[92:95]
 v_add_f32 v156, v156, v176
 v_add_f32 v117, v117, v137
 MM v[92:95], v[216:219], v[252:255], v[92:95]
 buffer_load_dwordx4 a[176:179], v1, s[16:19], s87 offen offset:2048 sc1
 MM v[88:91], v[212:215], v[252:255], v[88:91]
 v_add_f32 v157, v157, v177
 v_add_f32 v118, v118, v138
 MM v[88:91], a[8:11], a[192:195], v[88:91]
 buffer_load_dwordx4 a[180:183], v1, s[16:19], s87 offen offset:3072 sc1
 MM v[84:87], a[4:7], a[192:195], v[84:87]
 s_waitcnt vmcnt(30)
 v_add_f32 v158, v158, v178
 v_add_f32 v119, v119, v139
 MM v[84:87], v[208:211], v[252:255], v[84:87]
 buffer_load_dwordx4 a[184:187], v2, s[16:19], s87 offen offset:0 sc1
 MM a[48:51], a[200:203], a[196:199], a[48:51]
 s_waitcnt vmcnt(18)
 v_add_f32 v159, v159, v179
 v_add_f32 v120, v120, v140
 MM a[48:51], a[252:255], a[248:251], a[48:51]
 buffer_load_dwordx4 a[188:191], v13, s[16:19], s88 offen sc1
 s_waitcnt vmcnt(18)
 MM a[52:55], v[184:187], a[248:251], a[52:55]
 v_add_f32 v160, v160, v180
 v_add_f32 v121, v121, v141
 MM a[52:55], a[204:207], a[196:199], a[52:55]
 buffer_load_dwordx4 v[192:195], v14, s[16:19], s88 offen sc1
 MM a[56:59], a[208:211], a[196:199], a[56:59]
 s_waitcnt vmcnt(18)
 v_add_f32 v161, v161, v181
 v_add_f32 v122, v122, v142
 MM a[56:59], v[188:191], a[248:251], a[56:59]
 buffer_load_dwordx4 v[196:199], v15, s[16:19], s88 offen sc1
 s_waitcnt vmcnt(18)
 MM a[60:63], a[128:131], a[248:251], a[60:63]
 v_add_f32 v162, v162, v182
 v_add_f32 v123, v123, v143
 MM a[60:63], a[212:215], a[196:199], a[60:63]
 v_add_f32 v163, v163, v183
 v_add_f32 v104, v104, v144
 MM a[64:67], a[216:219], a[196:199], a[64:67]
 s_waitcnt vmcnt(16)
 v_add_f32 v105, v105, v145
 v_add_f32 v106, v106, v146
 MM a[64:67], a[132:135], a[248:251], a[64:67]
 s_waitcnt vmcnt(15)
 v_add_f32 v107, v107, v147
 v_add_f32 v108, v108, v148
 MM a[84:87], a[132:135], a[136:139], a[84:87]
 buffer_load_dwordx4 v[200:203], v12, s[16:19], s43 offen sc1
 MM a[84:87], a[216:219], a[220:223], a[84:87]
 v_add_f32 v109, v109, v149
 v_add_f32 v110, v110, v150
 MM a[80:83], a[212:215], a[220:223], a[80:83]
 v_add_f32 v111, v111, v151
 v_add_f32 v112, v112, v152
 MM a[80:83], a[128:131], a[136:139], a[80:83]
 v_add_f32 v113, v113, v153
 v_add_f32 v114, v114, v154
 MM a[76:79], v[188:191], a[136:139], a[76:79]
 v_add_f32 v115, v115, v155
 v_add_f32 v116, v116, v156
 MM a[76:79], a[208:211], a[220:223], a[76:79]
 v_add_f32 v117, v117, v157
 v_add_f32 v118, v118, v158
 MM a[72:75], a[204:207], a[220:223], a[72:75]
 v_add_f32 v119, v119, v159
 v_add_f32 v120, v120, v160
 MM a[72:75], v[184:187], a[136:139], a[72:75]
 v_add_f32 v121, v121, v161
 v_add_f32 v122, v122, v162
 MM a[68:71], a[252:255], a[136:139], a[68:71]
 v_add_f32 v123, v123, v163
 MM a[68:71], a[200:203], a[220:223], a[68:71]
 MM a[88:91], a[200:203], a[224:227], a[88:91]
 s_waitcnt vmcnt(15)
 MM a[88:91], a[252:255], a[140:143], a[88:91]
 buffer_load_dwordx4 v[204:207], v13, s[16:19], s43 offen sc1
 MM a[92:95], v[184:187], a[140:143], a[92:95]
 MM a[92:95], a[204:207], a[224:227], a[92:95]
 MM a[96:99], a[208:211], a[224:227], a[96:99]
 MM a[96:99], v[188:191], a[140:143], a[96:99]
 MM a[100:103], a[128:131], a[140:143], a[100:103]
 MM a[100:103], a[212:215], a[224:227], a[100:103]
 MM a[104:107], a[216:219], a[224:227], a[104:107]
 MM a[104:107], a[132:135], a[140:143], a[104:107]
 s_waitcnt vmcnt(15)
 MM a[124:127], a[132:135], a[144:147], a[124:127]
 buffer_load_dword v8, off, s[16:19], s91 offset:4 sc1
 MM a[124:127], a[216:219], a[228:231], a[124:127]
 buffer_load_dwordx4 v[208:211], v14, s[16:19], s43 offen sc1
 MM a[120:123], a[212:215], a[228:231], a[120:123]
 MM a[120:123], a[128:131], a[144:147], a[120:123]
 MM a[116:119], v[188:191], a[144:147], a[116:119]
 MM a[116:119], a[208:211], a[228:231], a[116:119]
 MM a[112:115], a[204:207], a[228:231], a[112:115]
 MM a[112:115], v[184:187], a[144:147], a[112:115]
 MM a[108:111], a[252:255], a[144:147], a[108:111]
 MM a[108:111], a[200:203], a[228:231], a[108:111]
 MM v[24:27], a[200:203], a[232:235], v[24:27]
 s_waitcnt vmcnt(16)
 MM v[24:27], a[252:255], a[148:151], v[24:27]
 buffer_load_dwordx4 v[212:215], v15, s[16:19], s43 offen sc1
 MM v[28:31], v[184:187], a[148:151], v[28:31]
 s_add_u32 s42, s22, 36864
 s_add_u32 s41, s86, 46080
 s_add_u32 s40, s84, 36864
 MM v[28:31], a[204:207], a[232:235], v[28:31]
 buffer_load_dwordx4 v[216:219], v12, s[16:19], s42 offen sc1
 MM v[32:35], a[208:211], a[232:235], v[32:35]
 MM v[32:35], v[188:191], a[148:151], v[32:35]
 buffer_load_dwordx4 v[220:223], v1, s[16:19], s41 offen offset:0 sc1
 MM v[36:39], a[128:131], a[148:151], v[36:39]
 MM v[36:39], a[212:215], a[232:235], v[36:39]
 buffer_load_dwordx4 v[224:227], v1, s[16:19], s41 offen offset:1024 sc1
 MM v[40:43], a[216:219], a[232:235], v[40:43]
 s_waitcnt vmcnt(19)
 MM v[40:43], a[132:135], a[148:151], v[40:43]
 buffer_load_dwordx4 v[228:231], v1, s[16:19], s41 offen offset:2048 sc1
 MM v[60:63], a[132:135], a[152:155], v[60:63]
 MM v[60:63], a[216:219], a[236:239], v[60:63]
 buffer_load_dwordx4 v[232:235], v1, s[16:19], s41 offen offset:3072 sc1
 MM v[56:59], a[212:215], a[236:239], v[56:59]
 MM v[56:59], a[128:131], a[152:155], v[56:59]
 buffer_load_dwordx4 v[236:239], v2, s[16:19], s41 offen offset:0 sc1
 MM v[52:55], v[188:191], a[152:155], v[52:55]
 MM v[52:55], a[208:211], a[236:239], v[52:55]
 buffer_load_dwordx4 v[240:243], v13, s[16:19], s42 offen sc1
 MM v[48:51], a[204:207], a[236:239], v[48:51]
 MM v[48:51], v[184:187], a[152:155], v[48:51]
 buffer_load_dwordx4 v[244:247], v14, s[16:19], s42 offen sc1
 MM v[44:47], a[252:255], a[152:155], v[44:47]
 MM v[44:47], a[200:203], a[236:239], v[44:47]
 buffer_load_dwordx4 v[248:251], v15, s[16:19], s42 offen sc1
 MM v[64:67], a[200:203], a[240:243], v[64:67]
 s_waitcnt vmcnt(24)
 MM v[64:67], a[252:255], a[156:159], v[64:67]
 buffer_load_dwordx4 v[252:255], v12, s[16:19], s40 offen sc1
 MM v[68:71], v[184:187], a[156:159], v[68:71]
 MM v[68:71], a[204:207], a[240:243], v[68:71]
 buffer_load_dwordx4 a[0:3], v13, s[16:19], s40 offen sc1
 MM v[72:75], a[208:211], a[240:243], v[72:75]
 MM v[72:75], v[188:191], a[156:159], v[72:75]
 buffer_load_dwordx4 a[4:7], v14, s[16:19], s40 offen sc1
 MM v[76:79], a[128:131], a[156:159], v[76:79]
 MM v[76:79], a[212:215], a[240:243], v[76:79]
 buffer_load_dwordx4 a[8:11], v15, s[16:19], s40 offen sc1
 MM v[80:83], a[216:219], a[240:243], v[80:83]
 s_add_u32 s88, s22, 40960
 s_add_u32 s87, s86, 51200
 s_add_u32 s43, s84, 40960
 MM v[80:83], a[132:135], a[156:159], v[80:83]
 buffer_load_dwordx4 a[12:15], v12, s[16:19], s88 offen sc1
 s_waitcnt vmcnt(28)
 MM v[100:103], a[132:135], a[160:163], v[100:103]
 MM v[100:103], a[216:219], a[244:247], v[100:103]
 buffer_load_dwordx4 a[16:19], v1, s[16:19], s87 offen offset:0 sc1
 MM v[96:99], a[212:215], a[244:247], v[96:99]
 MM v[96:99], a[128:131], a[160:163], v[96:99]
 buffer_load_dwordx4 a[20:23], v1, s[16:19], s87 offen offset:1024 sc1
 MM v[92:95], v[188:191], a[160:163], v[92:95]
 MM v[92:95], a[208:211], a[244:247], v[92:95]
 buffer_load_dwordx4 a[24:27], v1, s[16:19], s87 offen offset:2048 sc1
 MM v[88:91], a[204:207], a[244:247], v[88:91]
 MM v[88:91], v[184:187], a[160:163], v[88:91]
 buffer_load_dwordx4 a[28:31], v1, s[16:19], s87 offen offset:3072 sc1
 MM v[84:87], a[252:255], a[160:163], v[84:87]
 s_waitcnt vmcnt(30)
 MM v[84:87], a[200:203], a[244:247], v[84:87]
 buffer_load_dwordx4 a[32:35], v2, s[16:19], s87 offen offset:0 sc1
 MM a[48:51], a[168:171], a[164:167], a[48:51]
 s_waitcnt vmcnt(16)
 s_waitcnt vmcnt(17)
 MM a[48:51], v[220:223], v[216:219], a[48:51]
 buffer_load_dwordx4 a[36:39], v13, s[16:19], s88 offen sc1
 MM a[52:55], v[224:227], v[216:219], a[52:55]
 MM a[52:55], a[172:175], a[164:167], a[52:55]
 buffer_load_dwordx4 a[40:43], v14, s[16:19], s88 offen sc1
 MM a[56:59], a[176:179], a[164:167], a[56:59]
 s_waitcnt vmcnt(16)
 s_waitcnt vmcnt(17)
 MM a[56:59], v[228:231], v[216:219], a[56:59]
 buffer_load_dwordx4 a[44:47], v15, s[16:19], s88 offen sc1
 MM a[60:63], v[232:235], v[216:219], a[60:63]
 MM a[60:63], a[180:183], a[164:167], a[60:63]
 MM a[64:67], a[184:187], a[164:167], a[64:67]
 s_waitcnt vmcnt(16)
 MM a[64:67], v[236:239], v[216:219], a[64:67]
 s_waitcnt vmcnt(15)
 MM a[84:87], v[236:239], v[240:243], a[84:87]
 v_cmp_ne_u32 vcc, s61, v8
 s_cbranch_vccnz spin6
spun6:
 MM a[84:87], a[184:187], a[188:191], a[84:87]
 buffer_load_dwordx4 a[192:195], v12, s[16:19], s43 offen sc1
 MM a[80:83], a[180:183], a[188:191], a[80:83]
 MM a[80:83], v[232:235], v[240:243], a[80:83]
 MM a[76:79], v[228:231], v[240:243], a[76:79]
 MM a[76:79], a[176:179], a[188:191], a[76:79]
 buffer_load_dwordx4 v[124:127], v1, s[16:19], s95 offen offset:0 sc1
 MM a[72:75], a[172:175], a[188:191], a[72:75]
 buffer_load_dwordx4 v[128:131], v1, s[16:19], s95 offen offset:1024 sc1
 MM a[72:75], v[224:227], v[240:243], a[72:75]
 buffer_load_dwordx4 v[132:135], v1, s[16:19], s95 offen offset:2048 sc1
 MM a[68:71], v[220:223], v[240:243], a[68:71]
 buffer_load_dwordx4 v[136:139], v1, s[16:19], s95 offen offset:3072 sc1
 MM a[68:71], a[168:171], a[188:191], a[68:71]
 buffer_load_dwordx4 v[140:143], v2, s[16:19], s95 offen offset:0 sc1
 MM a[88:91], a[168:171], v[192:195], a[88:91]
 s_waitcnt vmcnt(20)
 MM a[88:91], v[220:223], v[244:247], a[88:91]
 buffer_load_dwordx4 a[196:199], v13, s[16:19], s43 offen sc1
 MM a[92:95], v[224:227], v[244:247], a[92:95]
 MM a[92:95], a[172:175], v[192:195], a[92:95]
 MM a[96:99], a[176:179], v[192:195], a[96:99]
 MM a[96:99], v[228:231], v[244:247], a[96:99]
 MM a[100:103], v[232:235], v[244:247], a[100:103]
 MM a[100:103], a[180:183], v[192:195], a[100:103]
 MM a[104:107], a[184:187], v[192:195], a[104:107]
 MM a[104:107], v[236:239], v[244:247], a[104:107]
 s_waitcnt vmcnt(20)
 MM a[124:127], v[236:239], v[248:251], a[124:127]
 buffer_load_dwordx4 a[200:203], v14, s[16:19], s43 offen sc1
 MM a[124:127], a[184:187], v[196:199], a[124:127]
 MM a[120:123], a[180:183], v[196:199], a[120:123]
 MM a[120:123], v[232:235], v[248:251], a[120:123]
 MM a[116:119], v[228:231], v[248:251], a[116:119]
 MM a[116:119], a[176:179], v[196:199], a[116:119]
 MM a[112:115], a[172:175], v[196:199], a[112:115]
 MM a[112:115], v[224:227], v[248:251], a[112:115]
 MM a[108:111], v[220:223], v[248:251], a[108:111]
 MM a[108:111], a[168:171], v[196:199], a[108:111]
 MM v[24:27], a[168:171], v[200:203], v[24:27]
 s_waitcnt vmcnt(20)
 MM v[24:27], v[220:223], v[252:255], v[24:27]
 buffer_load_dwordx4 a[204:207], v15, s[16:19], s43 offen sc1
 MM v[28:31], v[224:227], v[252:255], v[28:31]
 s_add_u32 s42, s22, 45056
 s_add_u32 s41, s86, 56320
 s_add_u32 s40, s84, 45056
 MM v[28:31], a[172:175], v[200:203], v[28:31]
 buffer_load_dwordx4 a[208:211], v12, s[16:19], s42 offen sc1
 MM v[32:35], a[176:179], v[200:203], v[32:35]
 MM v[32:35], v[228:231], v[252:255], v[32:35]
 buffer_load_dwordx4 a[212:215], v1, s[16:19], s41 offen offset:0 sc1
 MM v[36:39], v[232:235], v[252:255], v[36:39]
 MM v[36:39], a[180:183], v[200:203], v[36:39]
 buffer_load_dwordx4 a[216:219], v1, s[16:19], s41 offen offset:1024 sc1
 MM v[40:43], a[184:187], v[200:203], v[40:43]
 s_waitcnt vmcnt(23)
 MM v[40:43], v[236:239], v[252:255], v[40:43]
 buffer_load_dwordx4 a[220:223], v1, s[16:19], s41 offen offset:2048 sc1
 MM v[60:63], v[236:239], a[0:3], v[60:63]
 MM v[60:63], a[184:187], v[204:207], v[60:63]
 buffer_load_dwordx4 a[224:227], v1, s[16:19], s41 offen offset:3072 sc1
 MM v[56:59], a[180:183], v[204:207], v[56:59]
 MM v[56:59], v[232:235], a[0:3], v[56:59]
 buffer_load_dwordx4 a[228:231], v2, s[16:19], s41 offen offset:0 sc1
 MM v[52:55], v[228:231], a[0:3], v[52:55]
 MM v[52:55], a[176:179], v[204:207], v[52:55]
 buffer_load_dwordx4 a[232:235], v13, s[16:19], s42 offen sc1
 MM v[48:51], a[172:175], v[204:207], v[48:51]
 MM v[48:51], v[224:227], a[0:3], v[48:51]
 buffer_load_dwordx4 a[236:239], v14, s[16:19], s42 offen sc1
 MM v[44:47], v[220:223], a[0:3], v[44:47]
 MM v[44:47], a[168:171], v[204:207], v[44:47]
 buffer_load_dwordx4 a[240:243], v15, s[16:19], s42 offen sc1
 MM v[64:67], a[168:171], v[208:211], v[64:67]
 s_waitcnt vmcnt(28)
 MM v[64:67], v[220:223], a[4:7], v[64:67]
 buffer_load_dwordx4 a[244:247], v12, s[16:19], s40 offen sc1
 MM v[68:71], v[224:227], a[4:7], v[68:71]
 MM v[68:71], a[172:175], v[208:211], v[68:71]
 buffer_load_dwordx4 a[248:251], v13, s[16:19], s40 offen sc1
 MM v[72:75], a[176:179], v[208:211], v[72:75]
 MM v[72:75], v[228:231], a[4:7], v[72:75]
 buffer_load_dwordx4 a[252:255], v14, s[16:19], s40 offen sc1
 MM v[76:79], v[232:235], a[4:7], v[76:79]
 MM v[76:79], a[180:183], v[208:211], v[76:79]
 buffer_load_dwordx4 v[184:187], v15, s[16:19], s40 offen sc1
 MM v[80:83], a[184:187], v[208:211], v[80:83]
 s_add_u32 s88, s22, 49152
 s_add_u32 s87, s86, 61440
 s_add_u32 s43, s84, 49152
 MM v[80:83], v[236:239], a[4:7], v[80:83]
 buffer_load_dwordx4 v[188:191], v12, s[16:19], s88 offen sc1
 s_waitcnt vmcnt(32)
 MM v[100:103], v[236:239], a[8:11], v[100:103]
 MM v[100:103], a[184:187], v[212:215], v[100:103]
 buffer_load_dwordx4 a[128:131], v1, s[16:19], s87 offen offset:0 sc1
 MM v[96:99], a[180:183], v[212:215], v[96:99]
 MM v[96:99], v[232:235], a[8:11], v[96:99]
 buffer_load_dwordx4 a[132:135], v1, s[16:19], s87 offen offset:1024 sc1
 MM v[92:95], v[228:231], a[8:11], v[92:95]
 s_waitcnt vmcnt(23)
 v_add_f32 v104, v104, v124
 v_add_f32 v105, v105, v125
 MM v[92:95], a[176:179], v[212:215], v[92:95]
 buffer_load_dwordx4 a[136:139], v1, s[16:19], s87 offen offset:2048 sc1
 MM v[88:91], a[172:175], v[212:215], v[88:91]
 v_add_f32 v106, v106, v126
 v_add_f32 v107, v107, v127
 MM v[88:91], v[224:227], a[8:11], v[88:91]
 buffer_load_dwordx4 a[140:143], v1, s[16:19], s87 offen offset:3072 sc1
 MM v[84:87], v[220:223], a[8:11], v[84:87]
 s_waitcnt vmcnt(24)
 v_add_f32 v108, v108, v128
 v_add_f32 v109, v109, v129
 MM v[84:87], a[168:171], v[212:215], v[84:87]
 buffer_load_dwordx4 a[144:147], v2, s[16:19], s87 offen offset:0 sc1
 MM a[48:51], a[16:19], a[12:15], a[48:51]
 s_waitcnt vmcnt(17)
 v_add_f32 v110, v110, v130
 v_add_f32 v111, v111, v131
 MM a[48:51], a[212:215], a[208:211], a[48:51]
 buffer_load_dwordx4 a[148:151], v13, s[16:19], s88 offen sc1
 s_waitcnt vmcnt(17)
 MM a[52:55], a[216:219], a[208:211], a[52:55]
 v_add_f32 v112, v112, v132
 v_add_f32 v113, v113, v133
 MM a[52:55], a[20:23], a[12:15], a[52:55]
 buffer_load_dwordx4 a[152:155], v14, s[16:19], s88 offen sc1
 MM a[56:59], a[24:27], a[12:15], a[56:59]
 s_waitcnt vmcnt(17)
 v_add_f32 v114, v114, v134
 v_add_f32 v115, v115, v135
 MM a[56:59], a[220:223], a[208:211], a[56:59]
 buffer_load_dwordx4 a[156:159], v15, s[16:19], s88 offen sc1
 s_waitcnt vmcnt(17)
 MM a[60:63], a[224:227], a[208:211], a[60:63]
 v_add_f32 v116, v116, v136
 v_add_f32 v117, v117, v137
 MM a[60:63], a[28:31], a[12:15], a[60:63]
 v_add_f32 v118, v118, v138
 v_add_f32 v119, v119, v139
 MM a[64:67], a[32:35], a[12:15], a[64:67]
 s_waitcnt vmcnt(16)
 v_add_f32 v120, v120, v140
 v_add_f32 v121, v121, v141
 MM a[64:67], a[228:231], a[208:211], a[64:67]
 s_waitcnt vmcnt(15)
 v_add_f32 v122, v122, v142
 v_add_f32 v123, v123, v143
 MM a[84:87], a[228:231], a[232:235], a[84:87]
 buffer_load_dwordx4 a[160:163], v12, s[16:19], s43 offen sc1
 MM a[84:87], a[32:35], a[36:39], a[84:87]
 v_cvt_pk_bf16_f32 v124, v104, v105
 v_lshlrev_b32 v104, 16, v124
 MM a[80:83], a[28:31], a[36:39], a[80:83]
 v_and_b32 v105, 0xffff0000, v124
 v_cvt_pk_bf16_f32 v126, v106, v107
 MM a[80:83], a[224:227], a[232:235], a[80:83]
 v_lshlrev_b32 v106, 16, v126
 v_and_b32 v107, 0xffff0000, v126
 MM a[76:79], a[220:223], a[232:235], a[76:79]
 v_cvt_pk_bf16_f32 v128, v108, v109
 v_lshlrev_b32 v108, 16, v128
 MM a[76:79], a[24:27], a[36:39], a[76:79]
 v_and_b32 v109, 0xffff0000, v128
 v_cvt_pk_bf16_f32 v130, v110, v111
 MM a[72:75], a[20:23], a[36:39], a[72:75]
 v_lshlrev_b32 v110, 16, v130
 v_and_b32 v111, 0xffff0000, v130
 MM a[72:75], a[216:219], a[232:235], a[72:75]
 v_cvt_pk_bf16_f32 v132, v112, v113
 v_lshlrev_b32 v112, 16, v132
 MM a[68:71], a[212:215], a[232:235], a[68:71]
 v_and_b32 v113, 0xffff0000, v132
 v_cvt_pk_bf16_f32 v134, v114, v115
 MM a[68:71], a[16:19], a[36:39], a[68:71]
 v_lshlrev_b32 v114, 16, v134
 v_and_b32 v115, 0xffff0000, v134
 MM a[88:91], a[16:19], a[40:43], a[88:91]
 s_waitcnt vmcnt(15)
 v_cvt_pk_bf16_f32 v136, v116, v117
 v_lshlrev_b32 v116, 16, v136
 MM a[88:91], a[212:215], a[236:239], a[88:91]
 buffer_load_dwordx4 a[164:167], v13, s[16:19], s43 offen sc1
 MM a[92:95], a[216:219], a[236:239], a[92:95]
 v_and_b32 v117, 0xffff0000, v136
 v_cvt_pk_bf16_f32 v138, v118, v119
 MM a[92:95], a[20:23], a[40:43], a[92:95]
 v_lshlrev_b32 v118, 16, v138
 v_and_b32 v119, 0xffff0000, v138
 MM a[96:99], a[24:27], a[40:43], a[96:99]
 v_cvt_pk_bf16_f32 v140, v120, v121
 v_lshlrev_b32 v120, 16, v140
 MM a[96:99], a[220:223], a[236:239], a[96:99]
 v_and_b32 v121, 0xffff0000, v140
 v_cvt_pk_bf16_f32 v142, v122, v123
 MM a[100:103], a[224:227], a[236:239], a[100:103]
 v_lshlrev_b32 v122, 16, v142
 v_and_b32 v123, 0xffff0000, v142
 MM a[100:103], a[28:31], a[40:43], a[100:103]
 v_mul_f32 v124, 0xbfb8aa3b, v104
 v_mul_f32 v125, 0xbfb8aa3b, v105
 MM a[104:107], a[32:35], a[40:43], a[104:107]
 v_mul_f32 v126, 0xbfb8aa3b, v106
 v_mul_f32 v127, 0xbfb8aa3b, v107
 MM a[104:107], a[228:231], a[236:239], a[104:107]
 s_waitcnt vmcnt(15)
 v_mul_f32 v128, 0xbfb8aa3b, v108
 v_mul_f32 v129, 0xbfb8aa3b, v109
 MM a[124:127], a[228:231], a[240:243], a[124:127]
 buffer_load_dwordx4 a[168:171], v14, s[16:19], s43 offen sc1
 MM a[124:127], a[32:35], a[44:47], a[124:127]
 v_mul_f32 v130, 0xbfb8aa3b, v110
 v_mul_f32 v131, 0xbfb8aa3b, v111
 MM a[120:123], a[28:31], a[44:47], a[120:123]
 v_mul_f32 v132, 0xbfb8aa3b, v112
 v_mul_f32 v133, 0xbfb8aa3b, v113
 MM a[120:123], a[224:227], a[240:243], a[120:123]
 v_mul_f32 v134, 0xbfb8aa3b, v114
 v_mul_f32 v135, 0xbfb8aa3b, v115
 MM a[116:119], a[220:223], a[240:243], a[116:119]
 v_mul_f32 v136, 0xbfb8aa3b, v116
 v_mul_f32 v137, 0xbfb8aa3b, v117
 MM a[116:119], a[24:27], a[44:47], a[116:119]
 v_mul_f32 v138, 0xbfb8aa3b, v118
 v_mul_f32 v139, 0xbfb8aa3b, v119
 MM a[112:115], a[20:23], a[44:47], a[112:115]
 v_mul_f32 v140, 0xbfb8aa3b, v120
 v_mul_f32 v141, 0xbfb8aa3b, v121
 MM a[112:115], a[216:219], a[240:243], a[112:115]
 v_mul_f32 v142, 0xbfb8aa3b, v122
 v_mul_f32 v143, 0xbfb8aa3b, v123
 MM a[108:111], a[212:215], a[240:243], a[108:111]
 v_exp_f32 v124, v124
 MM a[108:111], a[16:19], a[44:47], a[108:111]
 v_exp_f32 v125, v125
 MM v[24:27], a[16:19], a[192:195], v[24:27]
 s_waitcnt vmcnt(15)
 v_exp_f32 v126, v126
 MM v[24:27], a[212:215], a[244:247], v[24:27]
 buffer_load_dwordx4 a[172:175], v15, s[16:19], s43 offen sc1
 MM v[28:31], a[216:219], a[244:247], v[28:31]
 s_add_u32 s42, s22, 53248
 s_add_u32 s41, s86, 66560
 s_add_u32 s40, s84, 53248
 MM v[28:31], a[20:23], a[192:195], v[28:31]
 buffer_load_dwordx4 a[176:179], v12, s[16:19], s42 offen sc1
 MM v[32:35], a[24:27], a[192:195], v[32:35]
 v_exp_f32 v127, v127
 MM v[32:35], a[220:223], a[244:247], v[32:35]
 buffer_load_dwordx4 a[180:183], v1, s[16:19], s41 offen offset:0 sc1
 MM v[36:39], a[224:227], a[244:247], v[36:39]
 v_exp_f32 v128, v128
 MM v[36:39], a[28:31], a[192:195], v[36:39]
 buffer_load_dwordx4 a[184:187], v1, s[16:19], s41 offen offset:1024 sc1
 MM v[40:43], a[32:35], a[192:195], v[40:43]
 s_waitcnt vmcnt(18)
 v_exp_f32 v129, v129
 MM v[40:43], a[228:231], a[244:247], v[40:43]
 buffer_load_dwordx4 a[188:191], v1, s[16:19], s41 offen offset:2048 sc1
 MM v[60:63], a[228:231], a[248:251], v[60:63]
 v_exp_f32 v130, v130
 MM v[60:63], a[32:35], a[196:199], v[60:63]
 buffer_load_dwordx4 v[192:195], v1, s[16:19], s41 offen offset:3072 sc1
 MM v[56:59], a[28:31], a[196:199], v[56:59]
 v_exp_f32 v131, v131
 MM v[56:59], a[224:227], a[248:251], v[56:59]
 buffer_load_dwordx4 v[196:199], v2, s[16:19], s41 offen offset:0 sc1
 MM v[52:55], a[220:223], a[248:251], v[52:55]
 v_exp_f32 v132, v132
 MM v[52:55], a[24:27], a[196:199], v[52:55]
 buffer_load_dwordx4 v[200:203], v13, s[16:19], s42 offen sc1
 MM v[48:51], a[20:23], a[196:199], v[48:51]
 v_exp_f32 v133, v133
 MM v[48:51], a[216:219], a[248:251], v[48:51]
 buffer_load_dwordx4 v[204:207], v14, s[16:19], s42 offen sc1
 MM v[44:47], a[212:215], a[248:251], v[44:47]
 v_exp_f32 v134, v134
 MM v[44:47], a[16:19], a[196:199], v[44:47]
 buffer_load_dwordx4 v[208:211], v15, s[16:19], s42 offen sc1
 MM v[64:67], a[16:19], a[200:203], v[64:67]
 s_waitcnt vmcnt(23)
 v_exp_f32 v135, v135
 MM v[64:67], a[212:215], a[252:255], v[64:67]
 buffer_load_dwordx4 v[212:215], v12, s[16:19], s40 offen sc1
 MM v[68:71], a[216:219], a[252:255], v[68:71]
 v_exp_f32 v136, v136
 MM v[68:71], a[20:23], a[200:203], v[68:71]
 buffer_load_dwordx4 v[216:219], v13, s[16:19], s40 offen sc1
 MM v[72:75], a[24:27], a[200:203], v[72:75]
 v_exp_f32 v137, v137
 MM v[72:75], a[220:223], a[252:255], v[72:75]
 buffer_load_dwordx4 v[220:223], v14, s[16:19], s40 offen sc1
 MM v[76:79], a[224:227], a[252:255], v[76:79]
 v_exp_f32 v138, v138
 MM v[76:79], a[28:31], a[200:203], v[76:79]
 buffer_load_dwordx4 v[224:227], v15, s[16:19], s40 offen sc1
 MM v[80:83], a[32:35], a[200:203], v[80:83]
 s_waitcnt vmcnt(26)
 s_add_u32 s43, s14, 0
 s_add_u32 s87, s15, 0
 MM v[80:83], a[228:231], a[252:255], v[80:83]
 buffer_load_dwordx4 v[228:231], v12, s[16:19], s43 offen sc1
 MM v[100:103], a[228:231], v[184:187], v[100:103]
 v_exp_f32 v139, v139
 MM v[100:103], a[32:35], a[204:207], v[100:103]
 buffer_load_dwordx4 v[232:235], v1, s[16:19], s87 offen offset:0 sc1
 MM v[96:99], a[28:31], a[204:207], v[96:99]
 v_exp_f32 v140, v140
 MM v[96:99], a[224:227], v[184:187], v[96:99]
 buffer_load_dwordx4 v[236:239], v1, s[16:19], s87 offen offset:1024 sc1
 MM v[92:95], a[220:223], v[184:187], v[92:95]
 v_exp_f32 v141, v141
 MM v[92:95], a[24:27], a[204:207], v[92:95]
 buffer_load_dwordx4 v[240:243], v1, s[16:19], s87 offen offset:2048 sc1
 MM v[88:91], a[20:23], a[204:207], v[88:91]
 v_exp_f32 v142, v142
 MM v[88:91], a[216:219], v[184:187], v[88:91]
 buffer_load_dwordx4 v[244:247], v1, s[16:19], s87 offen offset:3072 sc1
 MM v[84:87], a[212:215], v[184:187], v[84:87]
 s_waitcnt vmcnt(29)
 v_exp_f32 v143, v143
 MM v[84:87], a[16:19], a[204:207], v[84:87]
 buffer_load_dwordx4 v[248:251], v2, s[16:19], s87 offen offset:0 sc1
 MM a[48:51], a[128:131], v[188:191], a[48:51]
 s_waitcnt vmcnt(17)
 v_add_f32 v124, 1.0, v124
 v_add_f32 v125, 1.0, v125
 MM a[48:51], a[180:183], a[176:179], a[48:51]
 buffer_load_dwordx4 v[252:255], v13, s[16:19], s43 offen sc1
 s_waitcnt vmcnt(17)
 MM a[52:55], a[184:187], a[176:179], a[52:55]
 s_barrier
 v_add_f32 v126, 1.0, v126
 v_add_f32 v127, 1.0, v127
 MM a[52:55], a[132:135], v[188:191], a[52:55]
 buffer_load_dwordx4 a[0:3], v14, s[16:19], s43 offen sc1
 MM a[56:59], a[136:139], v[188:191], a[56:59]
 s_waitcnt vmcnt(17)
 v_add_f32 v128, 1.0, v128
 v_add_f32 v129, 1.0, v129
 MM a[56:59], a[188:191], a[176:179], a[56:59]
 buffer_load_dwordx4 a[4:7], v15, s[16:19], s43 offen sc1
 s_waitcnt vmcnt(17)
 MM a[60:63], v[192:195], a[176:179], a[60:63]
 s_add_u32 s40, s14, 4096
 s_add_u32 s41, s15, 5120
 v_add_f32 v130, 1.0, v130
 MM a[60:63], a[140:143], v[188:191], a[60:63]
 buffer_load_dwordx4 a[8:11], v12, s[16:19], s40 offen sc1
 MM a[64:67], a[144:147], v[188:191], a[64:67]
 s_waitcnt vmcnt(17)
 v_add_f32 v131, 1.0, v131
 v_add_f32 v132, 1.0, v132
 MM a[64:67], v[196:199], a[176:179], a[64:67]
 buffer_load_dwordx4 a[12:15], v1, s[16:19], s41 offen offset:0 sc1
 s_waitcnt vmcnt(17)
 MM a[84:87], v[196:199], v[200:203], a[84:87]
 ds_write_b128 v19, a[48:51] offset:0
 MM a[84:87], a[144:147], a[148:151], a[84:87]
 buffer_load_dwordx4 a[16:19], v1, s[16:19], s41 offen offset:1024 sc1
 MM a[80:83], a[140:143], a[148:151], a[80:83]
 ds_write_b128 v19, a[52:55] offset:1024
 MM a[80:83], v[192:195], v[200:203], a[80:83]
 buffer_load_dwordx4 a[20:23], v1, s[16:19], s41 offen offset:2048 sc1
 MM a[76:79], a[188:191], v[200:203], a[76:79]
 ds_write_b128 v19, a[56:59] offset:2048
 MM a[76:79], a[136:139], a[148:151], a[76:79]
 buffer_load_dwordx4 a[24:27], v1, s[16:19], s41 offen offset:3072 sc1
 MM a[72:75], a[132:135], a[148:151], a[72:75]
 ds_write_b128 v19, a[60:63] offset:3072
 MM a[72:75], a[184:187], v[200:203], a[72:75]
 buffer_load_dwordx4 a[28:31], v2, s[16:19], s41 offen offset:0 sc1
 MM a[68:71], a[180:183], v[200:203], a[68:71]
 ds_write_b128 v19, a[64:67] offset:4096
 MM a[68:71], a[128:131], a[148:151], a[68:71]
 buffer_load_dwordx4 a[32:35], v13, s[16:19], s40 offen sc1
 MM a[88:91], a[128:131], a[152:155], a[88:91]
 ds_write_b128 v10, a[84:87] offset:9216
 s_waitcnt vmcnt(21)
 MM a[88:91], a[180:183], v[204:207], a[88:91]
 buffer_load_dwordx4 a[36:39], v14, s[16:19], s40 offen sc1
 MM a[92:95], a[184:187], v[204:207], a[92:95]
 ds_write_b128 v10, a[80:83] offset:8192
 MM a[92:95], a[132:135], a[152:155], a[92:95]
 buffer_load_dwordx4 a[40:43], v15, s[16:19], s40 offen sc1
 MM a[96:99], a[136:139], a[152:155], a[96:99]
 s_add_u32 s43, s14, 8192
 s_add_u32 s87, s15, 10240
 v_add_f32 v133, 1.0, v133
 MM a[96:99], a[188:191], v[204:207], a[96:99]
 buffer_load_dwordx4 a[44:47], v12, s[16:19], s43 offen sc1
 MM a[100:103], v[192:195], v[204:207], a[100:103]
 ds_write_b128 v10, a[76:79] offset:7168
 MM a[100:103], a[140:143], a[152:155], a[100:103]
 buffer_load_dwordx4 a[192:195], v1, s[16:19], s87 offen offset:0 sc1
 MM a[104:107], a[144:147], a[152:155], a[104:107]
 ds_write_b128 v10, a[72:75] offset:6144
 MM a[104:107], v[196:199], v[204:207], a[104:107]
 buffer_load_dwordx4 a[196:199], v1, s[16:19], s87 offen offset:1024 sc1
 s_waitcnt vmcnt(25)
 MM a[124:127], v[196:199], v[208:211], a[124:127]
 ds_write_b128 v10, a[68:71] offset:5120
 MM a[124:127], a[144:147], a[156:159], a[124:127]
 buffer_load_dwordx4 a[200:203], v1, s[16:19], s87 offen offset:2048 sc1
 MM a[120:123], a[140:143], a[156:159], a[120:123]
 ds_write_b128 v23, a[88:91] offset:10240
 MM a[120:123], v[192:195], v[208:211], a[120:123]
 buffer_load_dwordx4 a[204:207], v1, s[16:19], s87 offen offset:3072 sc1
 MM a[116:119], a[188:191], v[208:211], a[116:119]
 ds_write_b128 v23, a[92:95] offset:11264
 MM a[116:119], a[136:139], a[156:159], a[116:119]
 buffer_load_dwordx4 a[208:211], v2, s[16:19], s87 offen offset:0 sc1
 MM a[112:115], a[132:135], a[156:159], a[112:115]
 ds_write_b128 v23, a[96:99] offset:12288
 MM a[112:115], a[184:187], v[208:211], a[112:115]
 buffer_load_dwordx4 a[212:215], v13, s[16:19], s43 offen sc1
 MM a[108:111], a[180:183], v[208:211], a[108:111]
 ds_write_b128 v23, a[100:103] offset:13312
 MM a[108:111], a[128:131], a[156:159], a[108:111]
 buffer_load_dwordx4 a[216:219], v14, s[16:19], s43 offen sc1
 MM v[24:27], a[128:131], a[160:163], v[24:27]
 ds_write_b128 v23, a[104:107] offset:14336
 s_waitcnt vmcnt(29)
 MM v[24:27], a[180:183], v[212:215], v[24:27]
 buffer_load_dwordx4 a[220:223], v15, s[16:19], s43 offen sc1
 MM v[28:31], a[184:187], v[212:215], v[28:31]
 s_add_u32 s40, s14, 12288
 s_add_u32 s41, s15, 15360
 v_add_f32 v134, 1.0, v134
 MM v[28:31], a[132:135], a[160:163], v[28:31]
 buffer_load_dwordx4 a[224:227], v12, s[16:19], s40 offen sc1
 MM v[32:35], a[136:139], a[160:163], v[32:35]
 ds_write_b128 v0, a[124:127] offset:19456
 MM v[32:35], a[188:191], v[212:215], v[32:35]
 buffer_load_dwordx4 a[228:231], v1, s[16:19], s41 offen offset:0 sc1
 MM v[36:39], v[192:195], v[212:215], v[36:39]
 ds_write_b128 v0, a[120:123] offset:18432
 MM v[36:39], a[140:143], a[160:163], v[36:39]
 ds_write_b128 v0, a[116:119] offset:17408
 MM v[40:43], a[144:147], a[160:163], v[40:43]
 ds_write_b128 v0, a[112:115] offset:16384
 MM v[40:43], v[196:199], v[212:215], v[40:43]
 ds_write_b128 v0, a[108:111] offset:15360
 s_waitcnt vmcnt(31)
 MM v[60:63], v[196:199], v[216:219], v[60:63]
 buffer_load_dwordx4 a[232:235], v1, s[16:19], s41 offen offset:1024 sc1
 MM v[60:63], a[144:147], a[164:167], v[60:63]
 buffer_load_dwordx4 a[236:239], v1, s[16:19], s41 offen offset:2048 sc1
 MM v[56:59], a[140:143], a[164:167], v[56:59]
 s_waitcnt lgkmcnt(0)
 s_barrier
 ds_read_b128 v[144:147], v22 offset:0
 MM v[56:59], v[192:195], v[216:219], v[56:59]
 s_lshl_b32 s3, s2, 4
 s_add_u32 s3, s3, s24
 ds_read_b128 v[148:151], v22 offset:5120
 MM v[52:55], a[188:191], v[216:219], v[52:55]
 s_lshl_b32 s3, s3, 3
 s_add_u32 s3, s3, 70746112
 ds_read_b128 v[152:155], v22 offset:10240
 MM v[52:55], a[136:139], a[164:167], v[52:55]
 ds_read_b128 v[156:159], v22 offset:15360
 v_mov_b32 v6, s61
 MM v[48:51], a[132:135], a[164:167], v[48:51]
 buffer_load_dwordx4 a[240:243], v1, s[16:19], s41 offen offset:3072 sc1
 MM v[48:51], a[184:187], v[216:219], v[48:51]
 buffer_load_dwordx4 a[244:247], v2, s[16:19], s41 offen offset:0 sc1
 MM v[44:47], a[180:183], v[216:219], v[44:47]
 buffer_load_dwordx4 a[248:251], v13, s[16:19], s40 offen sc1
 MM v[44:47], a[128:131], a[164:167], v[44:47]
 buffer_load_dwordx4 a[252:255], v14, s[16:19], s40 offen sc1
 MM v[64:67], a[128:131], a[168:171], v[64:67]
 buffer_load_dwordx4 v[184:187], v15, s[16:19], s40 offen sc1
 s_waitcnt vmcnt(37)
 MM v[64:67], a[180:183], v[220:223], v[64:67]
 ds_read_b128 v[160:163], v22 offset:1024
 s_waitcnt lgkmcnt(2)
 v_add_f32 v144, v144, v148
 MM v[68:71], a[184:187], v[220:223], v[68:71]
 ds_read_b128 v[164:167], v22 offset:6144
 v_add_f32 v145, v145, v149
 MM v[68:71], a[132:135], a[168:171], v[68:71]
 ds_read_b128 v[168:171], v22 offset:11264
 v_add_f32 v146, v146, v150
 MM v[72:75], a[136:139], a[168:171], v[72:75]
 ds_read_b128 v[172:175], v22 offset:16384
 v_add_f32 v147, v147, v151
 MM v[72:75], a[188:191], v[220:223], v[72:75]
 s_waitcnt lgkmcnt(4)
 v_add_f32 v152, v152, v156
 v_add_f32 v153, v153, v157
 MM v[76:79], v[192:195], v[220:223], v[76:79]
 v_add_f32 v154, v154, v158
 v_add_f32 v155, v155, v159
 MM v[76:79], a[140:143], a[168:171], v[76:79]
 v_add_f32 v144, v144, v152
 v_add_f32 v145, v145, v153
 MM v[80:83], a[144:147], a[168:171], v[80:83]
 s_waitcnt vmcnt(36)
 v_add_f32 v146, v146, v154
 v_add_f32 v147, v147, v155
 MM v[80:83], v[196:199], v[220:223], v[80:83]
 buffer_store_dwordx4 v[144:147], v1, s[16:19], s89 offen offset:0 sc1
 MM v[100:103], v[196:199], v[224:227], v[100:103]
 ds_read_b128 v[144:147], v22 offset:2048
 s_waitcnt lgkmcnt(2)
 v_add_f32 v160, v160, v164
 MM v[100:103], a[144:147], a[172:175], v[100:103]
 ds_read_b128 v[148:151], v22 offset:7168
 v_add_f32 v161, v161, v165
 MM v[96:99], a[140:143], a[172:175], v[96:99]
 ds_read_b128 v[152:155], v22 offset:12288
 v_add_f32 v162, v162, v166
 MM v[96:99], v[192:195], v[224:227], v[96:99]
 ds_read_b128 v[156:159], v22 offset:17408
 v_add_f32 v163, v163, v167
 MM v[92:95], a[188:191], v[224:227], v[92:95]
 s_waitcnt lgkmcnt(4)
 v_add_f32 v168, v168, v172
 v_add_f32 v169, v169, v173
 MM v[92:95], a[136:139], a[172:175], v[92:95]
 v_add_f32 v170, v170, v174
 v_add_f32 v171, v171, v175
 MM v[88:91], a[132:135], a[172:175], v[88:91]
 v_add_f32 v160, v160, v168
 v_add_f32 v161, v161, v169
 MM v[88:91], a[184:187], v[224:227], v[88:91]
 v_add_f32 v162, v162, v170
 v_add_f32 v163, v163, v171
 MM v[84:87], a[180:183], v[224:227], v[84:87]
 buffer_store_dwordx4 v[160:163], v1, s[16:19], s89 offen offset:1024 sc1
 MM v[84:87], a[128:131], a[172:175], v[84:87]
 s_waitcnt vmcnt(36)
 ds_read_b128 v[160:163], v22 offset:3072
 s_waitcnt lgkmcnt(2)
 v_add_f32 v144, v144, v148
 MM v[24:27], v[232:235], v[228:231], v[24:27]
 s_waitcnt vmcnt(27)
 ds_read_b128 v[164:167], v22 offset:8192
 v_add_f32 v145, v145, v149
 MM v[24:27], a[12:15], a[8:11], v[24:27]
 s_waitcnt vmcnt(26)
 ds_read_b128 v[168:171], v22 offset:13312
 v_add_f32 v146, v146, v150
 MM v[28:31], a[16:19], a[8:11], v[28:31]
 ds_read_b128 v[172:175], v22 offset:18432
 v_add_f32 v147, v147, v151
 MM v[28:31], v[236:239], v[228:231], v[28:31]
 s_waitcnt lgkmcnt(4)
 v_add_f32 v152, v152, v156
 v_add_f32 v153, v153, v157
 MM v[32:35], v[240:243], v[228:231], v[32:35]
 s_waitcnt vmcnt(25)
 v_add_f32 v154, v154, v158
 v_add_f32 v155, v155, v159
 MM v[32:35], a[20:23], a[8:11], v[32:35]
 s_waitcnt vmcnt(24)
 v_add_f32 v144, v144, v152
 v_add_f32 v145, v145, v153
 MM v[36:39], a[24:27], a[8:11], v[36:39]
 v_add_f32 v146, v146, v154
 v_add_f32 v147, v147, v155
 MM v[36:39], v[244:247], v[228:231], v[36:39]
 buffer_store_dwordx4 v[144:147], v1, s[16:19], s89 offen offset:2048 sc1
 MM v[40:43], v[248:251], v[228:231], v[40:43]
 s_waitcnt vmcnt(24)
 ds_read_b128 v[144:147], v22 offset:4096
 s_waitcnt lgkmcnt(2)
 v_add_f32 v160, v160, v164
 MM v[40:43], a[28:31], a[8:11], v[40:43]
 s_waitcnt vmcnt(23)
 ds_read_b128 v[148:151], v22 offset:9216
 v_add_f32 v161, v161, v165
 MM v[60:63], a[28:31], a[32:35], v[60:63]
 ds_read_b128 v[152:155], v22 offset:14336
 v_add_f32 v162, v162, v166
 MM v[60:63], v[248:251], v[252:255], v[60:63]
 ds_read_b128 v[156:159], v22 offset:19456
 v_add_f32 v163, v163, v167
 MM v[56:59], v[244:247], v[252:255], v[56:59]
 s_waitcnt lgkmcnt(4)
 v_add_f32 v168, v168, v172
 v_add_f32 v169, v169, v173
 MM v[56:59], a[24:27], a[32:35], v[56:59]
 v_add_f32 v170, v170, v174
 v_add_f32 v171, v171, v175
 MM v[52:55], a[20:23], a[32:35], v[52:55]
 v_add_f32 v160, v160, v168
 v_add_f32 v161, v161, v169
 MM v[52:55], v[240:243], v[252:255], v[52:55]
 v_add_f32 v162, v162, v170
 v_add_f32 v163, v163, v171
 MM v[48:51], v[236:239], v[252:255], v[48:51]
 buffer_store_dwordx4 v[160:163], v1, s[16:19], s89 offen offset:3072 sc1
 MM v[48:51], a[16:19], a[32:35], v[48:51]
 s_waitcnt lgkmcnt(1)
 v_add_f32 v144, v144, v148
 v_add_f32 v145, v145, v149
 MM v[44:47], a[12:15], a[32:35], v[44:47]
 v_add_f32 v146, v146, v150
 v_add_f32 v147, v147, v151
 MM v[44:47], v[232:235], v[252:255], v[44:47]
 s_waitcnt lgkmcnt(0)
 v_add_f32 v152, v152, v156
 v_add_f32 v153, v153, v157
 MM v[64:67], v[232:235], a[0:3], v[64:67]
 s_waitcnt vmcnt(23)
 v_add_f32 v154, v154, v158
 v_add_f32 v155, v155, v159
 MM v[64:67], a[12:15], a[36:39], v[64:67]
 v_add_f32 v144, v144, v152
 v_add_f32 v145, v145, v153
 MM v[68:71], a[16:19], a[36:39], v[68:71]
 v_add_f32 v146, v146, v154
 v_add_f32 v147, v147, v155
 MM v[68:71], v[236:239], a[0:3], v[68:71]
 buffer_store_dwordx4 v[144:147], v2, s[16:19], s89 offen offset:0 sc1
 MM v[72:75], v[240:243], a[0:3], v[72:75]
 v_add_f32 v135, 1.0, v135
 v_add_f32 v136, 1.0, v136
 MM v[72:75], a[20:23], a[36:39], v[72:75]
 v_add_f32 v137, 1.0, v137
 v_add_f32 v138, 1.0, v138
 MM v[76:79], a[24:27], a[36:39], v[76:79]
 v_add_f32 v139, 1.0, v139
 v_add_f32 v140, 1.0, v140
 MM v[76:79], v[244:247], a[0:3], v[76:79]
 v_add_f32 v141, 1.0, v141
 v_add_f32 v142, 1.0, v142
 MM v[80:83], v[248:251], a[0:3], v[80:83]
 v_add_f32 v143, 1.0, v143
 MM v[80:83], a[28:31], a[36:39], v[80:83]
 s_waitcnt vmcnt(23)
 v_rcp_f32 v124, v124
 MM v[100:103], a[28:31], a[40:43], v[100:103]
 v_rcp_f32 v125, v125
 MM v[100:103], v[248:251], a[4:7], v[100:103]
 v_rcp_f32 v126, v126
 MM v[96:99], v[244:247], a[4:7], v[96:99]
 v_rcp_f32 v127, v127
 MM v[96:99], a[24:27], a[40:43], v[96:99]
 v_rcp_f32 v128, v128
 MM v[92:95], a[20:23], a[40:43], v[92:95]
 v_rcp_f32 v129, v129
 MM v[92:95], v[240:243], a[4:7], v[92:95]
 v_rcp_f32 v130, v130
 MM v[88:91], v[236:239], a[4:7], v[88:91]
 v_rcp_f32 v131, v131
 MM v[88:91], a[16:19], a[40:43], v[88:91]
 v_rcp_f32 v132, v132
 MM v[84:87], a[12:15], a[40:43], v[84:87]
 v_rcp_f32 v133, v133
 MM v[84:87], v[232:235], a[4:7], v[84:87]
 s_waitcnt vmcnt(21)
 v_rcp_f32 v134, v134
 MM v[24:27], a[192:195], a[44:47], v[24:27]
 s_waitcnt vmcnt(12)
 v_rcp_f32 v135, v135
 MM v[24:27], a[228:231], a[224:227], v[24:27]
 s_waitcnt vmcnt(11)
 v_rcp_f32 v136, v136
 MM v[28:31], a[232:235], a[224:227], v[28:31]
 v_rcp_f32 v137, v137
 MM v[28:31], a[196:199], a[44:47], v[28:31]
 v_rcp_f32 v138, v138
 MM v[32:35], a[200:203], a[44:47], v[32:35]
 s_waitcnt vmcnt(10)
 v_rcp_f32 v139, v139
 MM v[32:35], a[236:239], a[224:227], v[32:35]
 s_waitcnt vmcnt(9)
 v_rcp_f32 v140, v140
 MM v[36:39], a[240:243], a[224:227], v[36:39]
 s_waitcnt vmcnt(0)
 v_rcp_f32 v141, v141
 MM v[36:39], a[204:207], a[44:47], v[36:39]
 s_mov_b64 exec, 1
 buffer_store_dword v6, off, s[16:19], s3 sc1
 s_mov_b64 exec, -1
 MM v[40:43], a[208:211], a[44:47], v[40:43]
 v_rcp_f32 v142, v142
 MM v[40:43], a[244:247], a[224:227], v[40:43]
 v_rcp_f32 v143, v143
 MM v[60:63], a[244:247], a[248:251], v[60:63]
 v_mul_f32 v104, v104, v124
 v_mul_f32 v105, v105, v125
 MM v[60:63], a[208:211], a[212:215], v[60:63]
 v_mul_f32 v106, v106, v126
 v_mul_f32 v107, v107, v127
 MM v[56:59], a[204:207], a[212:215], v[56:59]
 v_mul_f32 v108, v108, v128
 v_mul_f32 v109, v109, v129
 MM v[56:59], a[240:243], a[248:251], v[56:59]
 v_mul_f32 v110, v110, v130
 v_mul_f32 v111, v111, v131
 MM v[52:55], a[236:239], a[248:251], v[52:55]
 v_mul_f32 v112, v112, v132
 v_mul_f32 v113, v113, v133
 MM v[52:55], a[200:203], a[212:215], v[52:55]
 v_mul_f32 v114, v114, v134
 v_mul_f32 v115, v115, v135
 MM v[48:51], a[196:199], a[212:215], v[48:51]
 v_mul_f32 v116, v116, v136
 v_mul_f32 v117, v117, v137
 MM v[48:51], a[232:235], a[248:251], v[48:51]
 v_mul_f32 v118, v118, v138
 v_mul_f32 v119, v119, v139
 MM v[44:47], a[228:231], a[248:251], v[44:47]
 v_mul_f32 v120, v120, v140
 v_mul_f32 v121, v121, v141
 MM v[44:47], a[192:195], a[212:215], v[44:47]
 v_mul_f32 v122, v122, v142
 v_mul_f32 v123, v123, v143
 MM v[64:67], a[192:195], a[216:219], v[64:67]
 v_cvt_pk_bf16_f32 v124, v104, v105
 v_lshlrev_b32 v104, 16, v124
 v_and_b32 v105, 0xffff0000, v124
 v_cvt_pk_bf16_f32 v126, v106, v107
 v_lshlrev_b32 v106, 16, v126
 v_and_b32 v107, 0xffff0000, v126
 v_cvt_pk_bf16_f32 v128, v108, v109
 v_lshlrev_b32 v108, 16, v128
 v_and_b32 v109, 0xffff0000, v128
 v_cvt_pk_bf16_f32 v130, v110, v111
 v_lshlrev_b32 v110, 16, v130
 v_and_b32 v111, 0xffff0000, v130
 v_cvt_pk_bf16_f32 v132, v112, v113
 v_lshlrev_b32 v112, 16, v132
 v_and_b32 v113, 0xffff0000, v132
 v_cvt_pk_bf16_f32 v134, v114, v115
 v_lshlrev_b32 v114, 16, v134
 v_and_b32 v115, 0xffff0000, v134
 v_cvt_pk_bf16_f32 v136, v116, v117
 v_lshlrev_b32 v116, 16, v136
 v_and_b32 v117, 0xffff0000, v136
 v_cvt_pk_bf16_f32 v138, v118, v119
 v_lshlrev_b32 v118, 16, v138
 v_and_b32 v119, 0xffff0000, v138
 v_cvt_pk_bf16_f32 v140, v120, v121
 v_lshlrev_b32 v120, 16, v140
 v_and_b32 v121, 0xffff0000, v140
 v_cvt_pk_bf16_f32 v142, v122, v123
 v_lshlrev_b32 v122, 16, v142
 v_and_b32 v123, 0xffff0000, v142
 MM v[64:67], a[228:231], a[252:255], v[64:67]
 buffer_load_dword v8, off, s[16:19], s91 sc1
 MM v[68:71], a[232:235], a[252:255], v[68:71]
 ds_read_b64 v[126:127], v5 offset:0
 ds_read_b64 v[130:131], v5 offset:32
 MM v[68:71], a[196:199], a[216:219], v[68:71]
 ds_read_b64 v[134:135], v5 offset:64
 ds_read_b64 v[138:139], v5 offset:96
 MM v[72:75], a[200:203], a[216:219], v[72:75]
 ds_read_b64 v[142:143], v5 offset:128
 MM v[72:75], a[236:239], a[252:255], v[72:75]
 ds_write_b128 v16, v[24:27] offset:0
 MM v[76:79], a[240:243], a[252:255], v[76:79]
 ds_write_b128 v16, v[28:31] offset:1024
 MM v[76:79], a[204:207], a[216:219], v[76:79]
 ds_write_b128 v16, v[32:35] offset:2048
 MM v[80:83], a[208:211], a[216:219], v[80:83]
 s_waitcnt lgkmcnt(7)
 v_lshlrev_b32 v124, 16, v126
 v_and_b32 v125, 0xffff0000, v126
 MM v[80:83], a[244:247], a[252:255], v[80:83]
 v_lshlrev_b32 v126, 16, v127
 v_and_b32 v127, 0xffff0000, v127
 MM v[100:103], a[244:247], v[184:187], v[100:103]
 s_waitcnt lgkmcnt(4)
 v_lshlrev_b32 v128, 16, v130
 v_and_b32 v129, 0xffff0000, v130
 MM v[100:103], a[208:211], a[220:223], v[100:103]
 v_lshlrev_b32 v130, 16, v131
 v_and_b32 v131, 0xffff0000, v131
 MM v[96:99], a[204:207], a[220:223], v[96:99]
 v_lshlrev_b32 v132, 16, v134
 v_and_b32 v133, 0xffff0000, v134
 MM v[96:99], a[240:243], v[184:187], v[96:99]
 v_lshlrev_b32 v134, 16, v135
 v_and_b32 v135, 0xffff0000, v135
 MM v[92:95], a[236:239], v[184:187], v[92:95]
 v_lshlrev_b32 v136, 16, v138
 v_and_b32 v137, 0xffff0000, v138
 MM v[92:95], a[200:203], a[220:223], v[92:95]
 v_lshlrev_b32 v138, 16, v139
 v_and_b32 v139, 0xffff0000, v139
 MM v[88:91], a[196:199], a[220:223], v[88:91]
 s_waitcnt lgkmcnt(0)
 v_lshlrev_b32 v140, 16, v142
 v_and_b32 v141, 0xffff0000, v142
 MM v[88:91], a[232:235], v[184:187], v[88:91]
 v_lshlrev_b32 v142, 16, v143
 v_and_b32 v143, 0xffff0000, v143
 MM v[84:87], a[228:231], v[184:187], v[84:87]
 ds_write_b128 v16, v[36:39] offset:3072
 MM v[84:87], a[192:195], a[220:223], v[84:87]
 ds_write_b128 v16, v[40:43] offset:4096
 ds_write_b128 v3, v[60:63] offset:9216
 ds_write_b128 v3, v[56:59] offset:8192
 ds_write_b128 v3, v[52:55] offset:7168
 ds_write_b128 v3, v[48:51] offset:6144
 ds_write_b128 v3, v[44:47] offset:5120
 ds_write_b128 v18, v[64:67] offset:10240
 ds_write_b128 v18, v[68:71] offset:11264
 ds_write_b128 v18, v[72:75] offset:12288
 ds_write_b128 v18, v[76:79] offset:13312
 ds_write_b128 v18, v[80:83] offset:14336
 s_waitcnt vmcnt(0)
 v_cmp_ne_u32 vcc, s61, v8
 s_cbranch_vccnz spin7
spun7:
 buffer_load_dwordx4 v[144:147], v1, s[16:19], s90 offen offset:0 sc1
 buffer_load_dwordx4 v[148:151], v1, s[16:19], s90 offen offset:1024 sc1
 buffer_load_dwordx4 v[152:155], v1, s[16:19], s90 offen offset:2048 sc1
 buffer_load_dwordx4 v[156:159], v1, s[16:19], s90 offen offset:3072 sc1
 buffer_load_dwordx4 v[160:163], v2, s[16:19], s90 offen offset:0 sc1
 s_waitcnt lgkmcnt(0)
 s_barrier
 ds_read_b128 v[24:27], v7 offset:0
 ds_read_b128 v[44:47], v7 offset:5120
 ds_read_b128 v[64:67], v7 offset:10240
 ds_read_b128 v[28:31], v7 offset:1024
 ds_read_b128 v[48:51], v7 offset:6144
 ds_read_b128 v[68:71], v7 offset:11264
 ds_read_b128 v[32:35], v7 offset:2048
 ds_read_b128 v[52:55], v7 offset:7168
 ds_read_b128 v[72:75], v7 offset:12288
 ds_read_b128 v[36:39], v7 offset:3072
 ds_read_b128 v[56:59], v7 offset:8192
 ds_read_b128 v[76:79], v7 offset:13312
 ds_read_b128 v[40:43], v7 offset:4096
 ds_read_b128 v[60:63], v7 offset:9216
 ds_read_b128 v[80:83], v7 offset:14336
 s_waitcnt lgkmcnt(13)
 v_pk_add_f32 v[24:25], v[24:25], v[44:45]
 s_waitcnt lgkmcnt(12)
 v_pk_add_f32 v[64:65], v[64:65], v[84:85]
 v_pk_add_f32 v[26:27], v[26:27], v[46:47]
 v_pk_add_f32 v[66:67], v[66:67], v[86:87]
 v_pk_add_f32 v[24:25], v[24:25], v[64:65]
 v_pk_add_f32 v[26:27], v[26:27], v[66:67]
 s_waitcnt lgkmcnt(10)
 v_pk_add_f32 v[28:29], v[28:29], v[48:49]
 s_waitcnt lgkmcnt(9)
 v_pk_add_f32 v[68:69], v[68:69], v[88:89]
 v_pk_add_f32 v[30:31], v[30:31], v[50:51]
 v_pk_add_f32 v[70:71], v[70:71], v[90:91]
 v_pk_add_f32 v[28:29], v[28:29], v[68:69]
 v_pk_add_f32 v[30:31], v[30:31], v[70:71]
 s_waitcnt lgkmcnt(7)
 v_pk_add_f32 v[32:33], v[32:33], v[52:53]
 s_waitcnt lgkmcnt(6)
 v_pk_add_f32 v[72:73], v[72:73], v[92:93]
 v_pk_add_f32 v[34:35], v[34:35], v[54:55]
 v_pk_add_f32 v[74:75], v[74:75], v[94:95]
 v_pk_add_f32 v[32:33], v[32:33], v[72:73]
 v_pk_add_f32 v[34:35], v[34:35], v[74:75]
 s_waitcnt lgkmcnt(4)
 v_pk_add_f32 v[36:37], v[36:37], v[56:57]
 s_waitcnt lgkmcnt(3)
 v_pk_add_f32 v[76:77], v[76:77], v[96:97]
 v_pk_add_f32 v[38:39], v[38:39], v[58:59]
 v_pk_add_f32 v[78:79], v[78:79], v[98:99]
 v_pk_add_f32 v[36:37], v[36:37], v[76:77]
 v_pk_add_f32 v[38:39], v[38:39], v[78:79]
 s_waitcnt lgkmcnt(1)
 v_pk_add_f32 v[40:41], v[40:41], v[60:61]
 s_waitcnt lgkmcnt(0)
 v_pk_add_f32 v[80:81], v[80:81], v[100:101]
 v_pk_add_f32 v[42:43], v[42:43], v[62:63]
 v_pk_add_f32 v[82:83], v[82:83], v[102:103]
 v_pk_add_f32 v[40:41], v[40:41], v[80:81]
 v_pk_add_f32 v[42:43], v[42:43], v[82:83]
 s_waitcnt vmcnt(4)
 v_pk_add_f32 v[24:25], v[24:25], v[144:145]
 v_pk_add_f32 v[26:27], v[26:27], v[146:147]
 s_waitcnt vmcnt(3)
 v_pk_add_f32 v[28:29], v[28:29], v[148:149]
 v_pk_add_f32 v[30:31], v[30:31], v[150:151]
 s_waitcnt vmcnt(2)
 v_pk_add_f32 v[32:33], v[32:33], v[152:153]
 v_pk_add_f32 v[34:35], v[34:35], v[154:155]
 s_waitcnt vmcnt(1)
 v_pk_add_f32 v[36:37], v[36:37], v[156:157]
 v_pk_add_f32 v[38:39], v[38:39], v[158:159]
 s_waitcnt vmcnt(0)
 v_pk_add_f32 v[40:41], v[40:41], v[160:161]
 v_pk_add_f32 v[42:43], v[42:43], v[162:163]
 v_cvt_pk_bf16_f32 v44, v24, v25
 v_cvt_pk_bf16_f32 v46, v26, v27
 v_cvt_pk_bf16_f32 v48, v28, v29
 v_cvt_pk_bf16_f32 v50, v30, v31
 v_cvt_pk_bf16_f32 v52, v32, v33
 v_cvt_pk_bf16_f32 v54, v34, v35
 v_cvt_pk_bf16_f32 v56, v36, v37
 v_cvt_pk_bf16_f32 v58, v38, v39
 v_cvt_pk_bf16_f32 v60, v40, v41
 v_cvt_pk_bf16_f32 v62, v42, v43
 v_lshlrev_b32 v24, 16, v44
 v_and_b32 v25, 0xffff0000, v44
 v_lshlrev_b32 v26, 16, v46
 v_and_b32 v27, 0xffff0000, v46
 v_lshlrev_b32 v28, 16, v48
 v_and_b32 v29, 0xffff0000, v48
 v_lshlrev_b32 v30, 16, v50
 v_and_b32 v31, 0xffff0000, v50
 v_lshlrev_b32 v32, 16, v52
 v_and_b32 v33, 0xffff0000, v52
 v_lshlrev_b32 v34, 16, v54
 v_and_b32 v35, 0xffff0000, v54
 v_lshlrev_b32 v36, 16, v56
 v_and_b32 v37, 0xffff0000, v56
 v_lshlrev_b32 v38, 16, v58
 v_and_b32 v39, 0xffff0000, v58
 v_lshlrev_b32 v40, 16, v60
 v_and_b32 v41, 0xffff0000, v60
 v_lshlrev_b32 v42, 16, v62
 v_and_b32 v43, 0xffff0000, v62
 v_pk_mul_f32 v[24:25], v[24:25], v[104:105]
 v_pk_mul_f32 v[26:27], v[26:27], v[106:107]
 v_pk_mul_f32 v[28:29], v[28:29], v[108:109]
 v_pk_mul_f32 v[30:31], v[30:31], v[110:111]
 v_pk_mul_f32 v[32:33], v[32:33], v[112:113]
 v_pk_mul_f32 v[34:35], v[34:35], v[114:115]
 v_pk_mul_f32 v[36:37], v[36:37], v[116:117]
 v_pk_mul_f32 v[38:39], v[38:39], v[118:119]
 v_pk_mul_f32 v[40:41], v[40:41], v[120:121]
 v_pk_mul_f32 v[42:43], v[42:43], v[122:123]
 v_cvt_pk_bf16_f32 v44, v24, v25
 v_cvt_pk_bf16_f32 v46, v26, v27
 v_cvt_pk_bf16_f32 v48, v28, v29
 v_cvt_pk_bf16_f32 v50, v30, v31
 v_cvt_pk_bf16_f32 v52, v32, v33
 v_cvt_pk_bf16_f32 v54, v34, v35
 v_cvt_pk_bf16_f32 v56, v36, v37
 v_cvt_pk_bf16_f32 v58, v38, v39
 v_cvt_pk_bf16_f32 v60, v40, v41
 v_cvt_pk_bf16_f32 v62, v42, v43
 v_lshlrev_b32 v24, 16, v44
 v_and_b32 v25, 0xffff0000, v44
 v_lshlrev_b32 v26, 16, v46
 v_and_b32 v27, 0xffff0000, v46
 v_lshlrev_b32 v28, 16, v48
 v_and_b32 v29, 0xffff0000, v48
 v_lshlrev_b32 v30, 16, v50
 v_and_b32 v31, 0xffff0000, v50
 v_lshlrev_b32 v32, 16, v52
 v_and_b32 v33, 0xffff0000, v52
 v_lshlrev_b32 v34, 16, v54
 v_and_b32 v35, 0xffff0000, v54
 v_lshlrev_b32 v36, 16, v56
 v_and_b32 v37, 0xffff0000, v56
 v_lshlrev_b32 v38, 16, v58
 v_and_b32 v39, 0xffff0000, v58
 v_lshlrev_b32 v40, 16, v60
 v_and_b32 v41, 0xffff0000, v60
 v_lshlrev_b32 v42, 16, v62
 v_and_b32 v43, 0xffff0000, v62
 v_pk_add_f32 v[24:25], v[24:25], v[124:125]
 v_pk_add_f32 v[26:27], v[26:27], v[126:127]
 v_pk_add_f32 v[28:29], v[28:29], v[128:129]
 v_pk_add_f32 v[30:31], v[30:31], v[130:131]
 v_pk_add_f32 v[32:33], v[32:33], v[132:133]
 v_pk_add_f32 v[34:35], v[34:35], v[134:135]
 v_pk_add_f32 v[36:37], v[36:37], v[136:137]
 v_pk_add_f32 v[38:39], v[38:39], v[138:139]
 v_pk_add_f32 v[40:41], v[40:41], v[140:141]
 v_pk_add_f32 v[42:43], v[42:43], v[142:143]
 v_cvt_pk_bf16_f32 v44, v24, v25
 v_cvt_pk_bf16_f32 v45, v26, v27
 ds_write_b64 v5, v[44:45] offset:0
 v_cvt_pk_bf16_f32 v48, v28, v29
 v_cvt_pk_bf16_f32 v49, v30, v31
 ds_write_b64 v5, v[48:49] offset:32
 v_cvt_pk_bf16_f32 v52, v32, v33
 v_cvt_pk_bf16_f32 v53, v34, v35
 ds_write_b64 v5, v[52:53] offset:64
 v_cvt_pk_bf16_f32 v56, v36, v37
 v_cvt_pk_bf16_f32 v57, v38, v39
 ds_write_b64 v5, v[56:57] offset:96
 v_cvt_pk_bf16_f32 v60, v40, v41
 v_cvt_pk_bf16_f32 v61, v42, v43
 ds_write_b64 v5, v[60:61] offset:128
 v_add_u32 v8, s57, v1
 s_waitcnt lgkmcnt(0)
 ds_read_b128 v[24:27], v8 offset:0
 ds_read_b128 v[28:31], v8 offset:1024
 ds_read_b128 v[32:35], v8 offset:2048
 s_waitcnt lgkmcnt(2)
 buffer_store_dwordx4 v[24:27], v20, s[52:55], s56 offen
 s_waitcnt lgkmcnt(1)
 buffer_store_dwordx4 v[28:31], v21, s[52:55], s56 offen
 s_waitcnt lgkmcnt(0)
 buffer_store_dwordx4 v[32:35], v17, s[52:55], s56 offen
kend:
 s_endpgm
k_f_d1:
 s_nop 1
 v_cndmask_b32 v64, 0, v4, s[64:65]
 v_cndmask_b32 v65, 0, v4, s[66:67]
 v_cndmask_b32 v66, 0, v4, s[68:69]
 v_cndmask_b32 v67, 0, v4, s[70:71]
 v_cndmask_b32 v68, 0, v4, s[72:73]
 v_cndmask_b32 v69, 0, v4, s[74:75]
 v_cndmask_b32 v70, 0, v4, s[76:77]
 v_cndmask_b32 v71, 0, v4, s[78:79]
 MM v[64:67], v[192:195], a[128:131], v[64:67]
 MM v[64:67], v[196:199], a[132:135], v[64:67]
 MM v[64:67], v[200:203], a[136:139], v[64:67]
 MM v[64:67], v[204:207], a[140:143], v[64:67]
 MM v[80:83], v[204:207], a[156:159], 0
 MM v[80:83], v[200:203], a[152:155], v[80:83]
 MM v[80:83], v[196:199], a[148:151], v[80:83]
 MM v[80:83], v[192:195], a[144:147], v[80:83]
 MM v[96:99], v[192:195], a[160:163], 0
 s_nop 2
 v_max3_f32 v8, v64, v65, v66
 v_max_f32 v8, v8, v67
 MM v[96:99], v[196:199], a[164:167], v[96:99]
 v_mov_b32 v9, v8
 MM v[96:99], v[200:203], a[168:171], v[96:99]
 MM v[96:99], v[204:207], a[172:175], v[96:99]
 v_permlane16_swap_b32 v8, v9
 v_max_f32 v8, v8, v9
 MM v[112:115], v[204:207], a[188:191], 0
 v_mov_b32 v9, v8
 v_max3_f32 v10, v80, v81, v82
 MM v[112:115], v[200:203], a[184:187], v[112:115]
 v_max_f32 v10, v10, v83
 v_mov_b32 v11, v10
 MM v[112:115], v[196:199], a[180:183], v[112:115]
 v_permlane32_swap_b32 v8, v9
 v_max_f32 v8, v8, v9
 MM v[112:115], v[192:195], a[176:179], v[112:115]
 v_sub_f32 v48, 0, v8
 v_sub_f32 v49, 0, v8
 MM v[116:119], v[208:211], a[176:179], 0
 v_sub_f32 v50, 0, v8
 v_sub_f32 v51, 0, v8
 MM v[116:119], v[212:215], a[180:183], v[116:119]
 v_permlane16_swap_b32 v10, v11
 v_max_f32 v10, v10, v11
 MM v[116:119], v[216:219], a[184:187], v[116:119]
 v_mov_b32 v11, v10
 v_max3_f32 v12, v96, v97, v98
 MM v[116:119], v[220:223], a[188:191], v[116:119]
 v_max_f32 v12, v12, v99
 v_mov_b32 v13, v12
 MM v[100:103], v[220:223], a[172:175], 0
 v_permlane32_swap_b32 v10, v11
 v_max_f32 v10, v10, v11
 MM v[100:103], v[216:219], a[168:171], v[100:103]
 v_cndmask_b32 v72, v48, v4, s[80:81]
 v_cndmask_b32 v73, v48, v4, s[82:83]
 MM v[100:103], v[212:215], a[164:167], v[100:103]
 v_cndmask_b32 v74, v48, v4, s[84:85]
 v_cndmask_b32 v75, v48, v4, s[86:87]
 MM v[100:103], v[208:211], a[160:163], v[100:103]
 v_sub_f32 v52, 0, v10
 v_sub_f32 v53, 0, v10
 MM v[84:87], v[208:211], a[144:147], 0
 v_sub_f32 v54, 0, v10
 v_sub_f32 v55, 0, v10
 MM v[84:87], v[212:215], a[148:151], v[84:87]
 v_permlane16_swap_b32 v12, v13
 v_max_f32 v12, v12, v13
 MM v[84:87], v[216:219], a[152:155], v[84:87]
 v_mov_b32 v13, v12
 v_max3_f32 v14, v112, v113, v114
 MM v[84:87], v[220:223], a[156:159], v[84:87]
 v_max_f32 v14, v14, v115
 v_mov_b32 v15, v14
 MM v[68:71], v[220:223], a[140:143], v[68:71]
 v_permlane32_swap_b32 v12, v13
 v_max_f32 v12, v12, v13
 MM v[68:71], v[216:219], a[136:139], v[68:71]
 v_sub_f32 v56, 0, v12
 v_sub_f32 v57, 0, v12
 MM v[68:71], v[212:215], a[132:135], v[68:71]
 s_lshl_b32 s3, s2, 2
 v_sub_f32 v58, 0, v12
 v_sub_f32 v59, 0, v12
 MM v[68:71], v[208:211], a[128:131], v[68:71]
 s_add_u32 s3, s3, 70729728
 v_permlane16_swap_b32 v14, v15
 v_max_f32 v14, v14, v15
 MM v[72:75], v[224:227], a[128:131], v[72:75]
 s_add_u32 s3, s3, s100
 v_mov_b32 v15, v14
 v_mov_b32 v16, s61
 MM v[72:75], v[228:231], a[132:135], v[72:75]
 v_cndmask_b32 v76, v48, v4, s[88:89]
 v_cndmask_b32 v77, v48, v4, s[90:91]
 MM v[72:75], v[232:235], a[136:139], v[72:75]
 v_permlane32_swap_b32 v14, v15
 v_max_f32 v14, v14, v15
 MM v[72:75], v[236:239], a[140:143], v[72:75]
 v_sub_f32 v60, 0, v14
 v_sub_f32 v61, 0, v14
 MM v[88:91], v[236:239], a[156:159], v[52:55]
 v_sub_f32 v62, 0, v14
 v_sub_f32 v63, 0, v14
 MM v[88:91], v[232:235], a[152:155], v[88:91]
 v_cndmask_b32 v78, v48, v4, s[92:93]
 v_cndmask_b32 v79, v48, v4, s[94:95]
 MM v[88:91], v[228:231], a[148:151], v[88:91]
 v_sub_f32 v64, v64, v8
 v_sub_f32 v65, v65, v8
 MM v[88:91], v[224:227], a[144:147], v[88:91]
 v_sub_f32 v66, v66, v8
 v_sub_f32 v67, v67, v8
 MM v[104:107], v[224:227], a[160:163], v[56:59]
 v_sub_f32 v68, v68, v8
 v_sub_f32 v69, v69, v8
 MM v[104:107], v[228:231], a[164:167], v[104:107]
 v_sub_f32 v70, v70, v8
 v_sub_f32 v71, v71, v8
 MM v[104:107], v[232:235], a[168:171], v[104:107]
 v_sub_f32 v80, v80, v10
 v_sub_f32 v81, v81, v10
 MM v[104:107], v[236:239], a[172:175], v[104:107]
 v_sub_f32 v82, v82, v10
 v_sub_f32 v83, v83, v10
 MM v[120:123], v[236:239], a[188:191], v[60:63]
 v_sub_f32 v84, v84, v10
 v_sub_f32 v85, v85, v10
 MM v[120:123], v[232:235], a[184:187], v[120:123]
 v_sub_f32 v86, v86, v10
 v_sub_f32 v87, v87, v10
 MM v[120:123], v[228:231], a[180:183], v[120:123]
 v_sub_f32 v96, v96, v12
 v_sub_f32 v97, v97, v12
 MM v[120:123], v[224:227], a[176:179], v[120:123]
 v_sub_f32 v98, v98, v12
 v_sub_f32 v99, v99, v12
 MM v[124:127], v[240:243], a[176:179], v[60:63]
 v_sub_f32 v100, v100, v12
 v_sub_f32 v101, v101, v12
 MM v[124:127], v[244:247], a[180:183], v[124:127]
 v_sub_f32 v102, v102, v12
 v_sub_f32 v103, v103, v12
 MM v[124:127], v[248:251], a[184:187], v[124:127]
 v_sub_f32 v112, v112, v14
 v_sub_f32 v113, v113, v14
 MM v[124:127], v[252:255], a[188:191], v[124:127]
 v_sub_f32 v114, v114, v14
 v_sub_f32 v115, v115, v14
 MM v[108:111], v[252:255], a[172:175], v[56:59]
 v_sub_f32 v116, v116, v14
 v_sub_f32 v117, v117, v14
 MM v[108:111], v[248:251], a[168:171], v[108:111]
 s_waitcnt vmcnt(4)
 v_sub_f32 v118, v118, v14
 v_sub_f32 v119, v119, v14
 MM v[108:111], v[244:247], a[164:167], v[108:111]
 s_barrier
 ds_read_b128 v[192:195], v2 offset:16384
 v_max3_f32 v5, v68, v69, v70
 MM v[108:111], v[240:243], a[160:163], v[108:111]
 s_mov_b64 exec, 1
 buffer_store_dword v16, off, s[16:19], s3 sc1
 s_mov_b64 exec, -1
 MM v[92:95], v[240:243], a[144:147], v[52:55]
 ds_read_b128 v[196:199], v2 offset:17408
 v_max3_f32 v6, v71, v84, v85
 MM v[92:95], v[244:247], a[148:151], v[92:95]
 ds_read_b128 v[200:203], v2 offset:18432
 v_max3_f32 v5, v86, v87, v5
 MM v[92:95], v[248:251], a[152:155], v[92:95]
 ds_read_b128 v[204:207], v2 offset:19456
 v_max3_f32 v6, v100, v101, v6
 MM v[92:95], v[252:255], a[156:159], v[92:95]
 ds_read_b128 v[208:211], v2 offset:20480
 ds_read_b128 v[212:215], v2 offset:21504
 MM v[76:79], v[252:255], a[140:143], v[76:79]
 ds_read_b128 v[216:219], v2 offset:22528
 ds_read_b128 v[220:223], v2 offset:23552
 MM v[76:79], v[248:251], a[136:139], v[76:79]
 ds_read_b128 v[224:227], v2 offset:24576
 ds_read_b128 v[228:231], v2 offset:25600
 MM v[76:79], v[244:247], a[132:135], v[76:79]
 ds_read_b128 v[232:235], v2 offset:26624
 ds_read_b128 v[236:239], v2 offset:27648
 MM v[76:79], v[240:243], a[128:131], v[76:79]
 ds_read_b128 v[240:243], v2 offset:28672
 ds_read_b128 v[244:247], v2 offset:29696
 ds_read_b128 v[248:251], v2 offset:30720
 ds_read_b128 v[252:255], v2 offset:31744
 v_max3_f32 v5, v102, v103, v5
 v_max3_f32 v6, v116, v117, v6
 v_max3_f32 v5, v118, v119, v5
 v_max3_f32 v6, v72, v73, v6
 v_max3_f32 v5, v74, v75, v5
 v_max3_f32 v6, v88, v89, v6
 v_max3_f32 v5, v90, v91, v5
 v_max3_f32 v6, v104, v105, v6
 v_max3_f32 v5, v106, v107, v5
 v_max3_f32 v6, v120, v121, v6
 v_max3_f32 v5, v122, v123, v5
 v_max3_f32 v6, v124, v125, v6
 v_max3_f32 v5, v126, v127, v5
 v_max3_f32 v6, v108, v109, v6
 v_max3_f32 v5, v110, v111, v5
 v_max3_f32 v6, v92, v93, v6
 v_max3_f32 v5, v94, v95, v5
 v_max3_f32 v6, v76, v77, v6
 v_max3_f32 v5, v78, v79, v5
 v_max_f32 v5, v5, v6
 v_cmp_lt_f32 vcc, 0x42400000, v5
 s_waitcnt lgkmcnt(0)
 s_cbranch_vccnz ftSd1_r
ftSd1_ok:
 v_cndmask_b32 v144, v52, v4, s[64:65]
 v_cndmask_b32 v145, v52, v4, s[66:67]
 v_cndmask_b32 v146, v52, v4, s[68:69]
 v_cndmask_b32 v147, v52, v4, s[70:71]
 s_nop 1
 MM v[144:147], v[192:195], a[144:147], v[144:147]
 s_add_u32 m0, s30, 0
 ds_read_b128 a[220:223], v2 offset:39936
 v_cndmask_b32 v148, v52, v4, s[72:73]
 MM v[144:147], v[196:199], a[148:151], v[144:147]
 buffer_load_dwordx4 v1, s[4:7], s28 offen offset:0 sc1 lds
 MM v[144:147], v[200:203], a[152:155], v[144:147]
 ds_read_b128 a[252:255], v2 offset:48128
 v_cndmask_b32 v149, v52, v4, s[74:75]
 MM v[144:147], v[204:207], a[156:159], v[144:147]
 v_cndmask_b32 v150, v52, v4, s[76:77]
 v_cndmask_b32 v151, v52, v4, s[78:79]
 MM v[160:163], v[204:207], a[172:175], v[56:59]
 ds_read_b128 a[248:251], v2 offset:47104
 v_cndmask_b32 v152, v52, v4, s[80:81]
 MM v[160:163], v[200:203], a[168:171], v[160:163]
 v_cndmask_b32 v153, v52, v4, s[82:83]
 v_cndmask_b32 v154, v52, v4, s[84:85]
 MM v[160:163], v[196:199], a[164:167], v[160:163]
 v_cndmask_b32 v155, v52, v4, s[86:87]
 v_cndmask_b32 v156, v52, v4, s[88:89]
 MM v[160:163], v[192:195], a[160:163], v[160:163]
 ds_read_b128 a[216:219], v2 offset:38912
 v_cndmask_b32 v157, v52, v4, s[90:91]
 MM v[176:179], v[192:195], a[176:179], v[60:63]
 buffer_load_dwordx4 v1, s[4:7], s28 offen offset:1024 sc1 lds
 MM v[176:179], v[196:199], a[180:183], v[176:179]
 ds_read_b128 a[212:215], v2 offset:37888
 v_cndmask_b32 v158, v52, v4, s[92:93]
 MM v[176:179], v[200:203], a[184:187], v[176:179]
 v_cndmask_b32 v159, v52, v4, s[94:95]
 v_accvgpr_write_b32 a96, 0
 MM v[176:179], v[204:207], a[188:191], v[176:179]
 ds_read_b128 a[244:247], v2 offset:46080
 v_accvgpr_write_b32 a97, 0
 MM v[180:183], v[220:223], a[188:191], v[60:63]
 v_exp_f32 v64, v64
 MM v[180:183], v[216:219], a[184:187], v[180:183]
 v_exp_f32 v65, v65
 MM v[180:183], v[212:215], a[180:183], v[180:183]
 ds_read_b128 a[240:243], v2 offset:45056
 v_cvt_pk_bf16_f32 v64, v64, v65
 MM v[180:183], v[208:211], a[176:179], v[180:183]
 v_exp_f32 v66, v66
 MM v[164:167], v[208:211], a[160:163], v[56:59]
 buffer_load_dwordx4 v1, s[4:7], s28 offen offset:2048 sc1 lds
 MM v[164:167], v[212:215], a[164:167], v[164:167]
 ds_read_b128 a[208:211], v2 offset:36864
 v_accvgpr_write_b32 a98, 0
 MM v[164:167], v[216:219], a[168:171], v[164:167]
 v_exp_f32 v67, v67
 MM v[164:167], v[220:223], a[172:175], v[164:167]
 ds_read_b128 a[204:207], v2 offset:35840
 v_cvt_pk_bf16_f32 v65, v66, v67
 MM v[148:151], v[220:223], a[156:159], v[148:151]
 v_exp_f32 v68, v68
 MM v[148:151], v[216:219], a[152:155], v[148:151]
 ds_read_b128 a[236:239], v2 offset:44032
 v_accvgpr_write_b32 a99, 0
 MM v[148:151], v[212:215], a[148:151], v[148:151]
 v_exp_f32 v69, v69
 MM v[148:151], v[208:211], a[144:147], v[148:151]
 buffer_load_dwordx4 v1, s[4:7], s28 offen offset:3072 sc1 lds
 MM v[152:155], v[224:227], a[144:147], v[152:155]
 s_add_u32 s28, s28, 0x4000
 ds_read_b128 a[232:235], v2 offset:43008
 v_cvt_pk_bf16_f32 v66, v68, v69
 MM v[152:155], v[228:231], a[148:151], v[152:155]
 v_exp_f32 v70, v70
 MM v[152:155], v[232:235], a[152:155], v[152:155]
 ds_read_b128 a[200:203], v2 offset:34816
 v_accvgpr_write_b32 a100, 0
 MM v[152:155], v[236:239], a[156:159], v[152:155]
 s_add_u32 m0, s31, 32768
 v_exp_f32 v71, v71
 MM v[168:171], v[236:239], a[172:175], v[56:59]
 ds_read_b128 a[196:199], v2 offset:33792
 v_cvt_pk_bf16_f32 v67, v70, v71
 MM v[168:171], v[232:235], a[168:171], v[168:171]
 v_exp_f32 v72, v72
 MM v[168:171], v[228:231], a[164:167], v[168:171]
 ds_read_b128 a[228:231], v2 offset:41984
 v_accvgpr_write_b32 a101, 0
 MM v[168:171], v[224:227], a[160:163], v[168:171]
 buffer_load_dwordx4 v1, s[8:11], s29 offen offset:0 sc1 lds
 MM v[184:187], v[224:227], a[176:179], v[60:63]
 v_exp_f32 v73, v73
 MM v[184:187], v[228:231], a[180:183], v[184:187]
 v_exp_f32 v74, v74
 MM v[184:187], v[232:235], a[184:187], v[184:187]
 v_exp_f32 v75, v75
 MM v[184:187], v[236:239], a[188:191], v[184:187]
 v_exp_f32 v76, v76
 MM v[188:191], v[252:255], a[188:191], v[60:63]
 v_exp_f32 v77, v77
 MM v[188:191], v[248:251], a[184:187], v[188:191]
 v_exp_f32 v78, v78
 MM v[188:191], v[244:247], a[180:183], v[188:191]
 v_exp_f32 v79, v79
 MM v[188:191], v[240:243], a[176:179], v[188:191]
 buffer_load_dwordx4 v1, s[8:11], s29 offen offset:1024 sc1 lds
 MM v[172:175], v[240:243], a[160:163], v[56:59]
 v_cvt_pk_bf16_f32 v72, v72, v73
 v_cvt_pk_bf16_f32 v73, v74, v75
 MM v[172:175], v[244:247], a[164:167], v[172:175]
 v_cvt_pk_bf16_f32 v74, v76, v77
 v_cvt_pk_bf16_f32 v75, v78, v79
 MM v[172:175], v[248:251], a[168:171], v[172:175]
 ds_read_b128 a[224:227], v2 offset:40960
 v_accvgpr_write_b32 a102, 0
 MM v[172:175], v[252:255], a[172:175], v[172:175]
 ds_read_b128 a[192:195], v2 offset:32768
 v_accvgpr_write_b32 a103, 0
 MM v[156:159], v[252:255], a[156:159], v[156:159]
 v_exp_f32 v80, v80
 MM v[156:159], v[248:251], a[152:155], v[156:159]
 v_exp_f32 v81, v81
 MM v[156:159], v[244:247], a[148:151], v[156:159]
 buffer_load_dwordx4 v1, s[8:11], s29 offen offset:2048 sc1 lds
 MM v[156:159], v[240:243], a[144:147], v[156:159]
 s_waitcnt lgkmcnt(2)
 v_exp_f32 v82, v82
 MM a[28:31], a[220:223], v[64:67], 0
 v_exp_f32 v83, v83
 MM a[28:31], a[252:255], v[72:75], a[28:31]
 v_exp_f32 v84, v84
 MM a[24:27], a[248:251], v[72:75], 0
 v_exp_f32 v85, v85
 MM a[24:27], a[216:219], v[64:67], a[24:27]
 v_exp_f32 v86, v86
 MM a[20:23], a[212:215], v[64:67], 0
 v_exp_f32 v87, v87
 MM a[20:23], a[244:247], v[72:75], a[20:23]
 v_exp_f32 v88, v88
 MM a[16:19], a[240:243], v[72:75], 0
 buffer_load_dwordx4 v1, s[8:11], s29 offen offset:3072 sc1 lds
 MM a[16:19], a[208:211], v[64:67], a[16:19]
 s_add_u32 s29, s29, 0x4000
 v_exp_f32 v89, v89
 MM a[12:15], a[204:207], v[64:67], 0
 v_exp_f32 v90, v90
 MM a[12:15], a[236:239], v[72:75], a[12:15]
 v_exp_f32 v91, v91
 MM a[8:11], a[232:235], v[72:75], 0
 v_exp_f32 v92, v92
 MM a[8:11], a[200:203], v[64:67], a[8:11]
 v_exp_f32 v93, v93
 MM a[4:7], a[196:199], v[64:67], 0
 v_exp_f32 v94, v94
 MM a[4:7], a[228:231], v[72:75], a[4:7]
 s_waitcnt lgkmcnt(0)
 v_exp_f32 v95, v95
 MM a[0:3], a[224:227], v[72:75], 0
 v_cvt_pk_bf16_f32 v80, v80, v81
 v_cvt_pk_bf16_f32 v81, v82, v83
 MM a[0:3], a[192:195], v[64:67], a[0:3]
 v_cvt_pk_bf16_f32 v82, v84, v85
 v_cvt_pk_bf16_f32 v83, v86, v87
 v_cvt_pk_bf16_f32 v88, v88, v89
 v_cvt_pk_bf16_f32 v89, v90, v91
 v_cvt_pk_bf16_f32 v90, v92, v93
 v_cvt_pk_bf16_f32 v91, v94, v95
 MM v[32:35], v[28:31], v[64:67], 0
 v_exp_f32 v96, v96
 MM v[32:35], v[28:31], v[72:75], v[32:35]
 v_exp_f32 v97, v97
 MM a[32:35], a[224:227], v[88:91], 0
 v_exp_f32 v98, v98
 MM a[32:35], a[192:195], v[80:83], a[32:35]
 v_exp_f32 v99, v99
 MM a[36:39], a[196:199], v[80:83], 0
 v_exp_f32 v100, v100
 MM a[36:39], a[228:231], v[88:91], a[36:39]
 v_exp_f32 v101, v101
 MM a[40:43], a[232:235], v[88:91], 0
 v_exp_f32 v102, v102
 MM a[40:43], a[200:203], v[80:83], a[40:43]
 v_exp_f32 v103, v103
 MM a[44:47], a[204:207], v[80:83], 0
 v_exp_f32 v104, v104
 MM a[44:47], a[236:239], v[88:91], a[44:47]
 v_exp_f32 v105, v105
 MM a[48:51], a[240:243], v[88:91], 0
 v_exp_f32 v106, v106
 MM a[48:51], a[208:211], v[80:83], a[48:51]
 v_exp_f32 v107, v107
 MM a[52:55], a[212:215], v[80:83], 0
 v_exp_f32 v108, v108
 MM a[52:55], a[244:247], v[88:91], a[52:55]
 v_exp_f32 v109, v109
 MM a[56:59], a[248:251], v[88:91], 0
 v_exp_f32 v110, v110
 MM a[56:59], a[216:219], v[80:83], a[56:59]
 v_exp_f32 v111, v111
 MM a[60:63], a[220:223], v[80:83], 0
 v_cvt_pk_bf16_f32 v96, v96, v97
 v_cvt_pk_bf16_f32 v97, v98, v99
 MM a[60:63], a[252:255], v[88:91], a[60:63]
 v_cvt_pk_bf16_f32 v98, v100, v101
 v_cvt_pk_bf16_f32 v99, v102, v103
 v_cvt_pk_bf16_f32 v104, v104, v105
 v_cvt_pk_bf16_f32 v105, v106, v107
 v_cvt_pk_bf16_f32 v106, v108, v109
 v_cvt_pk_bf16_f32 v107, v110, v111
 MM v[36:39], v[28:31], v[88:91], 0
 ds_read_b128 v[192:195], v3 offset:0
 v_accvgpr_write_b32 a104, 0
 MM v[36:39], v[28:31], v[80:83], v[36:39]
 ds_read_b128 v[196:199], v3 offset:1024
 v_accvgpr_write_b32 a105, 0
 MM a[92:95], a[220:223], v[96:99], 0
 ds_read_b128 v[200:203], v3 offset:2048
 v_accvgpr_write_b32 a106, 0
 MM a[92:95], a[252:255], v[104:107], a[92:95]
 ds_read_b128 v[204:207], v3 offset:3072
 ds_read_b128 v[208:211], v3 offset:4096
 MM a[88:91], a[248:251], v[104:107], 0
 ds_read_b128 v[212:215], v3 offset:5120
 ds_read_b128 v[216:219], v3 offset:6144
 MM a[88:91], a[216:219], v[96:99], a[88:91]
 ds_read_b128 v[220:223], v3 offset:7168
 ds_read_b128 v[224:227], v3 offset:8192
 MM a[84:87], a[212:215], v[96:99], 0
 ds_read_b128 v[228:231], v3 offset:9216
 ds_read_b128 v[232:235], v3 offset:10240
 MM a[84:87], a[244:247], v[104:107], a[84:87]
 ds_read_b128 v[236:239], v3 offset:11264
 ds_read_b128 v[240:243], v3 offset:12288
 ds_read_b128 v[244:247], v3 offset:13312
 ds_read_b128 v[248:251], v3 offset:14336
 ds_read_b128 v[252:255], v3 offset:15360
 MM a[80:83], a[240:243], v[104:107], 0
 v_accvgpr_write_b32 a107, 0
 v_accvgpr_write_b32 a108, 0
 MM a[80:83], a[208:211], v[96:99], a[80:83]
 v_accvgpr_write_b32 a109, 0
 v_accvgpr_write_b32 a110, 0
 MM a[76:79], a[204:207], v[96:99], 0
 v_accvgpr_write_b32 a111, 0
 v_accvgpr_write_b32 a112, 0
 MM a[76:79], a[236:239], v[104:107], a[76:79]
 v_accvgpr_write_b32 a113, 0
 v_accvgpr_write_b32 a114, 0
 MM a[72:75], a[232:235], v[104:107], 0
 v_accvgpr_write_b32 a115, 0
 v_accvgpr_write_b32 a116, 0
 MM a[72:75], a[200:203], v[96:99], a[72:75]
 v_accvgpr_write_b32 a117, 0
 v_accvgpr_write_b32 a118, 0
 MM a[68:71], a[196:199], v[96:99], 0
 v_accvgpr_write_b32 a119, 0
 v_accvgpr_write_b32 a120, 0
 MM a[68:71], a[228:231], v[104:107], a[68:71]
 s_waitcnt vmcnt(4) lgkmcnt(0)
 v_accvgpr_write_b32 a121, 0
 v_accvgpr_write_b32 a122, 0
 MM a[64:67], a[224:227], v[104:107], 0
 s_barrier
 v_accvgpr_write_b32 a123, 0
 v_accvgpr_write_b32 a124, 0
 v_accvgpr_write_b32 a125, 0
 v_accvgpr_write_b32 a126, 0
 v_accvgpr_write_b32 a127, 0
 v_mov_b32 v44, 0
 v_mov_b32 v45, 0
 v_mov_b32 v46, 0
 v_mov_b32 v47, 0
 MM a[64:67], a[192:195], v[96:99], a[64:67]
 v_exp_f32 v112, v112
 v_exp_f32 v113, v113
 v_exp_f32 v114, v114
 v_exp_f32 v115, v115
 v_exp_f32 v116, v116
 v_exp_f32 v117, v117
 v_exp_f32 v118, v118
 v_exp_f32 v119, v119
 v_exp_f32 v120, v120
 v_exp_f32 v121, v121
 v_exp_f32 v122, v122
 v_exp_f32 v123, v123
 v_exp_f32 v124, v124
 v_exp_f32 v125, v125
 v_exp_f32 v126, v126
 v_exp_f32 v127, v127
 v_max3_f32 v5, v144, v145, v146
 v_max3_f32 v6, v147, v160, v161
 v_max3_f32 v5, v162, v163, v5
 v_max3_f32 v6, v176, v177, v6
 v_max3_f32 v5, v178, v179, v5
 v_max3_f32 v6, v180, v181, v6
 v_max3_f32 v5, v182, v183, v5
 v_max3_f32 v6, v164, v165, v6
 v_max3_f32 v5, v166, v167, v5
 v_max3_f32 v6, v148, v149, v6
 v_max3_f32 v5, v150, v151, v5
 v_max3_f32 v6, v152, v153, v6
 v_max3_f32 v5, v154, v155, v5
 v_max3_f32 v6, v168, v169, v6
 v_max3_f32 v5, v170, v171, v5
 v_max3_f32 v6, v184, v185, v6
 v_max3_f32 v5, v186, v187, v5
 v_max3_f32 v6, v188, v189, v6
 v_max3_f32 v5, v190, v191, v5
 v_max3_f32 v6, v172, v173, v6
 v_max3_f32 v5, v174, v175, v5
 v_max3_f32 v6, v156, v157, v6
 v_max3_f32 v5, v158, v159, v5
 MM v[40:43], v[28:31], v[96:99], 0
 v_cvt_pk_bf16_f32 v112, v112, v113
 v_cvt_pk_bf16_f32 v113, v114, v115
 v_cvt_pk_bf16_f32 v114, v116, v117
 v_cvt_pk_bf16_f32 v115, v118, v119
 v_cvt_pk_bf16_f32 v120, v120, v121
 v_cvt_pk_bf16_f32 v121, v122, v123
 v_cvt_pk_bf16_f32 v122, v124, v125
 v_cvt_pk_bf16_f32 v123, v126, v127
 v_mov_b32 v128, v4
 v_mov_b32 v129, v4
 v_mov_b32 v130, v4
 v_mov_b32 v131, v4
 v_mov_b32 v132, v4
 v_mov_b32 v133, v4
 v_mov_b32 v134, v4
 v_mov_b32 v135, v4
 v_mov_b32 v136, v4
 v_mov_b32 v137, v4
 v_mov_b32 v138, v4
 v_mov_b32 v139, v4
 v_mov_b32 v140, v4
 v_mov_b32 v141, v4
 v_mov_b32 v142, v4
 v_mov_b32 v143, v4
 v_max_f32 v5, v5, v6
 v_cmp_lt_f32 vcc, 0x42400000, v5
 MM v[40:43], v[28:31], v[104:107], v[40:43]
 s_cbranch_vccnz f0d1d2_r
f0d1d2_ok:
 s_branch k_d2r
k_d2rd:
 MM a[96:99], a[192:195], v[112:115], a[96:99]
 s_add_u32 m0, s31, 49152
 v_cndmask_b32 v64, v56, v4, s[64:65]
 v_cndmask_b32 v65, v56, v4, s[66:67]
 MM a[96:99], a[224:227], v[120:123], a[96:99]
 buffer_load_dwordx4 v1, s[8:11], s29 offen offset:0 sc1 lds
 MM a[100:103], a[228:231], v[120:123], a[100:103]
 s_and_b32 s12, s2, 3
 v_cndmask_b32 v66, v56, v4, s[68:69]
 v_cndmask_b32 v67, v56, v4, s[70:71]
 MM a[100:103], a[196:199], v[112:115], a[100:103]
 s_lshl_b32 s12, s12, 2
 v_cndmask_b32 v68, v56, v4, s[72:73]
 v_cndmask_b32 v69, v56, v4, s[74:75]
 MM a[104:107], a[200:203], v[112:115], a[104:107]
 s_lshr_b32 s37, s2, 6
 v_cndmask_b32 v70, v56, v4, s[76:77]
 v_cndmask_b32 v71, v56, v4, s[78:79]
 MM a[104:107], a[232:235], v[120:123], a[104:107]
 s_add_u32 s12, s12, s37
 v_cndmask_b32 v72, v56, v4, s[80:81]
 v_cndmask_b32 v73, v56, v4, s[82:83]
 MM a[108:111], a[236:239], v[120:123], a[108:111]
 s_lshl_b32 s12, s12, 1
 v_cndmask_b32 v74, v56, v4, s[84:85]
 v_cndmask_b32 v75, v56, v4, s[86:87]
 MM a[108:111], a[204:207], v[112:115], a[108:111]
 s_bfe_u32 s36, s2, 0x10002
 v_cndmask_b32 v76, v56, v4, s[88:89]
 v_cndmask_b32 v77, v56, v4, s[90:91]
 MM a[112:115], a[208:211], v[112:115], a[112:115]
 s_add_u32 s12, s12, s36
 v_cndmask_b32 v78, v56, v4, s[92:93]
 v_cndmask_b32 v79, v56, v4, s[94:95]
 MM a[112:115], a[240:243], v[120:123], a[112:115]
 s_bfe_u32 s13, s2, 0x30003
 v_exp_f32 v144, v144
 MM a[116:119], a[244:247], v[120:123], a[116:119]
 s_mov_b32 s50, 2621440
 v_exp_f32 v145, v145
 MM a[116:119], a[212:215], v[112:115], a[116:119]
 s_mov_b32 s51, 0x20000
 v_exp_f32 v146, v146
 MM a[120:123], a[216:219], v[112:115], a[120:123]
 s_lshl_b32 s39, s12, 6
 v_exp_f32 v147, v147
 MM a[120:123], a[248:251], v[120:123], a[120:123]
 s_lshl_b32 s37, s24, 4
 v_exp_f32 v148, v148
 MM a[124:127], a[252:255], v[120:123], a[124:127]
 s_add_u32 s39, s39, s37
 v_exp_f32 v149, v149
 MM a[124:127], a[220:223], v[112:115], a[124:127]
 s_mul_i32 s56, s39, 1280
 v_exp_f32 v150, v150
 MM v[44:47], v[28:31], v[112:115], v[44:47]
 buffer_load_dwordx4 v1, s[8:11], s29 offen offset:1024 sc1 lds
 MM v[44:47], v[28:31], v[120:123], v[44:47]
 s_mul_i32 s39, s13, 160
 v_exp_f32 v151, v151
 MM v[64:67], v[192:195], a[160:163], v[64:67]
 s_add_u32 s56, s56, s39
 ds_read_b128 a[224:227], v2 offset:57344
 v_cndmask_b32 v112, v60, v4, s[64:65]
 MM v[64:67], v[196:199], a[164:167], v[64:67]
 s_lshl_b32 s57, s24, 12
 v_cndmask_b32 v113, v60, v4, s[66:67]
 v_cndmask_b32 v114, v60, v4, s[68:69]
 MM v[64:67], v[200:203], a[168:171], v[64:67]
 s_add_u32 s57, s57, 0x24000
 ds_read_b128 a[192:195], v2 offset:49152
 v_cndmask_b32 v115, v60, v4, s[70:71]
 MM v[64:67], v[204:207], a[172:175], v[64:67]
 v_cndmask_b32 v116, v60, v4, s[72:73]
 v_cndmask_b32 v117, v60, v4, s[74:75]
 MM v[80:83], v[204:207], a[188:191], v[60:63]
 ds_read_b128 a[196:199], v2 offset:50176
 v_cndmask_b32 v118, v60, v4, s[76:77]
 MM v[80:83], v[200:203], a[184:187], v[80:83]
 ds_read_b128 v[200:203], v3 offset:18432
 v_cndmask_b32 v119, v60, v4, s[78:79]
 MM v[80:83], v[196:199], a[180:183], v[80:83]
 ds_read_b128 v[196:199], v3 offset:17408
 v_cndmask_b32 v120, v60, v4, s[80:81]
 MM v[80:83], v[192:195], a[176:179], v[80:83]
 ds_read_b128 a[228:231], v2 offset:58368
 v_cndmask_b32 v121, v60, v4, s[82:83]
 MM v[84:87], v[208:211], a[176:179], v[60:63]
 ds_read_b128 v[192:195], v3 offset:16384
 v_cndmask_b32 v122, v60, v4, s[84:85]
 MM v[84:87], v[212:215], a[180:183], v[84:87]
 ds_read_b128 a[232:235], v2 offset:59392
 v_cndmask_b32 v123, v60, v4, s[86:87]
 MM v[84:87], v[216:219], a[184:187], v[84:87]
 ds_read_b128 v[204:207], v3 offset:19456
 v_cndmask_b32 v124, v60, v4, s[88:89]
 MM v[84:87], v[220:223], a[188:191], v[84:87]
 ds_read_b128 a[200:203], v2 offset:51200
 v_cndmask_b32 v125, v60, v4, s[90:91]
 MM v[68:71], v[220:223], a[172:175], v[68:71]
 ds_read_b128 v[220:223], v3 offset:23552
 v_add_u32 v18, 70729728, v1
 MM v[68:71], v[216:219], a[168:171], v[68:71]
 buffer_load_dwordx4 v1, s[8:11], s29 offen offset:2048 sc1 lds
 MM v[68:71], v[212:215], a[164:167], v[68:71]
 ds_read_b128 a[204:207], v2 offset:52224
 v_cndmask_b32 v126, v60, v4, s[92:93]
 MM v[68:71], v[208:211], a[160:163], v[68:71]
 ds_read_b128 v[216:219], v3 offset:22528
 v_cndmask_b32 v127, v60, v4, s[94:95]
 MM v[72:75], v[224:227], a[160:163], v[72:75]
 ds_read_b128 a[236:239], v2 offset:60416
 v_cvt_pk_bf16_f32 v144, v144, v145
 MM v[72:75], v[228:231], a[164:167], v[72:75]
 ds_read_b128 v[212:215], v3 offset:21504
 v_cvt_pk_bf16_f32 v145, v146, v147
 MM v[72:75], v[232:235], a[168:171], v[72:75]
 ds_read_b128 v[208:211], v3 offset:20480
 v_cvt_pk_bf16_f32 v146, v148, v149
 MM v[72:75], v[236:239], a[172:175], v[72:75]
 ds_read_b128 a[240:243], v2 offset:61440
 v_cvt_pk_bf16_f32 v147, v150, v151
 MM v[88:91], v[236:239], a[188:191], v[60:63]
 ds_read_b128 v[236:239], v3 offset:27648
 v_add_u32 v20, 0, v1
 MM v[88:91], v[232:235], a[184:187], v[88:91]
 ds_read_b128 a[208:211], v2 offset:53248
 v_mul_u32_u24 v16, 205, v20
 MM v[88:91], v[228:231], a[180:183], v[88:91]
 ds_read_b128 v[228:231], v3 offset:25600
 v_lshrrev_b32 v16, 15, v16
 MM v[88:91], v[224:227], a[176:179], v[88:91]
 ds_read_b128 v[224:227], v3 offset:24576
 v_mul_u32_u24 v16, 1120, v16
 MM v[92:95], v[240:243], a[176:179], v[60:63]
 ds_read_b128 v[232:235], v3 offset:26624
 v_add_u32 v20, v20, v16
 MM v[92:95], v[244:247], a[180:183], v[92:95]
 buffer_load_dwordx4 v[8:11], v18, s[16:19], 0 offen sc1
 MM v[92:95], v[248:251], a[184:187], v[92:95]
 ds_read_b128 a[212:215], v2 offset:54272
 v_add_u32 v21, 1024, v1
 MM v[92:95], v[252:255], a[188:191], v[92:95]
 ds_read_b128 a[244:247], v2 offset:62464
 v_mul_u32_u24 v16, 205, v21
 MM v[76:79], v[252:255], a[172:175], v[76:79]
 buffer_load_dwordx4 v1, s[8:11], s29 offen offset:3072 sc1 lds
 MM v[76:79], v[248:251], a[168:171], v[76:79]
 s_add_u32 s29, s29, 0x4000
 ds_read_b128 v[252:255], v3 offset:31744
 v_lshrrev_b32 v16, 15, v16
 MM v[76:79], v[244:247], a[164:167], v[76:79]
 ds_read_b128 v[248:251], v3 offset:30720
 v_mul_u32_u24 v16, 1120, v16
 MM v[76:79], v[240:243], a[160:163], v[76:79]
 s_waitcnt lgkmcnt(4)
 ds_read_b128 v[244:247], v3 offset:29696
 v_add_u32 v21, v21, v16
 MM v[112:115], v[192:195], a[176:179], v[112:115]
 ds_read_b128 v[240:243], v3 offset:28672
 v_add_u32 v17, 2048, v1
 MM v[112:115], v[196:199], a[180:183], v[112:115]
 ds_read_b128 a[248:251], v2 offset:63488
 v_mul_u32_u24 v16, 205, v17
 MM v[112:115], v[200:203], a[184:187], v[112:115]
 ds_read_b128 a[216:219], v2 offset:55296
 v_lshrrev_b32 v16, 15, v16
 MM v[112:115], v[204:207], a[188:191], v[112:115]
 v_exp_f32 v152, v152
 MM v[116:119], v[220:223], a[188:191], v[116:119]
 v_exp_f32 v153, v153
 MM v[116:119], v[216:219], a[184:187], v[116:119]
 v_exp_f32 v154, v154
 MM v[116:119], v[212:215], a[180:183], v[116:119]
 v_exp_f32 v155, v155
 MM v[116:119], v[208:211], a[176:179], v[116:119]
 v_exp_f32 v156, v156
 MM v[120:123], v[224:227], a[176:179], v[120:123]
 v_exp_f32 v157, v157
 MM v[120:123], v[228:231], a[180:183], v[120:123]
 v_exp_f32 v158, v158
 MM v[120:123], v[232:235], a[184:187], v[120:123]
 v_exp_f32 v159, v159
 MM v[120:123], v[236:239], a[188:191], v[120:123]
 s_waitcnt lgkmcnt(0)
 v_cvt_pk_bf16_f32 v152, v152, v153
 v_cvt_pk_bf16_f32 v153, v154, v155
 MM v[124:127], v[252:255], a[188:191], v[124:127]
 v_cvt_pk_bf16_f32 v154, v156, v157
 v_cvt_pk_bf16_f32 v155, v158, v159
 MM v[124:127], v[248:251], a[184:187], v[124:127]
 ds_read_b128 a[220:223], v2 offset:56320
 ds_read_b128 a[252:255], v2 offset:64512
 MM v[124:127], v[244:247], a[180:183], v[124:127]
 v_exp_f32 v160, v160
 MM v[124:127], v[240:243], a[176:179], v[124:127]
 v_exp_f32 v161, v161
 MM a[32:35], a[224:227], v[152:155], a[32:35]
 v_exp_f32 v162, v162
 MM a[32:35], a[192:195], v[144:147], a[32:35]
 v_exp_f32 v163, v163
 MM a[36:39], a[196:199], v[144:147], a[36:39]
 v_exp_f32 v164, v164
 MM a[36:39], a[228:231], v[152:155], a[36:39]
 v_exp_f32 v165, v165
 MM a[40:43], a[232:235], v[152:155], a[40:43]
 v_exp_f32 v166, v166
 MM a[40:43], a[200:203], v[144:147], a[40:43]
 v_exp_f32 v167, v167
 MM a[44:47], a[204:207], v[144:147], a[44:47]
 v_exp_f32 v168, v168
 MM a[44:47], a[236:239], v[152:155], a[44:47]
 v_exp_f32 v169, v169
 MM a[48:51], a[240:243], v[152:155], a[48:51]
 v_exp_f32 v170, v170
 MM a[48:51], a[208:211], v[144:147], a[48:51]
 v_exp_f32 v171, v171
 MM a[52:55], a[212:215], v[144:147], a[52:55]
 v_exp_f32 v172, v172
 MM a[52:55], a[244:247], v[152:155], a[52:55]
 v_exp_f32 v173, v173
 MM a[56:59], a[248:251], v[152:155], a[56:59]
 v_exp_f32 v174, v174
 MM a[56:59], a[216:219], v[144:147], a[56:59]
 s_waitcnt lgkmcnt(0)
 v_exp_f32 v175, v175
 MM a[60:63], a[220:223], v[144:147], a[60:63]
 v_cvt_pk_bf16_f32 v160, v160, v161
 v_cvt_pk_bf16_f32 v161, v162, v163
 MM a[60:63], a[252:255], v[152:155], a[60:63]
 v_cvt_pk_bf16_f32 v162, v164, v165
 v_cvt_pk_bf16_f32 v163, v166, v167
 v_cvt_pk_bf16_f32 v168, v168, v169
 v_cvt_pk_bf16_f32 v169, v170, v171
 v_cvt_pk_bf16_f32 v170, v172, v173
 v_cvt_pk_bf16_f32 v171, v174, v175
 MM v[36:39], v[28:31], v[152:155], v[36:39]
 v_mul_u32_u24 v16, 1120, v16
 v_add_u32 v17, v17, v16
 v_lshrrev_b32 v16, 9, v1
 v_mul_u32_u24 v16, 0x700000, v16
 v_lshl_add_u32 v17, v16, 8, v17
 s_mul_i32 s14, s12, 745472
 s_add_u32 s14, s14, 37748736
 s_mul_i32 s15, s13, 931840
 s_add_u32 s15, s15, 62914560
 s_mul_i32 s38, s24, 7
 s_mul_i32 s36, s36, 27
 s_add_u32 s38, s38, s36
 s_add_u32 s38, s38, 128
 s_lshl_b32 s20, s38, 12
 s_xor_b32 s36, s12, 1
 s_mul_i32 s22, s36, 745472
 s_add_u32 s22, s22, 37748736
 s_add_u32 s23, s20, s22
 s_add_u32 s20, s20, s14
 s_mul_i32 s21, s38, 5120
 s_add_u32 s21, s21, s15
 s_add_u32 s37, s24, 1
 s_and_b32 s37, s37, 3
 s_lshl_b32 s37, s37, 10
 v_add_u32 v12, s37, v1
 s_add_u32 s37, s24, 2
 s_and_b32 s37, s37, 3
 s_lshl_b32 s37, s37, 10
 v_add_u32 v13, s37, v1
 s_add_u32 s37, s24, 3
 s_and_b32 s37, s37, 3
 s_lshl_b32 s37, s37, 10
 v_add_u32 v14, s37, v1
 s_add_u32 s37, s24, 4
 s_and_b32 s37, s37, 3
 s_lshl_b32 s37, s37, 10
 v_add_u32 v15, s37, v1
 MM v[36:39], v[28:31], v[144:147], v[36:39]
 s_add_u32 m0, s57, 0
 v_exp_f32 v176, v176
 MM a[92:95], a[220:223], v[160:163], a[92:95]
 buffer_load_dwordx4 v20, s[48:51], s56 offen lds
 MM a[92:95], a[252:255], v[168:171], a[92:95]
 s_add_u32 m0, s57, 1024
 v_exp_f32 v177, v177
 MM a[88:91], a[248:251], v[168:171], a[88:91]
 buffer_load_dwordx4 v21, s[48:51], s56 offen lds
 MM a[88:91], a[216:219], v[160:163], a[88:91]
 s_add_u32 m0, s57, 2048
 v_exp_f32 v178, v178
 MM a[84:87], a[212:215], v[160:163], a[84:87]
 buffer_load_dwordx4 v17, s[48:51], s56 offen lds
 MM a[84:87], a[244:247], v[168:171], a[84:87]
 v_exp_f32 v179, v179
 MM a[80:83], a[240:243], v[168:171], a[80:83]
 v_exp_f32 v180, v180
 MM a[80:83], a[208:211], v[160:163], a[80:83]
 s_xor_b32 s30, s30, 0x10000
 v_xor_b32 v2, 0x10000, v2
 v_xor_b32 v3, 0x10000, v3
 MM a[76:79], a[204:207], v[160:163], a[76:79]
 s_xor_b32 s31, s31, 0x10000
 v_exp_f32 v181, v181
 MM a[76:79], a[236:239], v[168:171], a[76:79]
 v_exp_f32 v182, v182
 MM a[72:75], a[232:235], v[168:171], a[72:75]
 v_exp_f32 v183, v183
 MM a[72:75], a[200:203], v[160:163], a[72:75]
 v_exp_f32 v184, v184
 MM a[68:71], a[196:199], v[160:163], a[68:71]
 v_exp_f32 v185, v185
 MM a[68:71], a[228:231], v[168:171], a[68:71]
 s_waitcnt vmcnt(3) lgkmcnt(0)
 v_exp_f32 v186, v186
 MM a[64:67], a[224:227], v[168:171], a[64:67]
 s_barrier
 v_exp_f32 v187, v187
 MM a[64:67], a[192:195], v[160:163], a[64:67]
 v_exp_f32 v188, v188
 v_exp_f32 v189, v189
 v_exp_f32 v190, v190
 v_exp_f32 v191, v191
 v_max3_f32 v5, v64, v65, v66
 v_max3_f32 v6, v67, v80, v81
 v_max3_f32 v5, v82, v83, v5
 v_max3_f32 v6, v84, v85, v6
 v_max3_f32 v5, v86, v87, v5
 v_max3_f32 v6, v68, v69, v6
 v_max3_f32 v5, v70, v71, v5
 v_max3_f32 v6, v72, v73, v6
 v_max3_f32 v5, v74, v75, v5
 v_max3_f32 v6, v88, v89, v6
 v_max3_f32 v5, v90, v91, v5
 v_max3_f32 v6, v92, v93, v6
 v_max3_f32 v5, v94, v95, v5
 v_max3_f32 v6, v76, v77, v6
 v_max3_f32 v5, v78, v79, v5
 v_max3_f32 v6, v112, v113, v6
 v_max3_f32 v5, v114, v115, v5
 v_max3_f32 v6, v116, v117, v6
 v_max3_f32 v5, v118, v119, v5
 v_max3_f32 v6, v120, v121, v6
 v_max3_f32 v5, v122, v123, v5
 v_max3_f32 v6, v124, v125, v6
 v_max3_f32 v5, v126, v127, v5
 MM v[40:43], v[28:31], v[160:163], v[40:43]
 v_cvt_pk_bf16_f32 v176, v176, v177
 v_cvt_pk_bf16_f32 v177, v178, v179
 v_cvt_pk_bf16_f32 v178, v180, v181
 v_cvt_pk_bf16_f32 v179, v182, v183
 v_cvt_pk_bf16_f32 v184, v184, v185
 v_cvt_pk_bf16_f32 v185, v186, v187
 v_cvt_pk_bf16_f32 v186, v188, v189
 v_cvt_pk_bf16_f32 v187, v190, v191
 v_mov_b32 v96, v4
 v_mov_b32 v97, v4
 v_mov_b32 v98, v4
 v_mov_b32 v99, v4
 v_mov_b32 v100, v4
 v_mov_b32 v101, v4
 v_mov_b32 v102, v4
 v_mov_b32 v103, v4
 v_mov_b32 v104, v4
 v_mov_b32 v105, v4
 v_mov_b32 v106, v4
 v_mov_b32 v107, v4
 v_mov_b32 v108, v4
 v_mov_b32 v109, v4
 v_mov_b32 v110, v4
 v_mov_b32 v111, v4
 v_max_f32 v5, v5, v6
 v_cmp_lt_f32 vcc, 0x42400000, v5
 MM v[40:43], v[28:31], v[168:171], v[40:43]
 s_cbranch_vccnz b1d2rd_r
b1d2rd_ok:
 s_nop 7
 v_rcp_f32 v34, v32
 v_rcp_f32 v35, v32
 v_rcp_f32 v38, v36
 v_rcp_f32 v39, v36
 v_accvgpr_read_b32 v128, a0
 v_accvgpr_read_b32 v129, a1
 v_accvgpr_read_b32 v130, a2
 v_accvgpr_read_b32 v131, a3
 v_accvgpr_read_b32 v132, a4
 v_accvgpr_read_b32 v133, a5
 v_accvgpr_read_b32 v134, a6
 v_accvgpr_read_b32 v135, a7
 v_pk_mul_f32 v[128:129], v[128:129], v[34:35]
 v_pk_mul_f32 v[130:131], v[130:131], v[34:35]
 v_pk_mul_f32 v[132:133], v[132:133], v[34:35]
 v_pk_mul_f32 v[134:135], v[134:135], v[34:35]
 v_cvt_pk_bf16_f32 v128, v128, v129
 v_cvt_pk_bf16_f32 v129, v130, v131
 v_cvt_pk_bf16_f32 v130, v132, v133
 v_cvt_pk_bf16_f32 v131, v134, v135
 s_add_u32 s41, s32, 0
 buffer_store_dwordx4 v[128:131], v1, s[16:19], s41 offen sc1
 v_accvgpr_read_b32 v136, a8
 v_accvgpr_read_b32 v137, a9
 v_accvgpr_read_b32 v138, a10
 v_accvgpr_read_b32 v139, a11
 v_accvgpr_read_b32 v140, a12
 v_accvgpr_read_b32 v141, a13
 v_accvgpr_read_b32 v142, a14
 v_accvgpr_read_b32 v143, a15
 v_pk_mul_f32 v[136:137], v[136:137], v[34:35]
 v_pk_mul_f32 v[138:139], v[138:139], v[34:35]
 v_pk_mul_f32 v[140:141], v[140:141], v[34:35]
 v_pk_mul_f32 v[142:143], v[142:143], v[34:35]
 v_cvt_pk_bf16_f32 v136, v136, v137
 v_cvt_pk_bf16_f32 v137, v138, v139
 v_cvt_pk_bf16_f32 v138, v140, v141
 v_cvt_pk_bf16_f32 v139, v142, v143
 s_add_u32 s42, s32, 4096
 buffer_store_dwordx4 v[136:139], v1, s[16:19], s42 offen sc1
 v_accvgpr_read_b32 v144, a16
 v_accvgpr_read_b32 v145, a17
 v_accvgpr_read_b32 v146, a18
 v_accvgpr_read_b32 v147, a19
 v_accvgpr_read_b32 v148, a20
 v_accvgpr_read_b32 v149, a21
 v_accvgpr_read_b32 v150, a22
 v_accvgpr_read_b32 v151, a23
 v_pk_mul_f32 v[144:145], v[144:145], v[34:35]
 v_pk_mul_f32 v[146:147], v[146:147], v[34:35]
 v_pk_mul_f32 v[148:149], v[148:149], v[34:35]
 v_pk_mul_f32 v[150:151], v[150:151], v[34:35]
 v_cvt_pk_bf16_f32 v144, v144, v145
 v_cvt_pk_bf16_f32 v145, v146, v147
 v_cvt_pk_bf16_f32 v146, v148, v149
 v_cvt_pk_bf16_f32 v147, v150, v151
 s_add_u32 s43, s32, 8192
 buffer_store_dwordx4 v[144:147], v1, s[16:19], s43 offen sc1
 v_accvgpr_read_b32 v152, a24
 v_accvgpr_read_b32 v153, a25
 v_accvgpr_read_b32 v154, a26
 v_accvgpr_read_b32 v155, a27
 v_accvgpr_read_b32 v156, a28
 v_accvgpr_read_b32 v157, a29
 v_accvgpr_read_b32 v158, a30
 v_accvgpr_read_b32 v159, a31
 v_pk_mul_f32 v[152:153], v[152:153], v[34:35]
 v_pk_mul_f32 v[154:155], v[154:155], v[34:35]
 v_pk_mul_f32 v[156:157], v[156:157], v[34:35]
 v_pk_mul_f32 v[158:159], v[158:159], v[34:35]
 v_cvt_pk_bf16_f32 v152, v152, v153
 v_cvt_pk_bf16_f32 v153, v154, v155
 v_cvt_pk_bf16_f32 v154, v156, v157
 v_cvt_pk_bf16_f32 v155, v158, v159
 s_add_u32 s40, s32, 12288
 buffer_store_dwordx4 v[152:155], v1, s[16:19], s40 offen sc1
 v_accvgpr_read_b32 v160, a32
 v_accvgpr_read_b32 v161, a33
 v_accvgpr_read_b32 v162, a34
 v_accvgpr_read_b32 v163, a35
 v_accvgpr_read_b32 v164, a36
 v_accvgpr_read_b32 v165, a37
 v_accvgpr_read_b32 v166, a38
 v_accvgpr_read_b32 v167, a39
 v_pk_mul_f32 v[160:161], v[160:161], v[38:39]
 v_pk_mul_f32 v[162:163], v[162:163], v[38:39]
 v_pk_mul_f32 v[164:165], v[164:165], v[38:39]
 v_pk_mul_f32 v[166:167], v[166:167], v[38:39]
 v_cvt_pk_bf16_f32 v160, v160, v161
 v_cvt_pk_bf16_f32 v161, v162, v163
 v_cvt_pk_bf16_f32 v162, v164, v165
 v_cvt_pk_bf16_f32 v163, v166, v167
 s_add_u32 s41, s33, 0
 buffer_store_dwordx4 v[160:163], v1, s[16:19], s41 offen sc1
 v_accvgpr_read_b32 v168, a40
 v_accvgpr_read_b32 v169, a41
 v_accvgpr_read_b32 v170, a42
 v_accvgpr_read_b32 v171, a43
 v_accvgpr_read_b32 v172, a44
 v_accvgpr_read_b32 v173, a45
 v_accvgpr_read_b32 v174, a46
 v_accvgpr_read_b32 v175, a47
 v_pk_mul_f32 v[168:169], v[168:169], v[38:39]
 v_pk_mul_f32 v[170:171], v[170:171], v[38:39]
 v_pk_mul_f32 v[172:173], v[172:173], v[38:39]
 v_pk_mul_f32 v[174:175], v[174:175], v[38:39]
 v_cvt_pk_bf16_f32 v168, v168, v169
 v_cvt_pk_bf16_f32 v169, v170, v171
 v_cvt_pk_bf16_f32 v170, v172, v173
 v_cvt_pk_bf16_f32 v171, v174, v175
 s_add_u32 s42, s33, 4096
 buffer_store_dwordx4 v[168:171], v1, s[16:19], s42 offen sc1
 v_accvgpr_read_b32 v128, a48
 v_accvgpr_read_b32 v129, a49
 v_accvgpr_read_b32 v130, a50
 v_accvgpr_read_b32 v131, a51
 v_accvgpr_read_b32 v132, a52
 v_accvgpr_read_b32 v133, a53
 v_accvgpr_read_b32 v134, a54
 v_accvgpr_read_b32 v135, a55
 v_pk_mul_f32 v[128:129], v[128:129], v[38:39]
 v_pk_mul_f32 v[130:131], v[130:131], v[38:39]
 v_pk_mul_f32 v[132:133], v[132:133], v[38:39]
 v_pk_mul_f32 v[134:135], v[134:135], v[38:39]
 v_cvt_pk_bf16_f32 v128, v128, v129
 v_cvt_pk_bf16_f32 v129, v130, v131
 v_cvt_pk_bf16_f32 v130, v132, v133
 v_cvt_pk_bf16_f32 v131, v134, v135
 s_add_u32 s43, s33, 8192
 buffer_store_dwordx4 v[128:131], v1, s[16:19], s43 offen sc1
 v_accvgpr_read_b32 v136, a56
 v_accvgpr_read_b32 v137, a57
 v_accvgpr_read_b32 v138, a58
 v_accvgpr_read_b32 v139, a59
 v_accvgpr_read_b32 v140, a60
 v_accvgpr_read_b32 v141, a61
 v_accvgpr_read_b32 v142, a62
 v_accvgpr_read_b32 v143, a63
 v_pk_mul_f32 v[136:137], v[136:137], v[38:39]
 v_pk_mul_f32 v[138:139], v[138:139], v[38:39]
 v_pk_mul_f32 v[140:141], v[140:141], v[38:39]
 v_pk_mul_f32 v[142:143], v[142:143], v[38:39]
 v_cvt_pk_bf16_f32 v136, v136, v137
 v_cvt_pk_bf16_f32 v137, v138, v139
 v_cvt_pk_bf16_f32 v138, v140, v141
 v_cvt_pk_bf16_f32 v139, v142, v143
 s_add_u32 s40, s33, 12288
 buffer_store_dwordx4 v[136:139], v1, s[16:19], s40 offen sc1
 s_branch k_last
k_spare:
 s_load_dwordx2 s[82:83], s[0:1], 72
 s_waitcnt vmcnt(31) lgkmcnt(0)
 MM v[64:67], v[192:195], a[192:195], 0
 s_add_u32 m0, s47, 32768
 s_add_u32 s41, s45, 1048576
 ds_read_b64_tr_b16 v[224:225], v13 offset:0
 s_waitcnt vmcnt(30)
 MM v[64:67], v[196:199], a[196:199], v[64:67]
 buffer_load_dwordx4 v7, s[48:51], s41 offen offset:0 lds
 s_waitcnt vmcnt(30)
 MM v[64:67], v[200:203], a[200:203], v[64:67]
 buffer_store_dwordx4 v[72:75], v1, s[16:19], s86 offen offset:1024 sc1
 s_waitcnt vmcnt(30)
 MM v[64:67], v[204:207], a[204:207], v[64:67]
 s_add_u32 s42, s45, 1113088
 ds_read_b64_tr_b16 v[226:227], v13 offset:512
 ds_read_b64_tr_b16 v[228:229], v13 offset:4096
 s_waitcnt vmcnt(26)
 MM v[68:71], v[204:207], a[220:223], 0
 ds_read_b64_tr_b16 v[230:231], v13 offset:4608
 ds_read_b64_tr_b16 v[232:233], v13 offset:8192
 MM v[68:71], v[200:203], a[216:219], v[68:71]
 s_waitcnt vmcnt(25)
 ds_read_b64_tr_b16 v[234:235], v13 offset:8704
 ds_read_b64_tr_b16 v[236:237], v13 offset:12288
 MM v[68:71], v[196:199], a[212:215], v[68:71]
 buffer_store_dwordx4 v[76:79], v1, s[16:19], s87 offen offset:1024 sc1
 MM v[68:71], v[192:195], a[208:211], v[68:71]
 buffer_load_dwordx4 v8, s[48:51], s42 offen offset:1024 lds
 MM v[72:75], v[192:195], a[224:227], 0
 s_add_u32 s43, s45, 1177600
 ds_read_b64_tr_b16 v[238:239], v13 offset:12800
 v_cvt_pk_bf16_f32 v56, v176, v177
 s_waitcnt vmcnt(26)
 MM v[72:75], v[196:199], a[228:231], v[72:75]
 s_waitcnt vmcnt(25)
 v_cvt_pk_bf16_f32 v57, v178, v179
 v_cvt_pk_bf16_f32 v58, v180, v181
 MM v[72:75], v[200:203], a[232:235], v[72:75]
 s_waitcnt vmcnt(20)
 s_waitcnt vmcnt(24)
 v_cvt_pk_bf16_f32 v59, v182, v183
 MM v[72:75], v[204:207], a[236:239], v[72:75]
 buffer_load_dwordx4 v7, s[48:51], s43 offen offset:2048 lds
 MM v[76:79], v[204:207], a[252:255], 0
 s_add_u32 s40, s45, 1242112
 ds_read_b64_tr_b16 v[240:241], v14 offset:0
 ds_read_b64_tr_b16 v[242:243], v14 offset:512
 MM v[76:79], v[200:203], a[248:251], v[76:79]
 ds_read_b64_tr_b16 v[244:245], v14 offset:4096
 ds_read_b64_tr_b16 v[246:247], v14 offset:4608
 MM v[76:79], v[196:199], a[244:247], v[76:79]
 buffer_store_dwordx4 v[96:99], v1, s[16:19], s84 offen offset:2048 sc1
 MM v[76:79], v[192:195], a[240:243], v[76:79]
 ds_read_b64_tr_b16 v[248:249], v14 offset:8192
 ds_read_b64_tr_b16 v[250:251], v14 offset:8704
 MM v[92:95], v[208:211], a[240:243], 0
 buffer_load_dwordx4 v8, s[48:51], s40 offen offset:3072 lds
 MM v[92:95], v[212:215], a[244:247], v[92:95]
 s_add_u32 m0, s47, 49152
 s_add_u32 s41, s45, 1048704
 ds_read_b64_tr_b16 v[252:253], v14 offset:12288
 MM v[92:95], v[216:219], a[248:251], v[92:95]
 ds_read_b64_tr_b16 v[254:255], v14 offset:12800
 MM v[92:95], v[220:223], a[252:255], v[92:95]
 MM v[88:91], v[220:223], a[236:239], 0
 buffer_store_dwordx4 v[100:103], v1, s[16:19], s85 offen offset:2048 sc1
 MM v[88:91], v[216:219], a[232:235], v[88:91]
 buffer_load_dwordx4 v7, s[48:51], s41 offen offset:0 lds
 MM v[88:91], v[212:215], a[228:231], v[88:91]
 s_add_u32 s42, s45, 1113216
 MM v[88:91], v[208:211], a[224:227], v[88:91]
 MM v[84:87], v[208:211], a[208:211], 0
 MM v[84:87], v[212:215], a[212:215], v[84:87]
 MM v[84:87], v[216:219], a[216:219], v[84:87]
 buffer_store_dwordx4 v[104:107], v1, s[16:19], s86 offen offset:2048 sc1
 MM v[84:87], v[220:223], a[220:223], v[84:87]
 buffer_load_dwordx4 v8, s[48:51], s42 offen offset:1024 lds
 MM v[80:83], v[220:223], a[204:207], 0
 s_add_u32 s43, s45, 1177728
 ds_read_b64_tr_b16 v[192:193], v11 offset:16384
 ds_read_b64_tr_b16 v[194:195], v11 offset:16896
 MM v[80:83], v[216:219], a[200:203], v[80:83]
 s_waitcnt lgkmcnt(2)
 ds_read_b64_tr_b16 v[196:197], v11 offset:20480
 ds_read_b64_tr_b16 v[198:199], v11 offset:20992
 MM v[80:83], v[212:215], a[196:199], v[80:83]
 s_barrier
 ds_read_b64_tr_b16 v[200:201], v11 offset:24576
 ds_read_b64_tr_b16 v[202:203], v11 offset:25088
 MM v[80:83], v[208:211], a[192:195], v[80:83]
 buffer_load_dwordx4 v7, s[48:51], s43 offen offset:2048 lds
 MM v[96:99], v[224:227], a[192:195], 0
 buffer_store_dwordx4 v[108:111], v1, s[16:19], s87 offen offset:2048 sc1
 MM v[96:99], v[228:231], a[196:199], v[96:99]
 s_add_u32 s40, s45, 1242240
 ds_read_b64_tr_b16 v[204:205], v11 offset:28672
 ds_read_b64_tr_b16 v[206:207], v11 offset:29184
 MM v[96:99], v[232:235], a[200:203], v[96:99]
 MM v[96:99], v[236:239], a[204:207], v[96:99]
 MM v[100:103], v[236:239], a[220:223], 0
 buffer_load_dwordx4 v8, s[48:51], s40 offen offset:3072 lds
 MM v[100:103], v[232:235], a[216:219], v[100:103]
 MM v[100:103], v[228:231], a[212:215], v[100:103]
 buffer_store_dwordx4 v[128:131], v1, s[16:19], s84 offen offset:3072 sc1
 MM v[100:103], v[224:227], a[208:211], v[100:103]
 MM v[104:107], v[224:227], a[224:227], 0
 MM v[104:107], v[228:231], a[228:231], v[104:107]
 MM v[104:107], v[232:235], a[232:235], v[104:107]
 MM v[104:107], v[236:239], a[236:239], v[104:107]
 MM v[108:111], v[236:239], a[252:255], 0
 buffer_store_dwordx4 v[132:135], v1, s[16:19], s85 offen offset:3072 sc1
 MM v[108:111], v[232:235], a[248:251], v[108:111]
 ds_read_b64_tr_b16 v[208:209], v12 offset:16384
 ds_read_b64_tr_b16 v[210:211], v12 offset:16896
 MM v[108:111], v[228:231], a[244:247], v[108:111]
 ds_read_b64_tr_b16 v[212:213], v12 offset:20480
 ds_read_b64_tr_b16 v[214:215], v12 offset:20992
 MM v[108:111], v[224:227], a[240:243], v[108:111]
 ds_read_b64_tr_b16 v[216:217], v12 offset:24576
 ds_read_b64_tr_b16 v[218:219], v12 offset:25088
 MM v[124:127], v[240:243], a[240:243], 0
 ds_read_b64_tr_b16 v[220:221], v12 offset:28672
 ds_read_b64_tr_b16 v[222:223], v12 offset:29184
 MM v[124:127], v[244:247], a[244:247], v[124:127]
 MM v[124:127], v[248:251], a[248:251], v[124:127]
 buffer_store_dwordx4 v[136:139], v1, s[16:19], s86 offen offset:3072 sc1
 MM v[124:127], v[252:255], a[252:255], v[124:127]
 MM v[120:123], v[252:255], a[236:239], 0
 s_add_u32 m0, s47, 65536
 s_add_u32 s41, s45, 2097152
 MM v[120:123], v[248:251], a[232:235], v[120:123]
 MM v[120:123], v[244:247], a[228:231], v[120:123]
 MM v[120:123], v[240:243], a[224:227], v[120:123]
 MM v[116:119], v[240:243], a[208:211], 0
 buffer_store_dwordx4 v[140:143], v1, s[16:19], s87 offen offset:3072 sc1
 MM v[116:119], v[244:247], a[212:215], v[116:119]
 buffer_load_dwordx4 v7, s[48:51], s41 offen offset:0 lds
 MM v[116:119], v[248:251], a[216:219], v[116:119]
 ds_read_b128 v[28:31], v22 offset:0
 MM v[116:119], v[252:255], a[220:223], v[116:119]
 MM v[112:115], v[252:255], a[204:207], 0
 s_add_u32 s42, s45, 2161664
 ds_read_b64_tr_b16 v[224:225], v13 offset:16384
 ds_read_b64_tr_b16 v[226:227], v13 offset:16896
 MM v[112:115], v[248:251], a[200:203], v[112:115]
 ds_read_b64_tr_b16 v[228:229], v13 offset:20480
 ds_read_b64_tr_b16 v[230:231], v13 offset:20992
 MM v[112:115], v[244:247], a[196:199], v[112:115]
 ds_read_b64_tr_b16 v[232:233], v13 offset:24576
 ds_read_b64_tr_b16 v[234:235], v13 offset:25088
 MM v[112:115], v[240:243], a[192:195], v[112:115]
 s_waitcnt lgkmcnt(7)
 ds_read_b64_tr_b16 v[236:237], v13 offset:28672
 ds_read_b64_tr_b16 v[238:239], v13 offset:29184
 MM v[128:131], v[192:195], a[192:195], 0
 buffer_load_dwordx4 v8, s[48:51], s42 offen offset:1024 lds
 MM v[128:131], v[196:199], a[196:199], v[128:131]
 MM v[128:131], v[200:203], a[200:203], v[128:131]
 MM v[128:131], v[204:207], a[204:207], v[128:131]
 MM v[132:135], v[204:207], a[220:223], 0
 s_add_u32 s43, s45, 2226176
 MM v[132:135], v[200:203], a[216:219], v[132:135]
 MM v[132:135], v[196:199], a[212:215], v[132:135]
 MM v[132:135], v[192:195], a[208:211], v[132:135]
 MM v[136:139], v[192:195], a[224:227], 0
 s_waitcnt lgkmcnt(0)
 buffer_store_dwordx4 v[28:31], v1, s[16:19], s88 offen offset:0 sc1
 MM v[136:139], v[196:199], a[228:231], v[136:139]
 buffer_load_dwordx4 v7, s[48:51], s43 offen offset:2048 lds
 MM v[136:139], v[200:203], a[232:235], v[136:139]
 MM v[136:139], v[204:207], a[236:239], v[136:139]
 MM v[140:143], v[204:207], a[252:255], 0
 s_add_u32 s40, s45, 2290688
 ds_read_b64_tr_b16 v[240:241], v14 offset:16384
 ds_read_b64_tr_b16 v[242:243], v14 offset:16896
 MM v[140:143], v[200:203], a[248:251], v[140:143]
 ds_read_b64_tr_b16 v[244:245], v14 offset:20480
 ds_read_b64_tr_b16 v[246:247], v14 offset:20992
 MM v[140:143], v[196:199], a[244:247], v[140:143]
 ds_read_b64_tr_b16 v[248:249], v14 offset:24576
 ds_read_b64_tr_b16 v[250:251], v14 offset:25088
 MM v[140:143], v[192:195], a[240:243], v[140:143]
 ds_read_b64_tr_b16 v[252:253], v14 offset:28672
 ds_read_b64_tr_b16 v[254:255], v14 offset:29184
 MM v[156:159], v[208:211], a[240:243], 0
 buffer_load_dwordx4 v8, s[48:51], s40 offen offset:3072 lds
 MM v[156:159], v[212:215], a[244:247], v[156:159]
 MM v[156:159], v[216:219], a[248:251], v[156:159]
 ds_read_b128 v[28:31], v22 offset:1024
 MM v[156:159], v[220:223], a[252:255], v[156:159]
 MM v[152:155], v[220:223], a[236:239], 0
 s_add_u32 m0, s47, 81920
 s_add_u32 s41, s45, 2097280
 MM v[152:155], v[216:219], a[232:235], v[152:155]
 MM v[152:155], v[212:215], a[228:231], v[152:155]
 MM v[152:155], v[208:211], a[224:227], v[152:155]
 MM v[148:151], v[208:211], a[208:211], 0
 buffer_load_dwordx4 v7, s[48:51], s41 offen offset:0 lds
 MM v[148:151], v[212:215], a[212:215], v[148:151]
 MM v[148:151], v[216:219], a[216:219], v[148:151]
 s_mul_i32 s12, s24, 5120
 MM v[148:151], v[220:223], a[220:223], v[148:151]
 MM v[144:147], v[220:223], a[204:207], 0
 s_add_u32 s42, s45, 2161792
 MM v[144:147], v[216:219], a[200:203], v[144:147]
 MM v[144:147], v[212:215], a[196:199], v[144:147]
 s_add_u32 s12, s12, 0x20000
 MM v[144:147], v[208:211], a[192:195], v[144:147]
 MM v[160:163], v[224:227], a[192:195], 0
 buffer_load_dwordx4 v8, s[48:51], s42 offen offset:1024 lds
 MM v[160:163], v[228:231], a[196:199], v[160:163]
 MM v[160:163], v[232:235], a[200:203], v[160:163]
 s_waitcnt lgkmcnt(0)
 buffer_store_dwordx4 v[28:31], v1, s[16:19], s90 offen offset:0 sc1
 MM v[160:163], v[236:239], a[204:207], v[160:163]
 s_lshr_b32 s92, s2, 1
 MM v[164:167], v[236:239], a[220:223], 0
 s_add_u32 s43, s45, 2226304
 MM v[164:167], v[232:235], a[216:219], v[164:167]
 MM v[164:167], v[228:231], a[212:215], v[164:167]
 s_and_b32 s93, s2, 1
 MM v[164:167], v[224:227], a[208:211], v[164:167]
 MM v[168:171], v[224:227], a[224:227], 0
 buffer_load_dwordx4 v7, s[48:51], s43 offen offset:2048 lds
 MM v[168:171], v[228:231], a[228:231], v[168:171]
 MM v[168:171], v[232:235], a[232:235], v[168:171]
 s_waitcnt vmcnt(13)
 s_barrier
 ds_read_b64_tr_b16 v[192:193], v11 offset:32768
 MM v[168:171], v[236:239], a[236:239], v[168:171]
 s_mul_i32 s13, s92, 40960
 ds_read_b64_tr_b16 v[194:195], v11 offset:33280
 ds_read_b64_tr_b16 v[196:197], v11 offset:36864
 MM v[172:175], v[236:239], a[252:255], 0
 s_add_u32 s40, s45, 2290816
 ds_read_b128 v[28:31], v22 offset:2048
 ds_read_b64_tr_b16 v[198:199], v11 offset:37376
 MM v[172:175], v[232:235], a[248:251], v[172:175]
 ds_read_b64_tr_b16 v[200:201], v11 offset:40960
 ds_read_b64_tr_b16 v[202:203], v11 offset:41472
 MM v[172:175], v[228:231], a[244:247], v[172:175]
 ds_read_b64_tr_b16 v[204:205], v11 offset:45056
 ds_read_b64_tr_b16 v[206:207], v11 offset:45568
 MM v[172:175], v[224:227], a[240:243], v[172:175]
 s_mul_i32 s94, s93, 640
 ds_read_b64_tr_b16 v[208:209], v12 offset:32768
 ds_read_b64_tr_b16 v[210:211], v12 offset:33280
 MM v[188:191], v[240:243], a[240:243], 0
 buffer_load_dwordx4 v8, s[48:51], s40 offen offset:3072 lds
 MM v[188:191], v[244:247], a[244:247], v[188:191]
 ds_read_b64_tr_b16 v[212:213], v12 offset:36864
 ds_read_b64_tr_b16 v[214:215], v12 offset:37376
 MM v[188:191], v[248:251], a[248:251], v[188:191]
 ds_read_b64_tr_b16 v[216:217], v12 offset:40960
 ds_read_b64_tr_b16 v[218:219], v12 offset:41472
 MM v[188:191], v[252:255], a[252:255], v[188:191]
 s_add_u32 s13, s13, s94
 ds_read_b64_tr_b16 v[220:221], v12 offset:45056
 ds_read_b64_tr_b16 v[222:223], v12 offset:45568
 MM v[184:187], v[252:255], a[236:239], 0
 MM v[184:187], v[248:251], a[232:235], v[184:187]
 MM v[184:187], v[244:247], a[228:231], v[184:187]
 MM v[184:187], v[240:243], a[224:227], v[184:187]
 MM v[180:183], v[240:243], a[208:211], 0
 s_lshl_b32 s93, s93, 2
 MM v[180:183], v[244:247], a[212:215], v[180:183]
 MM v[180:183], v[248:251], a[216:219], v[180:183]
 MM v[180:183], v[252:255], a[220:223], v[180:183]
 MM v[176:179], v[252:255], a[204:207], 0
 s_waitcnt lgkmcnt(0)
 buffer_store_dwordx4 v[28:31], v1, s[16:19], s88 offen offset:1024 sc1
 MM v[176:179], v[248:251], a[200:203], v[176:179]
 s_add_u32 s93, s93, s24
 ds_read_b64_tr_b16 v[224:225], v13 offset:32768
 ds_read_b64_tr_b16 v[226:227], v13 offset:33280
 MM v[176:179], v[244:247], a[196:199], v[176:179]
 s_add_u32 m0, s47, 98304
 s_add_u32 s41, s45, 3145728
 ds_read_b64_tr_b16 v[228:229], v13 offset:36864
 MM v[176:179], v[240:243], a[192:195], v[176:179]
 ds_read_b64_tr_b16 v[230:231], v13 offset:37376
 ds_read_b64_tr_b16 v[232:233], v13 offset:40960
 MM v[64:67], v[192:195], a[128:131], v[64:67]
 s_mul_i32 s93, s93, 182
 ds_read_b64_tr_b16 v[234:235], v13 offset:41472
 ds_read_b64_tr_b16 v[236:237], v13 offset:45056
 MM v[64:67], v[196:199], a[132:135], v[64:67]
 ds_read_b64_tr_b16 v[238:239], v13 offset:45568
 MM v[64:67], v[200:203], a[136:139], v[64:67]
 buffer_load_dwordx4 v7, s[48:51], s41 offen offset:0 lds
 MM v[64:67], v[204:207], a[140:143], v[64:67]
 buffer_load_dwordx4 a[192:195], v1, s[16:19], s36 offen offset:0 sc1
 MM v[68:71], v[204:207], a[156:159], v[68:71]
 s_add_u32 s93, s93, s92
 MM v[68:71], v[200:203], a[152:155], v[68:71]
 MM v[68:71], v[196:199], a[148:151], v[68:71]
 ds_read_b128 v[28:31], v22 offset:3072
 MM v[68:71], v[192:195], a[144:147], v[68:71]
 buffer_load_dwordx4 a[196:199], v1, s[16:19], s36 offen offset:1024 sc1
 MM v[72:75], v[192:195], a[160:163], v[72:75]
 MM v[72:75], v[196:199], a[164:167], v[72:75]
 s_mul_i32 s14, s93, 5120
 MM v[72:75], v[200:203], a[168:171], v[72:75]
 MM v[72:75], v[204:207], a[172:175], v[72:75]
 s_add_u32 s42, s45, 3210240
 MM v[76:79], v[204:207], a[188:191], v[76:79]
 buffer_load_dwordx4 a[200:203], v1, s[16:19], s36 offen offset:2048 sc1
 MM v[76:79], v[200:203], a[184:187], v[76:79]
 s_add_u32 s14, s14, 62914560
 ds_read_b64_tr_b16 v[240:241], v14 offset:32768
 ds_read_b64_tr_b16 v[242:243], v14 offset:33280
 MM v[76:79], v[196:199], a[180:183], v[76:79]
 ds_read_b64_tr_b16 v[244:245], v14 offset:36864
 ds_read_b64_tr_b16 v[246:247], v14 offset:37376
 MM v[76:79], v[192:195], a[176:179], v[76:79]
 buffer_load_dwordx4 v8, s[48:51], s42 offen offset:1024 lds
 MM v[92:95], v[208:211], a[176:179], v[92:95]
 ds_read_b64_tr_b16 v[248:249], v14 offset:40960
 ds_read_b64_tr_b16 v[250:251], v14 offset:41472
 MM v[92:95], v[212:215], a[180:183], v[92:95]
 buffer_load_dwordx4 a[204:207], v1, s[16:19], s36 offen offset:3072 sc1
 MM v[92:95], v[216:219], a[184:187], v[92:95]
 s_add_u32 s36, s36, 0x1000
 ds_read_b64_tr_b16 v[252:253], v14 offset:45056
 v_add_u32 v27, 0x1000, v1
 MM v[92:95], v[220:223], a[188:191], v[92:95]
 ds_read_b64_tr_b16 v[254:255], v14 offset:45568
 MM v[88:91], v[220:223], a[172:175], v[88:91]
 MM v[88:91], v[216:219], a[168:171], v[88:91]
 buffer_load_dwordx4 a[208:211], v1, s[16:19], s37 offen offset:0 sc1
 MM v[88:91], v[212:215], a[164:167], v[88:91]
 s_waitcnt lgkmcnt(4)
 buffer_store_dwordx4 v[28:31], v1, s[16:19], s90 offen offset:1024 sc1
 MM v[88:91], v[208:211], a[160:163], v[88:91]
 MM v[84:87], v[208:211], a[144:147], v[84:87]
 s_add_u32 s43, s45, 3274752
 MM v[84:87], v[212:215], a[148:151], v[84:87]
 MM v[84:87], v[216:219], a[152:155], v[84:87]
 buffer_load_dwordx4 a[212:215], v1, s[16:19], s37 offen offset:1024 sc1
 MM v[84:87], v[220:223], a[156:159], v[84:87]
 MM v[80:83], v[220:223], a[140:143], v[80:83]
 buffer_load_dwordx4 v7, s[48:51], s43 offen offset:2048 lds
 MM v[80:83], v[216:219], a[136:139], v[80:83]
 ds_read_b64_tr_b16 v[192:193], v11 offset:49152
 ds_read_b64_tr_b16 v[194:195], v11 offset:49664
 MM v[80:83], v[212:215], a[132:135], v[80:83]
 ds_read_b64_tr_b16 v[196:197], v11 offset:53248
 ds_read_b64_tr_b16 v[198:199], v11 offset:53760
 MM v[80:83], v[208:211], a[128:131], v[80:83]
 buffer_load_dwordx4 a[216:219], v1, s[16:19], s37 offen offset:2048 sc1
 MM v[96:99], v[224:227], a[128:131], v[96:99]
 ds_read_b128 v[28:31], v22 offset:4096
 ds_read_b64_tr_b16 v[200:201], v11 offset:57344
 MM v[96:99], v[228:231], a[132:135], v[96:99]
 ds_read_b64_tr_b16 v[202:203], v11 offset:57856
 ds_read_b64_tr_b16 v[204:205], v11 offset:61440
 MM v[96:99], v[232:235], a[136:139], v[96:99]
 ds_read_b64_tr_b16 v[206:207], v11 offset:61952
 MM v[96:99], v[236:239], a[140:143], v[96:99]
 buffer_load_dwordx4 a[220:223], v1, s[16:19], s37 offen offset:3072 sc1
 MM v[100:103], v[236:239], a[156:159], v[100:103]
 s_add_u32 s37, s37, 0x1000
 MM v[100:103], v[232:235], a[152:155], v[100:103]
 s_add_u32 s40, s45, 3339264
 MM v[100:103], v[228:231], a[148:151], v[100:103]
 MM v[100:103], v[224:227], a[144:147], v[100:103]
 MM v[104:107], v[224:227], a[160:163], v[104:107]
 buffer_load_dwordx4 a[224:227], v1, s[16:19], s38 offen offset:0 sc1
 MM v[104:107], v[228:231], a[164:167], v[104:107]
 buffer_load_dwordx4 v8, s[48:51], s40 offen offset:3072 lds
 MM v[104:107], v[232:235], a[168:171], v[104:107]
 MM v[104:107], v[236:239], a[172:175], v[104:107]
 MM v[108:111], v[236:239], a[188:191], v[108:111]
 ds_read_b64_tr_b16 v[208:209], v12 offset:49152
 ds_read_b64_tr_b16 v[210:211], v12 offset:49664
 MM v[108:111], v[232:235], a[184:187], v[108:111]
 buffer_load_dwordx4 a[228:231], v1, s[16:19], s38 offen offset:1024 sc1
 MM v[108:111], v[228:231], a[180:183], v[108:111]
 ds_read_b64_tr_b16 v[212:213], v12 offset:53248
 ds_read_b64_tr_b16 v[214:215], v12 offset:53760
 MM v[108:111], v[224:227], a[176:179], v[108:111]
 ds_read_b64_tr_b16 v[216:217], v12 offset:57344
 ds_read_b64_tr_b16 v[218:219], v12 offset:57856
 MM v[124:127], v[240:243], a[176:179], v[124:127]
 s_waitcnt lgkmcnt(6)
 buffer_store_dwordx4 v[28:31], v1, s[16:19], s88 offen offset:2048 sc1
 MM v[124:127], v[244:247], a[180:183], v[124:127]
 buffer_load_dwordx4 a[232:235], v1, s[16:19], s38 offen offset:2048 sc1
 MM v[124:127], v[248:251], a[184:187], v[124:127]
 s_add_u32 m0, s47, 114688
 s_add_u32 s41, s45, 3145856
 ds_read_b64_tr_b16 v[220:221], v12 offset:61440
 MM v[124:127], v[252:255], a[188:191], v[124:127]
 ds_read_b64_tr_b16 v[222:223], v12 offset:61952
 MM v[120:123], v[252:255], a[172:175], v[120:123]
 MM v[120:123], v[248:251], a[168:171], v[120:123]
 MM v[120:123], v[244:247], a[164:167], v[120:123]
 buffer_load_dwordx4 a[236:239], v1, s[16:19], s38 offen offset:3072 sc1
 MM v[120:123], v[240:243], a[160:163], v[120:123]
 buffer_load_dwordx4 v7, s[48:51], s41 offen offset:0 lds
 MM v[116:119], v[240:243], a[144:147], v[116:119]
 s_add_u32 s38, s38, 0x1000
 MM v[116:119], v[244:247], a[148:151], v[116:119]
 MM v[116:119], v[248:251], a[152:155], v[116:119]
 ds_read_b128 v[28:31], v22 offset:5120
 MM v[116:119], v[252:255], a[156:159], v[116:119]
 buffer_load_dwordx4 a[240:243], v1, s[16:19], s39 offen offset:0 sc1
 MM v[112:115], v[252:255], a[140:143], v[112:115]
 ds_read_b64_tr_b16 v[224:225], v13 offset:49152
 ds_read_b64_tr_b16 v[226:227], v13 offset:49664
 MM v[112:115], v[248:251], a[136:139], v[112:115]
 ds_read_b64_tr_b16 v[228:229], v13 offset:53248
 ds_read_b64_tr_b16 v[230:231], v13 offset:53760
 MM v[112:115], v[244:247], a[132:135], v[112:115]
 ds_read_b64_tr_b16 v[232:233], v13 offset:57344
 ds_read_b64_tr_b16 v[234:235], v13 offset:57856
 MM v[112:115], v[240:243], a[128:131], v[112:115]
 buffer_load_dwordx4 a[244:247], v1, s[16:19], s39 offen offset:1024 sc1
 MM v[128:131], v[192:195], a[128:131], v[128:131]
 s_add_u32 s42, s45, 3210368
 ds_read_b64_tr_b16 v[236:237], v13 offset:61440
 ds_read_b64_tr_b16 v[238:239], v13 offset:61952
 MM v[128:131], v[196:199], a[132:135], v[128:131]
 MM v[128:131], v[200:203], a[136:139], v[128:131]
 MM v[128:131], v[204:207], a[140:143], v[128:131]
 buffer_load_dwordx4 v8, s[48:51], s42 offen offset:1024 lds
 MM v[132:135], v[204:207], a[156:159], v[132:135]
 buffer_load_dwordx4 a[248:251], v1, s[16:19], s39 offen offset:2048 sc1
 MM v[132:135], v[200:203], a[152:155], v[132:135]
 MM v[132:135], v[196:199], a[148:151], v[132:135]
 MM v[132:135], v[192:195], a[144:147], v[132:135]
 MM v[136:139], v[192:195], a[160:163], v[136:139]
 MM v[136:139], v[196:199], a[164:167], v[136:139]
 buffer_load_dwordx4 a[252:255], v1, s[16:19], s39 offen offset:3072 sc1
 MM v[136:139], v[200:203], a[168:171], v[136:139]
 s_waitcnt lgkmcnt(0)
 buffer_store_dwordx4 v[28:31], v1, s[16:19], s90 offen offset:2048 sc1
 MM v[136:139], v[204:207], a[172:175], v[136:139]
 s_add_u32 s39, s39, 0x1000
 MM v[140:143], v[204:207], a[188:191], v[140:143]
 s_add_u32 s43, s45, 3274880
 ds_read_b64_tr_b16 v[240:241], v14 offset:49152
 ds_read_b64_tr_b16 v[242:243], v14 offset:49664
 MM v[140:143], v[200:203], a[184:187], v[140:143]
 ds_read_b64_tr_b16 v[244:245], v14 offset:53248
 ds_read_b64_tr_b16 v[246:247], v14 offset:53760
 MM v[140:143], v[196:199], a[180:183], v[140:143]
 ds_read_b64_tr_b16 v[248:249], v14 offset:57344
 ds_read_b64_tr_b16 v[250:251], v14 offset:57856
 MM v[140:143], v[192:195], a[176:179], v[140:143]
 ds_read_b64_tr_b16 v[252:253], v14 offset:61440
 ds_read_b64_tr_b16 v[254:255], v14 offset:61952
 MM v[156:159], v[208:211], a[176:179], v[156:159]
 buffer_load_dwordx4 v7, s[48:51], s43 offen offset:2048 lds
 MM v[156:159], v[212:215], a[180:183], v[156:159]
 MM v[156:159], v[216:219], a[184:187], v[156:159]
 MM v[156:159], v[220:223], a[188:191], v[156:159]
 MM v[152:155], v[220:223], a[172:175], v[152:155]
 ds_read_b128 v[28:31], v22 offset:6144
 MM v[152:155], v[216:219], a[168:171], v[152:155]
 MM v[152:155], v[212:215], a[164:167], v[152:155]
 MM v[152:155], v[208:211], a[160:163], v[152:155]
 MM v[148:151], v[208:211], a[144:147], v[148:151]
 MM v[148:151], v[212:215], a[148:151], v[148:151]
 s_add_u32 s40, s45, 3339392
 MM v[148:151], v[216:219], a[152:155], v[148:151]
 MM v[148:151], v[220:223], a[156:159], v[148:151]
 MM v[144:147], v[220:223], a[140:143], v[144:147]
 MM v[144:147], v[216:219], a[136:139], v[144:147]
 buffer_load_dwordx4 v8, s[48:51], s40 offen offset:3072 lds
 MM v[144:147], v[212:215], a[132:135], v[144:147]
 MM v[144:147], v[208:211], a[128:131], v[144:147]
 MM v[160:163], v[224:227], a[128:131], v[160:163]
 MM v[160:163], v[228:231], a[132:135], v[160:163]
 MM v[160:163], v[232:235], a[136:139], v[160:163]
 MM v[160:163], v[236:239], a[140:143], v[160:163]
 MM v[164:167], v[236:239], a[156:159], v[164:167]
 s_waitcnt lgkmcnt(0)
 buffer_store_dwordx4 v[28:31], v1, s[16:19], s88 offen offset:3072 sc1
 MM v[164:167], v[232:235], a[152:155], v[164:167]
 MM v[164:167], v[228:231], a[148:151], v[164:167]
 MM v[164:167], v[224:227], a[144:147], v[164:167]
 MM v[168:171], v[224:227], a[160:163], v[168:171]
 MM v[168:171], v[228:231], a[164:167], v[168:171]
 MM v[168:171], v[232:235], a[168:171], v[168:171]
 s_waitcnt vmcnt(29)
 s_barrier
 ds_read_b64_tr_b16 v[192:193], v15 offset:0
 MM v[168:171], v[236:239], a[172:175], v[168:171]
 ds_read_b64_tr_b16 v[194:195], v15 offset:512
 ds_read_b64_tr_b16 v[196:197], v15 offset:4096
 MM v[172:175], v[236:239], a[188:191], v[172:175]
 ds_read_b64_tr_b16 v[198:199], v15 offset:4608
 ds_read_b64_tr_b16 v[200:201], v15 offset:8192
 MM v[172:175], v[232:235], a[184:187], v[172:175]
 ds_read_b64_tr_b16 v[202:203], v15 offset:8704
 ds_read_b64_tr_b16 v[204:205], v15 offset:12288
 MM v[172:175], v[228:231], a[180:183], v[172:175]
 ds_read_b128 v[28:31], v22 offset:7168
 ds_read_b64_tr_b16 v[206:207], v15 offset:12800
 MM v[172:175], v[224:227], a[176:179], v[172:175]
 ds_read_b64_tr_b16 v[208:209], v16 offset:0
 ds_read_b64_tr_b16 v[210:211], v16 offset:512
 MM v[188:191], v[240:243], a[176:179], v[188:191]
 ds_read_b64_tr_b16 v[212:213], v16 offset:4096
 ds_read_b64_tr_b16 v[214:215], v16 offset:4608
 MM v[188:191], v[244:247], a[180:183], v[188:191]
 ds_read_b64_tr_b16 v[216:217], v16 offset:8192
 ds_read_b64_tr_b16 v[218:219], v16 offset:8704
 MM v[188:191], v[248:251], a[184:187], v[188:191]
 ds_read_b64_tr_b16 v[220:221], v16 offset:12288
 ds_read_b64_tr_b16 v[222:223], v16 offset:12800
 MM v[188:191], v[252:255], a[188:191], v[188:191]
 MM v[184:187], v[252:255], a[172:175], v[184:187]
 MM v[184:187], v[248:251], a[168:171], v[184:187]
 MM v[184:187], v[244:247], a[164:167], v[184:187]
 MM v[184:187], v[240:243], a[160:163], v[184:187]
 MM v[180:183], v[240:243], a[144:147], v[180:183]
 MM v[180:183], v[244:247], a[148:151], v[180:183]
 MM v[180:183], v[248:251], a[152:155], v[180:183]
 MM v[180:183], v[252:255], a[156:159], v[180:183]
 MM v[176:179], v[252:255], a[140:143], v[176:179]
 ds_read_b64_tr_b16 v[224:225], v17 offset:0
 ds_read_b64_tr_b16 v[226:227], v17 offset:512
 MM v[176:179], v[248:251], a[136:139], v[176:179]
 s_waitcnt vmcnt(26)
 ds_read_b64_tr_b16 v[228:229], v17 offset:4096
 ds_read_b64_tr_b16 v[230:231], v17 offset:4608
 MM v[176:179], v[244:247], a[132:135], v[176:179]
 s_waitcnt lgkmcnt(4)
 buffer_store_dwordx4 v[28:31], v1, s[16:19], s90 offen offset:3072 sc1
 MM v[176:179], v[240:243], a[128:131], v[176:179]
 s_add_u32 m0, s47, 0
 s_add_u32 s41, s45, 4194304
 ds_read_b64_tr_b16 v[232:233], v17 offset:8192
 MM v[64:67], v[192:195], a[192:195], v[64:67]
 s_waitcnt vmcnt(26)
 ds_read_b64_tr_b16 v[234:235], v17 offset:8704
 v_mov_b32 v28, 0x3f803f80
 MM v[64:67], v[196:199], a[196:199], v[64:67]
 s_waitcnt vmcnt(25)
 ds_read_b64_tr_b16 v[236:237], v17 offset:12288
 v_mov_b32 v29, 0x3f803f80
 MM v[64:67], v[200:203], a[200:203], v[64:67]
 buffer_load_dwordx4 v7, s[48:51], s41 offen offset:0 lds
 s_waitcnt vmcnt(24)
 MM v[64:67], v[204:207], a[204:207], v[64:67]
 buffer_load_dwordx4 a[128:131], v1, s[16:19], s36 offen offset:0 sc1
 s_waitcnt vmcnt(19)
 MM v[68:71], v[204:207], a[220:223], v[68:71]
 ds_read_b64_tr_b16 v[238:239], v17 offset:12800
 v_mov_b32 v30, 0x3f803f80
 MM v[68:71], v[200:203], a[216:219], v[68:71]
 v_mov_b32 v31, 0x3f803f80
 MM v[68:71], v[196:199], a[212:215], v[68:71]
 s_waitcnt vmcnt(18)
 MM v[68:71], v[192:195], a[208:211], v[68:71]
 buffer_load_dwordx4 a[132:135], v1, s[16:19], s36 offen offset:1024 sc1
 MM v[72:75], v[192:195], a[224:227], v[72:75]
 s_waitcnt vmcnt(17)
 MM v[72:75], v[196:199], a[228:231], v[72:75]
 s_waitcnt vmcnt(15)
 MM v[72:75], v[200:203], a[232:235], v[72:75]
 s_waitcnt vmcnt(14)
 MM v[72:75], v[204:207], a[236:239], v[72:75]
 s_waitcnt vmcnt(8)
 s_add_u32 s42, s45, 4258816
 MM v[76:79], v[204:207], a[252:255], v[76:79]
 buffer_load_dwordx4 a[136:139], v1, s[16:19], s36 offen offset:2048 sc1
 MM v[76:79], v[200:203], a[248:251], v[76:79]
 ds_read_b64_tr_b16 v[240:241], v18 offset:0
 ds_read_b64_tr_b16 v[242:243], v18 offset:512
 MM v[76:79], v[196:199], a[244:247], v[76:79]
 ds_read_b64_tr_b16 v[244:245], v18 offset:4096
 ds_read_b64_tr_b16 v[246:247], v18 offset:4608
 MM v[76:79], v[192:195], a[240:243], v[76:79]
 buffer_load_dwordx4 v8, s[48:51], s42 offen offset:1024 lds
 MM v[92:95], v[208:211], a[240:243], v[92:95]
 ds_read_b64_tr_b16 v[248:249], v18 offset:8192
 ds_read_b64_tr_b16 v[250:251], v18 offset:8704
 MM v[92:95], v[212:215], a[244:247], v[92:95]
 buffer_load_dwordx4 a[140:143], v1, s[16:19], s36 offen offset:3072 sc1
 MM v[92:95], v[216:219], a[248:251], v[92:95]
 s_add_u32 s36, s36, 0x1000
 ds_read_b64_tr_b16 v[252:253], v18 offset:12288
 ds_read_b64_tr_b16 v[254:255], v18 offset:12800
 MM v[92:95], v[220:223], a[252:255], v[92:95]
 MM v[88:91], v[220:223], a[236:239], v[88:91]
 MM v[88:91], v[216:219], a[232:235], v[88:91]
 buffer_load_dwordx4 a[144:147], v1, s[16:19], s37 offen offset:0 sc1
 MM v[88:91], v[212:215], a[228:231], v[88:91]
 MM v[88:91], v[208:211], a[224:227], v[88:91]
 MM v[84:87], v[208:211], a[208:211], v[84:87]
 buffer_store_dwordx4 v[32:35], v1, s[16:19], s89 offen offset:0 sc1
 MM v[84:87], v[212:215], a[212:215], v[84:87]
 s_add_u32 s43, s45, 4323328
 MM v[84:87], v[216:219], a[216:219], v[84:87]
 buffer_load_dwordx4 a[148:151], v1, s[16:19], s37 offen offset:1024 sc1
 MM v[84:87], v[220:223], a[220:223], v[84:87]
 MM v[80:83], v[220:223], a[204:207], v[80:83]
 buffer_load_dwordx4 v7, s[48:51], s43 offen offset:2048 lds
 MM v[80:83], v[216:219], a[200:203], v[80:83]
 ds_read_b64_tr_b16 v[192:193], v15 offset:16384
 ds_read_b64_tr_b16 v[194:195], v15 offset:16896
 MM v[80:83], v[212:215], a[196:199], v[80:83]
 s_waitcnt lgkmcnt(2)
 ds_read_b64_tr_b16 v[196:197], v15 offset:20480
 ds_read_b64_tr_b16 v[198:199], v15 offset:20992
 MM v[80:83], v[208:211], a[192:195], v[80:83]
 buffer_load_dwordx4 a[152:155], v1, s[16:19], s37 offen offset:2048 sc1
 MM v[96:99], v[224:227], a[192:195], v[96:99]
 ds_read_b64_tr_b16 v[200:201], v15 offset:24576
 ds_read_b64_tr_b16 v[202:203], v15 offset:25088
 MM v[96:99], v[228:231], a[196:199], v[96:99]
 ds_read_b64_tr_b16 v[204:205], v15 offset:28672
 ds_read_b64_tr_b16 v[206:207], v15 offset:29184
 MM v[96:99], v[232:235], a[200:203], v[96:99]
 MM v[96:99], v[236:239], a[204:207], v[96:99]
 buffer_load_dwordx4 a[156:159], v1, s[16:19], s37 offen offset:3072 sc1
 MM v[100:103], v[236:239], a[220:223], v[100:103]
 s_add_u32 s37, s37, 0x1000
 MM v[100:103], v[232:235], a[216:219], v[100:103]
 s_add_u32 s40, s45, 4387840
 MM v[100:103], v[228:231], a[212:215], v[100:103]
 MM v[100:103], v[224:227], a[208:211], v[100:103]
 MM v[104:107], v[224:227], a[224:227], v[104:107]
 buffer_load_dwordx4 a[160:163], v1, s[16:19], s38 offen offset:0 sc1
 MM v[104:107], v[228:231], a[228:231], v[104:107]
 buffer_load_dwordx4 v8, s[48:51], s40 offen offset:3072 lds
 MM v[104:107], v[232:235], a[232:235], v[104:107]
 MM v[104:107], v[236:239], a[236:239], v[104:107]
 MM v[108:111], v[236:239], a[252:255], v[108:111]
 ds_read_b64_tr_b16 v[208:209], v16 offset:16384
 ds_read_b64_tr_b16 v[210:211], v16 offset:16896
 MM v[108:111], v[232:235], a[248:251], v[108:111]
 buffer_load_dwordx4 a[164:167], v1, s[16:19], s38 offen offset:1024 sc1
 MM v[108:111], v[228:231], a[244:247], v[108:111]
 ds_read_b64_tr_b16 v[212:213], v16 offset:20480
 ds_read_b64_tr_b16 v[214:215], v16 offset:20992
 MM v[108:111], v[224:227], a[240:243], v[108:111]
 ds_read_b64_tr_b16 v[216:217], v16 offset:24576
 ds_read_b64_tr_b16 v[218:219], v16 offset:25088
 MM v[124:127], v[240:243], a[240:243], v[124:127]
 ds_read_b64_tr_b16 v[220:221], v16 offset:28672
 ds_read_b64_tr_b16 v[222:223], v16 offset:29184
 MM v[124:127], v[244:247], a[244:247], v[124:127]
 buffer_load_dwordx4 a[168:171], v1, s[16:19], s38 offen offset:2048 sc1
 MM v[124:127], v[248:251], a[248:251], v[124:127]
 buffer_store_dwordx4 v[36:39], v1, s[16:19], s91 offen offset:0 sc1
 MM v[124:127], v[252:255], a[252:255], v[124:127]
 s_add_u32 m0, s47, 16384
 s_add_u32 s41, s45, 4194432
 v_lshrrev_b32 v19, 4, v1
 MM v[120:123], v[252:255], a[236:239], v[120:123]
 s_mul_i32 s92, s24, 320
 v_add_u32 v19, s92, v19
 MM v[120:123], v[248:251], a[232:235], v[120:123]
 MM v[120:123], v[244:247], a[228:231], v[120:123]
 buffer_load_dwordx4 a[172:175], v1, s[16:19], s38 offen offset:3072 sc1
 MM v[120:123], v[240:243], a[224:227], v[120:123]
 buffer_load_dwordx4 v7, s[48:51], s41 offen offset:0 lds
 MM v[116:119], v[240:243], a[208:211], v[116:119]
 s_add_u32 s38, s38, 0x1000
 MM v[116:119], v[244:247], a[212:215], v[116:119]
 MM v[116:119], v[248:251], a[216:219], v[116:119]
 MM v[116:119], v[252:255], a[220:223], v[116:119]
 buffer_load_dwordx4 a[176:179], v1, s[16:19], s39 offen offset:0 sc1
 MM v[112:115], v[252:255], a[204:207], v[112:115]
 ds_read_b64_tr_b16 v[224:225], v17 offset:16384
 ds_read_b64_tr_b16 v[226:227], v17 offset:16896
 MM v[112:115], v[248:251], a[200:203], v[112:115]
 ds_read_b64_tr_b16 v[228:229], v17 offset:20480
 ds_read_b64_tr_b16 v[230:231], v17 offset:20992
 MM v[112:115], v[244:247], a[196:199], v[112:115]
 s_waitcnt lgkmcnt(4)
 ds_read_b64_tr_b16 v[232:233], v17 offset:24576
 ds_read_b64_tr_b16 v[234:235], v17 offset:25088
 MM v[112:115], v[240:243], a[192:195], v[112:115]
 buffer_load_dwordx4 a[180:183], v1, s[16:19], s39 offen offset:1024 sc1
 MM v[128:131], v[192:195], a[192:195], v[128:131]
 s_add_u32 s42, s45, 4258944
 ds_read_b64_tr_b16 v[236:237], v17 offset:28672
 ds_read_b64_tr_b16 v[238:239], v17 offset:29184
 MM v[128:131], v[196:199], a[196:199], v[128:131]
 MM v[128:131], v[200:203], a[200:203], v[128:131]
 MM v[128:131], v[204:207], a[204:207], v[128:131]
 buffer_load_dwordx4 v8, s[48:51], s42 offen offset:1024 lds
 MM v[132:135], v[204:207], a[220:223], v[132:135]
 buffer_load_dwordx4 a[184:187], v1, s[16:19], s39 offen offset:2048 sc1
 MM v[132:135], v[200:203], a[216:219], v[132:135]
 MM v[132:135], v[196:199], a[212:215], v[132:135]
 MM v[132:135], v[192:195], a[208:211], v[132:135]
 MM v[136:139], v[192:195], a[224:227], v[136:139]
 MM v[136:139], v[196:199], a[228:231], v[136:139]
 buffer_load_dwordx4 a[188:191], v1, s[16:19], s39 offen offset:3072 sc1
 MM v[136:139], v[200:203], a[232:235], v[136:139]
 s_add_u32 s39, s39, 0x1000
 s_mov_b32 s3, s60
 s_add_u32 s3, s3, s100
 MM v[136:139], v[204:207], a[236:239], v[136:139]
 v_mov_b32 v21, s61
 MM v[140:143], v[204:207], a[252:255], v[140:143]
 buffer_store_dwordx4 v[40:43], v1, s[16:19], s89 offen offset:1024 sc1
 MM v[140:143], v[200:203], a[248:251], v[140:143]
 s_add_u32 s43, s45, 4323456
 ds_read_b64_tr_b16 v[240:241], v18 offset:16384
 ds_read_b64_tr_b16 v[242:243], v18 offset:16896
 MM v[140:143], v[196:199], a[244:247], v[140:143]
 ds_read_b64_tr_b16 v[244:245], v18 offset:20480
 ds_read_b64_tr_b16 v[246:247], v18 offset:20992
 MM v[140:143], v[192:195], a[240:243], v[140:143]
 ds_read_b64_tr_b16 v[248:249], v18 offset:24576
 ds_read_b64_tr_b16 v[250:251], v18 offset:25088
 MM v[156:159], v[208:211], a[240:243], v[156:159]
 buffer_load_dwordx4 v7, s[48:51], s43 offen offset:2048 lds
 MM v[156:159], v[212:215], a[244:247], v[156:159]
 ds_read_b64_tr_b16 v[252:253], v18 offset:28672
 ds_read_b64_tr_b16 v[254:255], v18 offset:29184
 MM v[156:159], v[216:219], a[248:251], v[156:159]
 MM v[156:159], v[220:223], a[252:255], v[156:159]
 MM v[152:155], v[220:223], a[236:239], v[152:155]
 MM v[152:155], v[216:219], a[232:235], v[152:155]
 MM v[152:155], v[212:215], a[228:231], v[152:155]
 MM v[152:155], v[208:211], a[224:227], v[152:155]
 MM v[148:151], v[208:211], a[208:211], v[148:151]
 MM v[148:151], v[212:215], a[212:215], v[148:151]
 s_add_u32 s40, s45, 4387968
 MM v[148:151], v[216:219], a[216:219], v[148:151]
 MM v[148:151], v[220:223], a[220:223], v[148:151]
 MM v[144:147], v[220:223], a[204:207], v[144:147]
 MM v[144:147], v[216:219], a[200:203], v[144:147]
 buffer_load_dwordx4 v8, s[48:51], s40 offen offset:3072 lds
 MM v[144:147], v[212:215], a[196:199], v[144:147]
 MM v[144:147], v[208:211], a[192:195], v[144:147]
 s_waitcnt lgkmcnt(0)
 MM v[160:163], v[224:227], a[192:195], v[160:163]
 MM v[160:163], v[228:231], a[196:199], v[160:163]
 MM v[160:163], v[232:235], a[200:203], v[160:163]
 MM v[160:163], v[236:239], a[204:207], v[160:163]
 MM v[164:167], v[236:239], a[220:223], v[164:167]
 MM v[164:167], v[232:235], a[216:219], v[164:167]
 MM v[164:167], v[228:231], a[212:215], v[164:167]
 buffer_store_dwordx4 v[44:47], v1, s[16:19], s91 offen offset:1024 sc1
 MM v[164:167], v[224:227], a[208:211], v[164:167]
 MM v[168:171], v[224:227], a[224:227], v[168:171]
 MM v[168:171], v[228:231], a[228:231], v[168:171]
 MM v[168:171], v[232:235], a[232:235], v[168:171]
 s_waitcnt vmcnt(30)
 s_barrier
 ds_read_b64_tr_b16 v[192:193], v15 offset:32768
 MM v[168:171], v[236:239], a[236:239], v[168:171]
 ds_read_b64_tr_b16 v[194:195], v15 offset:33280
 v_add_u32 v24, 0, v19
 MM v[172:175], v[236:239], a[252:255], v[172:175]
 s_mov_b64 exec, 1
 buffer_store_dword v21, off, s[16:19], s3 sc1
 s_mov_b64 exec, -1
 MM v[172:175], v[232:235], a[248:251], v[172:175]
 v_mul_u32_u24 v20, 1639, v24
 v_lshrrev_b32 v20, 16, v20
 MM v[172:175], v[228:231], a[244:247], v[172:175]
 v_mul_u32_u24 v20, 640, v20
 v_lshl_add_u32 v24, v24, 4, v20
 MM v[172:175], v[224:227], a[240:243], v[172:175]
 s_add_u32 m0, s12, 0
 ds_read_b64_tr_b16 v[196:197], v15 offset:36864
 ds_read_b64_tr_b16 v[198:199], v15 offset:37376
 MM v[188:191], v[240:243], a[240:243], v[188:191]
 buffer_load_dwordx4 v24, s[56:59], s13 offen nt lds
 MM v[188:191], v[244:247], a[244:247], v[188:191]
 ds_read_b64_tr_b16 v[200:201], v15 offset:40960
 v_add_u32 v25, 64, v19
 MM v[188:191], v[248:251], a[248:251], v[188:191]
 ds_read_b64_tr_b16 v[202:203], v15 offset:41472
 v_mul_u32_u24 v20, 1639, v25
 MM v[188:191], v[252:255], a[252:255], v[188:191]
 ds_read_b64_tr_b16 v[204:205], v15 offset:45056
 v_lshrrev_b32 v20, 16, v20
 MM v[184:187], v[252:255], a[236:239], v[184:187]
 ds_read_b64_tr_b16 v[206:207], v15 offset:45568
 v_mul_u32_u24 v20, 640, v20
 MM v[184:187], v[248:251], a[232:235], v[184:187]
 v_lshl_add_u32 v25, v25, 4, v20
 s_add_u32 m0, s12, 1024
 MM v[184:187], v[244:247], a[228:231], v[184:187]
 buffer_load_dwordx4 v25, s[56:59], s13 offen nt lds
 MM v[184:187], v[240:243], a[224:227], v[184:187]
 v_add_u32 v24, 128, v19
 v_mul_u32_u24 v20, 1639, v24
 MM v[180:183], v[240:243], a[208:211], v[180:183]
 v_lshrrev_b32 v20, 16, v20
 v_mul_u32_u24 v20, 640, v20
 MM v[180:183], v[244:247], a[212:215], v[180:183]
 v_lshl_add_u32 v24, v24, 4, v20
 s_add_u32 m0, s12, 2048
 MM v[180:183], v[248:251], a[216:219], v[180:183]
 buffer_load_dwordx4 v24, s[56:59], s13 offen nt lds
 MM v[180:183], v[252:255], a[220:223], v[180:183]
 v_add_u32 v25, 192, v19
 v_mul_u32_u24 v20, 1639, v25
 MM v[176:179], v[252:255], a[204:207], v[176:179]
 v_lshrrev_b32 v20, 16, v20
 v_mul_u32_u24 v20, 640, v20
 MM v[176:179], v[248:251], a[200:203], v[176:179]
 v_lshl_add_u32 v25, v25, 4, v20
 s_add_u32 m0, s12, 3072
 MM v[176:179], v[244:247], a[196:199], v[176:179]
 buffer_load_dwordx4 v25, s[56:59], s13 offen nt lds
 MM v[176:179], v[240:243], a[192:195], v[176:179]
 s_waitcnt vmcnt(31) lgkmcnt(0)
 v_add_u32 v24, 256, v19
 v_mul_u32_u24 v20, 1639, v24
 MM v[64:67], v[192:195], a[128:131], v[64:67]
 s_waitcnt vmcnt(30)
 v_lshrrev_b32 v20, 16, v20
 v_mul_u32_u24 v20, 640, v20
 MM v[64:67], v[196:199], a[132:135], v[64:67]
 s_waitcnt vmcnt(29)
 v_lshl_add_u32 v24, v24, 4, v20
 s_add_u32 m0, s12, 4096
 MM v[64:67], v[200:203], a[136:139], v[64:67]
 buffer_load_dwordx4 v24, s[56:59], s13 offen nt lds
 s_waitcnt vmcnt(28)
 MM v[64:67], v[204:207], a[140:143], v[64:67]
 buffer_store_dwordx4 v[48:51], v1, s[16:19], s89 offen offset:2048 sc1
 s_waitcnt vmcnt(23)
 MM v[68:71], v[204:207], a[156:159], v[68:71]
 ds_read_b64_tr_b16 v[208:209], v16 offset:32768
 ds_read_b64_tr_b16 v[210:211], v16 offset:33280
 MM v[68:71], v[200:203], a[152:155], v[68:71]
 ds_read_b64_tr_b16 v[212:213], v16 offset:36864
 ds_read_b64_tr_b16 v[214:215], v16 offset:37376
 MM v[68:71], v[196:199], a[148:151], v[68:71]
 s_waitcnt vmcnt(20)
 ds_read_b64_tr_b16 v[216:217], v16 offset:40960
 ds_read_b64_tr_b16 v[218:219], v16 offset:41472
 MM v[68:71], v[192:195], a[144:147], v[68:71]
 s_waitcnt vmcnt(22)
 ds_read_b64_tr_b16 v[220:221], v16 offset:45056
 ds_read_b64_tr_b16 v[222:223], v16 offset:45568
 MM v[72:75], v[192:195], a[160:163], v[72:75]
 buffer_load_dwordx4 a[192:195], v1, s[16:19], s36 offen offset:0 sc1
 MM v[72:75], v[196:199], a[164:167], v[72:75]
 buffer_load_dwordx4 a[196:199], v1, s[16:19], s36 offen offset:1024 sc1
 s_waitcnt vmcnt(21)
 MM v[72:75], v[200:203], a[168:171], v[72:75]
 s_waitcnt vmcnt(19)
 ds_read_b64_tr_b16 v[224:225], v17 offset:32768
 ds_read_b64_tr_b16 v[226:227], v17 offset:33280
 MM v[72:75], v[204:207], a[172:175], v[72:75]
 s_waitcnt vmcnt(13)
 ds_read_b64_tr_b16 v[228:229], v17 offset:36864
 ds_read_b64_tr_b16 v[230:231], v17 offset:37376
 MM v[76:79], v[204:207], a[188:191], v[76:79]
 buffer_load_dwordx4 a[200:203], v1, s[16:19], s36 offen offset:2048 sc1
 MM v[76:79], v[200:203], a[184:187], v[76:79]
 ds_read_b64_tr_b16 v[232:233], v17 offset:40960
 ds_read_b64_tr_b16 v[234:235], v17 offset:41472
 MM v[76:79], v[196:199], a[180:183], v[76:79]
 ds_read_b64_tr_b16 v[236:237], v17 offset:45056
 ds_read_b64_tr_b16 v[238:239], v17 offset:45568
 MM v[76:79], v[192:195], a[176:179], v[76:79]
 s_waitcnt lgkmcnt(8)
 ds_read_b64_tr_b16 v[240:241], v18 offset:32768
 ds_read_b64_tr_b16 v[242:243], v18 offset:33280
 MM v[92:95], v[208:211], a[176:179], v[92:95]
 s_mul_i32 s80, s63, 3
 ds_read_b64_tr_b16 v[244:245], v18 offset:36864
 ds_read_b64_tr_b16 v[246:247], v18 offset:37376
 MM v[92:95], v[212:215], a[180:183], v[92:95]
 buffer_load_dwordx4 a[204:207], v1, s[16:19], s36 offen offset:3072 sc1
 MM v[92:95], v[216:219], a[184:187], v[92:95]
 s_add_u32 s36, s36, 0x1000
 ds_read_b64_tr_b16 v[248:249], v18 offset:40960
 ds_read_b64_tr_b16 v[250:251], v18 offset:41472
 MM v[92:95], v[220:223], a[188:191], v[92:95]
 s_mov_b32 s20, s82
 ds_read_b64_tr_b16 v[252:253], v18 offset:45056
 ds_read_b64_tr_b16 v[254:255], v18 offset:45568
 MM v[88:91], v[220:223], a[172:175], v[88:91]
 s_mov_b32 s21, s83
 s_mov_b32 s22, 2211840
 s_sub_u32 s45, s12, 98304
 MM v[88:91], v[216:219], a[168:171], v[88:91]
 buffer_load_dwordx4 a[208:211], v1, s[16:19], s37 offen offset:0 sc1
 MM v[88:91], v[212:215], a[164:167], v[88:91]
 MM v[88:91], v[208:211], a[160:163], v[88:91]
 MM v[84:87], v[208:211], a[144:147], v[84:87]
 MM v[84:87], v[212:215], a[148:151], v[84:87]
 MM v[84:87], v[216:219], a[152:155], v[84:87]
 buffer_store_dwordx4 v[52:55], v1, s[16:19], s91 offen offset:2048 sc1
 MM v[84:87], v[220:223], a[156:159], v[84:87]
 buffer_load_dwordx4 a[212:215], v1, s[16:19], s37 offen offset:1024 sc1
 MM v[80:83], v[220:223], a[140:143], v[80:83]
 ds_read_b64_tr_b16 v[192:193], v15 offset:49152
 ds_read_b64_tr_b16 v[194:195], v15 offset:49664
 MM v[80:83], v[216:219], a[136:139], v[80:83]
 ds_read_b64_tr_b16 v[196:197], v15 offset:53248
 ds_read_b64_tr_b16 v[198:199], v15 offset:53760
 MM v[80:83], v[212:215], a[132:135], v[80:83]
 s_waitcnt lgkmcnt(4)
 ds_read_b64_tr_b16 v[200:201], v15 offset:57344
 ds_read_b64_tr_b16 v[202:203], v15 offset:57856
 MM v[80:83], v[208:211], a[128:131], v[80:83]
 buffer_load_dwordx4 a[216:219], v1, s[16:19], s37 offen offset:2048 sc1
 MM v[96:99], v[224:227], a[128:131], v[96:99]
 ds_read_b64_tr_b16 v[204:205], v15 offset:61440
 ds_read_b64_tr_b16 v[206:207], v15 offset:61952
 MM v[96:99], v[228:231], a[132:135], v[96:99]
 MM v[96:99], v[232:235], a[136:139], v[96:99]
 MM v[96:99], v[236:239], a[140:143], v[96:99]
 buffer_load_dwordx4 a[220:223], v1, s[16:19], s37 offen offset:3072 sc1
 MM v[100:103], v[236:239], a[156:159], v[100:103]
 s_add_u32 s37, s37, 0x1000
 MM v[100:103], v[232:235], a[152:155], v[100:103]
 MM v[100:103], v[228:231], a[148:151], v[100:103]
 MM v[100:103], v[224:227], a[144:147], v[100:103]
 MM v[104:107], v[224:227], a[160:163], v[104:107]
 buffer_load_dwordx4 a[224:227], v1, s[16:19], s38 offen offset:0 sc1
 MM v[104:107], v[228:231], a[164:167], v[104:107]
 MM v[104:107], v[232:235], a[168:171], v[104:107]
 MM v[104:107], v[236:239], a[172:175], v[104:107]
 MM v[108:111], v[236:239], a[188:191], v[108:111]
 ds_read_b64_tr_b16 v[208:209], v16 offset:49152
 ds_read_b64_tr_b16 v[210:211], v16 offset:49664
 MM v[108:111], v[232:235], a[184:187], v[108:111]
 buffer_load_dwordx4 a[228:231], v1, s[16:19], s38 offen offset:1024 sc1
 MM v[108:111], v[228:231], a[180:183], v[108:111]
 ds_read_b64_tr_b16 v[212:213], v16 offset:53248
 ds_read_b64_tr_b16 v[214:215], v16 offset:53760
 MM v[108:111], v[224:227], a[176:179], v[108:111]
 ds_read_b64_tr_b16 v[216:217], v16 offset:57344
 ds_read_b64_tr_b16 v[218:219], v16 offset:57856
 MM v[124:127], v[240:243], a[176:179], v[124:127]
 ds_read_b64_tr_b16 v[220:221], v16 offset:61440
 ds_read_b64_tr_b16 v[222:223], v16 offset:61952
 MM v[124:127], v[244:247], a[180:183], v[124:127]
 buffer_load_dwordx4 a[232:235], v1, s[16:19], s38 offen offset:2048 sc1
 MM v[124:127], v[248:251], a[184:187], v[124:127]
 MM v[124:127], v[252:255], a[188:191], v[124:127]
 MM v[120:123], v[252:255], a[172:175], v[120:123]
 buffer_store_dwordx4 v[56:59], v1, s[16:19], s89 offen offset:3072 sc1
 MM v[120:123], v[248:251], a[168:171], v[120:123]
 MM v[120:123], v[244:247], a[164:167], v[120:123]
 buffer_load_dwordx4 a[236:239], v1, s[16:19], s38 offen offset:3072 sc1
 MM v[120:123], v[240:243], a[160:163], v[120:123]
 s_add_u32 s38, s38, 0x1000
 MM v[116:119], v[240:243], a[144:147], v[116:119]
 MM v[116:119], v[244:247], a[148:151], v[116:119]
 MM v[116:119], v[248:251], a[152:155], v[116:119]
 MM v[116:119], v[252:255], a[156:159], v[116:119]
 buffer_load_dwordx4 a[240:243], v1, s[16:19], s39 offen offset:0 sc1
 MM v[112:115], v[252:255], a[140:143], v[112:115]
 ds_read_b64_tr_b16 v[224:225], v17 offset:49152
 ds_read_b64_tr_b16 v[226:227], v17 offset:49664
 MM v[112:115], v[248:251], a[136:139], v[112:115]
 ds_read_b64_tr_b16 v[228:229], v17 offset:53248
 ds_read_b64_tr_b16 v[230:231], v17 offset:53760
 MM v[112:115], v[244:247], a[132:135], v[112:115]
 s_waitcnt lgkmcnt(4)
 ds_read_b64_tr_b16 v[232:233], v17 offset:57344
 ds_read_b64_tr_b16 v[234:235], v17 offset:57856
 MM v[112:115], v[240:243], a[128:131], v[112:115]
 buffer_load_dwordx4 a[244:247], v1, s[16:19], s39 offen offset:1024 sc1
 MM v[128:131], v[192:195], a[128:131], v[128:131]
 ds_read_b64_tr_b16 v[236:237], v17 offset:61440
 ds_read_b64_tr_b16 v[238:239], v17 offset:61952
 MM v[128:131], v[196:199], a[132:135], v[128:131]
 MM v[128:131], v[200:203], a[136:139], v[128:131]
 MM v[128:131], v[204:207], a[140:143], v[128:131]
 MM v[132:135], v[204:207], a[156:159], v[132:135]
 buffer_load_dwordx4 a[248:251], v1, s[16:19], s39 offen offset:2048 sc1
 MM v[132:135], v[200:203], a[152:155], v[132:135]
 MM v[132:135], v[196:199], a[148:151], v[132:135]
 MM v[132:135], v[192:195], a[144:147], v[132:135]
 MM v[136:139], v[192:195], a[160:163], v[136:139]
 MM v[136:139], v[196:199], a[164:167], v[136:139]
 buffer_load_dwordx4 a[252:255], v1, s[16:19], s39 offen offset:3072 sc1
 MM v[136:139], v[200:203], a[168:171], v[136:139]
 s_add_u32 s39, s39, 0x1000
 MM v[136:139], v[204:207], a[172:175], v[136:139]
 MM v[140:143], v[204:207], a[188:191], v[140:143]
 ds_read_b64_tr_b16 v[240:241], v18 offset:49152
 ds_read_b64_tr_b16 v[242:243], v18 offset:49664
 MM v[140:143], v[200:203], a[184:187], v[140:143]
 ds_read_b64_tr_b16 v[244:245], v18 offset:53248
 ds_read_b64_tr_b16 v[246:247], v18 offset:53760
 MM v[140:143], v[196:199], a[180:183], v[140:143]
 buffer_store_dwordx4 v[60:63], v1, s[16:19], s91 offen offset:3072 sc1
 MM v[140:143], v[192:195], a[176:179], v[140:143]
 ds_read_b64_tr_b16 v[248:249], v18 offset:57344
 ds_read_b64_tr_b16 v[250:251], v18 offset:57856
 MM v[156:159], v[208:211], a[176:179], v[156:159]
 ds_read_b64_tr_b16 v[252:253], v18 offset:61440
 ds_read_b64_tr_b16 v[254:255], v18 offset:61952
 MM v[156:159], v[212:215], a[180:183], v[156:159]
 MM v[156:159], v[216:219], a[184:187], v[156:159]
 MM v[156:159], v[220:223], a[188:191], v[156:159]
 MM v[152:155], v[220:223], a[172:175], v[152:155]
 MM v[152:155], v[216:219], a[168:171], v[152:155]
 MM v[152:155], v[212:215], a[164:167], v[152:155]
 MM v[152:155], v[208:211], a[160:163], v[152:155]
 MM v[148:151], v[208:211], a[144:147], v[148:151]
 MM v[148:151], v[212:215], a[148:151], v[148:151]
 MM v[148:151], v[216:219], a[152:155], v[148:151]
 MM v[148:151], v[220:223], a[156:159], v[148:151]
 MM v[144:147], v[220:223], a[140:143], v[144:147]
 MM v[144:147], v[216:219], a[136:139], v[144:147]
 MM v[144:147], v[212:215], a[132:135], v[144:147]
 MM v[144:147], v[208:211], a[128:131], v[144:147]
 s_waitcnt lgkmcnt(0)
 MM v[160:163], v[224:227], a[128:131], v[160:163]
 MM v[160:163], v[228:231], a[132:135], v[160:163]
 MM v[160:163], v[232:235], a[136:139], v[160:163]
 MM v[160:163], v[236:239], a[140:143], v[160:163]
 MM v[164:167], v[236:239], a[156:159], v[164:167]
 MM v[164:167], v[232:235], a[152:155], v[164:167]
 MM v[164:167], v[228:231], a[148:151], v[164:167]
 MM v[164:167], v[224:227], a[144:147], v[164:167]
 MM v[168:171], v[224:227], a[160:163], v[168:171]
 MM v[168:171], v[228:231], a[164:167], v[168:171]
 MM v[168:171], v[232:235], a[168:171], v[168:171]
 s_waitcnt vmcnt(27)
 s_barrier
 ds_read_b64_tr_b16 v[192:193], v11 offset:0
 MM v[168:171], v[236:239], a[172:175], v[168:171]
 ds_read_b64_tr_b16 v[194:195], v11 offset:512
 ds_read_b64_tr_b16 v[196:197], v11 offset:4096
 MM v[172:175], v[236:239], a[188:191], v[172:175]
 s_add_u32 s81, s80, 0
 ds_read_b64_tr_b16 v[198:199], v11 offset:4608
 ds_read_b64_tr_b16 v[200:201], v11 offset:8192
 MM v[172:175], v[232:235], a[184:187], v[172:175]
 s_lshr_b32 s46, s81, 1
 s_mul_i32 s46, s46, 40960
 ds_read_b64_tr_b16 v[202:203], v11 offset:8704
 MM v[172:175], v[228:231], a[180:183], v[172:175]
 s_and_b32 s81, s81, 1
 s_mul_i32 s81, s81, 640
 s_add_u32 s46, s46, s81
 MM v[172:175], v[224:227], a[176:179], v[172:175]
 v_add_u32 v24, 0, v19
 v_mul_u32_u24 v20, 1639, v24
 MM v[188:191], v[240:243], a[176:179], v[188:191]
 v_lshrrev_b32 v20, 16, v20
 v_mul_u32_u24 v20, 640, v20
 MM v[188:191], v[244:247], a[180:183], v[188:191]
 v_lshl_add_u32 v24, v24, 4, v20
 s_add_u32 m0, s45, 0
 MM v[188:191], v[248:251], a[184:187], v[188:191]
 ds_read_b64_tr_b16 v[204:205], v11 offset:12288
 ds_read_b64_tr_b16 v[206:207], v11 offset:12800
 MM v[188:191], v[252:255], a[188:191], v[188:191]
 buffer_load_dwordx4 v24, s[20:23], s46 offen nt lds
 MM v[184:187], v[252:255], a[172:175], v[184:187]
 v_add_u32 v25, 64, v19
 v_mul_u32_u24 v20, 1639, v25
 MM v[184:187], v[248:251], a[168:171], v[184:187]
 v_lshrrev_b32 v20, 16, v20
 v_mul_u32_u24 v20, 640, v20
 MM v[184:187], v[244:247], a[164:167], v[184:187]
 v_lshl_add_u32 v25, v25, 4, v20
 s_add_u32 m0, s45, 1024
 MM v[184:187], v[240:243], a[160:163], v[184:187]
 buffer_load_dwordx4 v25, s[20:23], s46 offen nt lds
 MM v[180:183], v[240:243], a[144:147], v[180:183]
 v_add_u32 v24, 128, v19
 v_mul_u32_u24 v20, 1639, v24
 MM v[180:183], v[244:247], a[148:151], v[180:183]
 v_lshrrev_b32 v20, 16, v20
 v_mul_u32_u24 v20, 640, v20
 MM v[180:183], v[248:251], a[152:155], v[180:183]
 v_lshl_add_u32 v24, v24, 4, v20
 s_add_u32 m0, s45, 2048
 MM v[180:183], v[252:255], a[156:159], v[180:183]
 buffer_load_dwordx4 v24, s[20:23], s46 offen nt lds
 MM v[176:179], v[252:255], a[140:143], v[176:179]
 ds_read_b64_tr_b16 v[208:209], v12 offset:0
 v_add_u32 v25, 192, v19
 MM v[176:179], v[248:251], a[136:139], v[176:179]
 ds_read_b64_tr_b16 v[210:211], v12 offset:512
 v_mul_u32_u24 v20, 1639, v25
 MM v[176:179], v[244:247], a[132:135], v[176:179]
 ds_read_b64_tr_b16 v[212:213], v12 offset:4096
 v_lshrrev_b32 v20, 16, v20
 MM v[176:179], v[240:243], a[128:131], v[176:179]
 s_waitcnt vmcnt(21) lgkmcnt(3)
 ds_read_b64_tr_b16 v[214:215], v12 offset:4608
 v_mul_u32_u24 v20, 640, v20
 MM v[64:67], v[192:195], a[192:195], v[64:67]
 s_waitcnt vmcnt(20)
 v_lshl_add_u32 v25, v25, 4, v20
 s_add_u32 m0, s45, 3072
 MM v[64:67], v[196:199], a[196:199], v[64:67]
 s_waitcnt vmcnt(19)
 ds_read_b64_tr_b16 v[216:217], v12 offset:8192
 ds_read_b64_tr_b16 v[218:219], v12 offset:8704
 MM v[64:67], v[200:203], a[200:203], v[64:67]
 buffer_load_dwordx4 v25, s[20:23], s46 offen nt lds
 s_waitcnt vmcnt(19)
 MM v[64:67], v[204:207], a[204:207], v[64:67]
 s_waitcnt vmcnt(14)
 ds_read_b64_tr_b16 v[220:221], v12 offset:12288
 v_add_u32 v24, 256, v19
 MM v[68:71], v[204:207], a[220:223], v[68:71]
 ds_read_b64_tr_b16 v[222:223], v12 offset:12800
 v_mul_u32_u24 v20, 1639, v24
 MM v[68:71], v[200:203], a[216:219], v[68:71]
 v_lshrrev_b32 v20, 16, v20
 v_mul_u32_u24 v20, 640, v20
 MM v[68:71], v[196:199], a[212:215], v[68:71]
 s_waitcnt vmcnt(13)
 v_lshl_add_u32 v24, v24, 4, v20
 s_add_u32 m0, s45, 4096
 MM v[68:71], v[192:195], a[208:211], v[68:71]
 buffer_load_dwordx4 v24, s[20:23], s46 offen nt lds
 MM v[72:75], v[192:195], a[224:227], v[72:75]
 s_waitcnt vmcnt(13)
 ds_read_b64_tr_b16 v[224:225], v13 offset:0
 ds_read_b64_tr_b16 v[226:227], v13 offset:512
 MM v[72:75], v[196:199], a[228:231], v[72:75]
 s_waitcnt vmcnt(12)
 ds_read_b64_tr_b16 v[228:229], v13 offset:4096
 ds_read_b64_tr_b16 v[230:231], v13 offset:4608
 MM v[72:75], v[200:203], a[232:235], v[72:75]
 s_add_u32 s81, s80, 1
 s_lshr_b32 s46, s81, 1
 s_mul_i32 s46, s46, 40960
 s_waitcnt vmcnt(10)
 MM v[72:75], v[204:207], a[236:239], v[72:75]
 s_and_b32 s81, s81, 1
 s_mul_i32 s81, s81, 640
 s_add_u32 s46, s46, s81
 s_waitcnt vmcnt(6)
 MM v[76:79], v[204:207], a[252:255], v[76:79]
 v_add_u32 v24, 0, v19
 v_mul_u32_u24 v20, 1639, v24
 MM v[76:79], v[200:203], a[248:251], v[76:79]
 v_lshrrev_b32 v20, 16, v20
 v_mul_u32_u24 v20, 640, v20
 MM v[76:79], v[196:199], a[244:247], v[76:79]
 s_waitcnt lgkmcnt(4)
 v_lshl_add_u32 v24, v24, 4, v20
 s_add_u32 m0, s45, 20480
 MM v[76:79], v[192:195], a[240:243], v[76:79]
 buffer_load_dwordx4 v24, s[20:23], s46 offen nt lds
 MM v[92:95], v[208:211], a[240:243], v[92:95]
 ds_read_b64_tr_b16 v[232:233], v13 offset:8192
 v_add_u32 v25, 64, v19
 MM v[92:95], v[212:215], a[244:247], v[92:95]
 ds_read_b64_tr_b16 v[234:235], v13 offset:8704
 v_mul_u32_u24 v20, 1639, v25
 MM v[92:95], v[216:219], a[248:251], v[92:95]
 ds_read_b64_tr_b16 v[236:237], v13 offset:12288
 v_lshrrev_b32 v20, 16, v20
 MM v[92:95], v[220:223], a[252:255], v[92:95]
 ds_read_b64_tr_b16 v[238:239], v13 offset:12800
 v_mul_u32_u24 v20, 640, v20
 MM v[88:91], v[220:223], a[236:239], v[88:91]
 v_lshl_add_u32 v25, v25, 4, v20
 s_add_u32 m0, s45, 21504
 MM v[88:91], v[216:219], a[232:235], v[88:91]
 buffer_load_dwordx4 v25, s[20:23], s46 offen nt lds
 MM v[88:91], v[212:215], a[228:231], v[88:91]
 v_add_u32 v24, 128, v19
 v_mul_u32_u24 v20, 1639, v24
 MM v[88:91], v[208:211], a[224:227], v[88:91]
 v_lshrrev_b32 v20, 16, v20
 v_mul_u32_u24 v20, 640, v20
 MM v[84:87], v[208:211], a[208:211], v[84:87]
 v_lshl_add_u32 v24, v24, 4, v20
 s_add_u32 m0, s45, 22528
 MM v[84:87], v[212:215], a[212:215], v[84:87]
 buffer_load_dwordx4 v24, s[20:23], s46 offen nt lds
 MM v[84:87], v[216:219], a[216:219], v[84:87]
 v_add_u32 v25, 192, v19
 v_mul_u32_u24 v20, 1639, v25
 MM v[84:87], v[220:223], a[220:223], v[84:87]
 v_lshrrev_b32 v20, 16, v20
 v_mul_u32_u24 v20, 640, v20
 MM v[80:83], v[220:223], a[204:207], v[80:83]
 v_lshl_add_u32 v25, v25, 4, v20
 s_add_u32 m0, s45, 23552
 MM v[80:83], v[216:219], a[200:203], v[80:83]
 s_waitcnt lgkmcnt(0)
 ds_read_b64_tr_b16 v[240:241], v14 offset:0
 v_cvt_pk_bf16_f32 v76, v76, v77
 MM v[80:83], v[212:215], a[196:199], v[80:83]
 s_waitcnt vmcnt(0)
 s_barrier
 ds_read_b64_tr_b16 v[242:243], v14 offset:512
 MM v[80:83], v[208:211], a[192:195], v[80:83]
 s_mov_b64 exec, 1
 buffer_store_dword v21, off, s[16:19], s3 offset:32 sc1
 s_mov_b64 exec, -1
 MM v[96:99], v[224:227], a[192:195], v[96:99]
 buffer_load_dwordx4 v25, s[20:23], s46 offen nt lds
 MM v[96:99], v[228:231], a[196:199], v[96:99]
 ds_read_b64_tr_b16 v[244:245], v14 offset:4096
 v_add_u32 v24, 256, v19
 MM v[96:99], v[232:235], a[200:203], v[96:99]
 ds_read_b64_tr_b16 v[246:247], v14 offset:4608
 v_mul_u32_u24 v20, 1639, v24
 MM v[96:99], v[236:239], a[204:207], v[96:99]
 ds_read_b64_tr_b16 v[248:249], v14 offset:8192
 v_lshrrev_b32 v20, 16, v20
 MM v[100:103], v[236:239], a[220:223], v[100:103]
 ds_read_b64_tr_b16 v[250:251], v14 offset:8704
 v_mul_u32_u24 v20, 640, v20
 MM v[100:103], v[232:235], a[216:219], v[100:103]
 ds_read_b64_tr_b16 v[252:253], v14 offset:12288
 v_lshl_add_u32 v24, v24, 4, v20
 MM v[100:103], v[228:231], a[212:215], v[100:103]
 s_add_u32 m0, s45, 24576
 ds_read_b64_tr_b16 v[254:255], v14 offset:12800
 v_cvt_pk_bf16_f32 v68, v68, v69
 MM v[100:103], v[224:227], a[208:211], v[100:103]
 buffer_load_dwordx4 v24, s[20:23], s46 offen nt lds
 MM v[104:107], v[224:227], a[224:227], v[104:107]
 s_add_u32 s81, s80, 2
 s_lshr_b32 s46, s81, 1
 s_mul_i32 s46, s46, 40960
 MM v[104:107], v[228:231], a[228:231], v[104:107]
 s_and_b32 s81, s81, 1
 s_mul_i32 s81, s81, 640
 s_add_u32 s46, s46, s81
 MM v[104:107], v[232:235], a[232:235], v[104:107]
 v_add_u32 v24, 0, v19
 v_mul_u32_u24 v20, 1639, v24
 MM v[104:107], v[236:239], a[236:239], v[104:107]
 v_lshrrev_b32 v20, 16, v20
 v_mul_u32_u24 v20, 640, v20
 MM v[108:111], v[236:239], a[252:255], v[108:111]
 v_lshl_add_u32 v24, v24, 4, v20
 s_add_u32 m0, s45, 40960
 MM v[108:111], v[232:235], a[248:251], v[108:111]
 buffer_load_dwordx4 v24, s[20:23], s46 offen nt lds
 MM v[108:111], v[228:231], a[244:247], v[108:111]
 ds_read_b64_tr_b16 v[192:193], v11 offset:16384
 v_add_u32 v25, 64, v19
 MM v[108:111], v[224:227], a[240:243], v[108:111]
 s_waitcnt lgkmcnt(1)
 ds_read_b64_tr_b16 v[194:195], v11 offset:16896
 v_mul_u32_u24 v20, 1639, v25
 MM v[124:127], v[240:243], a[240:243], v[124:127]
 ds_read_b64_tr_b16 v[196:197], v11 offset:20480
 v_lshrrev_b32 v20, 16, v20
 MM v[124:127], v[244:247], a[244:247], v[124:127]
 ds_read_b64_tr_b16 v[198:199], v11 offset:20992
 v_mul_u32_u24 v20, 640, v20
 MM v[124:127], v[248:251], a[248:251], v[124:127]
 ds_read_b64_tr_b16 v[200:201], v11 offset:24576
 v_lshl_add_u32 v25, v25, 4, v20
 MM v[124:127], v[252:255], a[252:255], v[124:127]
 s_add_u32 m0, s45, 41984
 ds_read_b64_tr_b16 v[202:203], v11 offset:25088
 v_cvt_pk_bf16_f32 v64, v64, v65
 MM v[120:123], v[252:255], a[236:239], v[120:123]
 ds_read_b64_tr_b16 v[204:205], v11 offset:28672
 v_cvt_pk_bf16_f32 v65, v66, v67
 MM v[120:123], v[248:251], a[232:235], v[120:123]
 ds_read_b64_tr_b16 v[206:207], v11 offset:29184
 v_cvt_pk_bf16_f32 v66, v80, v81
 MM v[120:123], v[244:247], a[228:231], v[120:123]
 buffer_load_dwordx4 v25, s[20:23], s46 offen nt lds
 MM v[120:123], v[240:243], a[224:227], v[120:123]
 v_add_u32 v24, 128, v19
 v_mul_u32_u24 v20, 1639, v24
 MM v[116:119], v[240:243], a[208:211], v[116:119]
 v_lshrrev_b32 v20, 16, v20
 v_mul_u32_u24 v20, 640, v20
 MM v[116:119], v[244:247], a[212:215], v[116:119]
 v_lshl_add_u32 v24, v24, 4, v20
 s_add_u32 m0, s45, 43008
 MM v[116:119], v[248:251], a[216:219], v[116:119]
 buffer_load_dwordx4 v24, s[20:23], s46 offen nt lds
 MM v[116:119], v[252:255], a[220:223], v[116:119]
 v_add_u32 v25, 192, v19
 v_mul_u32_u24 v20, 1639, v25
 MM v[112:115], v[252:255], a[204:207], v[112:115]
 v_lshrrev_b32 v20, 16, v20
 v_mul_u32_u24 v20, 640, v20
 MM v[112:115], v[248:251], a[200:203], v[112:115]
 v_lshl_add_u32 v25, v25, 4, v20
 s_add_u32 m0, s45, 44032
 MM v[112:115], v[244:247], a[196:199], v[112:115]
 buffer_load_dwordx4 v25, s[20:23], s46 offen nt lds
 MM v[112:115], v[240:243], a[192:195], v[112:115]
 s_waitcnt lgkmcnt(0)
 ds_read_b64_tr_b16 v[208:209], v12 offset:16384
 v_add_u32 v24, 256, v19
 MM v[128:131], v[192:195], a[192:195], v[128:131]
 ds_read_b64_tr_b16 v[210:211], v12 offset:16896
 v_mul_u32_u24 v20, 1639, v24
 MM v[128:131], v[196:199], a[196:199], v[128:131]
 ds_read_b64_tr_b16 v[212:213], v12 offset:20480
 v_lshrrev_b32 v20, 16, v20
 MM v[128:131], v[200:203], a[200:203], v[128:131]
 ds_read_b64_tr_b16 v[214:215], v12 offset:20992
 v_mul_u32_u24 v20, 640, v20
 MM v[128:131], v[204:207], a[204:207], v[128:131]
 ds_read_b64_tr_b16 v[216:217], v12 offset:24576
 v_lshl_add_u32 v24, v24, 4, v20
 MM v[132:135], v[204:207], a[220:223], v[132:135]
 s_add_u32 m0, s45, 45056
 ds_read_b64_tr_b16 v[218:219], v12 offset:25088
 v_cvt_pk_bf16_f32 v67, v82, v83
 MM v[132:135], v[200:203], a[216:219], v[132:135]
 ds_read_b64_tr_b16 v[220:221], v12 offset:28672
 v_accvgpr_write_b32 a128, v64
 MM v[132:135], v[196:199], a[212:215], v[132:135]
 ds_read_b64_tr_b16 v[222:223], v12 offset:29184
 v_accvgpr_write_b32 a129, v65
 MM v[132:135], v[192:195], a[208:211], v[132:135]
 buffer_load_dwordx4 v24, s[20:23], s46 offen nt lds
 MM v[136:139], v[192:195], a[224:227], v[136:139]
 ds_read_b64_tr_b16 v[224:225], v13 offset:16384
 v_accvgpr_write_b32 a130, v66
 MM v[136:139], v[196:199], a[228:231], v[136:139]
 ds_read_b64_tr_b16 v[226:227], v13 offset:16896
 v_accvgpr_write_b32 a131, v67
 MM v[136:139], v[200:203], a[232:235], v[136:139]
 ds_read_b64_tr_b16 v[228:229], v13 offset:20480
 v_cvt_pk_bf16_f32 v69, v70, v71
 MM v[136:139], v[204:207], a[236:239], v[136:139]
 ds_read_b64_tr_b16 v[230:231], v13 offset:20992
 v_cvt_pk_bf16_f32 v70, v84, v85
 MM v[140:143], v[204:207], a[252:255], v[140:143]
 ds_read_b64_tr_b16 v[232:233], v13 offset:24576
 v_cvt_pk_bf16_f32 v71, v86, v87
 MM v[140:143], v[200:203], a[248:251], v[140:143]
 ds_read_b64_tr_b16 v[234:235], v13 offset:25088
 v_accvgpr_write_b32 a144, v68
 MM v[140:143], v[196:199], a[244:247], v[140:143]
 ds_read_b64_tr_b16 v[236:237], v13 offset:28672
 v_accvgpr_write_b32 a145, v69
 MM v[140:143], v[192:195], a[240:243], v[140:143]
 s_waitcnt lgkmcnt(6)
 ds_read_b64_tr_b16 v[238:239], v13 offset:29184
 v_accvgpr_write_b32 a146, v70
 MM v[156:159], v[208:211], a[240:243], v[156:159]
 ds_read_b64_tr_b16 v[240:241], v14 offset:16384
 v_accvgpr_write_b32 a147, v71
 MM v[156:159], v[212:215], a[244:247], v[156:159]
 ds_read_b64_tr_b16 v[242:243], v14 offset:16896
 v_cvt_pk_bf16_f32 v72, v72, v73
 MM v[156:159], v[216:219], a[248:251], v[156:159]
 ds_read_b64_tr_b16 v[244:245], v14 offset:20480
 v_cvt_pk_bf16_f32 v73, v74, v75
 MM v[156:159], v[220:223], a[252:255], v[156:159]
 ds_read_b64_tr_b16 v[246:247], v14 offset:20992
 v_cvt_pk_bf16_f32 v74, v88, v89
 MM v[152:155], v[220:223], a[236:239], v[152:155]
 ds_read_b64_tr_b16 v[248:249], v14 offset:24576
 v_cvt_pk_bf16_f32 v75, v90, v91
 MM v[152:155], v[216:219], a[232:235], v[152:155]
 ds_read_b64_tr_b16 v[250:251], v14 offset:25088
 v_accvgpr_write_b32 a160, v72
 MM v[152:155], v[212:215], a[228:231], v[152:155]
 ds_read_b64_tr_b16 v[252:253], v14 offset:28672
 v_accvgpr_write_b32 a161, v73
 MM v[152:155], v[208:211], a[224:227], v[152:155]
 ds_read_b64_tr_b16 v[254:255], v14 offset:29184
 v_accvgpr_write_b32 a162, v74
 MM v[148:151], v[208:211], a[208:211], v[148:151]
 v_accvgpr_write_b32 a163, v75
 v_cvt_pk_bf16_f32 v77, v78, v79
 MM v[148:151], v[212:215], a[212:215], v[148:151]
 v_cvt_pk_bf16_f32 v78, v92, v93
 v_cvt_pk_bf16_f32 v79, v94, v95
 MM v[148:151], v[216:219], a[216:219], v[148:151]
 v_accvgpr_write_b32 a176, v76
 v_accvgpr_write_b32 a177, v77
 MM v[148:151], v[220:223], a[220:223], v[148:151]
 v_accvgpr_write_b32 a178, v78
 v_accvgpr_write_b32 a179, v79
 MM v[144:147], v[220:223], a[204:207], v[144:147]
 v_cmp_gt_i32 s[64:65], 0, v5
 v_cvt_pk_bf16_f32 v96, v96, v97
 MM v[144:147], v[216:219], a[200:203], v[144:147]
 v_cmp_gt_i32 s[66:67], 1, v5
 v_cvt_pk_bf16_f32 v97, v98, v99
 MM v[144:147], v[212:215], a[196:199], v[144:147]
 v_cmp_gt_i32 s[68:69], 2, v5
 v_cvt_pk_bf16_f32 v98, v112, v113
 MM v[144:147], v[208:211], a[192:195], v[144:147]
 s_waitcnt lgkmcnt(0)
 v_cmp_gt_i32 s[70:71], 3, v5
 v_cvt_pk_bf16_f32 v99, v114, v115
 MM v[160:163], v[224:227], a[192:195], v[160:163]
 v_cmp_gt_i32 s[72:73], 16, v5
 v_accvgpr_write_b32 a132, v96
 MM v[160:163], v[228:231], a[196:199], v[160:163]
 v_cmp_gt_i32 s[74:75], 17, v5
 v_accvgpr_write_b32 a133, v97
 MM v[160:163], v[232:235], a[200:203], v[160:163]
 v_cmp_gt_i32 s[76:77], 18, v5
 v_accvgpr_write_b32 a134, v98
 MM v[160:163], v[236:239], a[204:207], v[160:163]
 v_cmp_gt_i32 s[78:79], 19, v5
 v_accvgpr_write_b32 a135, v99
 MM v[164:167], v[236:239], a[220:223], v[164:167]
 v_cmp_gt_i32 s[80:81], 32, v5
 v_cvt_pk_bf16_f32 v100, v100, v101
 MM v[164:167], v[232:235], a[216:219], v[164:167]
 v_cmp_gt_i32 s[82:83], 33, v5
 v_cvt_pk_bf16_f32 v101, v102, v103
 MM v[164:167], v[228:231], a[212:215], v[164:167]
 v_cmp_gt_i32 s[84:85], 34, v5
 v_cvt_pk_bf16_f32 v102, v116, v117
 MM v[164:167], v[224:227], a[208:211], v[164:167]
 v_cmp_gt_i32 s[86:87], 35, v5
 v_cvt_pk_bf16_f32 v103, v118, v119
 MM v[168:171], v[224:227], a[224:227], v[168:171]
 v_cmp_gt_i32 s[88:89], 48, v5
 v_accvgpr_write_b32 a148, v100
 MM v[168:171], v[228:231], a[228:231], v[168:171]
 v_cmp_gt_i32 s[90:91], 49, v5
 v_accvgpr_write_b32 a149, v101
 MM v[168:171], v[232:235], a[232:235], v[168:171]
 v_cmp_gt_i32 s[92:93], 50, v5
 v_accvgpr_write_b32 a150, v102
 MM v[168:171], v[236:239], a[236:239], v[168:171]
 v_cmp_gt_i32 s[94:95], 51, v5
 v_accvgpr_write_b32 a151, v103
 MM v[172:175], v[236:239], a[252:255], v[172:175]
 v_cvt_pk_bf16_f32 v104, v104, v105
 v_cvt_pk_bf16_f32 v105, v106, v107
 MM v[172:175], v[232:235], a[248:251], v[172:175]
 v_cvt_pk_bf16_f32 v106, v120, v121
 v_cvt_pk_bf16_f32 v107, v122, v123
 MM v[172:175], v[228:231], a[244:247], v[172:175]
 v_accvgpr_write_b32 a164, v104
 v_accvgpr_write_b32 a165, v105
 MM v[172:175], v[224:227], a[240:243], v[172:175]
 v_accvgpr_write_b32 a166, v106
 v_accvgpr_write_b32 a167, v107
 MM v[188:191], v[240:243], a[240:243], v[188:191]
 v_cvt_pk_bf16_f32 v108, v108, v109
 v_cvt_pk_bf16_f32 v109, v110, v111
 MM v[188:191], v[244:247], a[244:247], v[188:191]
 v_cvt_pk_bf16_f32 v110, v124, v125
 v_cvt_pk_bf16_f32 v111, v126, v127
 MM v[188:191], v[248:251], a[248:251], v[188:191]
 v_accvgpr_write_b32 a180, v108
 v_accvgpr_write_b32 a181, v109
 MM v[188:191], v[252:255], a[252:255], v[188:191]
 v_accvgpr_write_b32 a182, v110
 v_accvgpr_write_b32 a183, v111
 MM v[184:187], v[252:255], a[236:239], v[184:187]
 v_cvt_pk_bf16_f32 v128, v128, v129
 v_cvt_pk_bf16_f32 v129, v130, v131
 MM v[184:187], v[248:251], a[232:235], v[184:187]
 v_cvt_pk_bf16_f32 v130, v144, v145
 v_cvt_pk_bf16_f32 v131, v146, v147
 MM v[184:187], v[244:247], a[228:231], v[184:187]
 v_accvgpr_write_b32 a136, v128
 v_accvgpr_write_b32 a137, v129
 MM v[184:187], v[240:243], a[224:227], v[184:187]
 v_accvgpr_write_b32 a138, v130
 v_accvgpr_write_b32 a139, v131
 MM v[180:183], v[240:243], a[208:211], v[180:183]
 v_cvt_pk_bf16_f32 v132, v132, v133
 v_cvt_pk_bf16_f32 v133, v134, v135
 MM v[180:183], v[244:247], a[212:215], v[180:183]
 v_cvt_pk_bf16_f32 v134, v148, v149
 v_cvt_pk_bf16_f32 v135, v150, v151
 MM v[180:183], v[248:251], a[216:219], v[180:183]
 v_accvgpr_write_b32 a152, v132
 v_accvgpr_write_b32 a153, v133
 MM v[180:183], v[252:255], a[220:223], v[180:183]
 v_accvgpr_write_b32 a154, v134
 v_accvgpr_write_b32 a155, v135
 MM v[176:179], v[252:255], a[204:207], v[176:179]
 v_cvt_pk_bf16_f32 v136, v136, v137
 v_cvt_pk_bf16_f32 v137, v138, v139
 MM v[176:179], v[248:251], a[200:203], v[176:179]
 v_cvt_pk_bf16_f32 v138, v152, v153
 v_cvt_pk_bf16_f32 v139, v154, v155
 MM v[176:179], v[244:247], a[196:199], v[176:179]
 v_accvgpr_write_b32 a168, v136
 v_accvgpr_write_b32 a169, v137
 MM v[176:179], v[240:243], a[192:195], v[176:179]
 v_accvgpr_write_b32 a170, v138
 v_accvgpr_write_b32 a171, v139
 v_cvt_pk_bf16_f32 v140, v140, v141
 v_cvt_pk_bf16_f32 v141, v142, v143
 v_cvt_pk_bf16_f32 v142, v156, v157
 v_cvt_pk_bf16_f32 v143, v158, v159
 v_accvgpr_write_b32 a184, v140
 v_accvgpr_write_b32 a185, v141
 v_accvgpr_write_b32 a186, v142
 v_accvgpr_write_b32 a187, v143
 v_cvt_pk_bf16_f32 v160, v160, v161
 v_cvt_pk_bf16_f32 v161, v162, v163
 v_cvt_pk_bf16_f32 v162, v176, v177
 v_cvt_pk_bf16_f32 v163, v178, v179
 v_accvgpr_write_b32 a140, v160
 v_accvgpr_write_b32 a141, v161
 v_accvgpr_write_b32 a142, v162
 v_accvgpr_write_b32 a143, v163
 v_cvt_pk_bf16_f32 v164, v164, v165
 v_cvt_pk_bf16_f32 v165, v166, v167
 v_cvt_pk_bf16_f32 v166, v180, v181
 v_cvt_pk_bf16_f32 v167, v182, v183
 v_accvgpr_write_b32 a156, v164
 v_accvgpr_write_b32 a157, v165
 v_accvgpr_write_b32 a158, v166
 v_accvgpr_write_b32 a159, v167
 v_cvt_pk_bf16_f32 v168, v168, v169
 v_cvt_pk_bf16_f32 v169, v170, v171
 v_cvt_pk_bf16_f32 v170, v184, v185
 v_cvt_pk_bf16_f32 v171, v186, v187
 v_accvgpr_write_b32 a172, v168
 v_accvgpr_write_b32 a173, v169
 v_accvgpr_write_b32 a174, v170
 v_accvgpr_write_b32 a175, v171
 v_cvt_pk_bf16_f32 v172, v172, v173
 v_cvt_pk_bf16_f32 v173, v174, v175
 v_cvt_pk_bf16_f32 v174, v188, v189
 v_cvt_pk_bf16_f32 v175, v190, v191
 v_accvgpr_write_b32 a188, v172
 v_accvgpr_write_b32 a189, v173
 v_accvgpr_write_b32 a190, v174
 v_accvgpr_write_b32 a191, v175
 s_waitcnt vmcnt(0)
 s_barrier
 v_subrev_u32 v19, 98304, v0
 ds_read_b64_tr_b16 v[32:33], v0 offset:0
 ds_read_b64_tr_b16 v[34:35], v0 offset:10240
 ds_read_b64_tr_b16 v[36:37], v0 offset:32
 ds_read_b64_tr_b16 v[38:39], v0 offset:10272
 ds_read_b64_tr_b16 v[40:41], v0 offset:64
 ds_read_b64_tr_b16 v[42:43], v0 offset:10304
 ds_read_b64_tr_b16 v[44:45], v0 offset:96
 ds_read_b64_tr_b16 v[46:47], v0 offset:10336
 ds_read_b64_tr_b16 v[48:49], v0 offset:128
 ds_read_b64_tr_b16 v[50:51], v0 offset:10368
 ds_read_b64_tr_b16 v[64:65], v19 offset:0
 ds_read_b64_tr_b16 v[66:67], v19 offset:10240
 ds_read_b64_tr_b16 v[68:69], v19 offset:32
 ds_read_b64_tr_b16 v[70:71], v19 offset:10272
 ds_read_b64_tr_b16 v[72:73], v19 offset:64
 ds_read_b64_tr_b16 v[74:75], v19 offset:10304
 ds_read_b64_tr_b16 v[76:77], v19 offset:96
 ds_read_b64_tr_b16 v[78:79], v19 offset:10336
 ds_read_b64_tr_b16 v[80:81], v19 offset:128
 ds_read_b64_tr_b16 v[82:83], v19 offset:10368
 ds_read_b64_tr_b16 v[84:85], v19 offset:20480
 ds_read_b64_tr_b16 v[86:87], v19 offset:30720
 ds_read_b64_tr_b16 v[88:89], v19 offset:20512
 ds_read_b64_tr_b16 v[90:91], v19 offset:30752
 ds_read_b64_tr_b16 v[92:93], v19 offset:20544
 ds_read_b64_tr_b16 v[94:95], v19 offset:30784
 ds_read_b64_tr_b16 v[96:97], v19 offset:20576
 ds_read_b64_tr_b16 v[98:99], v19 offset:30816
 ds_read_b64_tr_b16 v[100:101], v19 offset:20608
 ds_read_b64_tr_b16 v[102:103], v19 offset:30848
 ds_read_b64_tr_b16 v[104:105], v19 offset:40960
 ds_read_b64_tr_b16 v[106:107], v19 offset:51200
 ds_read_b64_tr_b16 v[108:109], v19 offset:40992
 ds_read_b64_tr_b16 v[110:111], v19 offset:51232
 ds_read_b64_tr_b16 v[112:113], v19 offset:41024
 ds_read_b64_tr_b16 v[114:115], v19 offset:51264
 ds_read_b64_tr_b16 v[116:117], v19 offset:41056
 ds_read_b64_tr_b16 v[118:119], v19 offset:51296
 ds_read_b64_tr_b16 v[120:121], v19 offset:41088
 ds_read_b64_tr_b16 v[122:123], v19 offset:51328
 buffer_load_dword v24, v23, s[16:19], 0 offen sc1
 buffer_load_dword v25, v23, s[16:19], 0 offen offset:32 sc1
 s_waitcnt lgkmcnt(15)
 buffer_store_dwordx4 v[32:35], v1, s[16:19], s14 offen offset:0 sc1
 buffer_store_dwordx4 v[36:39], v1, s[16:19], s14 offen offset:1024 sc1
 buffer_store_dwordx4 v[40:43], v1, s[16:19], s14 offen offset:2048 sc1
 buffer_store_dwordx4 v[44:47], v1, s[16:19], s14 offen offset:3072 sc1
 buffer_store_dwordx4 v[48:51], v27, s[16:19], s14 offen offset:0 sc1
 s_mul_i32 s40, s63, 3
 s_add_u32 s40, s40, 0
 s_lshr_b32 s41, s40, 1
 s_and_b32 s40, s40, 1
 s_lshl_b32 s40, s40, 2
 s_add_u32 s40, s40, s24
 s_mul_i32 s40, s40, 182
 s_add_u32 s40, s40, s41
 s_mul_i32 s40, s40, 5120
 s_add_u32 s40, s40, 63569920
 s_cmp_ge_u32 s63, 36
 s_cselect_b32 s45, 2130706432, s40
 buffer_store_dwordx4 v[64:67], v1, s[16:19], s45 offen offset:0 sc1
 buffer_store_dwordx4 v[68:71], v1, s[16:19], s45 offen offset:1024 sc1
 buffer_store_dwordx4 v[72:75], v1, s[16:19], s45 offen offset:2048 sc1
 buffer_store_dwordx4 v[76:79], v1, s[16:19], s45 offen offset:3072 sc1
 buffer_store_dwordx4 v[80:83], v27, s[16:19], s45 offen offset:0 sc1
 s_mul_i32 s40, s63, 3
 s_add_u32 s40, s40, 1
 s_lshr_b32 s41, s40, 1
 s_and_b32 s40, s40, 1
 s_lshl_b32 s40, s40, 2
 s_add_u32 s40, s40, s24
 s_mul_i32 s40, s40, 182
 s_add_u32 s40, s40, s41
 s_mul_i32 s40, s40, 5120
 s_add_u32 s40, s40, 63569920
 s_cmp_ge_u32 s63, 36
 s_cselect_b32 s46, 2130706432, s40
 buffer_store_dwordx4 v[84:87], v1, s[16:19], s46 offen offset:0 sc1
 buffer_store_dwordx4 v[88:91], v1, s[16:19], s46 offen offset:1024 sc1
 s_waitcnt lgkmcnt(14)
 buffer_store_dwordx4 v[92:95], v1, s[16:19], s46 offen offset:2048 sc1
 s_waitcnt lgkmcnt(12)
 buffer_store_dwordx4 v[96:99], v1, s[16:19], s46 offen offset:3072 sc1
 s_waitcnt lgkmcnt(10)
 buffer_store_dwordx4 v[100:103], v27, s[16:19], s46 offen offset:0 sc1
 s_mul_i32 s40, s63, 3
 s_add_u32 s40, s40, 2
 s_lshr_b32 s41, s40, 1
 s_and_b32 s40, s40, 1
 s_lshl_b32 s40, s40, 2
 s_add_u32 s40, s40, s24
 s_mul_i32 s40, s40, 182
 s_add_u32 s40, s40, s41
 s_mul_i32 s40, s40, 5120
 s_add_u32 s40, s40, 63569920
 s_cmp_ge_u32 s63, 36
 s_cselect_b32 s45, 2130706432, s40
 s_waitcnt lgkmcnt(8)
 buffer_store_dwordx4 v[104:107], v1, s[16:19], s45 offen offset:0 sc1
 s_waitcnt lgkmcnt(6)
 buffer_store_dwordx4 v[108:111], v1, s[16:19], s45 offen offset:1024 sc1
 s_waitcnt lgkmcnt(4)
 buffer_store_dwordx4 v[112:115], v1, s[16:19], s45 offen offset:2048 sc1
 s_waitcnt lgkmcnt(2)
 buffer_store_dwordx4 v[116:119], v1, s[16:19], s45 offen offset:3072 sc1
 s_waitcnt lgkmcnt(0)
 buffer_store_dwordx4 v[120:123], v27, s[16:19], s45 offen offset:0 sc1
 s_waitcnt lgkmcnt(0)
 s_barrier
 s_waitcnt vmcnt(21)
 v_cmp_ne_u32 vcc, s61, v24
 s_cbranch_vccnz spin8
spun8:
 s_waitcnt vmcnt(20)
 v_cmp_ne_u32 vcc, s61, v25
 s_cbranch_vccnz spin9
spun9:
 s_add_u32 m0, s30, 0
 s_nop 0
 buffer_load_dwordx4 v1, s[4:7], s28 offen offset:0 sc1 lds
 buffer_load_dwordx4 v1, s[4:7], s28 offen offset:1024 sc1 lds
 buffer_load_dwordx4 v1, s[4:7], s28 offen offset:2048 sc1 lds
 buffer_load_dwordx4 v1, s[4:7], s28 offen offset:3072 sc1 lds
 s_add_u32 s28, s28, 0x4000
 s_add_u32 m0, s30, 16384
 s_nop 0
 buffer_load_dwordx4 v1, s[4:7], s28 offen offset:0 sc1 lds
 buffer_load_dwordx4 v1, s[4:7], s28 offen offset:1024 sc1 lds
 buffer_load_dwordx4 v1, s[4:7], s28 offen offset:2048 sc1 lds
 buffer_load_dwordx4 v1, s[4:7], s28 offen offset:3072 sc1 lds
 s_add_u32 s28, s28, 0x4000
 s_add_u32 m0, s30, 32768
 s_nop 0
 buffer_load_dwordx4 v1, s[8:11], s29 offen offset:0 sc1 lds
 buffer_load_dwordx4 v1, s[8:11], s29 offen offset:1024 sc1 lds
 buffer_load_dwordx4 v1, s[8:11], s29 offen offset:2048 sc1 lds
 buffer_load_dwordx4 v1, s[8:11], s29 offen offset:3072 sc1 lds
 s_add_u32 s29, s29, 0x4000
 s_add_u32 m0, s30, 49152
 s_nop 0
 buffer_load_dwordx4 v1, s[8:11], s29 offen offset:0 sc1 lds
 buffer_load_dwordx4 v1, s[8:11], s29 offen offset:1024 sc1 lds
 buffer_load_dwordx4 v1, s[8:11], s29 offen offset:2048 sc1 lds
 buffer_load_dwordx4 v1, s[8:11], s29 offen offset:3072 sc1 lds
 s_add_u32 s29, s29, 0x4000
 s_add_u32 m0, s31, 0
 s_nop 0
 buffer_load_dwordx4 v1, s[4:7], s28 offen offset:0 sc1 lds
 buffer_load_dwordx4 v1, s[4:7], s28 offen offset:1024 sc1 lds
 buffer_load_dwordx4 v1, s[4:7], s28 offen offset:2048 sc1 lds
 buffer_load_dwordx4 v1, s[4:7], s28 offen offset:3072 sc1 lds
 s_add_u32 s28, s28, 0x4000
 s_add_u32 m0, s31, 16384
 s_nop 0
 buffer_load_dwordx4 v1, s[4:7], s28 offen offset:0 sc1 lds
 buffer_load_dwordx4 v1, s[4:7], s28 offen offset:1024 sc1 lds
 buffer_load_dwordx4 v1, s[4:7], s28 offen offset:2048 sc1 lds
 buffer_load_dwordx4 v1, s[4:7], s28 offen offset:3072 sc1 lds
 s_add_u32 s28, s28, 0x4000
 s_waitcnt vmcnt(16)
 s_barrier
 ds_read_b128 v[192:195], v2 offset:0
 ds_read_b128 v[196:199], v2 offset:1024
 ds_read_b128 v[200:203], v2 offset:2048
 ds_read_b128 v[204:207], v2 offset:3072
 ds_read_b128 v[208:211], v2 offset:4096
 ds_read_b128 v[212:215], v2 offset:5120
 ds_read_b128 v[216:219], v2 offset:6144
 ds_read_b128 v[220:223], v2 offset:7168
 ds_read_b128 v[224:227], v2 offset:8192
 ds_read_b128 v[228:231], v2 offset:9216
 ds_read_b128 v[232:235], v2 offset:10240
 ds_read_b128 v[236:239], v2 offset:11264
 ds_read_b128 v[240:243], v2 offset:12288
 ds_read_b128 v[244:247], v2 offset:13312
 ds_read_b128 v[248:251], v2 offset:14336
 ds_read_b128 v[252:255], v2 offset:15360
 s_waitcnt lgkmcnt(0)
 s_branch k_att
rare_S0:
 s_nop 7
 s_nop 7
 v_max3_f32 v23, v64, v65, v66
 v_max3_f32 v23, v67, v68, v23
 v_max3_f32 v23, v69, v70, v23
 v_max3_f32 v23, v71, v72, v23
 v_max3_f32 v23, v73, v74, v23
 v_max3_f32 v23, v75, v76, v23
 v_max3_f32 v23, v77, v78, v23
 v_max_f32 v23, v23, v79
 v_mov_b32 v24, v23
 s_nop 1
 v_permlane16_swap_b32 v23, v24
 v_max_f32 v23, v23, v24
 v_mov_b32 v24, v23
 s_nop 1
 v_permlane32_swap_b32 v23, v24
 v_max_f32 v23, v23, v24
 v_max_f32 v23, 0, v23
 v_ceil_f32 v23, v23
 v_exp_f32 v24, -v23
 v_sub_f32 v64, v64, v23
 v_sub_f32 v65, v65, v23
 v_sub_f32 v66, v66, v23
 v_sub_f32 v67, v67, v23
 v_sub_f32 v68, v68, v23
 v_sub_f32 v69, v69, v23
 v_sub_f32 v70, v70, v23
 v_sub_f32 v71, v71, v23
 v_sub_f32 v72, v72, v23
 v_sub_f32 v73, v73, v23
 v_sub_f32 v74, v74, v23
 v_sub_f32 v75, v75, v23
 v_sub_f32 v76, v76, v23
 v_sub_f32 v77, v77, v23
 v_sub_f32 v78, v78, v23
 v_sub_f32 v79, v79, v23
 v_sub_f32 v48, v48, v23
 v_sub_f32 v49, v49, v23
 v_sub_f32 v50, v50, v23
 v_sub_f32 v51, v51, v23
 v_mul_f32 v32, v32, v24
 v_mul_f32 v33, v33, v24
 v_mul_f32 v34, v34, v24
 v_mul_f32 v35, v35, v24
 v_accvgpr_read_b32 v25, a0
 v_mul_f32 v25, v25, v24
 v_accvgpr_write_b32 a0, v25
 v_accvgpr_read_b32 v25, a1
 v_mul_f32 v25, v25, v24
 v_accvgpr_write_b32 a1, v25
 v_accvgpr_read_b32 v25, a2
 v_mul_f32 v25, v25, v24
 v_accvgpr_write_b32 a2, v25
 v_accvgpr_read_b32 v25, a3
 v_mul_f32 v25, v25, v24
 v_accvgpr_write_b32 a3, v25
 v_accvgpr_read_b32 v25, a4
 v_mul_f32 v25, v25, v24
 v_accvgpr_write_b32 a4, v25
 v_accvgpr_read_b32 v25, a5
 v_mul_f32 v25, v25, v24
 v_accvgpr_write_b32 a5, v25
 v_accvgpr_read_b32 v25, a6
 v_mul_f32 v25, v25, v24
 v_accvgpr_write_b32 a6, v25
 v_accvgpr_read_b32 v25, a7
 v_mul_f32 v25, v25, v24
 v_accvgpr_write_b32 a7, v25
 v_accvgpr_read_b32 v25, a8
 v_mul_f32 v25, v25, v24
 v_accvgpr_write_b32 a8, v25
 v_accvgpr_read_b32 v25, a9
 v_mul_f32 v25, v25, v24
 v_accvgpr_write_b32 a9, v25
 v_accvgpr_read_b32 v25, a10
 v_mul_f32 v25, v25, v24
 v_accvgpr_write_b32 a10, v25
 v_accvgpr_read_b32 v25, a11
 v_mul_f32 v25, v25, v24
 v_accvgpr_write_b32 a11, v25
 v_accvgpr_read_b32 v25, a12
 v_mul_f32 v25, v25, v24
 v_accvgpr_write_b32 a12, v25
 v_accvgpr_read_b32 v25, a13
 v_mul_f32 v25, v25, v24
 v_accvgpr_write_b32 a13, v25
 v_accvgpr_read_b32 v25, a14
 v_mul_f32 v25, v25, v24
 v_accvgpr_write_b32 a14, v25
 v_accvgpr_read_b32 v25, a15
 v_mul_f32 v25, v25, v24
 v_accvgpr_write_b32 a15, v25
 v_accvgpr_read_b32 v25, a16
 v_mul_f32 v25, v25, v24
 v_accvgpr_write_b32 a16, v25
 v_accvgpr_read_b32 v25, a17
 v_mul_f32 v25, v25, v24
 v_accvgpr_write_b32 a17, v25
 v_accvgpr_read_b32 v25, a18
 v_mul_f32 v25, v25, v24
 v_accvgpr_write_b32 a18, v25
 v_accvgpr_read_b32 v25, a19
 v_mul_f32 v25, v25, v24
 v_accvgpr_write_b32 a19, v25
 v_accvgpr_read_b32 v25, a20
 v_mul_f32 v25, v25, v24
 v_accvgpr_write_b32 a20, v25
 v_accvgpr_read_b32 v25, a21
 v_mul_f32 v25, v25, v24
 v_accvgpr_write_b32 a21, v25
 v_accvgpr_read_b32 v25, a22
 v_mul_f32 v25, v25, v24
 v_accvgpr_write_b32 a22, v25
 v_accvgpr_read_b32 v25, a23
 v_mul_f32 v25, v25, v24
 v_accvgpr_write_b32 a23, v25
 v_accvgpr_read_b32 v25, a24
 v_mul_f32 v25, v25, v24
 v_accvgpr_write_b32 a24, v25
 v_accvgpr_read_b32 v25, a25
 v_mul_f32 v25, v25, v24
 v_accvgpr_write_b32 a25, v25
 v_accvgpr_read_b32 v25, a26
 v_mul_f32 v25, v25, v24
 v_accvgpr_write_b32 a26, v25
 v_accvgpr_read_b32 v25, a27
 v_mul_f32 v25, v25, v24
 v_accvgpr_write_b32 a27, v25
 v_accvgpr_read_b32 v25, a28
 v_mul_f32 v25, v25, v24
 v_accvgpr_write_b32 a28, v25
 v_accvgpr_read_b32 v25, a29
 v_mul_f32 v25, v25, v24
 v_accvgpr_write_b32 a29, v25
 v_accvgpr_read_b32 v25, a30
 v_mul_f32 v25, v25, v24
 v_accvgpr_write_b32 a30, v25
 v_accvgpr_read_b32 v25, a31
 v_mul_f32 v25, v25, v24
 v_accvgpr_write_b32 a31, v25
 v_max3_f32 v23, v80, v81, v82
 v_max3_f32 v23, v83, v84, v23
 v_max3_f32 v23, v85, v86, v23
 v_max3_f32 v23, v87, v88, v23
 v_max3_f32 v23, v89, v90, v23
 v_max3_f32 v23, v91, v92, v23
 v_max3_f32 v23, v93, v94, v23
 v_max_f32 v23, v23, v95
 v_mov_b32 v24, v23
 s_nop 1
 v_permlane16_swap_b32 v23, v24
 v_max_f32 v23, v23, v24
 v_mov_b32 v24, v23
 s_nop 1
 v_permlane32_swap_b32 v23, v24
 v_max_f32 v23, v23, v24
 v_max_f32 v23, 0, v23
 v_ceil_f32 v23, v23
 v_exp_f32 v24, -v23
 v_sub_f32 v80, v80, v23
 v_sub_f32 v81, v81, v23
 v_sub_f32 v82, v82, v23
 v_sub_f32 v83, v83, v23
 v_sub_f32 v84, v84, v23
 v_sub_f32 v85, v85, v23
 v_sub_f32 v86, v86, v23
 v_sub_f32 v87, v87, v23
 v_sub_f32 v88, v88, v23
 v_sub_f32 v89, v89, v23
 v_sub_f32 v90, v90, v23
 v_sub_f32 v91, v91, v23
 v_sub_f32 v92, v92, v23
 v_sub_f32 v93, v93, v23
 v_sub_f32 v94, v94, v23
 v_sub_f32 v95, v95, v23
 v_sub_f32 v52, v52, v23
 v_sub_f32 v53, v53, v23
 v_sub_f32 v54, v54, v23
 v_sub_f32 v55, v55, v23
 v_mul_f32 v36, v36, v24
 v_mul_f32 v37, v37, v24
 v_mul_f32 v38, v38, v24
 v_mul_f32 v39, v39, v24
 v_accvgpr_read_b32 v25, a32
 v_mul_f32 v25, v25, v24
 v_accvgpr_write_b32 a32, v25
 v_accvgpr_read_b32 v25, a33
 v_mul_f32 v25, v25, v24
 v_accvgpr_write_b32 a33, v25
 v_accvgpr_read_b32 v25, a34
 v_mul_f32 v25, v25, v24
 v_accvgpr_write_b32 a34, v25
 v_accvgpr_read_b32 v25, a35
 v_mul_f32 v25, v25, v24
 v_accvgpr_write_b32 a35, v25
 v_accvgpr_read_b32 v25, a36
 v_mul_f32 v25, v25, v24
 v_accvgpr_write_b32 a36, v25
 v_accvgpr_read_b32 v25, a37
 v_mul_f32 v25, v25, v24
 v_accvgpr_write_b32 a37, v25
 v_accvgpr_read_b32 v25, a38
 v_mul_f32 v25, v25, v24
 v_accvgpr_write_b32 a38, v25
 v_accvgpr_read_b32 v25, a39
 v_mul_f32 v25, v25, v24
 v_accvgpr_write_b32 a39, v25
 v_accvgpr_read_b32 v25, a40
 v_mul_f32 v25, v25, v24
 v_accvgpr_write_b32 a40, v25
 v_accvgpr_read_b32 v25, a41
 v_mul_f32 v25, v25, v24
 v_accvgpr_write_b32 a41, v25
 v_accvgpr_read_b32 v25, a42
 v_mul_f32 v25, v25, v24
 v_accvgpr_write_b32 a42, v25
 v_accvgpr_read_b32 v25, a43
 v_mul_f32 v25, v25, v24
 v_accvgpr_write_b32 a43, v25
 v_accvgpr_read_b32 v25, a44
 v_mul_f32 v25, v25, v24
 v_accvgpr_write_b32 a44, v25
 v_accvgpr_read_b32 v25, a45
 v_mul_f32 v25, v25, v24
 v_accvgpr_write_b32 a45, v25
 v_accvgpr_read_b32 v25, a46
 v_mul_f32 v25, v25, v24
 v_accvgpr_write_b32 a46, v25
 v_accvgpr_read_b32 v25, a47
 v_mul_f32 v25, v25, v24
 v_accvgpr_write_b32 a47, v25
 v_accvgpr_read_b32 v25, a48
 v_mul_f32 v25, v25, v24
 v_accvgpr_write_b32 a48, v25
 v_accvgpr_read_b32 v25, a49
 v_mul_f32 v25, v25, v24
 v_accvgpr_write_b32 a49, v25
 v_accvgpr_read_b32 v25, a50
 v_mul_f32 v25, v25, v24
 v_accvgpr_write_b32 a50, v25
 v_accvgpr_read_b32 v25, a51
 v_mul_f32 v25, v25, v24
 v_accvgpr_write_b32 a51, v25
 v_accvgpr_read_b32 v25, a52
 v_mul_f32 v25, v25, v24
 v_accvgpr_write_b32 a52, v25
 v_accvgpr_read_b32 v25, a53
 v_mul_f32 v25, v25, v24
 v_accvgpr_write_b32 a53, v25
 v_accvgpr_read_b32 v25, a54
 v_mul_f32 v25, v25, v24
 v_accvgpr_write_b32 a54, v25
 v_accvgpr_read_b32 v25, a55
 v_mul_f32 v25, v25, v24
 v_accvgpr_write_b32 a55, v25
 v_accvgpr_read_b32 v25, a56
 v_mul_f32 v25, v25, v24
 v_accvgpr_write_b32 a56, v25
 v_accvgpr_read_b32 v25, a57
 v_mul_f32 v25, v25, v24
 v_accvgpr_write_b32 a57, v25
 v_accvgpr_read_b32 v25, a58
 v_mul_f32 v25, v25, v24
 v_accvgpr_write_b32 a58, v25
 v_accvgpr_read_b32 v25, a59
 v_mul_f32 v25, v25, v24
 v_accvgpr_write_b32 a59, v25
 v_accvgpr_read_b32 v25, a60
 v_mul_f32 v25, v25, v24
 v_accvgpr_write_b32 a60, v25
 v_accvgpr_read_b32 v25, a61
 v_mul_f32 v25, v25, v24
 v_accvgpr_write_b32 a61, v25
 v_accvgpr_read_b32 v25, a62
 v_mul_f32 v25, v25, v24
 v_accvgpr_write_b32 a62, v25
 v_accvgpr_read_b32 v25, a63
 v_mul_f32 v25, v25, v24
 v_accvgpr_write_b32 a63, v25
 v_max3_f32 v23, v96, v97, v98
 v_max3_f32 v23, v99, v100, v23
 v_max3_f32 v23, v101, v102, v23
 v_max3_f32 v23, v103, v104, v23
 v_max3_f32 v23, v105, v106, v23
 v_max3_f32 v23, v107, v108, v23
 v_max3_f32 v23, v109, v110, v23
 v_max_f32 v23, v23, v111
 v_mov_b32 v24, v23
 s_nop 1
 v_permlane16_swap_b32 v23, v24
 v_max_f32 v23, v23, v24
 v_mov_b32 v24, v23
 s_nop 1
 v_permlane32_swap_b32 v23, v24
 v_max_f32 v23, v23, v24
 v_max_f32 v23, 0, v23
 v_ceil_f32 v23, v23
 v_exp_f32 v24, -v23
 v_sub_f32 v96, v96, v23
 v_sub_f32 v97, v97, v23
 v_sub_f32 v98, v98, v23
 v_sub_f32 v99, v99, v23
 v_sub_f32 v100, v100, v23
 v_sub_f32 v101, v101, v23
 v_sub_f32 v102, v102, v23
 v_sub_f32 v103, v103, v23
 v_sub_f32 v104, v104, v23
 v_sub_f32 v105, v105, v23
 v_sub_f32 v106, v106, v23
 v_sub_f32 v107, v107, v23
 v_sub_f32 v108, v108, v23
 v_sub_f32 v109, v109, v23
 v_sub_f32 v110, v110, v23
 v_sub_f32 v111, v111, v23
 v_sub_f32 v56, v56, v23
 v_sub_f32 v57, v57, v23
 v_sub_f32 v58, v58, v23
 v_sub_f32 v59, v59, v23
 v_mul_f32 v40, v40, v24
 v_mul_f32 v41, v41, v24
 v_mul_f32 v42, v42, v24
 v_mul_f32 v43, v43, v24
 v_accvgpr_read_b32 v25, a64
 v_mul_f32 v25, v25, v24
 v_accvgpr_write_b32 a64, v25
 v_accvgpr_read_b32 v25, a65
 v_mul_f32 v25, v25, v24
 v_accvgpr_write_b32 a65, v25
 v_accvgpr_read_b32 v25, a66
 v_mul_f32 v25, v25, v24
 v_accvgpr_write_b32 a66, v25
 v_accvgpr_read_b32 v25, a67
 v_mul_f32 v25, v25, v24
 v_accvgpr_write_b32 a67, v25
 v_accvgpr_read_b32 v25, a68
 v_mul_f32 v25, v25, v24
 v_accvgpr_write_b32 a68, v25
 v_accvgpr_read_b32 v25, a69
 v_mul_f32 v25, v25, v24
 v_accvgpr_write_b32 a69, v25
 v_accvgpr_read_b32 v25, a70
 v_mul_f32 v25, v25, v24
 v_accvgpr_write_b32 a70, v25
 v_accvgpr_read_b32 v25, a71
 v_mul_f32 v25, v25, v24
 v_accvgpr_write_b32 a71, v25
 v_accvgpr_read_b32 v25, a72
 v_mul_f32 v25, v25, v24
 v_accvgpr_write_b32 a72, v25
 v_accvgpr_read_b32 v25, a73
 v_mul_f32 v25, v25, v24
 v_accvgpr_write_b32 a73, v25
 v_accvgpr_read_b32 v25, a74
 v_mul_f32 v25, v25, v24
 v_accvgpr_write_b32 a74, v25
 v_accvgpr_read_b32 v25, a75
 v_mul_f32 v25, v25, v24
 v_accvgpr_write_b32 a75, v25
 v_accvgpr_read_b32 v25, a76
 v_mul_f32 v25, v25, v24
 v_accvgpr_write_b32 a76, v25
 v_accvgpr_read_b32 v25, a77
 v_mul_f32 v25, v25, v24
 v_accvgpr_write_b32 a77, v25
 v_accvgpr_read_b32 v25, a78
 v_mul_f32 v25, v25, v24
 v_accvgpr_write_b32 a78, v25
 v_accvgpr_read_b32 v25, a79
 v_mul_f32 v25, v25, v24
 v_accvgpr_write_b32 a79, v25
 v_accvgpr_read_b32 v25, a80
 v_mul_f32 v25, v25, v24
 v_accvgpr_write_b32 a80, v25
 v_accvgpr_read_b32 v25, a81
 v_mul_f32 v25, v25, v24
 v_accvgpr_write_b32 a81, v25
 v_accvgpr_read_b32 v25, a82
 v_mul_f32 v25, v25, v24
 v_accvgpr_write_b32 a82, v25
 v_accvgpr_read_b32 v25, a83
 v_mul_f32 v25, v25, v24
 v_accvgpr_write_b32 a83, v25
 v_accvgpr_read_b32 v25, a84
 v_mul_f32 v25, v25, v24
 v_accvgpr_write_b32 a84, v25
 v_accvgpr_read_b32 v25, a85
 v_mul_f32 v25, v25, v24
 v_accvgpr_write_b32 a85, v25
 v_accvgpr_read_b32 v25, a86
 v_mul_f32 v25, v25, v24
 v_accvgpr_write_b32 a86, v25
 v_accvgpr_read_b32 v25, a87
 v_mul_f32 v25, v25, v24
 v_accvgpr_write_b32 a87, v25
 v_accvgpr_read_b32 v25, a88
 v_mul_f32 v25, v25, v24
 v_accvgpr_write_b32 a88, v25
 v_accvgpr_read_b32 v25, a89
 v_mul_f32 v25, v25, v24
 v_accvgpr_write_b32 a89, v25
 v_accvgpr_read_b32 v25, a90
 v_mul_f32 v25, v25, v24
 v_accvgpr_write_b32 a90, v25
 v_accvgpr_read_b32 v25, a91
 v_mul_f32 v25, v25, v24
 v_accvgpr_write_b32 a91, v25
 v_accvgpr_read_b32 v25, a92
 v_mul_f32 v25, v25, v24
 v_accvgpr_write_b32 a92, v25
 v_accvgpr_read_b32 v25, a93
 v_mul_f32 v25, v25, v24
 v_accvgpr_write_b32 a93, v25
 v_accvgpr_read_b32 v25, a94
 v_mul_f32 v25, v25, v24
 v_accvgpr_write_b32 a94, v25
 v_accvgpr_read_b32 v25, a95
 v_mul_f32 v25, v25, v24
 v_accvgpr_write_b32 a95, v25
 v_max3_f32 v23, v112, v113, v114
 v_max3_f32 v23, v115, v116, v23
 v_max3_f32 v23, v117, v118, v23
 v_max3_f32 v23, v119, v120, v23
 v_max3_f32 v23, v121, v122, v23
 v_max3_f32 v23, v123, v124, v23
 v_max3_f32 v23, v125, v126, v23
 v_max_f32 v23, v23, v127
 v_mov_b32 v24, v23
 s_nop 1
 v_permlane16_swap_b32 v23, v24
 v_max_f32 v23, v23, v24
 v_mov_b32 v24, v23
 s_nop 1
 v_permlane32_swap_b32 v23, v24
 v_max_f32 v23, v23, v24
 v_max_f32 v23, 0, v23
 v_ceil_f32 v23, v23
 v_exp_f32 v24, -v23
 v_lshlrev_b32 v25, 16, v176
 v_and_b32 v176, 0xffff0000, v176
 v_mul_f32 v25, v25, v24
 v_mul_f32 v176, v176, v24
 v_cvt_pk_bf16_f32 v176, v25, v176
 v_lshlrev_b32 v25, 16, v177
 v_and_b32 v177, 0xffff0000, v177
 v_mul_f32 v25, v25, v24
 v_mul_f32 v177, v177, v24
 v_cvt_pk_bf16_f32 v177, v25, v177
 v_lshlrev_b32 v25, 16, v178
 v_and_b32 v178, 0xffff0000, v178
 v_mul_f32 v25, v25, v24
 v_mul_f32 v178, v178, v24
 v_cvt_pk_bf16_f32 v178, v25, v178
 v_lshlrev_b32 v25, 16, v179
 v_and_b32 v179, 0xffff0000, v179
 v_mul_f32 v25, v25, v24
 v_mul_f32 v179, v179, v24
 v_cvt_pk_bf16_f32 v179, v25, v179
 v_lshlrev_b32 v25, 16, v184
 v_and_b32 v184, 0xffff0000, v184
 v_mul_f32 v25, v25, v24
 v_mul_f32 v184, v184, v24
 v_cvt_pk_bf16_f32 v184, v25, v184
 v_lshlrev_b32 v25, 16, v185
 v_and_b32 v185, 0xffff0000, v185
 v_mul_f32 v25, v25, v24
 v_mul_f32 v185, v185, v24
 v_cvt_pk_bf16_f32 v185, v25, v185
 v_lshlrev_b32 v25, 16, v186
 v_and_b32 v186, 0xffff0000, v186
 v_mul_f32 v25, v25, v24
 v_mul_f32 v186, v186, v24
 v_cvt_pk_bf16_f32 v186, v25, v186
 v_lshlrev_b32 v25, 16, v187
 v_and_b32 v187, 0xffff0000, v187
 v_mul_f32 v25, v25, v24
 v_mul_f32 v187, v187, v24
 v_cvt_pk_bf16_f32 v187, v25, v187
 v_sub_f32 v112, v112, v23
 v_sub_f32 v113, v113, v23
 v_sub_f32 v114, v114, v23
 v_sub_f32 v115, v115, v23
 v_sub_f32 v116, v116, v23
 v_sub_f32 v117, v117, v23
 v_sub_f32 v118, v118, v23
 v_sub_f32 v119, v119, v23
 v_sub_f32 v120, v120, v23
 v_sub_f32 v121, v121, v23
 v_sub_f32 v122, v122, v23
 v_sub_f32 v123, v123, v23
 v_sub_f32 v124, v124, v23
 v_sub_f32 v125, v125, v23
 v_sub_f32 v126, v126, v23
 v_sub_f32 v127, v127, v23
 v_sub_f32 v60, v60, v23
 v_sub_f32 v61, v61, v23
 v_sub_f32 v62, v62, v23
 v_sub_f32 v63, v63, v23
 v_mul_f32 v44, v44, v24
 v_mul_f32 v45, v45, v24
 v_mul_f32 v46, v46, v24
 v_mul_f32 v47, v47, v24
 v_accvgpr_read_b32 v25, a96
 v_mul_f32 v25, v25, v24
 v_accvgpr_write_b32 a96, v25
 v_accvgpr_read_b32 v25, a97
 v_mul_f32 v25, v25, v24
 v_accvgpr_write_b32 a97, v25
 v_accvgpr_read_b32 v25, a98
 v_mul_f32 v25, v25, v24
 v_accvgpr_write_b32 a98, v25
 v_accvgpr_read_b32 v25, a99
 v_mul_f32 v25, v25, v24
 v_accvgpr_write_b32 a99, v25
 v_accvgpr_read_b32 v25, a100
 v_mul_f32 v25, v25, v24
 v_accvgpr_write_b32 a100, v25
 v_accvgpr_read_b32 v25, a101
 v_mul_f32 v25, v25, v24
 v_accvgpr_write_b32 a101, v25
 v_accvgpr_read_b32 v25, a102
 v_mul_f32 v25, v25, v24
 v_accvgpr_write_b32 a102, v25
 v_accvgpr_read_b32 v25, a103
 v_mul_f32 v25, v25, v24
 v_accvgpr_write_b32 a103, v25
 v_accvgpr_read_b32 v25, a104
 v_mul_f32 v25, v25, v24
 v_accvgpr_write_b32 a104, v25
 v_accvgpr_read_b32 v25, a105
 v_mul_f32 v25, v25, v24
 v_accvgpr_write_b32 a105, v25
 v_accvgpr_read_b32 v25, a106
 v_mul_f32 v25, v25, v24
 v_accvgpr_write_b32 a106, v25
 v_accvgpr_read_b32 v25, a107
 v_mul_f32 v25, v25, v24
 v_accvgpr_write_b32 a107, v25
 v_accvgpr_read_b32 v25, a108
 v_mul_f32 v25, v25, v24
 v_accvgpr_write_b32 a108, v25
 v_accvgpr_read_b32 v25, a109
 v_mul_f32 v25, v25, v24
 v_accvgpr_write_b32 a109, v25
 v_accvgpr_read_b32 v25, a110
 v_mul_f32 v25, v25, v24
 v_accvgpr_write_b32 a110, v25
 v_accvgpr_read_b32 v25, a111
 v_mul_f32 v25, v25, v24
 v_accvgpr_write_b32 a111, v25
 v_accvgpr_read_b32 v25, a112
 v_mul_f32 v25, v25, v24
 v_accvgpr_write_b32 a112, v25
 v_accvgpr_read_b32 v25, a113
 v_mul_f32 v25, v25, v24
 v_accvgpr_write_b32 a113, v25
 v_accvgpr_read_b32 v25, a114
 v_mul_f32 v25, v25, v24
 v_accvgpr_write_b32 a114, v25
 v_accvgpr_read_b32 v25, a115
 v_mul_f32 v25, v25, v24
 v_accvgpr_write_b32 a115, v25
 v_accvgpr_read_b32 v25, a116
 v_mul_f32 v25, v25, v24
 v_accvgpr_write_b32 a116, v25
 v_accvgpr_read_b32 v25, a117
 v_mul_f32 v25, v25, v24
 v_accvgpr_write_b32 a117, v25
 v_accvgpr_read_b32 v25, a118
 v_mul_f32 v25, v25, v24
 v_accvgpr_write_b32 a118, v25
 v_accvgpr_read_b32 v25, a119
 v_mul_f32 v25, v25, v24
 v_accvgpr_write_b32 a119, v25
 v_accvgpr_read_b32 v25, a120
 v_mul_f32 v25, v25, v24
 v_accvgpr_write_b32 a120, v25
 v_accvgpr_read_b32 v25, a121
 v_mul_f32 v25, v25, v24
 v_accvgpr_write_b32 a121, v25
 v_accvgpr_read_b32 v25, a122
 v_mul_f32 v25, v25, v24
 v_accvgpr_write_b32 a122, v25
 v_accvgpr_read_b32 v25, a123
 v_mul_f32 v25, v25, v24
 v_accvgpr_write_b32 a123, v25
 v_accvgpr_read_b32 v25, a124
 v_mul_f32 v25, v25, v24
 v_accvgpr_write_b32 a124, v25
 v_accvgpr_read_b32 v25, a125
 v_mul_f32 v25, v25, v24
 v_accvgpr_write_b32 a125, v25
 v_accvgpr_read_b32 v25, a126
 v_mul_f32 v25, v25, v24
 v_accvgpr_write_b32 a126, v25
 v_accvgpr_read_b32 v25, a127
 v_mul_f32 v25, v25, v24
 v_accvgpr_write_b32 a127, v25
 s_nop 1
 s_setpc_b64 s[98:99]
rare_S1:
 s_nop 7
 s_nop 7
 v_max3_f32 v23, v128, v129, v130
 v_max3_f32 v23, v131, v132, v23
 v_max3_f32 v23, v133, v134, v23
 v_max3_f32 v23, v135, v136, v23
 v_max3_f32 v23, v137, v138, v23
 v_max3_f32 v23, v139, v140, v23
 v_max3_f32 v23, v141, v142, v23
 v_max_f32 v23, v23, v143
 v_mov_b32 v24, v23
 s_nop 1
 v_permlane16_swap_b32 v23, v24
 v_max_f32 v23, v23, v24
 v_mov_b32 v24, v23
 s_nop 1
 v_permlane32_swap_b32 v23, v24
 v_max_f32 v23, v23, v24
 v_max_f32 v23, 0, v23
 v_ceil_f32 v23, v23
 v_exp_f32 v24, -v23
 v_sub_f32 v128, v128, v23
 v_sub_f32 v129, v129, v23
 v_sub_f32 v130, v130, v23
 v_sub_f32 v131, v131, v23
 v_sub_f32 v132, v132, v23
 v_sub_f32 v133, v133, v23
 v_sub_f32 v134, v134, v23
 v_sub_f32 v135, v135, v23
 v_sub_f32 v136, v136, v23
 v_sub_f32 v137, v137, v23
 v_sub_f32 v138, v138, v23
 v_sub_f32 v139, v139, v23
 v_sub_f32 v140, v140, v23
 v_sub_f32 v141, v141, v23
 v_sub_f32 v142, v142, v23
 v_sub_f32 v143, v143, v23
 v_sub_f32 v48, v48, v23
 v_sub_f32 v49, v49, v23
 v_sub_f32 v50, v50, v23
 v_sub_f32 v51, v51, v23
 v_mul_f32 v32, v32, v24
 v_mul_f32 v33, v33, v24
 v_mul_f32 v34, v34, v24
 v_mul_f32 v35, v35, v24
 v_accvgpr_read_b32 v25, a0
 v_mul_f32 v25, v25, v24
 v_accvgpr_write_b32 a0, v25
 v_accvgpr_read_b32 v25, a1
 v_mul_f32 v25, v25, v24
 v_accvgpr_write_b32 a1, v25
 v_accvgpr_read_b32 v25, a2
 v_mul_f32 v25, v25, v24
 v_accvgpr_write_b32 a2, v25
 v_accvgpr_read_b32 v25, a3
 v_mul_f32 v25, v25, v24
 v_accvgpr_write_b32 a3, v25
 v_accvgpr_read_b32 v25, a4
 v_mul_f32 v25, v25, v24
 v_accvgpr_write_b32 a4, v25
 v_accvgpr_read_b32 v25, a5
 v_mul_f32 v25, v25, v24
 v_accvgpr_write_b32 a5, v25
 v_accvgpr_read_b32 v25, a6
 v_mul_f32 v25, v25, v24
 v_accvgpr_write_b32 a6, v25
 v_accvgpr_read_b32 v25, a7
 v_mul_f32 v25, v25, v24
 v_accvgpr_write_b32 a7, v25
 v_accvgpr_read_b32 v25, a8
 v_mul_f32 v25, v25, v24
 v_accvgpr_write_b32 a8, v25
 v_accvgpr_read_b32 v25, a9
 v_mul_f32 v25, v25, v24
 v_accvgpr_write_b32 a9, v25
 v_accvgpr_read_b32 v25, a10
 v_mul_f32 v25, v25, v24
 v_accvgpr_write_b32 a10, v25
 v_accvgpr_read_b32 v25, a11
 v_mul_f32 v25, v25, v24
 v_accvgpr_write_b32 a11, v25
 v_accvgpr_read_b32 v25, a12
 v_mul_f32 v25, v25, v24
 v_accvgpr_write_b32 a12, v25
 v_accvgpr_read_b32 v25, a13
 v_mul_f32 v25, v25, v24
 v_accvgpr_write_b32 a13, v25
 v_accvgpr_read_b32 v25, a14
 v_mul_f32 v25, v25, v24
 v_accvgpr_write_b32 a14, v25
 v_accvgpr_read_b32 v25, a15
 v_mul_f32 v25, v25, v24
 v_accvgpr_write_b32 a15, v25
 v_accvgpr_read_b32 v25, a16
 v_mul_f32 v25, v25, v24
 v_accvgpr_write_b32 a16, v25
 v_accvgpr_read_b32 v25, a17
 v_mul_f32 v25, v25, v24
 v_accvgpr_write_b32 a17, v25
 v_accvgpr_read_b32 v25, a18
 v_mul_f32 v25, v25, v24
 v_accvgpr_write_b32 a18, v25
 v_accvgpr_read_b32 v25, a19
 v_mul_f32 v25, v25, v24
 v_accvgpr_write_b32 a19, v25
 v_accvgpr_read_b32 v25, a20
 v_mul_f32 v25, v25, v24
 v_accvgpr_write_b32 a20, v25
 v_accvgpr_read_b32 v25, a21
 v_mul_f32 v25, v25, v24
 v_accvgpr_write_b32 a21, v25
 v_accvgpr_read_b32 v25, a22
 v_mul_f32 v25, v25, v24
 v_accvgpr_write_b32 a22, v25
 v_accvgpr_read_b32 v25, a23
 v_mul_f32 v25, v25, v24
 v_accvgpr_write_b32 a23, v25
 v_accvgpr_read_b32 v25, a24
 v_mul_f32 v25, v25, v24
 v_accvgpr_write_b32 a24, v25
 v_accvgpr_read_b32 v25, a25
 v_mul_f32 v25, v25, v24
 v_accvgpr_write_b32 a25, v25
 v_accvgpr_read_b32 v25, a26
 v_mul_f32 v25, v25, v24
 v_accvgpr_write_b32 a26, v25
 v_accvgpr_read_b32 v25, a27
 v_mul_f32 v25, v25, v24
 v_accvgpr_write_b32 a27, v25
 v_accvgpr_read_b32 v25, a28
 v_mul_f32 v25, v25, v24
 v_accvgpr_write_b32 a28, v25
 v_accvgpr_read_b32 v25, a29
 v_mul_f32 v25, v25, v24
 v_accvgpr_write_b32 a29, v25
 v_accvgpr_read_b32 v25, a30
 v_mul_f32 v25, v25, v24
 v_accvgpr_write_b32 a30, v25
 v_accvgpr_read_b32 v25, a31
 v_mul_f32 v25, v25, v24
 v_accvgpr_write_b32 a31, v25
 v_max3_f32 v23, v144, v145, v146
 v_max3_f32 v23, v147, v148, v23
 v_max3_f32 v23, v149, v150, v23
 v_max3_f32 v23, v151, v152, v23
 v_max3_f32 v23, v153, v154, v23
 v_max3_f32 v23, v155, v156, v23
 v_max3_f32 v23, v157, v158, v23
 v_max_f32 v23, v23, v159
 v_mov_b32 v24, v23
 s_nop 1
 v_permlane16_swap_b32 v23, v24
 v_max_f32 v23, v23, v24
 v_mov_b32 v24, v23
 s_nop 1
 v_permlane32_swap_b32 v23, v24
 v_max_f32 v23, v23, v24
 v_max_f32 v23, 0, v23
 v_ceil_f32 v23, v23
 v_exp_f32 v24, -v23
 v_sub_f32 v144, v144, v23
 v_sub_f32 v145, v145, v23
 v_sub_f32 v146, v146, v23
 v_sub_f32 v147, v147, v23
 v_sub_f32 v148, v148, v23
 v_sub_f32 v149, v149, v23
 v_sub_f32 v150, v150, v23
 v_sub_f32 v151, v151, v23
 v_sub_f32 v152, v152, v23
 v_sub_f32 v153, v153, v23
 v_sub_f32 v154, v154, v23
 v_sub_f32 v155, v155, v23
 v_sub_f32 v156, v156, v23
 v_sub_f32 v157, v157, v23
 v_sub_f32 v158, v158, v23
 v_sub_f32 v159, v159, v23
 v_sub_f32 v52, v52, v23
 v_sub_f32 v53, v53, v23
 v_sub_f32 v54, v54, v23
 v_sub_f32 v55, v55, v23
 v_mul_f32 v36, v36, v24
 v_mul_f32 v37, v37, v24
 v_mul_f32 v38, v38, v24
 v_mul_f32 v39, v39, v24
 v_accvgpr_read_b32 v25, a32
 v_mul_f32 v25, v25, v24
 v_accvgpr_write_b32 a32, v25
 v_accvgpr_read_b32 v25, a33
 v_mul_f32 v25, v25, v24
 v_accvgpr_write_b32 a33, v25
 v_accvgpr_read_b32 v25, a34
 v_mul_f32 v25, v25, v24
 v_accvgpr_write_b32 a34, v25
 v_accvgpr_read_b32 v25, a35
 v_mul_f32 v25, v25, v24
 v_accvgpr_write_b32 a35, v25
 v_accvgpr_read_b32 v25, a36
 v_mul_f32 v25, v25, v24
 v_accvgpr_write_b32 a36, v25
 v_accvgpr_read_b32 v25, a37
 v_mul_f32 v25, v25, v24
 v_accvgpr_write_b32 a37, v25
 v_accvgpr_read_b32 v25, a38
 v_mul_f32 v25, v25, v24
 v_accvgpr_write_b32 a38, v25
 v_accvgpr_read_b32 v25, a39
 v_mul_f32 v25, v25, v24
 v_accvgpr_write_b32 a39, v25
 v_accvgpr_read_b32 v25, a40
 v_mul_f32 v25, v25, v24
 v_accvgpr_write_b32 a40, v25
 v_accvgpr_read_b32 v25, a41
 v_mul_f32 v25, v25, v24
 v_accvgpr_write_b32 a41, v25
 v_accvgpr_read_b32 v25, a42
 v_mul_f32 v25, v25, v24
 v_accvgpr_write_b32 a42, v25
 v_accvgpr_read_b32 v25, a43
 v_mul_f32 v25, v25, v24
 v_accvgpr_write_b32 a43, v25
 v_accvgpr_read_b32 v25, a44
 v_mul_f32 v25, v25, v24
 v_accvgpr_write_b32 a44, v25
 v_accvgpr_read_b32 v25, a45
 v_mul_f32 v25, v25, v24
 v_accvgpr_write_b32 a45, v25
 v_accvgpr_read_b32 v25, a46
 v_mul_f32 v25, v25, v24
 v_accvgpr_write_b32 a46, v25
 v_accvgpr_read_b32 v25, a47
 v_mul_f32 v25, v25, v24
 v_accvgpr_write_b32 a47, v25
 v_accvgpr_read_b32 v25, a48
 v_mul_f32 v25, v25, v24
 v_accvgpr_write_b32 a48, v25
 v_accvgpr_read_b32 v25, a49
 v_mul_f32 v25, v25, v24
 v_accvgpr_write_b32 a49, v25
 v_accvgpr_read_b32 v25, a50
 v_mul_f32 v25, v25, v24
 v_accvgpr_write_b32 a50, v25
 v_accvgpr_read_b32 v25, a51
 v_mul_f32 v25, v25, v24
 v_accvgpr_write_b32 a51, v25
 v_accvgpr_read_b32 v25, a52
 v_mul_f32 v25, v25, v24
 v_accvgpr_write_b32 a52, v25
 v_accvgpr_read_b32 v25, a53
 v_mul_f32 v25, v25, v24
 v_accvgpr_write_b32 a53, v25
 v_accvgpr_read_b32 v25, a54
 v_mul_f32 v25, v25, v24
 v_accvgpr_write_b32 a54, v25
 v_accvgpr_read_b32 v25, a55
 v_mul_f32 v25, v25, v24
 v_accvgpr_write_b32 a55, v25
 v_accvgpr_read_b32 v25, a56
 v_mul_f32 v25, v25, v24
 v_accvgpr_write_b32 a56, v25
 v_accvgpr_read_b32 v25, a57
 v_mul_f32 v25, v25, v24
 v_accvgpr_write_b32 a57, v25
 v_accvgpr_read_b32 v25, a58
 v_mul_f32 v25, v25, v24
 v_accvgpr_write_b32 a58, v25
 v_accvgpr_read_b32 v25, a59
 v_mul_f32 v25, v25, v24
 v_accvgpr_write_b32 a59, v25
 v_accvgpr_read_b32 v25, a60
 v_mul_f32 v25, v25, v24
 v_accvgpr_write_b32 a60, v25
 v_accvgpr_read_b32 v25, a61
 v_mul_f32 v25, v25, v24
 v_accvgpr_write_b32 a61, v25
 v_accvgpr_read_b32 v25, a62
 v_mul_f32 v25, v25, v24
 v_accvgpr_write_b32 a62, v25
 v_accvgpr_read_b32 v25, a63
 v_mul_f32 v25, v25, v24
 v_accvgpr_write_b32 a63, v25
 v_max3_f32 v23, v160, v161, v162
 v_max3_f32 v23, v163, v164, v23
 v_max3_f32 v23, v165, v166, v23
 v_max3_f32 v23, v167, v168, v23
 v_max3_f32 v23, v169, v170, v23
 v_max3_f32 v23, v171, v172, v23
 v_max3_f32 v23, v173, v174, v23
 v_max_f32 v23, v23, v175
 v_mov_b32 v24, v23
 s_nop 1
 v_permlane16_swap_b32 v23, v24
 v_max_f32 v23, v23, v24
 v_mov_b32 v24, v23
 s_nop 1
 v_permlane32_swap_b32 v23, v24
 v_max_f32 v23, v23, v24
 v_max_f32 v23, 0, v23
 v_ceil_f32 v23, v23
 v_exp_f32 v24, -v23
 v_sub_f32 v160, v160, v23
 v_sub_f32 v161, v161, v23
 v_sub_f32 v162, v162, v23
 v_sub_f32 v163, v163, v23
 v_sub_f32 v164, v164, v23
 v_sub_f32 v165, v165, v23
 v_sub_f32 v166, v166, v23
 v_sub_f32 v167, v167, v23
 v_sub_f32 v168, v168, v23
 v_sub_f32 v169, v169, v23
 v_sub_f32 v170, v170, v23
 v_sub_f32 v171, v171, v23
 v_sub_f32 v172, v172, v23
 v_sub_f32 v173, v173, v23
 v_sub_f32 v174, v174, v23
 v_sub_f32 v175, v175, v23
 v_sub_f32 v56, v56, v23
 v_sub_f32 v57, v57, v23
 v_sub_f32 v58, v58, v23
 v_sub_f32 v59, v59, v23
 v_mul_f32 v40, v40, v24
 v_mul_f32 v41, v41, v24
 v_mul_f32 v42, v42, v24
 v_mul_f32 v43, v43, v24
 v_accvgpr_read_b32 v25, a64
 v_mul_f32 v25, v25, v24
 v_accvgpr_write_b32 a64, v25
 v_accvgpr_read_b32 v25, a65
 v_mul_f32 v25, v25, v24
 v_accvgpr_write_b32 a65, v25
 v_accvgpr_read_b32 v25, a66
 v_mul_f32 v25, v25, v24
 v_accvgpr_write_b32 a66, v25
 v_accvgpr_read_b32 v25, a67
 v_mul_f32 v25, v25, v24
 v_accvgpr_write_b32 a67, v25
 v_accvgpr_read_b32 v25, a68
 v_mul_f32 v25, v25, v24
 v_accvgpr_write_b32 a68, v25
 v_accvgpr_read_b32 v25, a69
 v_mul_f32 v25, v25, v24
 v_accvgpr_write_b32 a69, v25
 v_accvgpr_read_b32 v25, a70
 v_mul_f32 v25, v25, v24
 v_accvgpr_write_b32 a70, v25
 v_accvgpr_read_b32 v25, a71
 v_mul_f32 v25, v25, v24
 v_accvgpr_write_b32 a71, v25
 v_accvgpr_read_b32 v25, a72
 v_mul_f32 v25, v25, v24
 v_accvgpr_write_b32 a72, v25
 v_accvgpr_read_b32 v25, a73
 v_mul_f32 v25, v25, v24
 v_accvgpr_write_b32 a73, v25
 v_accvgpr_read_b32 v25, a74
 v_mul_f32 v25, v25, v24
 v_accvgpr_write_b32 a74, v25
 v_accvgpr_read_b32 v25, a75
 v_mul_f32 v25, v25, v24
 v_accvgpr_write_b32 a75, v25
 v_accvgpr_read_b32 v25, a76
 v_mul_f32 v25, v25, v24
 v_accvgpr_write_b32 a76, v25
 v_accvgpr_read_b32 v25, a77
 v_mul_f32 v25, v25, v24
 v_accvgpr_write_b32 a77, v25
 v_accvgpr_read_b32 v25, a78
 v_mul_f32 v25, v25, v24
 v_accvgpr_write_b32 a78, v25
 v_accvgpr_read_b32 v25, a79
 v_mul_f32 v25, v25, v24
 v_accvgpr_write_b32 a79, v25
 v_accvgpr_read_b32 v25, a80
 v_mul_f32 v25, v25, v24
 v_accvgpr_write_b32 a80, v25
 v_accvgpr_read_b32 v25, a81
 v_mul_f32 v25, v25, v24
 v_accvgpr_write_b32 a81, v25
 v_accvgpr_read_b32 v25, a82
 v_mul_f32 v25, v25, v24
 v_accvgpr_write_b32 a82, v25
 v_accvgpr_read_b32 v25, a83
 v_mul_f32 v25, v25, v24
 v_accvgpr_write_b32 a83, v25
 v_accvgpr_read_b32 v25, a84
 v_mul_f32 v25, v25, v24
 v_accvgpr_write_b32 a84, v25
 v_accvgpr_read_b32 v25, a85
 v_mul_f32 v25, v25, v24
 v_accvgpr_write_b32 a85, v25
 v_accvgpr_read_b32 v25, a86
 v_mul_f32 v25, v25, v24
 v_accvgpr_write_b32 a86, v25
 v_accvgpr_read_b32 v25, a87
 v_mul_f32 v25, v25, v24
 v_accvgpr_write_b32 a87, v25
 v_accvgpr_read_b32 v25, a88
 v_mul_f32 v25, v25, v24
 v_accvgpr_write_b32 a88, v25
 v_accvgpr_read_b32 v25, a89
 v_mul_f32 v25, v25, v24
 v_accvgpr_write_b32 a89, v25
 v_accvgpr_read_b32 v25, a90
 v_mul_f32 v25, v25, v24
 v_accvgpr_write_b32 a90, v25
 v_accvgpr_read_b32 v25, a91
 v_mul_f32 v25, v25, v24
 v_accvgpr_write_b32 a91, v25
 v_accvgpr_read_b32 v25, a92
 v_mul_f32 v25, v25, v24
 v_accvgpr_write_b32 a92, v25
 v_accvgpr_read_b32 v25, a93
 v_mul_f32 v25, v25, v24
 v_accvgpr_write_b32 a93, v25
 v_accvgpr_read_b32 v25, a94
 v_mul_f32 v25, v25, v24
 v_accvgpr_write_b32 a94, v25
 v_accvgpr_read_b32 v25, a95
 v_mul_f32 v25, v25, v24
 v_accvgpr_write_b32 a95, v25
 v_max3_f32 v23, v176, v177, v178
 v_max3_f32 v23, v179, v180, v23
 v_max3_f32 v23, v181, v182, v23
 v_max3_f32 v23, v183, v184, v23
 v_max3_f32 v23, v185, v186, v23
 v_max3_f32 v23, v187, v188, v23
 v_max3_f32 v23, v189, v190, v23
 v_max_f32 v23, v23, v191
 v_mov_b32 v24, v23
 s_nop 1
 v_permlane16_swap_b32 v23, v24
 v_max_f32 v23, v23, v24
 v_mov_b32 v24, v23
 s_nop 1
 v_permlane32_swap_b32 v23, v24
 v_max_f32 v23, v23, v24
 v_max_f32 v23, 0, v23
 v_ceil_f32 v23, v23
 v_exp_f32 v24, -v23
 v_lshlrev_b32 v25, 16, v112
 v_and_b32 v112, 0xffff0000, v112
 v_mul_f32 v25, v25, v24
 v_mul_f32 v112, v112, v24
 v_cvt_pk_bf16_f32 v112, v25, v112
 v_lshlrev_b32 v25, 16, v113
 v_and_b32 v113, 0xffff0000, v113
 v_mul_f32 v25, v25, v24
 v_mul_f32 v113, v113, v24
 v_cvt_pk_bf16_f32 v113, v25, v113
 v_lshlrev_b32 v25, 16, v114
 v_and_b32 v114, 0xffff0000, v114
 v_mul_f32 v25, v25, v24
 v_mul_f32 v114, v114, v24
 v_cvt_pk_bf16_f32 v114, v25, v114
 v_lshlrev_b32 v25, 16, v115
 v_and_b32 v115, 0xffff0000, v115
 v_mul_f32 v25, v25, v24
 v_mul_f32 v115, v115, v24
 v_cvt_pk_bf16_f32 v115, v25, v115
 v_lshlrev_b32 v25, 16, v120
 v_and_b32 v120, 0xffff0000, v120
 v_mul_f32 v25, v25, v24
 v_mul_f32 v120, v120, v24
 v_cvt_pk_bf16_f32 v120, v25, v120
 v_lshlrev_b32 v25, 16, v121
 v_and_b32 v121, 0xffff0000, v121
 v_mul_f32 v25, v25, v24
 v_mul_f32 v121, v121, v24
 v_cvt_pk_bf16_f32 v121, v25, v121
 v_lshlrev_b32 v25, 16, v122
 v_and_b32 v122, 0xffff0000, v122
 v_mul_f32 v25, v25, v24
 v_mul_f32 v122, v122, v24
 v_cvt_pk_bf16_f32 v122, v25, v122
 v_lshlrev_b32 v25, 16, v123
 v_and_b32 v123, 0xffff0000, v123
 v_mul_f32 v25, v25, v24
 v_mul_f32 v123, v123, v24
 v_cvt_pk_bf16_f32 v123, v25, v123
 v_sub_f32 v176, v176, v23
 v_sub_f32 v177, v177, v23
 v_sub_f32 v178, v178, v23
 v_sub_f32 v179, v179, v23
 v_sub_f32 v180, v180, v23
 v_sub_f32 v181, v181, v23
 v_sub_f32 v182, v182, v23
 v_sub_f32 v183, v183, v23
 v_sub_f32 v184, v184, v23
 v_sub_f32 v185, v185, v23
 v_sub_f32 v186, v186, v23
 v_sub_f32 v187, v187, v23
 v_sub_f32 v188, v188, v23
 v_sub_f32 v189, v189, v23
 v_sub_f32 v190, v190, v23
 v_sub_f32 v191, v191, v23
 v_sub_f32 v60, v60, v23
 v_sub_f32 v61, v61, v23
 v_sub_f32 v62, v62, v23
 v_sub_f32 v63, v63, v23
 v_mul_f32 v44, v44, v24
 v_mul_f32 v45, v45, v24
 v_mul_f32 v46, v46, v24
 v_mul_f32 v47, v47, v24
 v_accvgpr_read_b32 v25, a96
 v_mul_f32 v25, v25, v24
 v_accvgpr_write_b32 a96, v25
 v_accvgpr_read_b32 v25, a97
 v_mul_f32 v25, v25, v24
 v_accvgpr_write_b32 a97, v25
 v_accvgpr_read_b32 v25, a98
 v_mul_f32 v25, v25, v24
 v_accvgpr_write_b32 a98, v25
 v_accvgpr_read_b32 v25, a99
 v_mul_f32 v25, v25, v24
 v_accvgpr_write_b32 a99, v25
 v_accvgpr_read_b32 v25, a100
 v_mul_f32 v25, v25, v24
 v_accvgpr_write_b32 a100, v25
 v_accvgpr_read_b32 v25, a101
 v_mul_f32 v25, v25, v24
 v_accvgpr_write_b32 a101, v25
 v_accvgpr_read_b32 v25, a102
 v_mul_f32 v25, v25, v24
 v_accvgpr_write_b32 a102, v25
 v_accvgpr_read_b32 v25, a103
 v_mul_f32 v25, v25, v24
 v_accvgpr_write_b32 a103, v25
 v_accvgpr_read_b32 v25, a104
 v_mul_f32 v25, v25, v24
 v_accvgpr_write_b32 a104, v25
 v_accvgpr_read_b32 v25, a105
 v_mul_f32 v25, v25, v24
 v_accvgpr_write_b32 a105, v25
 v_accvgpr_read_b32 v25, a106
 v_mul_f32 v25, v25, v24
 v_accvgpr_write_b32 a106, v25
 v_accvgpr_read_b32 v25, a107
 v_mul_f32 v25, v25, v24
 v_accvgpr_write_b32 a107, v25
 v_accvgpr_read_b32 v25, a108
 v_mul_f32 v25, v25, v24
 v_accvgpr_write_b32 a108, v25
 v_accvgpr_read_b32 v25, a109
 v_mul_f32 v25, v25, v24
 v_accvgpr_write_b32 a109, v25
 v_accvgpr_read_b32 v25, a110
 v_mul_f32 v25, v25, v24
 v_accvgpr_write_b32 a110, v25
 v_accvgpr_read_b32 v25, a111
 v_mul_f32 v25, v25, v24
 v_accvgpr_write_b32 a111, v25
 v_accvgpr_read_b32 v25, a112
 v_mul_f32 v25, v25, v24
 v_accvgpr_write_b32 a112, v25
 v_accvgpr_read_b32 v25, a113
 v_mul_f32 v25, v25, v24
 v_accvgpr_write_b32 a113, v25
 v_accvgpr_read_b32 v25, a114
 v_mul_f32 v25, v25, v24
 v_accvgpr_write_b32 a114, v25
 v_accvgpr_read_b32 v25, a115
 v_mul_f32 v25, v25, v24
 v_accvgpr_write_b32 a115, v25
 v_accvgpr_read_b32 v25, a116
 v_mul_f32 v25, v25, v24
 v_accvgpr_write_b32 a116, v25
 v_accvgpr_read_b32 v25, a117
 v_mul_f32 v25, v25, v24
 v_accvgpr_write_b32 a117, v25
 v_accvgpr_read_b32 v25, a118
 v_mul_f32 v25, v25, v24
 v_accvgpr_write_b32 a118, v25
 v_accvgpr_read_b32 v25, a119
 v_mul_f32 v25, v25, v24
 v_accvgpr_write_b32 a119, v25
 v_accvgpr_read_b32 v25, a120
 v_mul_f32 v25, v25, v24
 v_accvgpr_write_b32 a120, v25
 v_accvgpr_read_b32 v25, a121
 v_mul_f32 v25, v25, v24
 v_accvgpr_write_b32 a121, v25
 v_accvgpr_read_b32 v25, a122
 v_mul_f32 v25, v25, v24
 v_accvgpr_write_b32 a122, v25
 v_accvgpr_read_b32 v25, a123
 v_mul_f32 v25, v25, v24
 v_accvgpr_write_b32 a123, v25
 v_accvgpr_read_b32 v25, a124
 v_mul_f32 v25, v25, v24
 v_accvgpr_write_b32 a124, v25
 v_accvgpr_read_b32 v25, a125
 v_mul_f32 v25, v25, v24
 v_accvgpr_write_b32 a125, v25
 v_accvgpr_read_b32 v25, a126
 v_mul_f32 v25, v25, v24
 v_accvgpr_write_b32 a126, v25
 v_accvgpr_read_b32 v25, a127
 v_mul_f32 v25, v25, v24
 v_accvgpr_write_b32 a127, v25
 s_nop 1
 s_setpc_b64 s[98:99]
rare_R0:
 s_nop 7
 s_nop 7
 v_max3_f32 v23, v64, v65, v66
 v_max3_f32 v23, v67, v68, v23
 v_max3_f32 v23, v69, v70, v23
 v_max3_f32 v23, v71, v72, v23
 v_max3_f32 v23, v73, v74, v23
 v_max3_f32 v23, v75, v76, v23
 v_max3_f32 v23, v77, v78, v23
 v_max3_f32 v23, v79, v96, v23
 v_max3_f32 v23, v97, v98, v23
 v_max3_f32 v23, v99, v100, v23
 v_max3_f32 v23, v101, v102, v23
 v_max3_f32 v23, v103, v104, v23
 v_max3_f32 v23, v105, v106, v23
 v_max3_f32 v23, v107, v108, v23
 v_max3_f32 v23, v109, v110, v23
 v_max_f32 v23, v23, v111
 v_mov_b32 v24, v23
 s_nop 1
 v_permlane16_swap_b32 v23, v24
 v_max_f32 v23, v23, v24
 v_mov_b32 v24, v23
 s_nop 1
 v_permlane32_swap_b32 v23, v24
 v_max_f32 v23, v23, v24
 v_max_f32 v23, 0, v23
 v_ceil_f32 v23, v23
 v_exp_f32 v24, -v23
 v_sub_f32 v64, v64, v23
 v_sub_f32 v65, v65, v23
 v_sub_f32 v66, v66, v23
 v_sub_f32 v67, v67, v23
 v_sub_f32 v68, v68, v23
 v_sub_f32 v69, v69, v23
 v_sub_f32 v70, v70, v23
 v_sub_f32 v71, v71, v23
 v_sub_f32 v72, v72, v23
 v_sub_f32 v73, v73, v23
 v_sub_f32 v74, v74, v23
 v_sub_f32 v75, v75, v23
 v_sub_f32 v76, v76, v23
 v_sub_f32 v77, v77, v23
 v_sub_f32 v78, v78, v23
 v_sub_f32 v79, v79, v23
 v_sub_f32 v96, v96, v23
 v_sub_f32 v97, v97, v23
 v_sub_f32 v98, v98, v23
 v_sub_f32 v99, v99, v23
 v_sub_f32 v100, v100, v23
 v_sub_f32 v101, v101, v23
 v_sub_f32 v102, v102, v23
 v_sub_f32 v103, v103, v23
 v_sub_f32 v104, v104, v23
 v_sub_f32 v105, v105, v23
 v_sub_f32 v106, v106, v23
 v_sub_f32 v107, v107, v23
 v_sub_f32 v108, v108, v23
 v_sub_f32 v109, v109, v23
 v_sub_f32 v110, v110, v23
 v_sub_f32 v111, v111, v23
 v_sub_f32 v56, v56, v23
 v_sub_f32 v57, v57, v23
 v_sub_f32 v58, v58, v23
 v_sub_f32 v59, v59, v23
 v_mul_f32 v40, v40, v24
 v_mul_f32 v41, v41, v24
 v_mul_f32 v42, v42, v24
 v_mul_f32 v43, v43, v24
 v_accvgpr_read_b32 v25, a64
 v_mul_f32 v25, v25, v24
 v_accvgpr_write_b32 a64, v25
 v_accvgpr_read_b32 v25, a65
 v_mul_f32 v25, v25, v24
 v_accvgpr_write_b32 a65, v25
 v_accvgpr_read_b32 v25, a66
 v_mul_f32 v25, v25, v24
 v_accvgpr_write_b32 a66, v25
 v_accvgpr_read_b32 v25, a67
 v_mul_f32 v25, v25, v24
 v_accvgpr_write_b32 a67, v25
 v_accvgpr_read_b32 v25, a68
 v_mul_f32 v25, v25, v24
 v_accvgpr_write_b32 a68, v25
 v_accvgpr_read_b32 v25, a69
 v_mul_f32 v25, v25, v24
 v_accvgpr_write_b32 a69, v25
 v_accvgpr_read_b32 v25, a70
 v_mul_f32 v25, v25, v24
 v_accvgpr_write_b32 a70, v25
 v_accvgpr_read_b32 v25, a71
 v_mul_f32 v25, v25, v24
 v_accvgpr_write_b32 a71, v25
 v_accvgpr_read_b32 v25, a72
 v_mul_f32 v25, v25, v24
 v_accvgpr_write_b32 a72, v25
 v_accvgpr_read_b32 v25, a73
 v_mul_f32 v25, v25, v24
 v_accvgpr_write_b32 a73, v25
 v_accvgpr_read_b32 v25, a74
 v_mul_f32 v25, v25, v24
 v_accvgpr_write_b32 a74, v25
 v_accvgpr_read_b32 v25, a75
 v_mul_f32 v25, v25, v24
 v_accvgpr_write_b32 a75, v25
 v_accvgpr_read_b32 v25, a76
 v_mul_f32 v25, v25, v24
 v_accvgpr_write_b32 a76, v25
 v_accvgpr_read_b32 v25, a77
 v_mul_f32 v25, v25, v24
 v_accvgpr_write_b32 a77, v25
 v_accvgpr_read_b32 v25, a78
 v_mul_f32 v25, v25, v24
 v_accvgpr_write_b32 a78, v25
 v_accvgpr_read_b32 v25, a79
 v_mul_f32 v25, v25, v24
 v_accvgpr_write_b32 a79, v25
 v_accvgpr_read_b32 v25, a80
 v_mul_f32 v25, v25, v24
 v_accvgpr_write_b32 a80, v25
 v_accvgpr_read_b32 v25, a81
 v_mul_f32 v25, v25, v24
 v_accvgpr_write_b32 a81, v25
 v_accvgpr_read_b32 v25, a82
 v_mul_f32 v25, v25, v24
 v_accvgpr_write_b32 a82, v25
 v_accvgpr_read_b32 v25, a83
 v_mul_f32 v25, v25, v24
 v_accvgpr_write_b32 a83, v25
 v_accvgpr_read_b32 v25, a84
 v_mul_f32 v25, v25, v24
 v_accvgpr_write_b32 a84, v25
 v_accvgpr_read_b32 v25, a85
 v_mul_f32 v25, v25, v24
 v_accvgpr_write_b32 a85, v25
 v_accvgpr_read_b32 v25, a86
 v_mul_f32 v25, v25, v24
 v_accvgpr_write_b32 a86, v25
 v_accvgpr_read_b32 v25, a87
 v_mul_f32 v25, v25, v24
 v_accvgpr_write_b32 a87, v25
 v_accvgpr_read_b32 v25, a88
 v_mul_f32 v25, v25, v24
 v_accvgpr_write_b32 a88, v25
 v_accvgpr_read_b32 v25, a89
 v_mul_f32 v25, v25, v24
 v_accvgpr_write_b32 a89, v25
 v_accvgpr_read_b32 v25, a90
 v_mul_f32 v25, v25, v24
 v_accvgpr_write_b32 a90, v25
 v_accvgpr_read_b32 v25, a91
 v_mul_f32 v25, v25, v24
 v_accvgpr_write_b32 a91, v25
 v_accvgpr_read_b32 v25, a92
 v_mul_f32 v25, v25, v24
 v_accvgpr_write_b32 a92, v25
 v_accvgpr_read_b32 v25, a93
 v_mul_f32 v25, v25, v24
 v_accvgpr_write_b32 a93, v25
 v_accvgpr_read_b32 v25, a94
 v_mul_f32 v25, v25, v24
 v_accvgpr_write_b32 a94, v25
 v_accvgpr_read_b32 v25, a95
 v_mul_f32 v25, v25, v24
 v_accvgpr_write_b32 a95, v25
 v_max3_f32 v23, v80, v81, v82
 v_max3_f32 v23, v83, v84, v23
 v_max3_f32 v23, v85, v86, v23
 v_max3_f32 v23, v87, v88, v23
 v_max3_f32 v23, v89, v90, v23
 v_max3_f32 v23, v91, v92, v23
 v_max3_f32 v23, v93, v94, v23
 v_max3_f32 v23, v95, v112, v23
 v_max3_f32 v23, v113, v114, v23
 v_max3_f32 v23, v115, v116, v23
 v_max3_f32 v23, v117, v118, v23
 v_max3_f32 v23, v119, v120, v23
 v_max3_f32 v23, v121, v122, v23
 v_max3_f32 v23, v123, v124, v23
 v_max3_f32 v23, v125, v126, v23
 v_max_f32 v23, v23, v127
 v_mov_b32 v24, v23
 s_nop 1
 v_permlane16_swap_b32 v23, v24
 v_max_f32 v23, v23, v24
 v_mov_b32 v24, v23
 s_nop 1
 v_permlane32_swap_b32 v23, v24
 v_max_f32 v23, v23, v24
 v_max_f32 v23, 0, v23
 v_ceil_f32 v23, v23
 v_exp_f32 v24, -v23
 v_lshlrev_b32 v25, 16, v176
 v_and_b32 v176, 0xffff0000, v176
 v_mul_f32 v25, v25, v24
 v_mul_f32 v176, v176, v24
 v_cvt_pk_bf16_f32 v176, v25, v176
 v_lshlrev_b32 v25, 16, v177
 v_and_b32 v177, 0xffff0000, v177
 v_mul_f32 v25, v25, v24
 v_mul_f32 v177, v177, v24
 v_cvt_pk_bf16_f32 v177, v25, v177
 v_lshlrev_b32 v25, 16, v178
 v_and_b32 v178, 0xffff0000, v178
 v_mul_f32 v25, v25, v24
 v_mul_f32 v178, v178, v24
 v_cvt_pk_bf16_f32 v178, v25, v178
 v_lshlrev_b32 v25, 16, v179
 v_and_b32 v179, 0xffff0000, v179
 v_mul_f32 v25, v25, v24
 v_mul_f32 v179, v179, v24
 v_cvt_pk_bf16_f32 v179, v25, v179
 v_lshlrev_b32 v25, 16, v184
 v_and_b32 v184, 0xffff0000, v184
 v_mul_f32 v25, v25, v24
 v_mul_f32 v184, v184, v24
 v_cvt_pk_bf16_f32 v184, v25, v184
 v_lshlrev_b32 v25, 16, v185
 v_and_b32 v185, 0xffff0000, v185
 v_mul_f32 v25, v25, v24
 v_mul_f32 v185, v185, v24
 v_cvt_pk_bf16_f32 v185, v25, v185
 v_lshlrev_b32 v25, 16, v186
 v_and_b32 v186, 0xffff0000, v186
 v_mul_f32 v25, v25, v24
 v_mul_f32 v186, v186, v24
 v_cvt_pk_bf16_f32 v186, v25, v186
 v_lshlrev_b32 v25, 16, v187
 v_and_b32 v187, 0xffff0000, v187
 v_mul_f32 v25, v25, v24
 v_mul_f32 v187, v187, v24
 v_cvt_pk_bf16_f32 v187, v25, v187
 v_sub_f32 v80, v80, v23
 v_sub_f32 v81, v81, v23
 v_sub_f32 v82, v82, v23
 v_sub_f32 v83, v83, v23
 v_sub_f32 v84, v84, v23
 v_sub_f32 v85, v85, v23
 v_sub_f32 v86, v86, v23
 v_sub_f32 v87, v87, v23
 v_sub_f32 v88, v88, v23
 v_sub_f32 v89, v89, v23
 v_sub_f32 v90, v90, v23
 v_sub_f32 v91, v91, v23
 v_sub_f32 v92, v92, v23
 v_sub_f32 v93, v93, v23
 v_sub_f32 v94, v94, v23
 v_sub_f32 v95, v95, v23
 v_sub_f32 v112, v112, v23
 v_sub_f32 v113, v113, v23
 v_sub_f32 v114, v114, v23
 v_sub_f32 v115, v115, v23
 v_sub_f32 v116, v116, v23
 v_sub_f32 v117, v117, v23
 v_sub_f32 v118, v118, v23
 v_sub_f32 v119, v119, v23
 v_sub_f32 v120, v120, v23
 v_sub_f32 v121, v121, v23
 v_sub_f32 v122, v122, v23
 v_sub_f32 v123, v123, v23
 v_sub_f32 v124, v124, v23
 v_sub_f32 v125, v125, v23
 v_sub_f32 v126, v126, v23
 v_sub_f32 v127, v127, v23
 v_sub_f32 v60, v60, v23
 v_sub_f32 v61, v61, v23
 v_sub_f32 v62, v62, v23
 v_sub_f32 v63, v63, v23
 v_mul_f32 v44, v44, v24
 v_mul_f32 v45, v45, v24
 v_mul_f32 v46, v46, v24
 v_mul_f32 v47, v47, v24
 v_accvgpr_read_b32 v25, a96
 v_mul_f32 v25, v25, v24
 v_accvgpr_write_b32 a96, v25
 v_accvgpr_read_b32 v25, a97
 v_mul_f32 v25, v25, v24
 v_accvgpr_write_b32 a97, v25
 v_accvgpr_read_b32 v25, a98
 v_mul_f32 v25, v25, v24
 v_accvgpr_write_b32 a98, v25
 v_accvgpr_read_b32 v25, a99
 v_mul_f32 v25, v25, v24
 v_accvgpr_write_b32 a99, v25
 v_accvgpr_read_b32 v25, a100
 v_mul_f32 v25, v25, v24
 v_accvgpr_write_b32 a100, v25
 v_accvgpr_read_b32 v25, a101
 v_mul_f32 v25, v25, v24
 v_accvgpr_write_b32 a101, v25
 v_accvgpr_read_b32 v25, a102
 v_mul_f32 v25, v25, v24
 v_accvgpr_write_b32 a102, v25
 v_accvgpr_read_b32 v25, a103
 v_mul_f32 v25, v25, v24
 v_accvgpr_write_b32 a103, v25
 v_accvgpr_read_b32 v25, a104
 v_mul_f32 v25, v25, v24
 v_accvgpr_write_b32 a104, v25
 v_accvgpr_read_b32 v25, a105
 v_mul_f32 v25, v25, v24
 v_accvgpr_write_b32 a105, v25
 v_accvgpr_read_b32 v25, a106
 v_mul_f32 v25, v25, v24
 v_accvgpr_write_b32 a106, v25
 v_accvgpr_read_b32 v25, a107
 v_mul_f32 v25, v25, v24
 v_accvgpr_write_b32 a107, v25
 v_accvgpr_read_b32 v25, a108
 v_mul_f32 v25, v25, v24
 v_accvgpr_write_b32 a108, v25
 v_accvgpr_read_b32 v25, a109
 v_mul_f32 v25, v25, v24
 v_accvgpr_write_b32 a109, v25
 v_accvgpr_read_b32 v25, a110
 v_mul_f32 v25, v25, v24
 v_accvgpr_write_b32 a110, v25
 v_accvgpr_read_b32 v25, a111
 v_mul_f32 v25, v25, v24
 v_accvgpr_write_b32 a111, v25
 v_accvgpr_read_b32 v25, a112
 v_mul_f32 v25, v25, v24
 v_accvgpr_write_b32 a112, v25
 v_accvgpr_read_b32 v25, a113
 v_mul_f32 v25, v25, v24
 v_accvgpr_write_b32 a113, v25
 v_accvgpr_read_b32 v25, a114
 v_mul_f32 v25, v25, v24
 v_accvgpr_write_b32 a114, v25
 v_accvgpr_read_b32 v25, a115
 v_mul_f32 v25, v25, v24
 v_accvgpr_write_b32 a115, v25
 v_accvgpr_read_b32 v25, a116
 v_mul_f32 v25, v25, v24
 v_accvgpr_write_b32 a116, v25
 v_accvgpr_read_b32 v25, a117
 v_mul_f32 v25, v25, v24
 v_accvgpr_write_b32 a117, v25
 v_accvgpr_read_b32 v25, a118
 v_mul_f32 v25, v25, v24
 v_accvgpr_write_b32 a118, v25
 v_accvgpr_read_b32 v25, a119
 v_mul_f32 v25, v25, v24
 v_accvgpr_write_b32 a119, v25
 v_accvgpr_read_b32 v25, a120
 v_mul_f32 v25, v25, v24
 v_accvgpr_write_b32 a120, v25
 v_accvgpr_read_b32 v25, a121
 v_mul_f32 v25, v25, v24
 v_accvgpr_write_b32 a121, v25
 v_accvgpr_read_b32 v25, a122
 v_mul_f32 v25, v25, v24
 v_accvgpr_write_b32 a122, v25
 v_accvgpr_read_b32 v25, a123
 v_mul_f32 v25, v25, v24
 v_accvgpr_write_b32 a123, v25
 v_accvgpr_read_b32 v25, a124
 v_mul_f32 v25, v25, v24
 v_accvgpr_write_b32 a124, v25
 v_accvgpr_read_b32 v25, a125
 v_mul_f32 v25, v25, v24
 v_accvgpr_write_b32 a125, v25
 v_accvgpr_read_b32 v25, a126
 v_mul_f32 v25, v25, v24
 v_accvgpr_write_b32 a126, v25
 v_accvgpr_read_b32 v25, a127
 v_mul_f32 v25, v25, v24
 v_accvgpr_write_b32 a127, v25
 s_nop 1
 s_setpc_b64 s[98:99]
rare_R1:
 s_nop 7
 s_nop 7
 v_max3_f32 v23, v128, v129, v130
 v_max3_f32 v23, v131, v132, v23
 v_max3_f32 v23, v133, v134, v23
 v_max3_f32 v23, v135, v136, v23
 v_max3_f32 v23, v137, v138, v23
 v_max3_f32 v23, v139, v140, v23
 v_max3_f32 v23, v141, v142, v23
 v_max3_f32 v23, v143, v160, v23
 v_max3_f32 v23, v161, v162, v23
 v_max3_f32 v23, v163, v164, v23
 v_max3_f32 v23, v165, v166, v23
 v_max3_f32 v23, v167, v168, v23
 v_max3_f32 v23, v169, v170, v23
 v_max3_f32 v23, v171, v172, v23
 v_max3_f32 v23, v173, v174, v23
 v_max_f32 v23, v23, v175
 v_mov_b32 v24, v23
 s_nop 1
 v_permlane16_swap_b32 v23, v24
 v_max_f32 v23, v23, v24
 v_mov_b32 v24, v23
 s_nop 1
 v_permlane32_swap_b32 v23, v24
 v_max_f32 v23, v23, v24
 v_max_f32 v23, 0, v23
 v_ceil_f32 v23, v23
 v_exp_f32 v24, -v23
 v_sub_f32 v128, v128, v23
 v_sub_f32 v129, v129, v23
 v_sub_f32 v130, v130, v23
 v_sub_f32 v131, v131, v23
 v_sub_f32 v132, v132, v23
 v_sub_f32 v133, v133, v23
 v_sub_f32 v134, v134, v23
 v_sub_f32 v135, v135, v23
 v_sub_f32 v136, v136, v23
 v_sub_f32 v137, v137, v23
 v_sub_f32 v138, v138, v23
 v_sub_f32 v139, v139, v23
 v_sub_f32 v140, v140, v23
 v_sub_f32 v141, v141, v23
 v_sub_f32 v142, v142, v23
 v_sub_f32 v143, v143, v23
 v_sub_f32 v160, v160, v23
 v_sub_f32 v161, v161, v23
 v_sub_f32 v162, v162, v23
 v_sub_f32 v163, v163, v23
 v_sub_f32 v164, v164, v23
 v_sub_f32 v165, v165, v23
 v_sub_f32 v166, v166, v23
 v_sub_f32 v167, v167, v23
 v_sub_f32 v168, v168, v23
 v_sub_f32 v169, v169, v23
 v_sub_f32 v170, v170, v23
 v_sub_f32 v171, v171, v23
 v_sub_f32 v172, v172, v23
 v_sub_f32 v173, v173, v23
 v_sub_f32 v174, v174, v23
 v_sub_f32 v175, v175, v23
 v_sub_f32 v56, v56, v23
 v_sub_f32 v57, v57, v23
 v_sub_f32 v58, v58, v23
 v_sub_f32 v59, v59, v23
 v_mul_f32 v40, v40, v24
 v_mul_f32 v41, v41, v24
 v_mul_f32 v42, v42, v24
 v_mul_f32 v43, v43, v24
 v_accvgpr_read_b32 v25, a64
 v_mul_f32 v25, v25, v24
 v_accvgpr_write_b32 a64, v25
 v_accvgpr_read_b32 v25, a65
 v_mul_f32 v25, v25, v24
 v_accvgpr_write_b32 a65, v25
 v_accvgpr_read_b32 v25, a66
 v_mul_f32 v25, v25, v24
 v_accvgpr_write_b32 a66, v25
 v_accvgpr_read_b32 v25, a67
 v_mul_f32 v25, v25, v24
 v_accvgpr_write_b32 a67, v25
 v_accvgpr_read_b32 v25, a68
 v_mul_f32 v25, v25, v24
 v_accvgpr_write_b32 a68, v25
 v_accvgpr_read_b32 v25, a69
 v_mul_f32 v25, v25, v24
 v_accvgpr_write_b32 a69, v25
 v_accvgpr_read_b32 v25, a70
 v_mul_f32 v25, v25, v24
 v_accvgpr_write_b32 a70, v25
 v_accvgpr_read_b32 v25, a71
 v_mul_f32 v25, v25, v24
 v_accvgpr_write_b32 a71, v25
 v_accvgpr_read_b32 v25, a72
 v_mul_f32 v25, v25, v24
 v_accvgpr_write_b32 a72, v25
 v_accvgpr_read_b32 v25, a73
 v_mul_f32 v25, v25, v24
 v_accvgpr_write_b32 a73, v25
 v_accvgpr_read_b32 v25, a74
 v_mul_f32 v25, v25, v24
 v_accvgpr_write_b32 a74, v25
 v_accvgpr_read_b32 v25, a75
 v_mul_f32 v25, v25, v24
 v_accvgpr_write_b32 a75, v25
 v_accvgpr_read_b32 v25, a76
 v_mul_f32 v25, v25, v24
 v_accvgpr_write_b32 a76, v25
 v_accvgpr_read_b32 v25, a77
 v_mul_f32 v25, v25, v24
 v_accvgpr_write_b32 a77, v25
 v_accvgpr_read_b32 v25, a78
 v_mul_f32 v25, v25, v24
 v_accvgpr_write_b32 a78, v25
 v_accvgpr_read_b32 v25, a79
 v_mul_f32 v25, v25, v24
 v_accvgpr_write_b32 a79, v25
 v_accvgpr_read_b32 v25, a80
 v_mul_f32 v25, v25, v24
 v_accvgpr_write_b32 a80, v25
 v_accvgpr_read_b32 v25, a81
 v_mul_f32 v25, v25, v24
 v_accvgpr_write_b32 a81, v25
 v_accvgpr_read_b32 v25, a82
 v_mul_f32 v25, v25, v24
 v_accvgpr_write_b32 a82, v25
 v_accvgpr_read_b32 v25, a83
 v_mul_f32 v25, v25, v24
 v_accvgpr_write_b32 a83, v25
 v_accvgpr_read_b32 v25, a84
 v_mul_f32 v25, v25, v24
 v_accvgpr_write_b32 a84, v25
 v_accvgpr_read_b32 v25, a85
 v_mul_f32 v25, v25, v24
 v_accvgpr_write_b32 a85, v25
 v_accvgpr_read_b32 v25, a86
 v_mul_f32 v25, v25, v24
 v_accvgpr_write_b32 a86, v25
 v_accvgpr_read_b32 v25, a87
 v_mul_f32 v25, v25, v24
 v_accvgpr_write_b32 a87, v25
 v_accvgpr_read_b32 v25, a88
 v_mul_f32 v25, v25, v24
 v_accvgpr_write_b32 a88, v25
 v_accvgpr_read_b32 v25, a89
 v_mul_f32 v25, v25, v24
 v_accvgpr_write_b32 a89, v25
 v_accvgpr_read_b32 v25, a90
 v_mul_f32 v25, v25, v24
 v_accvgpr_write_b32 a90, v25
 v_accvgpr_read_b32 v25, a91
 v_mul_f32 v25, v25, v24
 v_accvgpr_write_b32 a91, v25
 v_accvgpr_read_b32 v25, a92
 v_mul_f32 v25, v25, v24
 v_accvgpr_write_b32 a92, v25
 v_accvgpr_read_b32 v25, a93
 v_mul_f32 v25, v25, v24
 v_accvgpr_write_b32 a93, v25
 v_accvgpr_read_b32 v25, a94
 v_mul_f32 v25, v25, v24
 v_accvgpr_write_b32 a94, v25
 v_accvgpr_read_b32 v25, a95
 v_mul_f32 v25, v25, v24
 v_accvgpr_write_b32 a95, v25
 v_max3_f32 v23, v144, v145, v146
 v_max3_f32 v23, v147, v148, v23
 v_max3_f32 v23, v149, v150, v23
 v_max3_f32 v23, v151, v152, v23
 v_max3_f32 v23, v153, v154, v23
 v_max3_f32 v23, v155, v156, v23
 v_max3_f32 v23, v157, v158, v23
 v_max3_f32 v23, v159, v176, v23
 v_max3_f32 v23, v177, v178, v23
 v_max3_f32 v23, v179, v180, v23
 v_max3_f32 v23, v181, v182, v23
 v_max3_f32 v23, v183, v184, v23
 v_max3_f32 v23, v185, v186, v23
 v_max3_f32 v23, v187, v188, v23
 v_max3_f32 v23, v189, v190, v23
 v_max_f32 v23, v23, v191
 v_mov_b32 v24, v23
 s_nop 1
 v_permlane16_swap_b32 v23, v24
 v_max_f32 v23, v23, v24
 v_mov_b32 v24, v23
 s_nop 1
 v_permlane32_swap_b32 v23, v24
 v_max_f32 v23, v23, v24
 v_max_f32 v23, 0, v23
 v_ceil_f32 v23, v23
 v_exp_f32 v24, -v23
 v_lshlrev_b32 v25, 16, v112
 v_and_b32 v112, 0xffff0000, v112
 v_mul_f32 v25, v25, v24
 v_mul_f32 v112, v112, v24
 v_cvt_pk_bf16_f32 v112, v25, v112
 v_lshlrev_b32 v25, 16, v113
 v_and_b32 v113, 0xffff0000, v113
 v_mul_f32 v25, v25, v24
 v_mul_f32 v113, v113, v24
 v_cvt_pk_bf16_f32 v113, v25, v113
 v_lshlrev_b32 v25, 16, v114
 v_and_b32 v114, 0xffff0000, v114
 v_mul_f32 v25, v25, v24
 v_mul_f32 v114, v114, v24
 v_cvt_pk_bf16_f32 v114, v25, v114
 v_lshlrev_b32 v25, 16, v115
 v_and_b32 v115, 0xffff0000, v115
 v_mul_f32 v25, v25, v24
 v_mul_f32 v115, v115, v24
 v_cvt_pk_bf16_f32 v115, v25, v115
 v_lshlrev_b32 v25, 16, v120
 v_and_b32 v120, 0xffff0000, v120
 v_mul_f32 v25, v25, v24
 v_mul_f32 v120, v120, v24
 v_cvt_pk_bf16_f32 v120, v25, v120
 v_lshlrev_b32 v25, 16, v121
 v_and_b32 v121, 0xffff0000, v121
 v_mul_f32 v25, v25, v24
 v_mul_f32 v121, v121, v24
 v_cvt_pk_bf16_f32 v121, v25, v121
 v_lshlrev_b32 v25, 16, v122
 v_and_b32 v122, 0xffff0000, v122
 v_mul_f32 v25, v25, v24
 v_mul_f32 v122, v122, v24
 v_cvt_pk_bf16_f32 v122, v25, v122
 v_lshlrev_b32 v25, 16, v123
 v_and_b32 v123, 0xffff0000, v123
 v_mul_f32 v25, v25, v24
 v_mul_f32 v123, v123, v24
 v_cvt_pk_bf16_f32 v123, v25, v123
 v_sub_f32 v144, v144, v23
 v_sub_f32 v145, v145, v23
 v_sub_f32 v146, v146, v23
 v_sub_f32 v147, v147, v23
 v_sub_f32 v148, v148, v23
 v_sub_f32 v149, v149, v23
 v_sub_f32 v150, v150, v23
 v_sub_f32 v151, v151, v23
 v_sub_f32 v152, v152, v23
 v_sub_f32 v153, v153, v23
 v_sub_f32 v154, v154, v23
 v_sub_f32 v155, v155, v23
 v_sub_f32 v156, v156, v23
 v_sub_f32 v157, v157, v23
 v_sub_f32 v158, v158, v23
 v_sub_f32 v159, v159, v23
 v_sub_f32 v176, v176, v23
 v_sub_f32 v177, v177, v23
 v_sub_f32 v178, v178, v23
 v_sub_f32 v179, v179, v23
 v_sub_f32 v180, v180, v23
 v_sub_f32 v181, v181, v23
 v_sub_f32 v182, v182, v23
 v_sub_f32 v183, v183, v23
 v_sub_f32 v184, v184, v23
 v_sub_f32 v185, v185, v23
 v_sub_f32 v186, v186, v23
 v_sub_f32 v187, v187, v23
 v_sub_f32 v188, v188, v23
 v_sub_f32 v189, v189, v23
 v_sub_f32 v190, v190, v23
 v_sub_f32 v191, v191, v23
 v_sub_f32 v60, v60, v23
 v_sub_f32 v61, v61, v23
 v_sub_f32 v62, v62, v23
 v_sub_f32 v63, v63, v23
 v_mul_f32 v44, v44, v24
 v_mul_f32 v45, v45, v24
 v_mul_f32 v46, v46, v24
 v_mul_f32 v47, v47, v24
 v_accvgpr_read_b32 v25, a96
 v_mul_f32 v25, v25, v24
 v_accvgpr_write_b32 a96, v25
 v_accvgpr_read_b32 v25, a97
 v_mul_f32 v25, v25, v24
 v_accvgpr_write_b32 a97, v25
 v_accvgpr_read_b32 v25, a98
 v_mul_f32 v25, v25, v24
 v_accvgpr_write_b32 a98, v25
 v_accvgpr_read_b32 v25, a99
 v_mul_f32 v25, v25, v24
 v_accvgpr_write_b32 a99, v25
 v_accvgpr_read_b32 v25, a100
 v_mul_f32 v25, v25, v24
 v_accvgpr_write_b32 a100, v25
 v_accvgpr_read_b32 v25, a101
 v_mul_f32 v25, v25, v24
 v_accvgpr_write_b32 a101, v25
 v_accvgpr_read_b32 v25, a102
 v_mul_f32 v25, v25, v24
 v_accvgpr_write_b32 a102, v25
 v_accvgpr_read_b32 v25, a103
 v_mul_f32 v25, v25, v24
 v_accvgpr_write_b32 a103, v25
 v_accvgpr_read_b32 v25, a104
 v_mul_f32 v25, v25, v24
 v_accvgpr_write_b32 a104, v25
 v_accvgpr_read_b32 v25, a105
 v_mul_f32 v25, v25, v24
 v_accvgpr_write_b32 a105, v25
 v_accvgpr_read_b32 v25, a106
 v_mul_f32 v25, v25, v24
 v_accvgpr_write_b32 a106, v25
 v_accvgpr_read_b32 v25, a107
 v_mul_f32 v25, v25, v24
 v_accvgpr_write_b32 a107, v25
 v_accvgpr_read_b32 v25, a108
 v_mul_f32 v25, v25, v24
 v_accvgpr_write_b32 a108, v25
 v_accvgpr_read_b32 v25, a109
 v_mul_f32 v25, v25, v24
 v_accvgpr_write_b32 a109, v25
 v_accvgpr_read_b32 v25, a110
 v_mul_f32 v25, v25, v24
 v_accvgpr_write_b32 a110, v25
 v_accvgpr_read_b32 v25, a111
 v_mul_f32 v25, v25, v24
 v_accvgpr_write_b32 a111, v25
 v_accvgpr_read_b32 v25, a112
 v_mul_f32 v25, v25, v24
 v_accvgpr_write_b32 a112, v25
 v_accvgpr_read_b32 v25, a113
 v_mul_f32 v25, v25, v24
 v_accvgpr_write_b32 a113, v25
 v_accvgpr_read_b32 v25, a114
 v_mul_f32 v25, v25, v24
 v_accvgpr_write_b32 a114, v25
 v_accvgpr_read_b32 v25, a115
 v_mul_f32 v25, v25, v24
 v_accvgpr_write_b32 a115, v25
 v_accvgpr_read_b32 v25, a116
 v_mul_f32 v25, v25, v24
 v_accvgpr_write_b32 a116, v25
 v_accvgpr_read_b32 v25, a117
 v_mul_f32 v25, v25, v24
 v_accvgpr_write_b32 a117, v25
 v_accvgpr_read_b32 v25, a118
 v_mul_f32 v25, v25, v24
 v_accvgpr_write_b32 a118, v25
 v_accvgpr_read_b32 v25, a119
 v_mul_f32 v25, v25, v24
 v_accvgpr_write_b32 a119, v25
 v_accvgpr_read_b32 v25, a120
 v_mul_f32 v25, v25, v24
 v_accvgpr_write_b32 a120, v25
 v_accvgpr_read_b32 v25, a121
 v_mul_f32 v25, v25, v24
 v_accvgpr_write_b32 a121, v25
 v_accvgpr_read_b32 v25, a122
 v_mul_f32 v25, v25, v24
 v_accvgpr_write_b32 a122, v25
 v_accvgpr_read_b32 v25, a123
 v_mul_f32 v25, v25, v24
 v_accvgpr_write_b32 a123, v25
 v_accvgpr_read_b32 v25, a124
 v_mul_f32 v25, v25, v24
 v_accvgpr_write_b32 a124, v25
 v_accvgpr_read_b32 v25, a125
 v_mul_f32 v25, v25, v24
 v_accvgpr_write_b32 a125, v25
 v_accvgpr_read_b32 v25, a126
 v_mul_f32 v25, v25, v24
 v_accvgpr_write_b32 a126, v25
 v_accvgpr_read_b32 v25, a127
 v_mul_f32 v25, v25, v24
 v_accvgpr_write_b32 a127, v25
 s_nop 1
 s_setpc_b64 s[98:99]
spin0:
 s_mov_b32 s3, 0
spin0l:
 s_sleep 6
 buffer_load_dword v31, off, s[96:99], 0 sc1
 s_add_u32 s3, s3, 1
 s_waitcnt vmcnt(0)
 v_cmp_eq_u32 vcc, 0, v31
 s_cbranch_vccz spun0
 s_cmp_lt_u32 s3, 0x40000
 s_cbranch_scc1 spin0l
 s_branch spun0
spin1:
 s_mov_b32 s3, 0
spin1l:
 s_sleep 6
 buffer_load_dword v24, v26, s[16:19], 0 offen sc1
 s_add_u32 s3, s3, 1
 s_waitcnt vmcnt(0)
 v_cmp_ne_u32 vcc, s61, v24
 s_cbranch_vccz spun1
 s_cmp_lt_u32 s3, 0x40000
 s_cbranch_scc1 spin1l
 s_branch spun1
spin2:
 s_mov_b32 s3, 0
spin2l:
 s_sleep 6
 buffer_load_dword v24, v23, s[16:19], 0 offen sc1
 s_add_u32 s3, s3, 1
 s_waitcnt vmcnt(0)
 v_cmp_ne_u32 vcc, s61, v24
 s_cbranch_vccz spun2
 s_cmp_lt_u32 s3, 0x40000
 s_cbranch_scc1 spin2l
 s_branch spun2
spin3:
 s_mov_b32 s3, 0
spin3l:
 s_sleep 6
 buffer_load_dword v25, v23, s[16:19], 0 offen offset:32 sc1
 s_add_u32 s3, s3, 1
 s_waitcnt vmcnt(0)
 v_cmp_ne_u32 vcc, s61, v25
 s_cbranch_vccz spun3
 s_cmp_lt_u32 s3, 0x40000
 s_cbranch_scc1 spin3l
 s_branch spun3
spin4:
 s_mov_b32 s3, 0
spin4l:
 s_sleep 6
 buffer_load_dwordx4 v[8:11], v18, s[16:19], 0 offen sc1
 s_add_u32 s3, s3, 1
 s_waitcnt vmcnt(0)
 v_xor_b32 v8, s61, v8
 v_xor_b32 v9, s61, v9
 v_xor_b32 v10, s61, v10
 v_xor_b32 v11, s61, v11
 v_or3_b32 v8, v8, v9, v10
 v_or_b32 v8, v8, v11
 v_cmp_ne_u32 vcc, 0, v8
 s_cbranch_vccz spun4
 s_cmp_lt_u32 s3, 0x40000
 s_cbranch_scc1 spin4l
 s_branch spun4
spin5:
 s_mov_b32 s3, 0
spin5l:
 s_sleep 6
 buffer_load_dword v6, v4, s[16:19], 0 offen sc1
 s_add_u32 s3, s3, 1
 s_waitcnt vmcnt(0)
 v_cmp_ne_u32 vcc, s61, v6
 s_cbranch_vccz spun5
 s_cmp_lt_u32 s3, 0x40000
 s_cbranch_scc1 spin5l
 s_branch spun5
spin6:
 s_mov_b32 s3, 0
spin6l:
 s_sleep 6
 buffer_load_dword v8, off, s[16:19], s91 offset:4 sc1
 s_add_u32 s3, s3, 1
 s_waitcnt vmcnt(0)
 v_cmp_ne_u32 vcc, s61, v8
 s_cbranch_vccz spun6
 s_cmp_lt_u32 s3, 0x40000
 s_cbranch_scc1 spin6l
 s_branch spun6
spin7:
 s_mov_b32 s3, 0
spin7l:
 s_sleep 6
 buffer_load_dword v8, off, s[16:19], s91 sc1
 s_add_u32 s3, s3, 1
 s_waitcnt vmcnt(0)
 v_cmp_ne_u32 vcc, s61, v8
 s_cbranch_vccz spun7
 s_cmp_lt_u32 s3, 0x40000
 s_cbranch_scc1 spin7l
 s_branch spun7
spin8:
 s_mov_b32 s3, 0
spin8l:
 s_sleep 6
 buffer_load_dword v24, v23, s[16:19], 0 offen sc1
 s_add_u32 s3, s3, 1
 s_waitcnt vmcnt(0)
 v_cmp_ne_u32 vcc, s61, v24
 s_cbranch_vccz spun8
 s_cmp_lt_u32 s3, 0x40000
 s_cbranch_scc1 spin8l
 s_branch spun8
spin9:
 s_mov_b32 s3, 0
spin9l:
 s_sleep 6
 buffer_load_dword v25, v23, s[16:19], 0 offen offset:32 sc1
 s_add_u32 s3, s3, 1
 s_waitcnt vmcnt(0)
 v_cmp_ne_u32 vcc, s61, v25
 s_cbranch_vccz spun9
 s_cmp_lt_u32 s3, 0x40000
 s_cbranch_scc1 spin9l
 s_branch spun9
ftS_r:
 s_call_b64 s[98:99], rare_S0
 s_branch ftS_ok
f0ss_r:
 s_call_b64 s[98:99], rare_S1
 s_branch f0ss_ok
b0ss_r:
 s_call_b64 s[98:99], rare_S1
 s_branch b0ss_ok
b1ss_r:
 s_call_b64 s[98:99], rare_S0
 s_branch b1ss_ok
b1sd1_r:
 s_call_b64 s[98:99], rare_S0
 s_branch b1sd1_ok
b0d1d2_r:
 s_call_b64 s[98:99], rare_S1
 s_branch b0d1d2_ok
b1d2r_r:
 s_call_b64 s[98:99], rare_R0
 s_branch b1d2r_ok
b0rr_r:
 s_call_b64 s[98:99], rare_R1
 s_branch b0rr_ok
b1rr_r:
 s_call_b64 s[98:99], rare_R0
 s_branch b1rr_ok
b1rrd_r:
 s_call_b64 s[98:99], rare_R0
 s_branch b1rrd_ok
ftSd1_r:
 s_call_b64 s[98:99], rare_S0
 s_branch ftSd1_ok
f0d1d2_r:
 s_call_b64 s[98:99], rare_S1
 s_branch f0d1d2_ok
b1d2rd_r:
 s_call_b64 s[98:99], rare_R0
 s_branch b1d2rd_ok
.if (. - recurrent_scan__compressed_kv_cla__glu_gated_bilinear__prompt_kernel) < 0x1c100
.fill (0x1c100 - (. - recurrent_scan__compressed_kv_cla__glu_gated_bilinear__prompt_kernel)) / 4, 4, 0xBF810000
.endif
.section .rodata,"a"
.p2align 6
.amdhsa_kernel recurrent_scan__compressed_kv_cla__glu_gated_bilinear__prompt_kernel
  .amdhsa_next_free_vgpr 512
  .amdhsa_next_free_sgpr 102
  .amdhsa_accum_offset 256
  .amdhsa_group_segment_fixed_size 0
  .amdhsa_kernarg_size 104
  .amdhsa_user_sgpr_count 2
  .amdhsa_user_sgpr_kernarg_segment_ptr 1
  .amdhsa_system_sgpr_workgroup_id_x 1
.end_amdhsa_kernel
```
